```python
import torch

def _softmax(x, axis=-1):
    return torch.softmax(x, dim=axis)

def _gelu(x):
    return torch.nn.functional.gelu(x, approximate='tanh')

def _silu(x):
    return torch.nn.functional.silu(x)

def _sigmoid(x):
    return torch.sigmoid(x)

def _layernorm(x, axis=-1, eps=1e-05):
    m = x.mean(dim=axis, keepdim=True)
    v = x.var(dim=axis, keepdim=True, unbiased=False)
    return (x - m) / torch.sqrt(v + eps)

def _scatter_add(tgt, idx, src, axis=0):
    return tgt.clone().index_add_(axis, idx, src)

def _segment_sum(src, seg, n):
    out = torch.zeros((n,) + src.shape[1:], dtype=src.dtype)
    return out.index_add_(0, seg, src)

def _pad(x, pw):
    flat = tuple((v for pair in reversed(pw) for v in pair))
    return torch.nn.functional.pad(x, flat)
kernel_name = 'interleave_layers__memory_aug_recurrent_mem_tr__dense_activation_relu__prompt'

def setup_inputs():

    _w = lambda a: (lambda t: t.to(torch.bfloat16) if t.is_floating_point() else t)(torch.as_tensor(a))

    def _A_setup():
        B, S, Dm = (1, 2048, 512)
        H, Dh = (32, 128)
        M, seg = (8, 32)
        seg = min(seg, S)
        S = S // seg * seg
        return {'x': _w((lambda *s: torch.randn(*s, dtype=torch.bfloat16) * 0.05)(B, S, Dm)), 'mem0': _w((lambda *s: torch.randn(*s, dtype=torch.bfloat16) * 0.8)(B, M, Dm)), 'Wq': _w((lambda *s: torch.randn(*s, dtype=torch.bfloat16) * 0.8)(Dm, H, Dh) * Dm ** (-0.5)), 'Wk': _w((lambda *s: torch.randn(*s, dtype=torch.bfloat16) * 0.8)(Dm, H, Dh) * Dm ** (-0.5)), 'Wv': _w((lambda *s: torch.randn(*s, dtype=torch.bfloat16) * 0.8)(Dm, H, Dh) * Dm ** (-0.5)), 'Wo': _w((lambda *s: torch.randn(*s, dtype=torch.bfloat16) * 0.8)(H, Dh, Dm) * (H * Dh) ** (-0.5)), 'seg_len': seg}
    _A_in = _A_setup()

    def _B_setup():
        B, S, D, Dff = (1, 2048, 512, 1792)
        return {'x': _w((lambda *s: torch.randn(*s, dtype=torch.bfloat16) * 0.05)(B, S, D)), 'w1': _w((lambda *s: torch.randn(*s, dtype=torch.bfloat16) * 0.05)(D, Dff)), 'w2': _w((lambda *s: torch.randn(*s, dtype=torch.bfloat16) * 0.05)(Dff, D))}
    _B_in = _B_setup()
    return {'A_x': _A_in['x'], 'A_mem0': _A_in['mem0'], 'A_Wq': _A_in['Wq'], 'A_Wk': _A_in['Wk'], 'A_Wv': _A_in['Wv'], 'A_Wo': _A_in['Wo'], 'A_seg_len': _A_in['seg_len'], 'B_x': _B_in['x'], 'B_w1': _B_in['w1'], 'B_w2': _B_in['w2']}

def reference(A_x, A_mem0, A_Wq, A_Wk, A_Wv, A_Wo, A_seg_len, B_x, B_w1, B_w2):

    def _A_ref(x, mem0, Wq, Wk, Wv, Wo, seg_len):
        B, S, Dm = x.shape
        H, Dh = (Wq.shape[1], Wq.shape[2])
        M = mem0.shape[1]
        scale = Dh ** (-0.5)
        n_seg = S // seg_len
        L = M + seg_len
        idx = torch.arange(L)
        mask = (idx[:, None] < M) | (idx[:, None] >= idx[None, :])
        mem = mem0
        outs = []
        for s in range(n_seg):
            xs = x[:, s * seg_len:(s + 1) * seg_len, :].clone()
            h = torch.concatenate([mem, xs], axis=1)
            q = torch.einsum('btd,dhe->bhte', h, Wq)
            k = torch.einsum('btd,dhe->bhte', h, Wk)
            v = torch.einsum('btd,dhe->bhte', h, Wv)
            scores = torch.einsum('bhqe,bhke->bhqk', q, k) * scale
            scores = torch.where(mask[None, None], scores, -1000000000.0)
            p = _softmax(scores, axis=-1)
            o = torch.einsum('bhqk,bhke->bhqe', p, v)
            o = torch.einsum('bhte,hed->btd', o, Wo)
            mem = o[:, :M, :].clone()
            outs.append(o[:, M:, :])
        return torch.concatenate(outs, axis=1)

    def _B_ref(x, w1, w2):
        h = torch.einsum('bsd,df->bsf', x, w1)
        zero = torch.zeros_like(h)
        h = torch.maximum(h, zero)
        return torch.einsum('bsf,fd->bsd', h, w2)
    x = A_x
    x = x + _A_ref(_layernorm(x, axis=-1), A_mem0, A_Wq, A_Wk, A_Wv, A_Wo, A_seg_len)
    x = x + _B_ref(_layernorm(x, axis=-1), B_w1, B_w2)
    x = x + _A_ref(_layernorm(x, axis=-1), A_mem0, A_Wq, A_Wk, A_Wv, A_Wo, A_seg_len)
    x = x + _B_ref(_layernorm(x, axis=-1), B_w1, B_w2)
    return x
```

```asm
; @launch grid=(256,1,1) block=(256,1,1) lds=163840
.amdgcn_target "amdgcn-amd-amdhsa--gfx950"
.text
.globl interleave_layers__memory_aug_recurrent_mem_tr__dense_activation_relu__prompt_kernel
.p2align 8
.type interleave_layers__memory_aug_recurrent_mem_tr__dense_activation_relu__prompt_kernel,@function
interleave_layers__memory_aug_recurrent_mem_tr__dense_activation_relu__prompt_kernel:
  s_load_dwordx2 s[4:5], s[0:1], 96
  s_load_dwordx2 s[8:9], s[0:1], 16
  s_load_dwordx2 s[12:13], s[0:1], 24
  s_load_dwordx2 s[16:17], s[0:1], 32
  s_load_dwordx2 s[20:21], s[0:1], 40
  s_load_dwordx2 s[24:25], s[0:1], 64
  s_load_dwordx2 s[28:29], s[0:1], 72
  s_load_dwordx2 s[32:33], s[0:1], 80
  s_load_dwordx2 s[36:37], s[0:1], 88
  s_load_dwordx2 s[40:41], s[0:1], 0
  s_load_dwordx2 s[44:45], s[0:1], 8
  s_mov_b32 s6, 0x10000000
  s_mov_b32 s7, 0x20000
  s_mov_b32 s10, 0x400000
  s_mov_b32 s11, 0x20000
  s_mov_b32 s14, 0x400000
  s_mov_b32 s15, 0x20000
  s_mov_b32 s18, 0x400000
  s_mov_b32 s19, 0x20000
  s_mov_b32 s22, 0x400000
  s_mov_b32 s23, 0x20000
  s_mov_b32 s26, 0x1c0000
  s_mov_b32 s27, 0x20000
  s_mov_b32 s30, 0x1c0000
  s_mov_b32 s31, 0x20000
  s_mov_b32 s34, 0x200000
  s_mov_b32 s35, 0x20000
  s_mov_b32 s38, 0x100
  s_mov_b32 s39, 0x20000
  s_mov_b32 s42, 0x200000
  s_mov_b32 s43, 0x20000
  s_mov_b32 s46, 0x2000
  s_mov_b32 s47, 0x20000
  s_waitcnt lgkmcnt(0)
  s_cmp_ge_u32 s2, 256
  s_cbranch_scc1 main_end
  v_readfirstlane_b32 s48, v0
  s_lshr_b32 s48, s48, 6
  v_and_b32 v0, 63, v0
  s_getreg_b32 s49, hwreg(HW_REG_XCC_ID)
  s_and_b32 s49, s49, 7
  s_lshl_b32 s49, s49, 2
  s_lshr_b32 s49, 0x36247510, s49
  s_and_b32 s49, s49, 7
  s_mov_b32 s51, 100000
  s_cmp_lg_u32 s48, 0
  s_cbranch_scc1 disp_wait
  v_mov_b32 v2, 0x40000000
  v_cmp_eq_u32 vcc, 0, v0
  s_nop 1
  v_cndmask_b32 v2, v2, 0, vcc
  v_mov_b32 v1, 1
  s_mov_b32 s54, 0xc440c000
  s_mov_b32 s55, 0x8480ccc8
  s_lshl_b32 s56, s49, 3
  s_lshr_b64 s[54:55], s[54:55], s56
  s_and_b32 s54, s54, 0xff
  buffer_atomic_add v1, v2, s[36:39], s54 offen sc0 sc1
  s_waitcnt vmcnt(0)
  v_readfirstlane_b32 s55, v1
  s_lshl_b32 s50, s49, 5
  s_add_u32 s50, s50, s55
  s_cmp_lt_u32 s55, 32
  s_cbranch_scc1 disp_pub
  v_mov_b32 v1, 1
  buffer_atomic_add v1, v2, s[36:39], 0 offen offset:208 sc0 sc1
  s_waitcnt vmcnt(0)
  v_readfirstlane_b32 s55, v1
  v_lshlrev_b32 v3, 2, v0
disp_cnt:
  s_sub_u32 s51, s51, 1
  s_cbranch_scc1 main_end
  buffer_load_dword v1, v3, s[36:39], 0 offen sc1
  s_waitcnt vmcnt(0)
  v_readlane_b32 s60, v1, 0
  v_readlane_b32 s61, v1, 48
  v_readlane_b32 s62, v1, 16
  v_readlane_b32 s63, v1, 49
  v_readlane_b32 s64, v1, 50
  v_readlane_b32 s65, v1, 51
  v_readlane_b32 s66, v1, 32
  v_readlane_b32 s67, v1, 33
  s_add_u32 s56, s60, s61
  s_add_u32 s56, s56, s62
  s_add_u32 s56, s56, s63
  s_add_u32 s56, s56, s64
  s_add_u32 s56, s56, s65
  s_add_u32 s56, s56, s66
  s_add_u32 s56, s56, s67
  s_cmp_lt_u32 s56, 256
  s_cbranch_scc1 disp_cnt
  s_mov_b32 s50, 255
  s_min_u32 s57, s60, 32
  s_add_u32 s58, s57, s55
  s_cmp_lt_u32 s58, 32
  s_cbranch_scc0 disp_n0
  s_add_u32 s50, s58, 0
  s_branch disp_pub
disp_n0:
  s_sub_u32 s55, s58, 32
  s_min_u32 s57, s61, 32
  s_add_u32 s58, s57, s55
  s_cmp_lt_u32 s58, 32
  s_cbranch_scc0 disp_n1
  s_add_u32 s50, s58, 32
  s_branch disp_pub
disp_n1:
  s_sub_u32 s55, s58, 32
  s_min_u32 s57, s62, 32
  s_add_u32 s58, s57, s55
  s_cmp_lt_u32 s58, 32
  s_cbranch_scc0 disp_n2
  s_add_u32 s50, s58, 64
  s_branch disp_pub
disp_n2:
  s_sub_u32 s55, s58, 32
  s_min_u32 s57, s63, 32
  s_add_u32 s58, s57, s55
  s_cmp_lt_u32 s58, 32
  s_cbranch_scc0 disp_n3
  s_add_u32 s50, s58, 96
  s_branch disp_pub
disp_n3:
  s_sub_u32 s55, s58, 32
  s_min_u32 s57, s64, 32
  s_add_u32 s58, s57, s55
  s_cmp_lt_u32 s58, 32
  s_cbranch_scc0 disp_n4
  s_add_u32 s50, s58, 128
  s_branch disp_pub
disp_n4:
  s_sub_u32 s55, s58, 32
  s_min_u32 s57, s65, 32
  s_add_u32 s58, s57, s55
  s_cmp_lt_u32 s58, 32
  s_cbranch_scc0 disp_n5
  s_add_u32 s50, s58, 160
  s_branch disp_pub
disp_n5:
  s_sub_u32 s55, s58, 32
  s_min_u32 s57, s66, 32
  s_add_u32 s58, s57, s55
  s_cmp_lt_u32 s58, 32
  s_cbranch_scc0 disp_n6
  s_add_u32 s50, s58, 192
  s_branch disp_pub
disp_n6:
  s_sub_u32 s55, s58, 32
  s_min_u32 s57, s67, 32
  s_add_u32 s58, s57, s55
  s_cmp_lt_u32 s58, 32
  s_cbranch_scc0 disp_n7
  s_add_u32 s50, s58, 224
  s_branch disp_pub
disp_n7:
  s_sub_u32 s55, s58, 32
disp_pub:
  v_mov_b32 v1, s50
  v_mov_b32 v2, 0
  ds_write_b32 v2, v1
  s_waitcnt lgkmcnt(0)
disp_wait:
  s_barrier
  v_mov_b32 v2, 0
  ds_read_b32 v1, v2
  s_waitcnt lgkmcnt(0)
  v_readfirstlane_b32 s50, v1
  s_barrier
  s_lshl_b32 s52, s50, 16
  s_add_u32 s52, s52, 0xe000000
  s_sub_u32 s70, s50, 192
  s_cmp_lt_u32 s70, 64
  s_cbranch_scc0 p_idone
  v_lshrrev_b32 v1, 3, v0
  v_and_b32 v2, 7, v0
  v_lshlrev_b32 v2, 4, v2
  v_lshl_add_u32 v2, v1, 10, v2
  s_lshl_b32 s54, s48, 13
  v_add_u32 v2, s54, v2
  s_lshl_b32 s55, s70, 15
  buffer_load_dwordx4 v[40:43], v2, s[40:43], s55 offen offset:0
  buffer_load_dwordx4 v[44:47], v2, s[40:43], s55 offen offset:128
  buffer_load_dwordx4 v[48:51], v2, s[40:43], s55 offen offset:256
  buffer_load_dwordx4 v[52:55], v2, s[40:43], s55 offen offset:384
  buffer_load_dwordx4 v[56:59], v2, s[40:43], s55 offen offset:512
  buffer_load_dwordx4 v[60:63], v2, s[40:43], s55 offen offset:640
  buffer_load_dwordx4 v[64:67], v2, s[40:43], s55 offen offset:768
  buffer_load_dwordx4 v[68:71], v2, s[40:43], s55 offen offset:896
  s_lshl_b32 s54, s70, 2
  s_add_u32 s54, s54, s48
  v_and_b32 v6, 1, v0
  v_bfe_u32 v7, v0, 2, 2
  v_lshl_add_u32 v6, v7, 1, v6
  v_lshlrev_b32 v6, 10, v6
  v_bfe_u32 v7, v0, 1, 1
  v_lshl_add_u32 v6, v7, 4, v6
  v_bfe_u32 v7, v0, 4, 1
  v_lshl_add_u32 v6, v7, 5, v6
  s_and_b32 s57, s54, 15
  s_lshl_b32 s57, s57, 6
  buffer_load_dwordx4 v[24:27], v6, s[44:47], s57 offen
  v_lshlrev_b32 v1, 4, v0
  v_mov_b32 v8, 0
  v_mov_b32 v9, 0
  v_mov_b32 v10, 0
  v_mov_b32 v11, 0
  v_mov_b32 v20, -1
  v_mov_b32 v21, -1
  v_mov_b32 v22, -1
  v_mov_b32 v23, -1
  s_lshl_b32 s58, s54, 10
  s_add_u32 s58, s58, 0x20000
  buffer_store_dwordx4 v[8:11], v1, s[4:7], s58 offen sc1
  s_lshl_b32 s58, s54, 12
  s_add_u32 s58, s58, 0x100000
  buffer_store_dwordx4 v[20:23], v1, s[4:7], s58 offen offset:0 sc1
  buffer_store_dwordx4 v[20:23], v1, s[4:7], s58 offen offset:1024 sc1
  buffer_store_dwordx4 v[20:23], v1, s[4:7], s58 offen offset:2048 sc1
  buffer_store_dwordx4 v[20:23], v1, s[4:7], s58 offen offset:3072 sc1
  s_lshl_b32 s58, s70, 16
  s_add_u32 s58, s58, 0x1000000
  s_add_u32 s59, s58, 0x8000
  v_mov_b32 v12, 0
  v_mov_b32 v13, 0
  v_mov_b32 v14, 0
  v_mov_b32 v15, 0
  s_waitcnt vmcnt(13)
  v_lshlrev_b32 v72, 16, v40
  v_and_b32 v73, 0xffff0000, v40
  v_lshlrev_b32 v74, 16, v41
  v_and_b32 v75, 0xffff0000, v41
  v_lshlrev_b32 v76, 16, v42
  v_and_b32 v77, 0xffff0000, v42
  v_lshlrev_b32 v78, 16, v43
  v_and_b32 v79, 0xffff0000, v43
  v_min_u32 v40, -2, v40
  v_min_u32 v42, -2, v42
  buffer_store_dwordx4 v[40:43], v2, s[4:7], s59 offen offset:0 sc1
  v_pk_add_f32 v[12:13], v[12:13], v[72:73]
  v_pk_fma_f32 v[14:15], v[72:73], v[72:73], v[14:15]
  v_pk_add_f32 v[12:13], v[12:13], v[74:75]
  v_pk_fma_f32 v[14:15], v[74:75], v[74:75], v[14:15]
  v_pk_add_f32 v[12:13], v[12:13], v[76:77]
  v_pk_fma_f32 v[14:15], v[76:77], v[76:77], v[14:15]
  v_pk_add_f32 v[12:13], v[12:13], v[78:79]
  v_pk_fma_f32 v[14:15], v[78:79], v[78:79], v[14:15]
  s_waitcnt vmcnt(13)
  v_lshlrev_b32 v80, 16, v44
  v_and_b32 v81, 0xffff0000, v44
  v_lshlrev_b32 v82, 16, v45
  v_and_b32 v83, 0xffff0000, v45
  v_lshlrev_b32 v84, 16, v46
  v_and_b32 v85, 0xffff0000, v46
  v_lshlrev_b32 v86, 16, v47
  v_and_b32 v87, 0xffff0000, v47
  v_min_u32 v44, -2, v44
  v_min_u32 v46, -2, v46
  buffer_store_dwordx4 v[44:47], v2, s[4:7], s59 offen offset:128 sc1
  v_pk_add_f32 v[12:13], v[12:13], v[80:81]
  v_pk_fma_f32 v[14:15], v[80:81], v[80:81], v[14:15]
  v_pk_add_f32 v[12:13], v[12:13], v[82:83]
  v_pk_fma_f32 v[14:15], v[82:83], v[82:83], v[14:15]
  v_pk_add_f32 v[12:13], v[12:13], v[84:85]
  v_pk_fma_f32 v[14:15], v[84:85], v[84:85], v[14:15]
  v_pk_add_f32 v[12:13], v[12:13], v[86:87]
  v_pk_fma_f32 v[14:15], v[86:87], v[86:87], v[14:15]
  s_waitcnt vmcnt(13)
  v_lshlrev_b32 v88, 16, v48
  v_and_b32 v89, 0xffff0000, v48
  v_lshlrev_b32 v90, 16, v49
  v_and_b32 v91, 0xffff0000, v49
  v_lshlrev_b32 v92, 16, v50
  v_and_b32 v93, 0xffff0000, v50
  v_lshlrev_b32 v94, 16, v51
  v_and_b32 v95, 0xffff0000, v51
  v_min_u32 v48, -2, v48
  v_min_u32 v50, -2, v50
  buffer_store_dwordx4 v[48:51], v2, s[4:7], s59 offen offset:256 sc1
  v_pk_add_f32 v[12:13], v[12:13], v[88:89]
  v_pk_fma_f32 v[14:15], v[88:89], v[88:89], v[14:15]
  v_pk_add_f32 v[12:13], v[12:13], v[90:91]
  v_pk_fma_f32 v[14:15], v[90:91], v[90:91], v[14:15]
  v_pk_add_f32 v[12:13], v[12:13], v[92:93]
  v_pk_fma_f32 v[14:15], v[92:93], v[92:93], v[14:15]
  v_pk_add_f32 v[12:13], v[12:13], v[94:95]
  v_pk_fma_f32 v[14:15], v[94:95], v[94:95], v[14:15]
  s_waitcnt vmcnt(13)
  v_lshlrev_b32 v96, 16, v52
  v_and_b32 v97, 0xffff0000, v52
  v_lshlrev_b32 v98, 16, v53
  v_and_b32 v99, 0xffff0000, v53
  v_lshlrev_b32 v100, 16, v54
  v_and_b32 v101, 0xffff0000, v54
  v_lshlrev_b32 v102, 16, v55
  v_and_b32 v103, 0xffff0000, v55
  v_min_u32 v52, -2, v52
  v_min_u32 v54, -2, v54
  buffer_store_dwordx4 v[52:55], v2, s[4:7], s59 offen offset:384 sc1
  v_pk_add_f32 v[12:13], v[12:13], v[96:97]
  v_pk_fma_f32 v[14:15], v[96:97], v[96:97], v[14:15]
  v_pk_add_f32 v[12:13], v[12:13], v[98:99]
  v_pk_fma_f32 v[14:15], v[98:99], v[98:99], v[14:15]
  v_pk_add_f32 v[12:13], v[12:13], v[100:101]
  v_pk_fma_f32 v[14:15], v[100:101], v[100:101], v[14:15]
  v_pk_add_f32 v[12:13], v[12:13], v[102:103]
  v_pk_fma_f32 v[14:15], v[102:103], v[102:103], v[14:15]
  s_waitcnt vmcnt(13)
  v_lshlrev_b32 v104, 16, v56
  v_and_b32 v105, 0xffff0000, v56
  v_lshlrev_b32 v106, 16, v57
  v_and_b32 v107, 0xffff0000, v57
  v_lshlrev_b32 v108, 16, v58
  v_and_b32 v109, 0xffff0000, v58
  v_lshlrev_b32 v110, 16, v59
  v_and_b32 v111, 0xffff0000, v59
  v_min_u32 v56, -2, v56
  v_min_u32 v58, -2, v58
  buffer_store_dwordx4 v[56:59], v2, s[4:7], s59 offen offset:512 sc1
  v_pk_add_f32 v[12:13], v[12:13], v[104:105]
  v_pk_fma_f32 v[14:15], v[104:105], v[104:105], v[14:15]
  v_pk_add_f32 v[12:13], v[12:13], v[106:107]
  v_pk_fma_f32 v[14:15], v[106:107], v[106:107], v[14:15]
  v_pk_add_f32 v[12:13], v[12:13], v[108:109]
  v_pk_fma_f32 v[14:15], v[108:109], v[108:109], v[14:15]
  v_pk_add_f32 v[12:13], v[12:13], v[110:111]
  v_pk_fma_f32 v[14:15], v[110:111], v[110:111], v[14:15]
  s_waitcnt vmcnt(13)
  v_lshlrev_b32 v112, 16, v60
  v_and_b32 v113, 0xffff0000, v60
  v_lshlrev_b32 v114, 16, v61
  v_and_b32 v115, 0xffff0000, v61
  v_lshlrev_b32 v116, 16, v62
  v_and_b32 v117, 0xffff0000, v62
  v_lshlrev_b32 v118, 16, v63
  v_and_b32 v119, 0xffff0000, v63
  v_min_u32 v60, -2, v60
  v_min_u32 v62, -2, v62
  buffer_store_dwordx4 v[60:63], v2, s[4:7], s59 offen offset:640 sc1
  v_pk_add_f32 v[12:13], v[12:13], v[112:113]
  v_pk_fma_f32 v[14:15], v[112:113], v[112:113], v[14:15]
  v_pk_add_f32 v[12:13], v[12:13], v[114:115]
  v_pk_fma_f32 v[14:15], v[114:115], v[114:115], v[14:15]
  v_pk_add_f32 v[12:13], v[12:13], v[116:117]
  v_pk_fma_f32 v[14:15], v[116:117], v[116:117], v[14:15]
  v_pk_add_f32 v[12:13], v[12:13], v[118:119]
  v_pk_fma_f32 v[14:15], v[118:119], v[118:119], v[14:15]
  s_waitcnt vmcnt(13)
  v_lshlrev_b32 v120, 16, v64
  v_and_b32 v121, 0xffff0000, v64
  v_lshlrev_b32 v122, 16, v65
  v_and_b32 v123, 0xffff0000, v65
  v_lshlrev_b32 v124, 16, v66
  v_and_b32 v125, 0xffff0000, v66
  v_lshlrev_b32 v126, 16, v67
  v_and_b32 v127, 0xffff0000, v67
  v_min_u32 v64, -2, v64
  v_min_u32 v66, -2, v66
  buffer_store_dwordx4 v[64:67], v2, s[4:7], s59 offen offset:768 sc1
  v_pk_add_f32 v[12:13], v[12:13], v[120:121]
  v_pk_fma_f32 v[14:15], v[120:121], v[120:121], v[14:15]
  v_pk_add_f32 v[12:13], v[12:13], v[122:123]
  v_pk_fma_f32 v[14:15], v[122:123], v[122:123], v[14:15]
  v_pk_add_f32 v[12:13], v[12:13], v[124:125]
  v_pk_fma_f32 v[14:15], v[124:125], v[124:125], v[14:15]
  v_pk_add_f32 v[12:13], v[12:13], v[126:127]
  v_pk_fma_f32 v[14:15], v[126:127], v[126:127], v[14:15]
  s_waitcnt vmcnt(13)
  v_lshlrev_b32 v128, 16, v68
  v_and_b32 v129, 0xffff0000, v68
  v_lshlrev_b32 v130, 16, v69
  v_and_b32 v131, 0xffff0000, v69
  v_lshlrev_b32 v132, 16, v70
  v_and_b32 v133, 0xffff0000, v70
  v_lshlrev_b32 v134, 16, v71
  v_and_b32 v135, 0xffff0000, v71
  v_min_u32 v68, -2, v68
  v_min_u32 v70, -2, v70
  buffer_store_dwordx4 v[68:71], v2, s[4:7], s59 offen offset:896 sc1
  v_pk_add_f32 v[12:13], v[12:13], v[128:129]
  v_pk_fma_f32 v[14:15], v[128:129], v[128:129], v[14:15]
  v_pk_add_f32 v[12:13], v[12:13], v[130:131]
  v_pk_fma_f32 v[14:15], v[130:131], v[130:131], v[14:15]
  v_pk_add_f32 v[12:13], v[12:13], v[132:133]
  v_pk_fma_f32 v[14:15], v[132:133], v[132:133], v[14:15]
  v_pk_add_f32 v[12:13], v[12:13], v[134:135]
  v_pk_fma_f32 v[14:15], v[134:135], v[134:135], v[14:15]
  v_add_f32 v12, v12, v13
  v_add_f32 v14, v14, v15
  s_nop 0
  v_add_f32_dpp v12, v12, v12 quad_perm:[1,0,3,2] row_mask:0xf bank_mask:0xf
  v_add_f32_dpp v14, v14, v14 quad_perm:[1,0,3,2] row_mask:0xf bank_mask:0xf
  s_nop 0
  v_add_f32_dpp v12, v12, v12 quad_perm:[2,3,0,1] row_mask:0xf bank_mask:0xf
  v_add_f32_dpp v14, v14, v14 quad_perm:[2,3,0,1] row_mask:0xf bank_mask:0xf
  s_nop 0
  v_add_f32_dpp v12, v12, v12 row_half_mirror row_mask:0xf bank_mask:0xf
  v_add_f32_dpp v14, v14, v14 row_half_mirror row_mask:0xf bank_mask:0xf
  v_mul_f32 v12, 0x3b000000, v12
  v_mul_f32 v14, 0x3b000000, v14
  v_fma_f32 v14, -v12, v12, v14
  v_max_f32 v14, 0, v14
  v_cvt_pk_bf16_f32 v13, v12, v14
  v_and_b32 v14, 0xffff0000, v13
  v_add_f32 v14, 0x3727c5ac, v14
  v_cvt_pk_bf16_f32 v14, v14, v14
  v_lshlrev_b32 v14, 16, v14
  v_sqrt_f32 v14, v14
  v_lshlrev_b32 v12, 16, v13
  v_cvt_pk_bf16_f32 v14, v14, v14
  v_lshlrev_b32 v14, 16, v14
  v_rcp_f32 v14, v14
  v_sub_f32 v72, v72, v12
  v_sub_f32 v73, v73, v12
  v_sub_f32 v74, v74, v12
  v_sub_f32 v75, v75, v12
  v_sub_f32 v76, v76, v12
  v_sub_f32 v77, v77, v12
  v_sub_f32 v78, v78, v12
  v_sub_f32 v79, v79, v12
  v_cvt_pk_bf16_f32 v16, v72, v73
  v_cvt_pk_bf16_f32 v17, v74, v75
  v_cvt_pk_bf16_f32 v18, v76, v77
  v_cvt_pk_bf16_f32 v19, v78, v79
  v_lshlrev_b32 v72, 16, v16
  v_and_b32 v73, 0xffff0000, v16
  v_lshlrev_b32 v74, 16, v17
  v_and_b32 v75, 0xffff0000, v17
  v_lshlrev_b32 v76, 16, v18
  v_and_b32 v77, 0xffff0000, v18
  v_lshlrev_b32 v78, 16, v19
  v_and_b32 v79, 0xffff0000, v19
  v_mul_f32 v72, v72, v14
  v_mul_f32 v73, v73, v14
  v_mul_f32 v74, v74, v14
  v_mul_f32 v75, v75, v14
  v_mul_f32 v76, v76, v14
  v_mul_f32 v77, v77, v14
  v_mul_f32 v78, v78, v14
  v_mul_f32 v79, v79, v14
  v_cvt_pk_bf16_f32 v72, v72, v73
  v_cvt_pk_bf16_f32 v73, v74, v75
  v_cvt_pk_bf16_f32 v74, v76, v77
  v_cvt_pk_bf16_f32 v75, v78, v79
  v_min_u32 v72, -2, v72
  buffer_store_dwordx4 v[72:75], v2, s[4:7], s58 offen offset:0 sc1
  v_sub_f32 v80, v80, v12
  v_sub_f32 v81, v81, v12
  v_sub_f32 v82, v82, v12
  v_sub_f32 v83, v83, v12
  v_sub_f32 v84, v84, v12
  v_sub_f32 v85, v85, v12
  v_sub_f32 v86, v86, v12
  v_sub_f32 v87, v87, v12
  v_cvt_pk_bf16_f32 v16, v80, v81
  v_cvt_pk_bf16_f32 v17, v82, v83
  v_cvt_pk_bf16_f32 v18, v84, v85
  v_cvt_pk_bf16_f32 v19, v86, v87
  v_lshlrev_b32 v80, 16, v16
  v_and_b32 v81, 0xffff0000, v16
  v_lshlrev_b32 v82, 16, v17
  v_and_b32 v83, 0xffff0000, v17
  v_lshlrev_b32 v84, 16, v18
  v_and_b32 v85, 0xffff0000, v18
  v_lshlrev_b32 v86, 16, v19
  v_and_b32 v87, 0xffff0000, v19
  v_mul_f32 v80, v80, v14
  v_mul_f32 v81, v81, v14
  v_mul_f32 v82, v82, v14
  v_mul_f32 v83, v83, v14
  v_mul_f32 v84, v84, v14
  v_mul_f32 v85, v85, v14
  v_mul_f32 v86, v86, v14
  v_mul_f32 v87, v87, v14
  v_cvt_pk_bf16_f32 v80, v80, v81
  v_cvt_pk_bf16_f32 v81, v82, v83
  v_cvt_pk_bf16_f32 v82, v84, v85
  v_cvt_pk_bf16_f32 v83, v86, v87
  v_min_u32 v80, -2, v80
  buffer_store_dwordx4 v[80:83], v2, s[4:7], s58 offen offset:128 sc1
  v_sub_f32 v88, v88, v12
  v_sub_f32 v89, v89, v12
  v_sub_f32 v90, v90, v12
  v_sub_f32 v91, v91, v12
  v_sub_f32 v92, v92, v12
  v_sub_f32 v93, v93, v12
  v_sub_f32 v94, v94, v12
  v_sub_f32 v95, v95, v12
  v_cvt_pk_bf16_f32 v16, v88, v89
  v_cvt_pk_bf16_f32 v17, v90, v91
  v_cvt_pk_bf16_f32 v18, v92, v93
  v_cvt_pk_bf16_f32 v19, v94, v95
  v_lshlrev_b32 v88, 16, v16
  v_and_b32 v89, 0xffff0000, v16
  v_lshlrev_b32 v90, 16, v17
  v_and_b32 v91, 0xffff0000, v17
  v_lshlrev_b32 v92, 16, v18
  v_and_b32 v93, 0xffff0000, v18
  v_lshlrev_b32 v94, 16, v19
  v_and_b32 v95, 0xffff0000, v19
  v_mul_f32 v88, v88, v14
  v_mul_f32 v89, v89, v14
  v_mul_f32 v90, v90, v14
  v_mul_f32 v91, v91, v14
  v_mul_f32 v92, v92, v14
  v_mul_f32 v93, v93, v14
  v_mul_f32 v94, v94, v14
  v_mul_f32 v95, v95, v14
  v_cvt_pk_bf16_f32 v88, v88, v89
  v_cvt_pk_bf16_f32 v89, v90, v91
  v_cvt_pk_bf16_f32 v90, v92, v93
  v_cvt_pk_bf16_f32 v91, v94, v95
  v_min_u32 v88, -2, v88
  buffer_store_dwordx4 v[88:91], v2, s[4:7], s58 offen offset:256 sc1
  v_sub_f32 v96, v96, v12
  v_sub_f32 v97, v97, v12
  v_sub_f32 v98, v98, v12
  v_sub_f32 v99, v99, v12
  v_sub_f32 v100, v100, v12
  v_sub_f32 v101, v101, v12
  v_sub_f32 v102, v102, v12
  v_sub_f32 v103, v103, v12
  v_cvt_pk_bf16_f32 v16, v96, v97
  v_cvt_pk_bf16_f32 v17, v98, v99
  v_cvt_pk_bf16_f32 v18, v100, v101
  v_cvt_pk_bf16_f32 v19, v102, v103
  v_lshlrev_b32 v96, 16, v16
  v_and_b32 v97, 0xffff0000, v16
  v_lshlrev_b32 v98, 16, v17
  v_and_b32 v99, 0xffff0000, v17
  v_lshlrev_b32 v100, 16, v18
  v_and_b32 v101, 0xffff0000, v18
  v_lshlrev_b32 v102, 16, v19
  v_and_b32 v103, 0xffff0000, v19
  v_mul_f32 v96, v96, v14
  v_mul_f32 v97, v97, v14
  v_mul_f32 v98, v98, v14
  v_mul_f32 v99, v99, v14
  v_mul_f32 v100, v100, v14
  v_mul_f32 v101, v101, v14
  v_mul_f32 v102, v102, v14
  v_mul_f32 v103, v103, v14
  v_cvt_pk_bf16_f32 v96, v96, v97
  v_cvt_pk_bf16_f32 v97, v98, v99
  v_cvt_pk_bf16_f32 v98, v100, v101
  v_cvt_pk_bf16_f32 v99, v102, v103
  v_min_u32 v96, -2, v96
  buffer_store_dwordx4 v[96:99], v2, s[4:7], s58 offen offset:384 sc1
  v_sub_f32 v104, v104, v12
  v_sub_f32 v105, v105, v12
  v_sub_f32 v106, v106, v12
  v_sub_f32 v107, v107, v12
  v_sub_f32 v108, v108, v12
  v_sub_f32 v109, v109, v12
  v_sub_f32 v110, v110, v12
  v_sub_f32 v111, v111, v12
  v_cvt_pk_bf16_f32 v16, v104, v105
  v_cvt_pk_bf16_f32 v17, v106, v107
  v_cvt_pk_bf16_f32 v18, v108, v109
  v_cvt_pk_bf16_f32 v19, v110, v111
  v_lshlrev_b32 v104, 16, v16
  v_and_b32 v105, 0xffff0000, v16
  v_lshlrev_b32 v106, 16, v17
  v_and_b32 v107, 0xffff0000, v17
  v_lshlrev_b32 v108, 16, v18
  v_and_b32 v109, 0xffff0000, v18
  v_lshlrev_b32 v110, 16, v19
  v_and_b32 v111, 0xffff0000, v19
  v_mul_f32 v104, v104, v14
  v_mul_f32 v105, v105, v14
  v_mul_f32 v106, v106, v14
  v_mul_f32 v107, v107, v14
  v_mul_f32 v108, v108, v14
  v_mul_f32 v109, v109, v14
  v_mul_f32 v110, v110, v14
  v_mul_f32 v111, v111, v14
  v_cvt_pk_bf16_f32 v104, v104, v105
  v_cvt_pk_bf16_f32 v105, v106, v107
  v_cvt_pk_bf16_f32 v106, v108, v109
  v_cvt_pk_bf16_f32 v107, v110, v111
  v_min_u32 v104, -2, v104
  buffer_store_dwordx4 v[104:107], v2, s[4:7], s58 offen offset:512 sc1
  v_sub_f32 v112, v112, v12
  v_sub_f32 v113, v113, v12
  v_sub_f32 v114, v114, v12
  v_sub_f32 v115, v115, v12
  v_sub_f32 v116, v116, v12
  v_sub_f32 v117, v117, v12
  v_sub_f32 v118, v118, v12
  v_sub_f32 v119, v119, v12
  v_cvt_pk_bf16_f32 v16, v112, v113
  v_cvt_pk_bf16_f32 v17, v114, v115
  v_cvt_pk_bf16_f32 v18, v116, v117
  v_cvt_pk_bf16_f32 v19, v118, v119
  v_lshlrev_b32 v112, 16, v16
  v_and_b32 v113, 0xffff0000, v16
  v_lshlrev_b32 v114, 16, v17
  v_and_b32 v115, 0xffff0000, v17
  v_lshlrev_b32 v116, 16, v18
  v_and_b32 v117, 0xffff0000, v18
  v_lshlrev_b32 v118, 16, v19
  v_and_b32 v119, 0xffff0000, v19
  v_mul_f32 v112, v112, v14
  v_mul_f32 v113, v113, v14
  v_mul_f32 v114, v114, v14
  v_mul_f32 v115, v115, v14
  v_mul_f32 v116, v116, v14
  v_mul_f32 v117, v117, v14
  v_mul_f32 v118, v118, v14
  v_mul_f32 v119, v119, v14
  v_cvt_pk_bf16_f32 v112, v112, v113
  v_cvt_pk_bf16_f32 v113, v114, v115
  v_cvt_pk_bf16_f32 v114, v116, v117
  v_cvt_pk_bf16_f32 v115, v118, v119
  v_min_u32 v112, -2, v112
  buffer_store_dwordx4 v[112:115], v2, s[4:7], s58 offen offset:640 sc1
  v_sub_f32 v120, v120, v12
  v_sub_f32 v121, v121, v12
  v_sub_f32 v122, v122, v12
  v_sub_f32 v123, v123, v12
  v_sub_f32 v124, v124, v12
  v_sub_f32 v125, v125, v12
  v_sub_f32 v126, v126, v12
  v_sub_f32 v127, v127, v12
  v_cvt_pk_bf16_f32 v16, v120, v121
  v_cvt_pk_bf16_f32 v17, v122, v123
  v_cvt_pk_bf16_f32 v18, v124, v125
  v_cvt_pk_bf16_f32 v19, v126, v127
  v_lshlrev_b32 v120, 16, v16
  v_and_b32 v121, 0xffff0000, v16
  v_lshlrev_b32 v122, 16, v17
  v_and_b32 v123, 0xffff0000, v17
  v_lshlrev_b32 v124, 16, v18
  v_and_b32 v125, 0xffff0000, v18
  v_lshlrev_b32 v126, 16, v19
  v_and_b32 v127, 0xffff0000, v19
  v_mul_f32 v120, v120, v14
  v_mul_f32 v121, v121, v14
  v_mul_f32 v122, v122, v14
  v_mul_f32 v123, v123, v14
  v_mul_f32 v124, v124, v14
  v_mul_f32 v125, v125, v14
  v_mul_f32 v126, v126, v14
  v_mul_f32 v127, v127, v14
  v_cvt_pk_bf16_f32 v120, v120, v121
  v_cvt_pk_bf16_f32 v121, v122, v123
  v_cvt_pk_bf16_f32 v122, v124, v125
  v_cvt_pk_bf16_f32 v123, v126, v127
  v_min_u32 v120, -2, v120
  buffer_store_dwordx4 v[120:123], v2, s[4:7], s58 offen offset:768 sc1
  v_sub_f32 v128, v128, v12
  v_sub_f32 v129, v129, v12
  v_sub_f32 v130, v130, v12
  v_sub_f32 v131, v131, v12
  v_sub_f32 v132, v132, v12
  v_sub_f32 v133, v133, v12
  v_sub_f32 v134, v134, v12
  v_sub_f32 v135, v135, v12
  v_cvt_pk_bf16_f32 v16, v128, v129
  v_cvt_pk_bf16_f32 v17, v130, v131
  v_cvt_pk_bf16_f32 v18, v132, v133
  v_cvt_pk_bf16_f32 v19, v134, v135
  v_lshlrev_b32 v128, 16, v16
  v_and_b32 v129, 0xffff0000, v16
  v_lshlrev_b32 v130, 16, v17
  v_and_b32 v131, 0xffff0000, v17
  v_lshlrev_b32 v132, 16, v18
  v_and_b32 v133, 0xffff0000, v18
  v_lshlrev_b32 v134, 16, v19
  v_and_b32 v135, 0xffff0000, v19
  v_mul_f32 v128, v128, v14
  v_mul_f32 v129, v129, v14
  v_mul_f32 v130, v130, v14
  v_mul_f32 v131, v131, v14
  v_mul_f32 v132, v132, v14
  v_mul_f32 v133, v133, v14
  v_mul_f32 v134, v134, v14
  v_mul_f32 v135, v135, v14
  v_cvt_pk_bf16_f32 v128, v128, v129
  v_cvt_pk_bf16_f32 v129, v130, v131
  v_cvt_pk_bf16_f32 v130, v132, v133
  v_cvt_pk_bf16_f32 v131, v134, v135
  v_min_u32 v128, -2, v128
  buffer_store_dwordx4 v[128:131], v2, s[4:7], s58 offen offset:896 sc1
  s_cmp_ge_u32 s54, 128
  s_cbranch_scc1 prep_done
  s_and_b32 s57, s54, 63
  s_cmp_ge_u32 s57, 16
  s_cbranch_scc1 prep_sent
  s_mov_b32 s62, 0x05040100
  s_mov_b32 s63, 0x07060302
  s_waitcnt vmcnt(21)
  v_perm_b32 v20, v26, v24, s62
  v_perm_b32 v21, v26, v24, s63
  v_perm_b32 v22, v27, v25, s62
  v_perm_b32 v23, v27, v25, s63
prep_sent:
  v_mov_b32 v7, 0x40000000
  v_cmp_gt_u32 vcc, 32, v0
  s_nop 1
  v_cndmask_b32 v2, v7, v1, vcc
  s_lshl_b32 s58, s54, 9
  s_add_u32 s58, s58, 0x200000
  buffer_store_dwordx4 v[20:23], v2, s[4:7], s58 offen sc1
prep_done:
  v_mov_b32 v1, 0x40000000
  v_cmp_eq_u32 vcc, 0, v0
  s_nop 1
  v_cndmask_b32 v2, v1, 0, vcc
  v_mov_b32 v1, 1
  s_waitcnt vmcnt(0)
  s_barrier
  s_cmp_lg_u32 s48, 0
  s_cbranch_scc1 p_idone
  buffer_atomic_add v1, v2, s[36:39], 0 offen offset:68 sc1
p_idone:
  s_lshr_b32 s54, s50, 5
  s_cmp_eq_u32 s54, 1
  s_cbranch_scc0 dlc_go
  s_cmp_lg_u32 s48, 0
  s_cbranch_scc1 dlc_w
  v_lshlrev_b32 v3, 2, v0
  s_mov_b32 s58, 0xff000000
  s_and_b32 s59, s58, 0x20303040
  s_add_u32 s59, s59, 256
dlc_cnt:
  s_sub_u32 s51, s51, 1
  s_cbranch_scc1 main_end
  buffer_load_dword v1, v3, s[36:39], 0 offen sc1
  s_waitcnt vmcnt(0)
  v_readlane_b32 s60, v1, 0
  v_readlane_b32 s61, v1, 48
  v_readlane_b32 s62, v1, 16
  v_readlane_b32 s63, v1, 49
  v_readlane_b32 s64, v1, 50
  v_readlane_b32 s65, v1, 51
  v_readlane_b32 s66, v1, 32
  v_readlane_b32 s67, v1, 33
  v_readlane_b32 s57, v1, 17
  s_add_u32 s56, s60, s61
  s_add_u32 s56, s56, s62
  s_add_u32 s56, s56, s63
  s_add_u32 s56, s56, s64
  s_add_u32 s56, s56, s65
  s_add_u32 s56, s56, s66
  s_add_u32 s56, s56, s67
  s_and_b32 s57, s57, s58
  s_add_u32 s56, s56, s57
  s_cmp_lt_u32 s56, s59
  s_cbranch_scc1 dlc_cnt
dlc_w:
  s_barrier
dlc_go:
  s_lshr_b32 s54, s50, 5
  s_cmp_eq_u32 s54, 3
  s_cbranch_scc0 dlk_go
  s_cmp_lg_u32 s48, 0
  s_cbranch_scc1 dlk_w
  v_lshlrev_b32 v3, 2, v0
  s_mov_b32 s58, 0xff000000
  s_and_b32 s59, s58, 0x20303040
  s_add_u32 s59, s59, 256
dlk_cnt:
  s_sub_u32 s51, s51, 1
  s_cbranch_scc1 main_end
  buffer_load_dword v1, v3, s[36:39], 0 offen sc1
  s_waitcnt vmcnt(0)
  v_readlane_b32 s60, v1, 0
  v_readlane_b32 s61, v1, 48
  v_readlane_b32 s62, v1, 16
  v_readlane_b32 s63, v1, 49
  v_readlane_b32 s64, v1, 50
  v_readlane_b32 s65, v1, 51
  v_readlane_b32 s66, v1, 32
  v_readlane_b32 s67, v1, 33
  v_readlane_b32 s57, v1, 17
  s_add_u32 s56, s60, s61
  s_add_u32 s56, s56, s62
  s_add_u32 s56, s56, s63
  s_add_u32 s56, s56, s64
  s_add_u32 s56, s56, s65
  s_add_u32 s56, s56, s66
  s_add_u32 s56, s56, s67
  s_and_b32 s57, s57, s58
  s_add_u32 s56, s56, s57
  s_cmp_lt_u32 s56, s59
  s_cbranch_scc1 dlk_cnt
dlk_w:
  s_barrier
dlk_go:
  s_sub_u32 s57, s50, 0
  s_cmp_lt_u32 s57, 64
  s_cbranch_scc1 role_c
  s_mov_b32 s55, 0
  s_mov_b32 s56, 0
  s_sub_u32 s57, s50, 64
  s_cmp_lt_u32 s57, 32
  s_cbranch_scc1 role_kv
  s_mov_b32 s55, 1
  s_mov_b32 s56, 0
  s_sub_u32 s57, s50, 96
  s_cmp_lt_u32 s57, 32
  s_cbranch_scc1 role_kv
  s_mov_b32 s55, 0
  s_mov_b32 s56, 0
  s_sub_u32 s57, s50, 128
  s_cmp_lt_u32 s57, 32
  s_cbranch_scc1 role_o
  s_mov_b32 s55, 0
  s_mov_b32 s56, 0
  s_sub_u32 s57, s50, 160
  s_cmp_lt_u32 s57, 32
  s_cbranch_scc1 role_n
  s_mov_b32 s55, 1
  s_mov_b32 s56, 0
  s_sub_u32 s57, s50, 192
  s_cmp_lt_u32 s57, 32
  s_cbranch_scc1 role_o
  s_mov_b32 s55, 1
  s_mov_b32 s56, 0
  s_sub_u32 s57, s50, 224
  s_cmp_lt_u32 s57, 32
  s_cbranch_scc1 role_n
main_end:
  s_endpgm
role_c:
  s_and_b32 s71, s50, 31
  s_lshr_b32 s89, s50, 5
  v_bfe_u32 v125, v0, 2, 2
  v_lshrrev_b32 v126, 4, v0
  v_lshl_add_u32 v2, v126, 3, v125
  v_lshlrev_b32 v2, 8, v2
  v_xor_b32 v127, s48, v125
  v_lshl_add_u32 v2, v127, 6, v2
  v_and_b32 v127, 3, v0
  v_lshl_add_u32 v2, v127, 4, v2
  v_add_u32 v3, 0x10000, v2
  v_add_u32 v4, 0x20000, v2
  v_lshlrev_b32 v5, 4, v127
  v_lshl_add_u32 v5, v126, 12, v5
  v_bfe_u32 v127, v0, 2, 1
  v_lshl_add_u32 v5, v127, 10, v5
  v_bfe_u32 v127, v0, 3, 1
  v_lshl_add_u32 v5, v127, 6, v5
  s_lshl_b32 s54, s48, 8
  v_add_u32 v5, s54, v5
  v_add_u32 v6, 0x10000, v5
  v_add_u32 v7, 0x20000, v5
  v_lshlrev_b32 v125, 2, v126
  v_and_b32 v10, 15, v0
  v_xor_b32 v10, v10, v125
  v_lshlrev_b32 v10, 4, v10
  s_lshl_b32 s54, s48, 4
  v_add_u32 v125, s54, v125
  v_lshl_add_u32 v10, v125, 13, v10
  v_lshlrev_b32 v115, 4, v0
  s_lshl_b32 s88, s48, 12
  v_add_u32 v118, s88, v115
  v_add_u32 v119, 0x10000, v118
  s_lshl_b32 s86, s71, 8
  s_lshl_b32 s83, s71, 17
  s_or_b32 s54, s89, s48
  v_or_b32 v125, s54, v0
  v_mov_b32 v126, 0x40000000
  v_cmp_eq_u32 vcc, 0, v125
  s_nop 1
  v_cndmask_b32 v126, v126, 0, vcc
  v_mov_b32 v125, 0x1000000
  s_lshl_b32 s54, s89, 11
  s_add_u32 s54, s54, s71
  s_lshl_b32 s92, s54, 6
  s_lshl_b32 s55, s48, 2
  s_add_u32 s92, s92, s55
  s_add_u32 s92, s92, 0x20000
  s_lshl_b32 s93, s54, 13
  s_lshl_b32 s55, s48, 11
  s_add_u32 s93, s93, s55
  s_add_u32 s93, s93, 0x6000000
  s_add_u32 s68, s93, 0x1fff800
  s_lshl_b32 s94, s89, 15
  s_add_u32 s94, s94, s55
  s_add_u32 s94, s94, 0x200000
  s_add_u32 s69, s88, 0x24000
  v_lshlrev_b32 v21, 2, v0
  s_cmp_eq_u32 s89, 0
  s_cselect_b32 s58, 0xffff, -1
  s_and_b32 s59, s58, 0x20303040
  s_add_u32 s59, s59, 256
  s_lshl_b32 s90, s89, 19
  s_lshl_b32 s55, s48, 18
  s_add_u32 s90, s90, s55
  s_lshl_b32 s55, s71, 13
  s_add_u32 s90, s90, s55
  s_add_u32 s90, s90, 0x100000
  s_lshl_b32 s91, s89, 1
  s_and_b32 s55, s71, 1
  s_add_u32 s91, s91, s55
  s_lshl_b32 s91, s91, 1
  s_add_u32 s91, s91, s48
  s_lshl_b32 s91, s91, 13
  s_add_u32 s91, s91, 0x1fc000
  s_cmp_lt_u32 s48, 2
  s_cselect_b32 s90, s90, s91
  v_lshlrev_b32 v28, 7, v0
  v_mov_b32 v29, 0x40000000
  s_lshr_b32 s55, s8, 8
  s_add_u32 s53, s55, s71
  s_and_b32 s53, s53, 31
  s_sub_u32 s54, s53, 1
  s_and_b32 s54, s54, 3
  v_lshrrev_b32 v22, 1, v0
  s_lshl_b32 s56, s48, 4
  v_add_u32 v22, s56, v22
  v_lshlrev_b32 v22, 13, v22
  v_and_b32 v23, 1, v0
  v_lshl_add_u32 v22, v23, 7, v22
  v_mov_b32 v26, 0x40000000
  v_cmp_gt_u32 vcc, 32, v0
  s_nop 1
  v_cndmask_b32 v22, v26, v22, vcc
  s_sub_u32 s56, 29, s55
  s_and_b32 s56, s56, 31
  s_lshl_b32 s56, s56, 8
  v_add_u32 v23, s56, v22
  s_sub_u32 s56, 31, s55
  s_and_b32 s56, s56, 31
  s_lshl_b32 s56, s56, 8
  v_add_u32 v24, s56, v22
  s_sub_u32 s56, s71, s54
  s_and_b32 s56, s56, 31
  s_lshl_b32 s56, s56, 8
  v_add_u32 v22, s56, v22
  s_cmp_eq_u32 s53, 31
  s_cselect_b32 s54, 0, s54
  s_add_u32 m0, s88, 0x18000
  s_add_u32 s87, s86, 0x0
  buffer_load_dwordx4 v10, s[8:11], s87 offen lds
  s_add_u32 m0, s88, 0x18400
  s_add_u32 s87, s86, 0x2000
  buffer_load_dwordx4 v10, s[8:11], s87 offen lds
  s_add_u32 m0, s88, 0x18800
  s_add_u32 s87, s86, 0x4000
  buffer_load_dwordx4 v10, s[8:11], s87 offen lds
  s_add_u32 m0, s88, 0x18c00
  s_add_u32 s87, s86, 0x6000
  buffer_load_dwordx4 v10, s[8:11], s87 offen lds
  s_cmp_eq_u32 s54, 1
  s_cselect_b64 vcc, -1, 0
  s_mov_b32 s55, 0x100000
  v_cndmask_b32 v25, v26, v22, vcc
  buffer_load_dword v27, v25, s[8:11], s55 offen
  s_add_u32 m0, s88, 0x1c000
  s_add_u32 s87, s86, 0x80000
  buffer_load_dwordx4 v10, s[8:11], s87 offen lds
  s_add_u32 m0, s88, 0x1c400
  s_add_u32 s87, s86, 0x82000
  buffer_load_dwordx4 v10, s[8:11], s87 offen lds
  s_add_u32 m0, s88, 0x1c800
  s_add_u32 s87, s86, 0x84000
  buffer_load_dwordx4 v10, s[8:11], s87 offen lds
  s_add_u32 m0, s88, 0x1cc00
  s_add_u32 s87, s86, 0x86000
  buffer_load_dwordx4 v10, s[8:11], s87 offen lds
  s_add_u32 m0, s88, 0x20000
  s_add_u32 s87, s86, 0x100000
  buffer_load_dwordx4 v10, s[8:11], s87 offen lds
  s_add_u32 m0, s88, 0x20400
  s_add_u32 s87, s86, 0x102000
  buffer_load_dwordx4 v10, s[8:11], s87 offen lds
  s_add_u32 m0, s88, 0x20800
  s_add_u32 s87, s86, 0x104000
  buffer_load_dwordx4 v10, s[8:11], s87 offen lds
  s_add_u32 m0, s88, 0x20c00
  s_add_u32 s87, s86, 0x106000
  buffer_load_dwordx4 v10, s[8:11], s87 offen lds
  s_cmp_eq_u32 s54, 2
  s_cselect_b64 vcc, -1, 0
  s_mov_b32 s55, 0x200000
  v_cndmask_b32 v25, v26, v22, vcc
  buffer_load_dword v27, v25, s[8:11], s55 offen
  s_cmp_eq_u32 s53, 2
  s_cselect_b64 vcc, -1, 0
  s_mov_b32 s55, 0x200000
  v_cndmask_b32 v25, v26, v23, vcc
  buffer_load_dword v27, v25, s[8:11], s55 offen
  s_add_u32 m0, s88, 0x24000
  s_add_u32 s87, s86, 0x180000
  buffer_load_dwordx4 v10, s[8:11], s87 offen lds
  s_add_u32 m0, s88, 0x24400
  s_add_u32 s87, s86, 0x182000
  buffer_load_dwordx4 v10, s[8:11], s87 offen lds
  s_add_u32 m0, s88, 0x24800
  s_add_u32 s87, s86, 0x184000
  buffer_load_dwordx4 v10, s[8:11], s87 offen lds
  s_add_u32 m0, s88, 0x24c00
  s_add_u32 s87, s86, 0x186000
  buffer_load_dwordx4 v10, s[8:11], s87 offen lds
  s_add_u32 m0, s88, 0x0
  s_add_u32 s87, s86, 0x200000
  buffer_load_dwordx4 v10, s[8:11], s87 offen lds
  s_add_u32 m0, s88, 0x400
  s_add_u32 s87, s86, 0x202000
  buffer_load_dwordx4 v10, s[8:11], s87 offen lds
  s_add_u32 m0, s88, 0x800
  s_add_u32 s87, s86, 0x204000
  buffer_load_dwordx4 v10, s[8:11], s87 offen lds
  s_add_u32 m0, s88, 0xc00
  s_add_u32 s87, s86, 0x206000
  buffer_load_dwordx4 v10, s[8:11], s87 offen lds
  s_cmp_eq_u32 s54, 3
  s_cselect_b64 vcc, -1, 0
  s_mov_b32 s55, 0x300000
  v_cndmask_b32 v25, v26, v22, vcc
  buffer_load_dword v27, v25, s[8:11], s55 offen
  s_add_u32 m0, s88, 0x4000
  s_add_u32 s87, s86, 0x280000
  buffer_load_dwordx4 v10, s[8:11], s87 offen lds
  s_add_u32 m0, s88, 0x4400
  s_add_u32 s87, s86, 0x282000
  buffer_load_dwordx4 v10, s[8:11], s87 offen lds
  s_add_u32 m0, s88, 0x4800
  s_add_u32 s87, s86, 0x284000
  buffer_load_dwordx4 v10, s[8:11], s87 offen lds
  s_add_u32 m0, s88, 0x4c00
  s_add_u32 s87, s86, 0x286000
  buffer_load_dwordx4 v10, s[8:11], s87 offen lds
  s_cmp_eq_u32 s53, 23
  s_cselect_b64 vcc, -1, 0
  s_mov_b32 s55, 0x380000
  v_cndmask_b32 v25, v26, v24, vcc
  buffer_load_dword v27, v25, s[8:11], s55 offen
  s_add_u32 m0, s88, 0x8000
  s_add_u32 s87, s86, 0x300000
  buffer_load_dwordx4 v10, s[8:11], s87 offen lds
  s_add_u32 m0, s88, 0x8400
  s_add_u32 s87, s86, 0x302000
  buffer_load_dwordx4 v10, s[8:11], s87 offen lds
  s_add_u32 m0, s88, 0x8800
  s_add_u32 s87, s86, 0x304000
  buffer_load_dwordx4 v10, s[8:11], s87 offen lds
  s_add_u32 m0, s88, 0x8c00
  s_add_u32 s87, s86, 0x306000
  buffer_load_dwordx4 v10, s[8:11], s87 offen lds
  s_cmp_eq_u32 s54, 1
  s_cselect_b64 vcc, -1, 0
  s_mov_b32 s55, 0x0
  v_cndmask_b32 v25, v26, v22, vcc
  buffer_load_dword v27, v25, s[16:19], s55 offen
  s_add_u32 m0, s88, 0xc000
  s_add_u32 s87, s86, 0x380000
  buffer_load_dwordx4 v10, s[8:11], s87 offen lds
  s_add_u32 m0, s88, 0xc400
  s_add_u32 s87, s86, 0x382000
  buffer_load_dwordx4 v10, s[8:11], s87 offen lds
  s_add_u32 m0, s88, 0xc800
  s_add_u32 s87, s86, 0x384000
  buffer_load_dwordx4 v10, s[8:11], s87 offen lds
  s_add_u32 m0, s88, 0xcc00
  s_add_u32 s87, s86, 0x386000
  buffer_load_dwordx4 v10, s[8:11], s87 offen lds
  s_waitcnt vmcnt(34) lgkmcnt(0)
  s_barrier
  s_add_u32 m0, s88, 0x10000
  s_add_u32 s87, s86, 0x0
  buffer_load_dwordx4 v10, s[16:19], s87 offen lds
  s_add_u32 m0, s88, 0x10400
  s_add_u32 s87, s86, 0x2000
  buffer_load_dwordx4 v10, s[16:19], s87 offen lds
  s_add_u32 m0, s88, 0x10800
  s_add_u32 s87, s86, 0x4000
  buffer_load_dwordx4 v10, s[16:19], s87 offen lds
  s_add_u32 m0, s88, 0x10c00
  s_add_u32 s87, s86, 0x6000
  buffer_load_dwordx4 v10, s[16:19], s87 offen lds
  s_cmp_eq_u32 s54, 2
  s_cselect_b64 vcc, -1, 0
  s_mov_b32 s55, 0x100000
  v_cndmask_b32 v25, v26, v22, vcc
  buffer_load_dword v27, v25, s[16:19], s55 offen
  s_cmp_eq_u32 s53, 7
  s_cselect_b64 vcc, -1, 0
  s_mov_b32 s55, 0x100000
  v_cndmask_b32 v25, v26, v23, vcc
  buffer_load_dword v27, v25, s[16:19], s55 offen
  ds_read_b64_tr_b16 a[0:1], v3 offset:32768
  ds_read_b64_tr_b16 a[2:3], v3 offset:33792
  ds_read_b64_tr_b16 a[4:5], v3 offset:40960
  ds_read_b64_tr_b16 a[6:7], v3 offset:41984
  ds_read_b64_tr_b16 a[8:9], v3 offset:32776
  ds_read_b64_tr_b16 a[10:11], v3 offset:33800
  ds_read_b64_tr_b16 a[12:13], v3 offset:40968
  ds_read_b64_tr_b16 a[14:15], v3 offset:41992
  s_waitcnt vmcnt(35) lgkmcnt(0)
  s_barrier
  s_add_u32 m0, s88, 0x14000
  s_add_u32 s87, s86, 0x80000
  buffer_load_dwordx4 v10, s[16:19], s87 offen lds
  s_add_u32 m0, s88, 0x14400
  s_add_u32 s87, s86, 0x82000
  buffer_load_dwordx4 v10, s[16:19], s87 offen lds
  s_add_u32 m0, s88, 0x14800
  s_add_u32 s87, s86, 0x84000
  buffer_load_dwordx4 v10, s[16:19], s87 offen lds
  s_add_u32 m0, s88, 0x14c00
  s_add_u32 s87, s86, 0x86000
  buffer_load_dwordx4 v10, s[16:19], s87 offen lds
  ds_read_b64_tr_b16 a[16:17], v3 offset:49152
  ds_read_b64_tr_b16 a[18:19], v3 offset:50176
  ds_read_b64_tr_b16 a[20:21], v3 offset:57344
  ds_read_b64_tr_b16 a[22:23], v3 offset:58368
  ds_read_b64_tr_b16 a[24:25], v3 offset:49160
  ds_read_b64_tr_b16 a[26:27], v3 offset:50184
  ds_read_b64_tr_b16 a[28:29], v3 offset:57352
  ds_read_b64_tr_b16 a[30:31], v3 offset:58376
  s_waitcnt vmcnt(35) lgkmcnt(0)
  s_barrier
  s_add_u32 m0, s88, 0x18000
  s_add_u32 s87, s86, 0x100000
  buffer_load_dwordx4 v10, s[16:19], s87 offen lds
  s_add_u32 m0, s88, 0x18400
  s_add_u32 s87, s86, 0x102000
  buffer_load_dwordx4 v10, s[16:19], s87 offen lds
  s_add_u32 m0, s88, 0x18800
  s_add_u32 s87, s86, 0x104000
  buffer_load_dwordx4 v10, s[16:19], s87 offen lds
  s_add_u32 m0, s88, 0x18c00
  s_add_u32 s87, s86, 0x106000
  buffer_load_dwordx4 v10, s[16:19], s87 offen lds
  s_cmp_eq_u32 s54, 3
  s_cselect_b64 vcc, -1, 0
  s_mov_b32 s55, 0x200000
  v_cndmask_b32 v25, v26, v22, vcc
  buffer_load_dword v27, v25, s[16:19], s55 offen
  ds_read_b64_tr_b16 a[32:33], v4 offset:0
  ds_read_b64_tr_b16 a[34:35], v4 offset:1024
  ds_read_b64_tr_b16 a[36:37], v4 offset:8192
  ds_read_b64_tr_b16 a[38:39], v4 offset:9216
  ds_read_b64_tr_b16 a[40:41], v4 offset:8
  ds_read_b64_tr_b16 a[42:43], v4 offset:1032
  ds_read_b64_tr_b16 a[44:45], v4 offset:8200
  ds_read_b64_tr_b16 a[46:47], v4 offset:9224
  s_waitcnt vmcnt(34) lgkmcnt(0)
  s_barrier
  s_add_u32 m0, s88, 0x1c000
  s_add_u32 s87, s86, 0x180000
  buffer_load_dwordx4 v10, s[16:19], s87 offen lds
  s_add_u32 m0, s88, 0x1c400
  s_add_u32 s87, s86, 0x182000
  buffer_load_dwordx4 v10, s[16:19], s87 offen lds
  s_add_u32 m0, s88, 0x1c800
  s_add_u32 s87, s86, 0x184000
  buffer_load_dwordx4 v10, s[16:19], s87 offen lds
  s_add_u32 m0, s88, 0x1cc00
  s_add_u32 s87, s86, 0x186000
  buffer_load_dwordx4 v10, s[16:19], s87 offen lds
  ds_read_b64_tr_b16 a[48:49], v4 offset:16384
  ds_read_b64_tr_b16 a[50:51], v4 offset:17408
  ds_read_b64_tr_b16 a[52:53], v4 offset:24576
  ds_read_b64_tr_b16 a[54:55], v4 offset:25600
  ds_read_b64_tr_b16 a[56:57], v4 offset:16392
  ds_read_b64_tr_b16 a[58:59], v4 offset:17416
  ds_read_b64_tr_b16 a[60:61], v4 offset:24584
  ds_read_b64_tr_b16 a[62:63], v4 offset:25608
  s_waitcnt vmcnt(34) lgkmcnt(0)
  s_barrier
  s_add_u32 m0, s88, 0x20000
  s_add_u32 s87, s86, 0x200000
  buffer_load_dwordx4 v10, s[16:19], s87 offen lds
  s_add_u32 m0, s88, 0x20400
  s_add_u32 s87, s86, 0x202000
  buffer_load_dwordx4 v10, s[16:19], s87 offen lds
  s_add_u32 m0, s88, 0x20800
  s_add_u32 s87, s86, 0x204000
  buffer_load_dwordx4 v10, s[16:19], s87 offen lds
  s_add_u32 m0, s88, 0x20c00
  s_add_u32 s87, s86, 0x206000
  buffer_load_dwordx4 v10, s[16:19], s87 offen lds
  s_cmp_eq_u32 s54, 1
  s_cselect_b64 vcc, -1, 0
  s_mov_b32 s55, 0x300000
  v_cndmask_b32 v25, v26, v22, vcc
  buffer_load_dword v27, v25, s[16:19], s55 offen
  ds_read_b64_tr_b16 a[64:65], v2 offset:0
  ds_read_b64_tr_b16 a[66:67], v2 offset:1024
  ds_read_b64_tr_b16 a[68:69], v2 offset:8192
  ds_read_b64_tr_b16 a[70:71], v2 offset:9216
  ds_read_b64_tr_b16 a[72:73], v2 offset:8
  ds_read_b64_tr_b16 a[74:75], v2 offset:1032
  ds_read_b64_tr_b16 a[76:77], v2 offset:8200
  ds_read_b64_tr_b16 a[78:79], v2 offset:9224
  s_waitcnt vmcnt(34) lgkmcnt(0)
  s_barrier
  s_add_u32 m0, s88, 0x24000
  s_add_u32 s87, s86, 0x280000
  buffer_load_dwordx4 v10, s[16:19], s87 offen lds
  s_add_u32 m0, s88, 0x24400
  s_add_u32 s87, s86, 0x282000
  buffer_load_dwordx4 v10, s[16:19], s87 offen lds
  s_add_u32 m0, s88, 0x24800
  s_add_u32 s87, s86, 0x284000
  buffer_load_dwordx4 v10, s[16:19], s87 offen lds
  s_add_u32 m0, s88, 0x24c00
  s_add_u32 s87, s86, 0x286000
  buffer_load_dwordx4 v10, s[16:19], s87 offen lds
  s_cmp_eq_u32 s53, 4
  s_cselect_b64 vcc, -1, 0
  s_mov_b32 s55, 0x380000
  v_cndmask_b32 v25, v26, v24, vcc
  buffer_load_dword v27, v25, s[16:19], s55 offen
  ds_read_b64_tr_b16 a[80:81], v2 offset:16384
  ds_read_b64_tr_b16 a[82:83], v2 offset:17408
  ds_read_b64_tr_b16 a[84:85], v2 offset:24576
  ds_read_b64_tr_b16 a[86:87], v2 offset:25600
  ds_read_b64_tr_b16 a[88:89], v2 offset:16392
  ds_read_b64_tr_b16 a[90:91], v2 offset:17416
  ds_read_b64_tr_b16 a[92:93], v2 offset:24584
  ds_read_b64_tr_b16 a[94:95], v2 offset:25608
  s_waitcnt vmcnt(34) lgkmcnt(0)
  s_barrier
  s_add_u32 m0, s88, 0x0
  s_add_u32 s87, s86, 0x300000
  buffer_load_dwordx4 v10, s[16:19], s87 offen lds
  s_add_u32 m0, s88, 0x400
  s_add_u32 s87, s86, 0x302000
  buffer_load_dwordx4 v10, s[16:19], s87 offen lds
  s_add_u32 m0, s88, 0x800
  s_add_u32 s87, s86, 0x304000
  buffer_load_dwordx4 v10, s[16:19], s87 offen lds
  s_add_u32 m0, s88, 0xc00
  s_add_u32 s87, s86, 0x306000
  buffer_load_dwordx4 v10, s[16:19], s87 offen lds
  ds_read_b64_tr_b16 a[96:97], v2 offset:32768
  ds_read_b64_tr_b16 a[98:99], v2 offset:33792
  ds_read_b64_tr_b16 a[100:101], v2 offset:40960
  ds_read_b64_tr_b16 a[102:103], v2 offset:41984
  ds_read_b64_tr_b16 a[104:105], v2 offset:32776
  ds_read_b64_tr_b16 a[106:107], v2 offset:33800
  ds_read_b64_tr_b16 a[108:109], v2 offset:40968
  ds_read_b64_tr_b16 a[110:111], v2 offset:41992
  s_waitcnt vmcnt(33) lgkmcnt(0)
  s_barrier
  s_add_u32 m0, s88, 0x4000
  s_add_u32 s87, s86, 0x380000
  buffer_load_dwordx4 v10, s[16:19], s87 offen lds
  s_add_u32 m0, s88, 0x4400
  s_add_u32 s87, s86, 0x382000
  buffer_load_dwordx4 v10, s[16:19], s87 offen lds
  s_add_u32 m0, s88, 0x4800
  s_add_u32 s87, s86, 0x384000
  buffer_load_dwordx4 v10, s[16:19], s87 offen lds
  s_add_u32 m0, s88, 0x4c00
  s_add_u32 s87, s86, 0x386000
  buffer_load_dwordx4 v10, s[16:19], s87 offen lds
  ds_read_b64_tr_b16 a[112:113], v2 offset:49152
  ds_read_b64_tr_b16 a[114:115], v2 offset:50176
  ds_read_b64_tr_b16 a[116:117], v2 offset:57344
  ds_read_b64_tr_b16 a[118:119], v2 offset:58368
  ds_read_b64_tr_b16 a[120:121], v2 offset:49160
  ds_read_b64_tr_b16 a[122:123], v2 offset:50184
  ds_read_b64_tr_b16 a[124:125], v2 offset:57352
  ds_read_b64_tr_b16 a[126:127], v2 offset:58376
  s_waitcnt vmcnt(33) lgkmcnt(0)
  s_barrier
  s_add_u32 m0, s88, 0x8000
  s_add_u32 s87, s83, 0x0
  buffer_load_dwordx4 v118, s[20:23], s87 offen lds
  s_add_u32 m0, s88, 0x8400
  s_add_u32 s87, s83, 0x400
  buffer_load_dwordx4 v118, s[20:23], s87 offen lds
  s_add_u32 m0, s88, 0x8800
  s_add_u32 s87, s83, 0x800
  buffer_load_dwordx4 v118, s[20:23], s87 offen lds
  s_add_u32 m0, s88, 0x8c00
  s_add_u32 s87, s83, 0xc00
  buffer_load_dwordx4 v118, s[20:23], s87 offen lds
  ds_read_b64_tr_b16 a[128:129], v3 offset:0
  ds_read_b64_tr_b16 a[130:131], v3 offset:1024
  ds_read_b64_tr_b16 a[132:133], v3 offset:8192
  ds_read_b64_tr_b16 a[134:135], v3 offset:9216
  ds_read_b64_tr_b16 a[136:137], v3 offset:8
  ds_read_b64_tr_b16 a[138:139], v3 offset:1032
  ds_read_b64_tr_b16 a[140:141], v3 offset:8200
  ds_read_b64_tr_b16 a[142:143], v3 offset:9224
  s_waitcnt vmcnt(31) lgkmcnt(0)
  s_barrier
  s_add_u32 m0, s88, 0xc000
  s_add_u32 s87, s83, 0x4000
  buffer_load_dwordx4 v118, s[20:23], s87 offen lds
  s_add_u32 m0, s88, 0xc400
  s_add_u32 s87, s83, 0x4400
  buffer_load_dwordx4 v118, s[20:23], s87 offen lds
  s_add_u32 m0, s88, 0xc800
  s_add_u32 s87, s83, 0x4800
  buffer_load_dwordx4 v118, s[20:23], s87 offen lds
  s_add_u32 m0, s88, 0xcc00
  s_add_u32 s87, s83, 0x4c00
  buffer_load_dwordx4 v118, s[20:23], s87 offen lds
  ds_read_b64_tr_b16 a[144:145], v3 offset:16384
  ds_read_b64_tr_b16 a[146:147], v3 offset:17408
  ds_read_b64_tr_b16 a[148:149], v3 offset:24576
  ds_read_b64_tr_b16 a[150:151], v3 offset:25600
  ds_read_b64_tr_b16 a[152:153], v3 offset:16392
  ds_read_b64_tr_b16 a[154:155], v3 offset:17416
  ds_read_b64_tr_b16 a[156:157], v3 offset:24584
  ds_read_b64_tr_b16 a[158:159], v3 offset:25608
  s_waitcnt vmcnt(31) lgkmcnt(0)
  s_barrier
  s_add_u32 m0, s88, 0x10000
  s_add_u32 s87, s83, 0x8000
  buffer_load_dwordx4 v118, s[20:23], s87 offen lds
  s_add_u32 m0, s88, 0x10400
  s_add_u32 s87, s83, 0x8400
  buffer_load_dwordx4 v118, s[20:23], s87 offen lds
  s_add_u32 m0, s88, 0x10800
  s_add_u32 s87, s83, 0x8800
  buffer_load_dwordx4 v118, s[20:23], s87 offen lds
  s_add_u32 m0, s88, 0x10c00
  s_add_u32 s87, s83, 0x8c00
  buffer_load_dwordx4 v118, s[20:23], s87 offen lds
  ds_read_b64_tr_b16 a[160:161], v3 offset:32768
  ds_read_b64_tr_b16 a[162:163], v3 offset:33792
  ds_read_b64_tr_b16 a[164:165], v3 offset:40960
  ds_read_b64_tr_b16 a[166:167], v3 offset:41984
  ds_read_b64_tr_b16 a[168:169], v3 offset:32776
  ds_read_b64_tr_b16 a[170:171], v3 offset:33800
  ds_read_b64_tr_b16 a[172:173], v3 offset:40968
  ds_read_b64_tr_b16 a[174:175], v3 offset:41992
  s_waitcnt vmcnt(30) lgkmcnt(0)
  s_barrier
  s_add_u32 m0, s88, 0x14000
  s_add_u32 s87, s83, 0xc000
  buffer_load_dwordx4 v118, s[20:23], s87 offen lds
  s_add_u32 m0, s88, 0x14400
  s_add_u32 s87, s83, 0xc400
  buffer_load_dwordx4 v118, s[20:23], s87 offen lds
  s_add_u32 m0, s88, 0x14800
  s_add_u32 s87, s83, 0xc800
  buffer_load_dwordx4 v118, s[20:23], s87 offen lds
  s_add_u32 m0, s88, 0x14c00
  s_add_u32 s87, s83, 0xcc00
  buffer_load_dwordx4 v118, s[20:23], s87 offen lds
  ds_read_b64_tr_b16 a[176:177], v3 offset:49152
  ds_read_b64_tr_b16 a[178:179], v3 offset:50176
  ds_read_b64_tr_b16 a[180:181], v3 offset:57344
  ds_read_b64_tr_b16 a[182:183], v3 offset:58368
  ds_read_b64_tr_b16 a[184:185], v3 offset:49160
  ds_read_b64_tr_b16 a[186:187], v3 offset:50184
  ds_read_b64_tr_b16 a[188:189], v3 offset:57352
  ds_read_b64_tr_b16 a[190:191], v3 offset:58376
  s_waitcnt vmcnt(30) lgkmcnt(0)
  s_barrier
  s_add_u32 m0, s88, 0x18000
  s_add_u32 s87, s83, 0x10000
  buffer_load_dwordx4 v118, s[20:23], s87 offen lds
  s_add_u32 m0, s88, 0x18400
  s_add_u32 s87, s83, 0x10400
  buffer_load_dwordx4 v118, s[20:23], s87 offen lds
  s_add_u32 m0, s88, 0x18800
  s_add_u32 s87, s83, 0x10800
  buffer_load_dwordx4 v118, s[20:23], s87 offen lds
  s_add_u32 m0, s88, 0x18c00
  s_add_u32 s87, s83, 0x10c00
  buffer_load_dwordx4 v118, s[20:23], s87 offen lds
  buffer_load_dword v20, v21, s[36:39], 0 offen sc1
  s_cmp_eq_u32 s54, 2
  s_cselect_b64 vcc, -1, 0
  s_mov_b32 s55, 0x0
  v_cndmask_b32 v25, v26, v22, vcc
  buffer_load_dword v27, v25, s[12:15], s55 offen
  s_cmp_eq_u32 s53, 12
  s_cselect_b64 vcc, -1, 0
  s_mov_b32 s55, 0x0
  v_cndmask_b32 v25, v26, v23, vcc
  buffer_load_dword v27, v25, s[12:15], s55 offen
  ds_read_b64_tr_b16 a[192:193], v4 offset:0
  ds_read_b64_tr_b16 a[194:195], v4 offset:1024
  ds_read_b64_tr_b16 a[196:197], v4 offset:8192
  ds_read_b64_tr_b16 a[198:199], v4 offset:9216
  ds_read_b64_tr_b16 a[200:201], v4 offset:8
  ds_read_b64_tr_b16 a[202:203], v4 offset:1032
  ds_read_b64_tr_b16 a[204:205], v4 offset:8200
  ds_read_b64_tr_b16 a[206:207], v4 offset:9224
  s_waitcnt vmcnt(32) lgkmcnt(0)
  s_barrier
  s_add_u32 m0, s88, 0x1c000
  s_add_u32 s87, s83, 0x14000
  buffer_load_dwordx4 v118, s[20:23], s87 offen lds
  s_add_u32 m0, s88, 0x1c400
  s_add_u32 s87, s83, 0x14400
  buffer_load_dwordx4 v118, s[20:23], s87 offen lds
  s_add_u32 m0, s88, 0x1c800
  s_add_u32 s87, s83, 0x14800
  buffer_load_dwordx4 v118, s[20:23], s87 offen lds
  s_add_u32 m0, s88, 0x1cc00
  s_add_u32 s87, s83, 0x14c00
  buffer_load_dwordx4 v118, s[20:23], s87 offen lds
  ds_read_b64_tr_b16 a[208:209], v4 offset:16384
  ds_read_b64_tr_b16 a[210:211], v4 offset:17408
  ds_read_b64_tr_b16 a[212:213], v4 offset:24576
  ds_read_b64_tr_b16 a[214:215], v4 offset:25600
  ds_read_b64_tr_b16 a[216:217], v4 offset:16392
  ds_read_b64_tr_b16 a[218:219], v4 offset:17416
  ds_read_b64_tr_b16 a[220:221], v4 offset:24584
  ds_read_b64_tr_b16 a[222:223], v4 offset:25608
  s_waitcnt vmcnt(31) lgkmcnt(0)
  s_barrier
  s_add_u32 m0, s88, 0x20000
  s_add_u32 s87, s86, 0x0
  buffer_load_dwordx4 v10, s[12:15], s87 offen lds
  s_add_u32 m0, s88, 0x20400
  s_add_u32 s87, s86, 0x2000
  buffer_load_dwordx4 v10, s[12:15], s87 offen lds
  s_add_u32 m0, s88, 0x20800
  s_add_u32 s87, s86, 0x4000
  buffer_load_dwordx4 v10, s[12:15], s87 offen lds
  s_add_u32 m0, s88, 0x20c00
  s_add_u32 s87, s86, 0x6000
  buffer_load_dwordx4 v10, s[12:15], s87 offen lds
  s_cmp_eq_u32 s54, 3
  s_cselect_b64 vcc, -1, 0
  s_mov_b32 s55, 0x80000
  v_cndmask_b32 v25, v26, v22, vcc
  buffer_load_dword v27, v25, s[12:15], s55 offen
  ds_read_b64_tr_b16 a[224:225], v2 offset:0
  ds_read_b64_tr_b16 a[226:227], v2 offset:1024
  ds_read_b64_tr_b16 a[228:229], v2 offset:8192
  ds_read_b64_tr_b16 a[230:231], v2 offset:9216
  ds_read_b64_tr_b16 a[232:233], v2 offset:8
  ds_read_b64_tr_b16 a[234:235], v2 offset:1032
  ds_read_b64_tr_b16 a[236:237], v2 offset:8200
  ds_read_b64_tr_b16 a[238:239], v2 offset:9224
  s_waitcnt vmcnt(32) lgkmcnt(0)
  s_barrier
  s_add_u32 m0, s88, 0x24000
  s_add_u32 s87, s86, 0x200000
  buffer_load_dwordx4 v10, s[12:15], s87 offen lds
  s_add_u32 m0, s88, 0x24400
  s_add_u32 s87, s86, 0x202000
  buffer_load_dwordx4 v10, s[12:15], s87 offen lds
  s_add_u32 m0, s88, 0x24800
  s_add_u32 s87, s86, 0x204000
  buffer_load_dwordx4 v10, s[12:15], s87 offen lds
  s_add_u32 m0, s88, 0x24c00
  s_add_u32 s87, s86, 0x206000
  buffer_load_dwordx4 v10, s[12:15], s87 offen lds
  ds_read_b64_tr_b16 a[240:241], v2 offset:16384
  ds_read_b64_tr_b16 a[242:243], v2 offset:17408
  ds_read_b64_tr_b16 a[244:245], v2 offset:24576
  ds_read_b64_tr_b16 a[246:247], v2 offset:25600
  ds_read_b64_tr_b16 a[248:249], v2 offset:16392
  ds_read_b64_tr_b16 a[250:251], v2 offset:17416
  ds_read_b64_tr_b16 a[252:253], v2 offset:24584
  ds_read_b64_tr_b16 a[254:255], v2 offset:25608
  s_waitcnt vmcnt(32) lgkmcnt(0)
  s_barrier
  s_add_u32 m0, s88, 0x0
  s_add_u32 s87, s86, 0x80000
  buffer_load_dwordx4 v10, s[12:15], s87 offen lds
  s_add_u32 m0, s88, 0x400
  s_add_u32 s87, s86, 0x82000
  buffer_load_dwordx4 v10, s[12:15], s87 offen lds
  s_add_u32 m0, s88, 0x800
  s_add_u32 s87, s86, 0x84000
  buffer_load_dwordx4 v10, s[12:15], s87 offen lds
  s_add_u32 m0, s88, 0xc00
  s_add_u32 s87, s86, 0x86000
  buffer_load_dwordx4 v10, s[12:15], s87 offen lds
  s_cmp_eq_u32 s54, 1
  s_cselect_b64 vcc, -1, 0
  s_mov_b32 s55, 0x180000
  v_cndmask_b32 v25, v26, v22, vcc
  buffer_load_dword v27, v25, s[12:15], s55 offen
  ds_read_b64_tr_b16 v[160:161], v5 offset:32768
  ds_read_b64_tr_b16 v[162:163], v5 offset:34816
  ds_read_b64_tr_b16 v[168:169], v5 offset:32776
  ds_read_b64_tr_b16 v[170:171], v5 offset:34824
  ds_read_b64_tr_b16 v[176:177], v5 offset:32896
  ds_read_b64_tr_b16 v[178:179], v5 offset:34944
  ds_read_b64_tr_b16 v[184:185], v5 offset:32904
  ds_read_b64_tr_b16 v[186:187], v5 offset:34952
  s_waitcnt vmcnt(33) lgkmcnt(0)
  s_barrier
  s_add_u32 m0, s88, 0x4000
  s_add_u32 s87, s86, 0x100000
  buffer_load_dwordx4 v10, s[12:15], s87 offen lds
  s_add_u32 m0, s88, 0x4400
  s_add_u32 s87, s86, 0x102000
  buffer_load_dwordx4 v10, s[12:15], s87 offen lds
  s_add_u32 m0, s88, 0x4800
  s_add_u32 s87, s86, 0x104000
  buffer_load_dwordx4 v10, s[12:15], s87 offen lds
  s_add_u32 m0, s88, 0x4c00
  s_add_u32 s87, s86, 0x106000
  buffer_load_dwordx4 v10, s[12:15], s87 offen lds
  s_cmp_eq_u32 s53, 10
  s_cselect_b64 vcc, -1, 0
  s_mov_b32 s55, 0x280000
  v_cndmask_b32 v25, v26, v24, vcc
  buffer_load_dword v27, v25, s[12:15], s55 offen
  ds_read_b64_tr_b16 v[164:165], v5 offset:49152
  ds_read_b64_tr_b16 v[166:167], v5 offset:51200
  ds_read_b64_tr_b16 v[172:173], v5 offset:49160
  ds_read_b64_tr_b16 v[174:175], v5 offset:51208
  ds_read_b64_tr_b16 v[180:181], v5 offset:49280
  ds_read_b64_tr_b16 v[182:183], v5 offset:51328
  ds_read_b64_tr_b16 v[188:189], v5 offset:49288
  ds_read_b64_tr_b16 v[190:191], v5 offset:51336
  s_waitcnt vmcnt(34) lgkmcnt(0)
  s_barrier
  s_add_u32 m0, s88, 0x8000
  s_add_u32 s87, s86, 0x180000
  buffer_load_dwordx4 v10, s[12:15], s87 offen lds
  s_add_u32 m0, s88, 0x8400
  s_add_u32 s87, s86, 0x182000
  buffer_load_dwordx4 v10, s[12:15], s87 offen lds
  s_add_u32 m0, s88, 0x8800
  s_add_u32 s87, s86, 0x184000
  buffer_load_dwordx4 v10, s[12:15], s87 offen lds
  s_add_u32 m0, s88, 0x8c00
  s_add_u32 s87, s86, 0x186000
  buffer_load_dwordx4 v10, s[12:15], s87 offen lds
  s_cmp_eq_u32 s54, 2
  s_cselect_b64 vcc, -1, 0
  s_mov_b32 s55, 0x300000
  v_cndmask_b32 v25, v26, v22, vcc
  buffer_load_dword v27, v25, s[12:15], s55 offen
  s_cmp_eq_u32 s53, 18
  s_cselect_b64 vcc, -1, 0
  s_mov_b32 s55, 0x300000
  v_cndmask_b32 v25, v26, v23, vcc
  buffer_load_dword v27, v25, s[12:15], s55 offen
  ds_read_b64_tr_b16 v[192:193], v6 offset:0
  ds_read_b64_tr_b16 v[194:195], v6 offset:2048
  ds_read_b64_tr_b16 v[200:201], v6 offset:8
  ds_read_b64_tr_b16 v[202:203], v6 offset:2056
  ds_read_b64_tr_b16 v[208:209], v6 offset:128
  ds_read_b64_tr_b16 v[210:211], v6 offset:2176
  ds_read_b64_tr_b16 v[216:217], v6 offset:136
  ds_read_b64_tr_b16 v[218:219], v6 offset:2184
  s_waitcnt vmcnt(36) lgkmcnt(0)
  s_barrier
  s_add_u32 m0, s88, 0xc000
  s_add_u32 s87, s86, 0x280000
  buffer_load_dwordx4 v10, s[12:15], s87 offen lds
  s_add_u32 m0, s88, 0xc400
  s_add_u32 s87, s86, 0x282000
  buffer_load_dwordx4 v10, s[12:15], s87 offen lds
  s_add_u32 m0, s88, 0xc800
  s_add_u32 s87, s86, 0x284000
  buffer_load_dwordx4 v10, s[12:15], s87 offen lds
  s_add_u32 m0, s88, 0xcc00
  s_add_u32 s87, s86, 0x286000
  buffer_load_dwordx4 v10, s[12:15], s87 offen lds
  s_cmp_eq_u32 s54, 3
  s_cselect_b64 vcc, -1, 0
  s_mov_b32 s55, 0x380000
  v_cndmask_b32 v25, v26, v22, vcc
  buffer_load_dword v27, v25, s[12:15], s55 offen
  ds_read_b64_tr_b16 v[196:197], v6 offset:16384
  ds_read_b64_tr_b16 v[198:199], v6 offset:18432
  ds_read_b64_tr_b16 v[204:205], v6 offset:16392
  ds_read_b64_tr_b16 v[206:207], v6 offset:18440
  ds_read_b64_tr_b16 v[212:213], v6 offset:16512
  ds_read_b64_tr_b16 v[214:215], v6 offset:18560
  ds_read_b64_tr_b16 v[220:221], v6 offset:16520
  ds_read_b64_tr_b16 v[222:223], v6 offset:18568
  s_waitcnt vmcnt(37) lgkmcnt(0)
  s_barrier
  s_add_u32 m0, s88, 0x10000
  s_add_u32 s87, s86, 0x300000
  buffer_load_dwordx4 v10, s[12:15], s87 offen lds
  s_add_u32 m0, s88, 0x10400
  s_add_u32 s87, s86, 0x302000
  buffer_load_dwordx4 v10, s[12:15], s87 offen lds
  s_add_u32 m0, s88, 0x10800
  s_add_u32 s87, s86, 0x304000
  buffer_load_dwordx4 v10, s[12:15], s87 offen lds
  s_add_u32 m0, s88, 0x10c00
  s_add_u32 s87, s86, 0x306000
  buffer_load_dwordx4 v10, s[12:15], s87 offen lds
  ds_read_b64_tr_b16 v[224:225], v6 offset:32768
  ds_read_b64_tr_b16 v[226:227], v6 offset:34816
  ds_read_b64_tr_b16 v[232:233], v6 offset:32776
  ds_read_b64_tr_b16 v[234:235], v6 offset:34824
  ds_read_b64_tr_b16 v[240:241], v6 offset:32896
  ds_read_b64_tr_b16 v[242:243], v6 offset:34944
  ds_read_b64_tr_b16 v[248:249], v6 offset:32904
  ds_read_b64_tr_b16 v[250:251], v6 offset:34952
  s_waitcnt vmcnt(34) lgkmcnt(0)
  s_barrier
  s_add_u32 m0, s88, 0x14000
  s_add_u32 s87, s86, 0x380000
  buffer_load_dwordx4 v10, s[12:15], s87 offen lds
  s_add_u32 m0, s88, 0x14400
  s_add_u32 s87, s86, 0x382000
  buffer_load_dwordx4 v10, s[12:15], s87 offen lds
  s_add_u32 m0, s88, 0x14800
  s_add_u32 s87, s86, 0x384000
  buffer_load_dwordx4 v10, s[12:15], s87 offen lds
  s_add_u32 m0, s88, 0x14c00
  s_add_u32 s87, s86, 0x386000
  buffer_load_dwordx4 v10, s[12:15], s87 offen lds
  v_readlane_b32 s60, v20, 0
  v_readlane_b32 s61, v20, 48
  v_readlane_b32 s62, v20, 16
  v_readlane_b32 s63, v20, 49
  v_readlane_b32 s64, v20, 50
  v_readlane_b32 s65, v20, 51
  v_readlane_b32 s66, v20, 32
  v_readlane_b32 s67, v20, 33
  v_readlane_b32 s57, v20, 17
  s_add_u32 s56, s60, s61
  s_add_u32 s56, s56, s62
  s_add_u32 s56, s56, s63
  s_add_u32 s56, s56, s64
  s_add_u32 s56, s56, s65
  s_add_u32 s56, s56, s66
  s_add_u32 s56, s56, s67
  s_and_b32 s57, s57, s58
  s_add_u32 s56, s56, s57
  s_cmp_lt_u32 s56, s59
  s_cselect_b32 s95, 0, 1
  buffer_load_dword v20, off, s[4:7], s92 sc1
  buffer_load_dwordx4 v[12:15], v115, s[4:7], s94 offen offset:0 sc1
  buffer_load_dwordx4 v[16:19], v115, s[4:7], s94 offen offset:1024 sc1
  ds_read_b64_tr_b16 v[228:229], v6 offset:49152
  ds_read_b64_tr_b16 v[230:231], v6 offset:51200
  ds_read_b64_tr_b16 v[236:237], v6 offset:49160
  ds_read_b64_tr_b16 v[238:239], v6 offset:51208
  ds_read_b64_tr_b16 v[244:245], v6 offset:49280
  ds_read_b64_tr_b16 v[246:247], v6 offset:51328
  ds_read_b64_tr_b16 v[252:253], v6 offset:49288
  ds_read_b64_tr_b16 v[254:255], v6 offset:51336
  s_waitcnt vmcnt(37) lgkmcnt(0)
  s_barrier
  s_add_u32 m0, s88, 0x18000
  s_add_u32 s87, s83, 0x18000
  buffer_load_dwordx4 v118, s[20:23], s87 offen lds
  s_add_u32 m0, s88, 0x18400
  s_add_u32 s87, s83, 0x18400
  buffer_load_dwordx4 v118, s[20:23], s87 offen lds
  s_add_u32 m0, s88, 0x18800
  s_add_u32 s87, s83, 0x18800
  buffer_load_dwordx4 v118, s[20:23], s87 offen lds
  s_add_u32 m0, s88, 0x18c00
  s_add_u32 s87, s83, 0x18c00
  buffer_load_dwordx4 v118, s[20:23], s87 offen lds
  ds_read_b64_tr_b16 v[128:129], v4 offset:0
  ds_read_b64_tr_b16 v[130:131], v4 offset:1024
  ds_read_b64_tr_b16 v[132:133], v4 offset:8192
  ds_read_b64_tr_b16 v[134:135], v4 offset:9216
  ds_read_b64_tr_b16 v[136:137], v4 offset:8
  ds_read_b64_tr_b16 v[138:139], v4 offset:1032
  ds_read_b64_tr_b16 v[140:141], v4 offset:8200
  ds_read_b64_tr_b16 v[142:143], v4 offset:9224
  s_waitcnt vmcnt(36) lgkmcnt(0)
  s_barrier
  s_add_u32 m0, s88, 0x1c000
  s_add_u32 s87, s83, 0x1c000
  buffer_load_dwordx4 v118, s[20:23], s87 offen lds
  s_add_u32 m0, s88, 0x1c400
  s_add_u32 s87, s83, 0x1c400
  buffer_load_dwordx4 v118, s[20:23], s87 offen lds
  s_add_u32 m0, s88, 0x1c800
  s_add_u32 s87, s83, 0x1c800
  buffer_load_dwordx4 v118, s[20:23], s87 offen lds
  s_add_u32 m0, s88, 0x1cc00
  s_add_u32 s87, s83, 0x1cc00
  buffer_load_dwordx4 v118, s[20:23], s87 offen lds
  ds_read_b64_tr_b16 v[144:145], v4 offset:16384
  ds_read_b64_tr_b16 v[146:147], v4 offset:17408
  ds_read_b64_tr_b16 v[148:149], v4 offset:24576
  ds_read_b64_tr_b16 v[150:151], v4 offset:25600
  ds_read_b64_tr_b16 v[152:153], v4 offset:16392
  ds_read_b64_tr_b16 v[154:155], v4 offset:17416
  ds_read_b64_tr_b16 v[156:157], v4 offset:24584
  ds_read_b64_tr_b16 v[158:159], v4 offset:25608
  s_waitcnt vmcnt(36) lgkmcnt(0)
  s_barrier
  ds_read_b64_tr_b16 v[66:67], v2 offset:0
  ds_read_b64_tr_b16 v[68:69], v2 offset:1024
  ds_read_b64_tr_b16 v[70:71], v2 offset:8192
  ds_read_b64_tr_b16 v[72:73], v2 offset:9216
  ds_read_b64_tr_b16 v[74:75], v2 offset:8
  ds_read_b64_tr_b16 v[76:77], v2 offset:1032
  ds_read_b64_tr_b16 v[78:79], v2 offset:8200
  ds_read_b64_tr_b16 v[80:81], v2 offset:9224
  s_waitcnt vmcnt(31) lgkmcnt(0)
  s_barrier
  ds_read_b64_tr_b16 v[82:83], v2 offset:16384
  ds_read_b64_tr_b16 v[84:85], v2 offset:17408
  ds_read_b64_tr_b16 v[86:87], v2 offset:24576
  ds_read_b64_tr_b16 v[88:89], v2 offset:25600
  ds_read_b64_tr_b16 v[90:91], v2 offset:16392
  ds_read_b64_tr_b16 v[92:93], v2 offset:17416
  ds_read_b64_tr_b16 v[94:95], v2 offset:24584
  ds_read_b64_tr_b16 v[96:97], v2 offset:25608
  ds_write_b128 v118, v[66:69] offset:0
  ds_write_b128 v118, v[70:73] offset:1024
  ds_write_b128 v118, v[74:77] offset:2048
  ds_write_b128 v118, v[78:81] offset:3072
  s_waitcnt vmcnt(26) lgkmcnt(0)
  s_barrier
  ds_read_b64_tr_b16 v[66:67], v2 offset:32768
  ds_read_b64_tr_b16 v[68:69], v2 offset:33792
  ds_read_b64_tr_b16 v[70:71], v2 offset:40960
  ds_read_b64_tr_b16 v[72:73], v2 offset:41984
  ds_read_b64_tr_b16 v[74:75], v2 offset:32776
  ds_read_b64_tr_b16 v[76:77], v2 offset:33800
  ds_read_b64_tr_b16 v[78:79], v2 offset:40968
  ds_read_b64_tr_b16 v[80:81], v2 offset:41992
  ds_write_b128 v118, v[82:85] offset:16384
  ds_write_b128 v118, v[86:89] offset:17408
  ds_write_b128 v118, v[90:93] offset:18432
  ds_write_b128 v118, v[94:97] offset:19456
  s_waitcnt vmcnt(20) lgkmcnt(0)
  s_barrier
  buffer_atomic_add v125, v126, s[36:39], 0 offen offset:68 sc1
  ds_read_b64_tr_b16 v[82:83], v2 offset:49152
  ds_read_b64_tr_b16 v[84:85], v2 offset:50176
  ds_read_b64_tr_b16 v[86:87], v2 offset:57344
  ds_read_b64_tr_b16 v[88:89], v2 offset:58368
  ds_read_b64_tr_b16 v[90:91], v2 offset:49160
  ds_read_b64_tr_b16 v[92:93], v2 offset:50184
  ds_read_b64_tr_b16 v[94:95], v2 offset:57352
  ds_read_b64_tr_b16 v[96:97], v2 offset:58376
  ds_write_b128 v118, v[66:69] offset:32768
  ds_write_b128 v118, v[70:73] offset:33792
  ds_write_b128 v118, v[74:77] offset:34816
  ds_write_b128 v118, v[78:81] offset:35840
  s_waitcnt vmcnt(16) lgkmcnt(0)
  s_barrier
  ds_read_b64_tr_b16 v[66:67], v3 offset:0
  ds_read_b64_tr_b16 v[68:69], v3 offset:1024
  ds_read_b64_tr_b16 v[70:71], v3 offset:8192
  ds_read_b64_tr_b16 v[72:73], v3 offset:9216
  ds_read_b64_tr_b16 v[74:75], v3 offset:8
  ds_read_b64_tr_b16 v[76:77], v3 offset:1032
  ds_read_b64_tr_b16 v[78:79], v3 offset:8200
  ds_read_b64_tr_b16 v[80:81], v3 offset:9224
  ds_write_b128 v118, v[82:85] offset:49152
  ds_write_b128 v118, v[86:89] offset:50176
  ds_write_b128 v118, v[90:93] offset:51200
  ds_write_b128 v118, v[94:97] offset:52224
  s_waitcnt vmcnt(12) lgkmcnt(0)
  s_barrier
  ds_read_b64_tr_b16 v[82:83], v3 offset:16384
  ds_read_b64_tr_b16 v[84:85], v3 offset:17408
  ds_read_b64_tr_b16 v[86:87], v3 offset:24576
  ds_read_b64_tr_b16 v[88:89], v3 offset:25600
  ds_read_b64_tr_b16 v[90:91], v3 offset:16392
  ds_read_b64_tr_b16 v[92:93], v3 offset:17416
  ds_read_b64_tr_b16 v[94:95], v3 offset:24584
  ds_read_b64_tr_b16 v[96:97], v3 offset:25608
  ds_write_b128 v119, v[66:69] offset:0
  ds_write_b128 v119, v[70:73] offset:1024
  ds_write_b128 v119, v[74:77] offset:2048
  ds_write_b128 v119, v[78:81] offset:3072
  s_waitcnt vmcnt(5) lgkmcnt(0)
  s_barrier
  v_readfirstlane_b32 s57, v20
  s_mov_b32 m0, s69
  s_cmp_eq_u32 s57, 1
  s_cselect_b32 s94, s95, 0
  buffer_load_dwordx4 v115, s[4:7], s93 offen offset:0 sc1 lds
  buffer_load_dwordx4 v115, s[4:7], s93 offen offset:1024 sc1 lds
  buffer_load_dwordx4 v115, s[4:7], s68 offen offset:2048 sc1 lds
  buffer_load_dwordx4 v115, s[4:7], s68 offen offset:3072 sc1 lds
  s_cmp_eq_u32 s95, 1
  s_cselect_b64 vcc, -1, 0
  v_cndmask_b32 v28, v29, v28, vcc
  buffer_load_dword v29, v28, s[4:7], s90 offen
  buffer_load_dword v21, off, s[4:7], s92 sc1
  ds_read_b64_tr_b16 v[34:35], v6 offset:32768
  ds_read_b64_tr_b16 v[36:37], v6 offset:34816
  ds_read_b64_tr_b16 v[42:43], v6 offset:32776
  ds_read_b64_tr_b16 v[44:45], v6 offset:34824
  ds_read_b64_tr_b16 v[50:51], v6 offset:32896
  ds_read_b64_tr_b16 v[52:53], v6 offset:34944
  ds_read_b64_tr_b16 v[58:59], v6 offset:32904
  ds_read_b64_tr_b16 v[60:61], v6 offset:34952
  ds_write_b128 v119, v[82:85] offset:16384
  ds_write_b128 v119, v[86:89] offset:17408
  ds_write_b128 v119, v[90:93] offset:18432
  ds_write_b128 v119, v[94:97] offset:19456
  s_waitcnt vmcnt(7) lgkmcnt(0)
  s_barrier
  ds_read_b64_tr_b16 v[38:39], v6 offset:49152
  ds_read_b64_tr_b16 v[40:41], v6 offset:51200
  ds_read_b64_tr_b16 v[46:47], v6 offset:49160
  ds_read_b64_tr_b16 v[48:49], v6 offset:51208
  ds_read_b64_tr_b16 v[54:55], v6 offset:49280
  ds_read_b64_tr_b16 v[56:57], v6 offset:51328
  ds_read_b64_tr_b16 v[62:63], v6 offset:49288
  ds_read_b64_tr_b16 v[64:65], v6 offset:51336
  s_waitcnt lgkmcnt(0)
  s_barrier
  ds_write_b128 v119, v[34:37] offset:32768
  ds_write_b128 v119, v[38:41] offset:33792
  ds_write_b128 v119, v[42:45] offset:34816
  ds_write_b128 v119, v[46:49] offset:35840
  ds_write_b128 v119, v[50:53] offset:49152
  ds_write_b128 v119, v[54:57] offset:50176
  ds_write_b128 v119, v[58:61] offset:51200
  ds_write_b128 v119, v[62:65] offset:52224
  s_cmp_eq_u32 s94, 1
  s_cbranch_scc1 c_early
  s_waitcnt vmcnt(0)
  v_readfirstlane_b32 s57, v21
  s_cmp_eq_u32 s57, 1
  s_cselect_b32 s94, s95, 0
  buffer_load_dwordx4 v115, s[4:7], s93 offen offset:0 sc1 lds
  buffer_load_dwordx4 v115, s[4:7], s93 offen offset:1024 sc1 lds
  buffer_load_dwordx4 v115, s[4:7], s68 offen offset:2048 sc1 lds
  buffer_load_dwordx4 v115, s[4:7], s68 offen offset:3072 sc1 lds
c_early:
  v_mov_b32 v126, 0x3f80
  v_mov_b32 v127, 0x3f800000
  v_and_b32 v125, 15, v0
  v_mov_b32 v102, 0
  v_cmp_eq_u32 vcc, 0, v125
  s_nop 1
  v_cndmask_b32 v102, v102, v126, vcc
  v_cmp_eq_u32 vcc, 1, v125
  s_nop 1
  v_cndmask_b32 v102, v102, v127, vcc
  v_mov_b32 v103, 0
  v_cmp_eq_u32 vcc, 2, v125
  s_nop 1
  v_cndmask_b32 v103, v103, v126, vcc
  v_cmp_eq_u32 vcc, 3, v125
  s_nop 1
  v_cndmask_b32 v103, v103, v127, vcc
  v_mov_b32 v104, 0
  v_cmp_eq_u32 vcc, 4, v125
  s_nop 1
  v_cndmask_b32 v104, v104, v126, vcc
  v_cmp_eq_u32 vcc, 5, v125
  s_nop 1
  v_cndmask_b32 v104, v104, v127, vcc
  v_mov_b32 v105, 0
  v_cmp_eq_u32 vcc, 6, v125
  s_nop 1
  v_cndmask_b32 v105, v105, v126, vcc
  v_cmp_eq_u32 vcc, 7, v125
  s_nop 1
  v_cndmask_b32 v105, v105, v127, vcc
  v_mov_b32 v110, 0x3f803f80
  v_mov_b32 v111, 0x3f803f80
  v_mov_b32 v112, 0x3f003f00
  v_mov_b32 v113, 0x3f003f00
  s_mov_b32 s90, 0x00ff00ff
  s_mov_b32 s91, 0x00ff00ff
  s_mov_b32 s92, 0xff00ff00
  s_mov_b32 s93, 0xff00ff00
  v_mov_b32 v126, 0x44444444
  v_mov_b32 v114, 0xeeeeeeee
  v_cndmask_b32 v114, v114, v126, s[90:91]
  v_add_u32 v116, 0x10000, v115
  v_add_u32 v117, 0x20000, v115
  v_lshrrev_b32 v126, 4, v0
  v_and_b32 v118, 7, v0
  v_lshlrev_b32 v118, 4, v118
  v_add_u32 v118, 0x20000, v118
  v_lshl_add_u32 v118, v126, 7, v118
  v_bfe_u32 v127, v0, 3, 1
  v_lshl_add_u32 v119, v127, 3, v118
  v_and_b32 v120, 7, v0
  v_lshlrev_b32 v120, 4, v120
  v_lshrrev_b32 v127, 5, v0
  v_lshl_add_u32 v120, v127, 7, v120
  v_bfe_u32 v127, v0, 4, 1
  v_lshl_add_u32 v120, v127, 3, v120
  v_add_u32 v120, 0x20000, v120
  v_and_b32 v127, 3, v0
  v_lshlrev_b32 v121, 4, v127
  v_bfe_u32 v127, v0, 2, 2
  v_lshl_add_u32 v121, v127, 12, v121
  v_bfe_u32 v127, v0, 4, 1
  v_lshl_add_u32 v121, v127, 11, v121
  v_lshrrev_b32 v127, 5, v0
  v_lshl_add_u32 v121, v127, 14, v121
  v_and_b32 v123, 1, v0
  v_lshlrev_b32 v123, 4, v123
  v_bfe_u32 v127, v0, 1, 1
  v_lshl_add_u32 v123, v127, 6, v123
  v_cmp_eq_u32 vcc, 0, v127
  v_mov_b32 v127, 0x44444444
  v_mov_b32 v122, 0xeeeeeeee
  v_cndmask_b32 v122, v122, v127, vcc
  v_lshl_add_u32 v123, v126, 2, v123
  v_mov_b32 v127, 0x40000000
  v_cmp_gt_u32 vcc, 4, v125
  s_nop 1
  v_cndmask_b32 v123, v127, v123, vcc
  s_mov_b32 s85, 0x3e0293ee
  s_mov_b32 s70, 0
  s_lshl_b32 s72, s89, 11
  s_add_u32 s72, s72, s71
  s_lshl_b32 s82, s72, 6
  s_lshl_b32 s54, s48, 2
  s_add_u32 s82, s82, s54
  s_add_u32 s82, s82, 0x20000
  s_lshl_b32 s81, s48, 10
  s_add_u32 s81, s81, s52
  s_lshl_b32 s80, s72, 13
  s_lshl_b32 s54, s48, 11
  s_add_u32 s83, s80, s54
  s_add_u32 s83, s83, 0x6000000
  s_add_u32 s80, s80, 0xa000000
  s_lshl_b32 s55, s71, 2
  s_add_u32 s55, s55, s48
  s_lshl_b32 s86, s89, 19
  s_add_u32 s86, s86, 0x100000
  s_lshl_b32 s78, s55, 11
  s_add_u32 s78, s78, s86
  s_lshl_b32 s76, s48, 16
  s_add_u32 s76, s76, s86
  s_lshl_b32 s86, s71, 6
  s_add_u32 s76, s76, s86
  s_lshl_b32 s89, s89, 15
  s_add_u32 s89, s89, 0x200000
  s_lshl_b32 s88, s71, 8
  s_and_b32 s54, s48, 1
  s_lshl_b32 s54, s54, 7
  s_add_u32 s88, s88, s54
  s_and_b32 s54, s48, 2
  s_lshl_b32 s54, s54, 4
  s_add_u32 s88, s88, s54
  s_mov_b32 s84, 1
  s_cmp_eq_u32 s95, 1
  s_cbranch_scc1 ch_done
  v_lshlrev_b32 v3, 2, v0
  s_lshr_b32 s58, s50, 5
  s_bitcmp1_b32 0xca, s58
  s_cselect_b32 s58, -1, 0xffff
  s_and_b32 s59, s58, 0x20303040
  s_add_u32 s59, s59, 256
ch_cnt:
  s_sub_u32 s51, s51, 1
  s_cbranch_scc1 main_end
  buffer_load_dword v1, v3, s[36:39], 0 offen sc1
  s_waitcnt vmcnt(0)
  v_readlane_b32 s60, v1, 0
  v_readlane_b32 s61, v1, 48
  v_readlane_b32 s62, v1, 16
  v_readlane_b32 s63, v1, 49
  v_readlane_b32 s64, v1, 50
  v_readlane_b32 s65, v1, 51
  v_readlane_b32 s66, v1, 32
  v_readlane_b32 s67, v1, 33
  v_readlane_b32 s57, v1, 17
  s_add_u32 s56, s60, s61
  s_add_u32 s56, s56, s62
  s_add_u32 s56, s56, s63
  s_add_u32 s56, s56, s64
  s_add_u32 s56, s56, s65
  s_add_u32 s56, s56, s66
  s_add_u32 s56, s56, s67
  s_and_b32 s57, s57, s58
  s_add_u32 s56, s56, s57
  s_cmp_lt_u32 s56, s59
  s_cbranch_scc1 ch_cnt
ch_done:
  s_cmp_lt_u32 s50, 32
  s_cselect_b32 s54, s60, s61
  v_and_b32 v125, 7, v0
  v_lshrrev_b32 v126, 4, v0
  v_lshlrev_b32 v126, 1, v126
  v_sub_u32 v125, v125, v126
  v_mov_b32 v126, 0x3f80
  v_mov_b32 v127, 0x3f800000
  v_mov_b32 v107, 0
  v_cmp_eq_u32 vcc, 0, v125
  s_nop 1
  v_cndmask_b32 v107, v107, v126, vcc
  v_cmp_eq_u32 vcc, 1, v125
  s_nop 1
  v_cndmask_b32 v107, v107, v127, vcc
  v_mov_b32 v106, v107
  v_mov_b64 v[108:109], 0
  v_mov_b64 v[98:99], 0
  v_mov_b64 v[100:101], 0
  v_mov_b32 v127, 0x40000000
  v_cmp_gt_u32 vcc, 12, v0
  v_lshlrev_b32 v0, 2, v0
  s_nop 0
  v_cndmask_b32 v0, v127, v0, vcc
  v_mov_b32 v1, 0x7fc17fc1
  s_mov_b32 s90, s85
  s_mov_b32 s91, s85
  s_waitcnt lgkmcnt(0)
  s_barrier
  v_mov_b32 v34, 0
  v_mov_b32 v35, 0
  v_mov_b32 v36, 0
  v_mov_b32 v37, 0
  v_mov_b32 v38, 0
  v_mov_b32 v39, 0
  v_mov_b32 v40, 0
  v_mov_b32 v41, 0
  v_mov_b32 v42, 0
  v_mov_b32 v43, 0
  v_mov_b32 v44, 0
  v_mov_b32 v45, 0
  v_mov_b32 v46, 0
  v_mov_b32 v47, 0
  v_mov_b32 v48, 0
  v_mov_b32 v49, 0
  v_mov_b32 v58, 0
  v_mov_b32 v59, 0
  v_mov_b32 v60, 0
  v_mov_b32 v61, 0
  v_mov_b32 v62, 0
  v_mov_b32 v63, 0
  v_mov_b32 v64, 0
  v_mov_b32 v65, 0
  s_cmp_lt_u32 s54, 32
  s_cselect_b32 s54, 4, 0
  s_add_u32 s54, s54, s48
  s_cmp_eq_u32 s54, 0
  s_cbranch_scc1 c00_entry
  s_cmp_eq_u32 s54, 1
  s_cbranch_scc1 c10_entry
  s_cmp_eq_u32 s54, 2
  s_cbranch_scc1 c20_entry
  s_cmp_eq_u32 s54, 3
  s_cbranch_scc1 c30_entry
  s_cmp_eq_u32 s54, 4
  s_cbranch_scc1 c01_entry
  s_cmp_eq_u32 s54, 5
  s_cbranch_scc1 c11_entry
  s_cmp_eq_u32 s54, 6
  s_cbranch_scc1 c21_entry
  s_cmp_eq_u32 s54, 7
  s_cbranch_scc1 c31_entry
c_exit:
  buffer_store_dwordx4 v[98:101], v115, s[4:7], s81 offen sc1
  s_add_u32 s87, s81, 0xfffe0400
  buffer_store_dwordx2 v[30:31], v119, s[4:7], s87 offen sc1
  s_endpgm
c00_entry:
  s_branch c00_tail
c00_poll0:
c00_poll:
  s_waitcnt vmcnt(0)
  ds_write_b128 v117, v[2:5] offset:0
  ds_write_b128 v117, v[6:9] offset:1024
  v_max3_u32 v125, v2, v3, v4
  v_max3_u32 v126, v5, v6, v7
  v_max3_u32 v125, v125, v8, v9
  v_max_u32 v125, v125, v126
  v_cmp_eq_u32 vcc, -1, v125
  s_cbranch_vccz c00_poll_ok
  s_mov_b64 exec, vcc
  buffer_load_dwordx4 v[2:5], v115, s[4:7], s73 offen offset:0 sc1
  buffer_load_dwordx4 v[6:9], v115, s[4:7], s73 offen offset:1024 sc1
  s_sub_u32 s51, s51, 1
  s_cbranch_scc0 c00_poll
  s_endpgm
c00_poll_ok:
  s_mov_b64 exec, -1
  v_smfmac_f32_16x16x64_bf16 v[42:45], v[6:9], v[66:73], v122
  v_smfmac_f32_16x16x64_bf16 v[46:49], v[6:9], v[74:81], v122
  s_waitcnt lgkmcnt(0)
  s_barrier
  buffer_load_dword v124, off, s[4:7], s82 offset:2048 sc1
  v_smfmac_f32_16x16x64_bf16 v[34:37], v[2:5], a[0:7], v122
  ds_read_b128 v[10:13], v117 offset:2048
  v_smfmac_f32_16x16x64_bf16 v[38:41], v[2:5], a[8:15], v122
  buffer_store_dwordx2 v[30:31], v119, s[4:7], s87 offen sc1
  ds_read_b128 v[14:17], v117 offset:3072
  v_smfmac_f32_16x16x64_bf16 v[34:37], v[6:9], a[16:23], v122
  ds_read_b128 v[18:21], v117 offset:4096
  v_smfmac_f32_16x16x64_bf16 v[38:41], v[6:9], a[24:31], v122
  ds_read_b128 v[22:25], v117 offset:5120
  s_waitcnt lgkmcnt(3)
  v_smfmac_f32_16x16x64_bf16 v[42:45], v[10:13], v[82:89], v122
  ds_read_b128 v[26:29], v117 offset:6144
  v_smfmac_f32_16x16x64_bf16 v[46:49], v[10:13], v[90:97], v122
  ds_read_b128 v[30:33], v117 offset:7168
  v_smfmac_f32_16x16x64_bf16 v[34:37], v[10:13], a[32:39], v122
  buffer_store_dwordx4 v[98:101], v115, s[4:7], s81 offen sc1
  ds_read_b128 v[66:69], v115 offset:32768
  v_smfmac_f32_16x16x64_bf16 v[38:41], v[10:13], a[40:47], v122
  ds_read_b128 v[70:73], v115 offset:33792
  s_waitcnt lgkmcnt(6)
  v_smfmac_f32_16x16x64_bf16 v[34:37], v[14:17], a[48:55], v122
  ds_read_b128 v[74:77], v115 offset:34816
  v_smfmac_f32_16x16x64_bf16 v[38:41], v[14:17], a[56:63], v122
  ds_read_b128 v[78:81], v115 offset:35840
  s_waitcnt lgkmcnt(7)
  v_mov_b32 v126, -1
  v_smfmac_f32_16x16x64_bf16 v[34:37], v[18:21], a[64:71], v122
  buffer_store_dword v126, v123, s[4:7], s75 offen
  ds_read_b128 v[82:85], v115 offset:49152
  v_smfmac_f32_16x16x64_bf16 v[38:41], v[18:21], a[72:79], v122
  ds_read_b128 v[86:89], v115 offset:50176
  s_waitcnt lgkmcnt(8)
  v_smfmac_f32_16x16x64_bf16 v[34:37], v[22:25], a[80:87], v122
  ds_read_b128 v[90:93], v115 offset:51200
  v_smfmac_f32_16x16x64_bf16 v[38:41], v[22:25], a[88:95], v122
  s_add_u32 s83, s83, 0x40000
  ds_read_b128 v[94:97], v115 offset:52224
  s_waitcnt lgkmcnt(9)
  v_smfmac_f32_16x16x64_bf16 v[34:37], v[26:29], a[96:103], v122
  s_mov_b32 m0, 0x24000
  s_add_u32 s86, s83, 0x1fff800
  v_smfmac_f32_16x16x64_bf16 v[38:41], v[26:29], a[104:111], v122
  s_mov_b64 vcc, s[92:93]
  s_waitcnt lgkmcnt(8)
  v_smfmac_f32_16x16x64_bf16 v[34:37], v[30:33], a[112:119], v122
  v_smfmac_f32_16x16x64_bf16 v[38:41], v[30:33], a[120:127], v122
  s_waitcnt lgkmcnt(6)
  v_smfmac_f32_16x16x64_bf16 v[42:45], v[14:17], v[66:73], v122
  ds_read_b128 v[66:69], v116 offset:0
  s_waitcnt lgkmcnt(5)
  v_cvt_pk_bf16_f32 v98, v34, v35
  v_cvt_pk_bf16_f32 v99, v36, v37
  v_smfmac_f32_16x16x64_bf16 v[46:49], v[14:17], v[74:81], v122
  ds_read_b128 v[70:73], v116 offset:1024
  v_mfma_f32_16x16x32_bf16 v[34:37], v[98:101], v[106:109], 0
  ds_read_b128 v[74:77], v116 offset:2048
  s_waitcnt lgkmcnt(5)
  v_cvt_pk_bf16_f32 v100, v38, v39
  v_cvt_pk_bf16_f32 v101, v40, v41
  v_smfmac_f32_16x16x64_bf16 v[42:45], v[22:25], v[82:89], v122
  ds_read_b128 v[78:81], v116 offset:3072
  v_mfma_f32_16x16x32_bf16 v[38:41], v[100:103], v[106:109], 0
  ds_read_b128 v[82:85], v116 offset:16384
  s_waitcnt lgkmcnt(5)
  v_cvt_pk_bf16_f32 v34, v34, v35
  v_cvt_pk_bf16_f32 v35, v36, v37
  v_smfmac_f32_16x16x64_bf16 v[46:49], v[22:25], v[90:97], v122
  ds_read_b128 v[86:89], v116 offset:17408
  v_smfmac_f32_16x16x64_bf16 v[42:45], v[2:5], v[128:135], v122
  ds_read_b128 v[90:93], v116 offset:18432
  ds_read_b128 v[94:97], v116 offset:19456
  v_cvt_pk_bf16_f32 v36, v38, v39
  v_cvt_pk_bf16_f32 v37, v40, v41
  v_smfmac_f32_16x16x64_bf16 v[42:45], v[18:21], v[144:151], v122
  s_nop 0
  v_mfma_f32_16x16x32_bf16 v[38:41], v[50:53], v[34:37], 0
  v_mfma_f32_16x16x32_bf16 v[50:53], v[54:57], v[34:37], 0
  s_waitcnt lgkmcnt(6)
  v_smfmac_f32_16x16x64_bf16 v[42:45], v[26:29], v[66:73], v122
  s_waitcnt lgkmcnt(2)
  v_smfmac_f32_16x16x64_bf16 v[42:45], v[30:33], v[82:89], v122
  v_cndmask_b32 v38, v38, v50, vcc
  v_smfmac_f32_16x16x64_bf16 v[46:49], v[2:5], v[136:143], v122
  v_cndmask_b32 v39, v39, v51, vcc
  v_smfmac_f32_16x16x64_bf16 v[46:49], v[18:21], v[152:159], v122
  v_cvt_pk_bf16_f32 v98, v42, v43
  v_smfmac_f32_16x16x64_bf16 v[46:49], v[26:29], v[74:81], v122
  s_waitcnt lgkmcnt(0)
  v_cvt_pk_bf16_f32 v99, v44, v45
  v_smfmac_f32_16x16x64_bf16 v[46:49], v[30:33], v[90:97], v122
  v_cndmask_b32 v40, v40, v52, vcc
  v_mfma_f32_16x16x32_bf16 v[42:45], v[98:101], v[106:109], 0
  v_cndmask_b32 v41, v41, v53, vcc
  s_nop 1
  v_cvt_pk_bf16_f32 v100, v46, v47
  v_cvt_pk_bf16_f32 v101, v48, v49
  s_nop 1
  v_mfma_f32_16x16x32_bf16 v[46:49], v[100:103], v[106:109], 0
  v_cvt_pk_bf16_f32 v42, v42, v43
  v_cvt_pk_bf16_f32 v43, v44, v45
  v_smfmac_f32_16x16x64_bf16 v[58:61], v[2:5], a[128:135], v122
  ds_write_b128 v117, v[38:41] offset:8192
  s_nop 2
  v_cvt_pk_bf16_f32 v44, v46, v47
  v_cvt_pk_bf16_f32 v45, v48, v49
  s_nop 1
  v_mfma_f32_16x16x32_bf16 v[46:49], v[42:45], v[34:37], 0
  v_smfmac_f32_16x16x64_bf16 v[62:65], v[2:5], a[136:143], v122
  s_nop 3
  v_cndmask_b32 v46, v46, v48, vcc
  v_cndmask_b32 v47, v47, v49, vcc
  v_smfmac_f32_16x16x64_bf16 v[58:61], v[6:9], a[144:151], v122
  ds_write_b64 v119, v[46:47] offset:12288
  v_smfmac_f32_16x16x64_bf16 v[62:65], v[6:9], a[152:159], v122
  ds_read_b64 v[94:95], v120 offset:12288
  v_smfmac_f32_16x16x64_bf16 v[58:61], v[30:33], a[240:247], v122
  ds_read_b64 v[2:3], v117 offset:18440
  ds_read_b64 v[4:5], v117 offset:19456
  s_waitcnt vmcnt(3)
  buffer_load_dwordx4 v115, s[4:7], s83 offen offset:0 sc1 lds
  v_smfmac_f32_16x16x64_bf16 v[62:65], v[30:33], a[248:255], v122
  ds_read_b64 v[6:7], v117 offset:18432
  ds_read_b64 v[8:9], v117 offset:19464
  v_readfirstlane_b32 s84, v124
  v_smfmac_f32_16x16x64_bf16 v[58:61], v[10:13], a[160:167], v122
  s_waitcnt lgkmcnt(5)
  s_barrier
  v_smfmac_f32_16x16x64_bf16 v[62:65], v[10:13], a[168:175], v122
  ds_read_b128 v[50:53], v117 offset:9216
  ds_read_b128 v[54:57], v117 offset:10240
  v_cndmask_b32 v30, v42, v44, vcc
  v_smfmac_f32_16x16x64_bf16 v[58:61], v[14:17], a[176:183], v122
  ds_read_b128 v[86:89], v117 offset:11264
  ds_read_b64 v[96:97], v120 offset:12800
  v_cndmask_b32 v31, v43, v45, vcc
  v_smfmac_f32_16x16x64_bf16 v[62:65], v[14:17], a[184:191], v122
  ds_read_b64 v[90:91], v120 offset:13312
  ds_read_b64 v[92:93], v120 offset:13824
  v_mov_b64 v[10:11], 0
  v_smfmac_f32_16x16x64_bf16 v[58:61], v[18:21], a[192:199], v122
  ds_read_b128 v[66:69], v116 offset:32768
  buffer_load_dwordx4 v115, s[4:7], s83 offen offset:1024 sc1 lds
  v_mov_b64 v[12:13], 0
  v_smfmac_f32_16x16x64_bf16 v[62:65], v[18:21], a[200:207], v122
  ds_read_b128 v[70:73], v116 offset:33792
  s_xor_b32 s84, s84, 1
  v_mov_b64 v[14:15], 0
  v_smfmac_f32_16x16x64_bf16 v[58:61], v[22:25], a[208:215], v122
  ds_read_b128 v[74:77], v116 offset:34816
  v_mov_b64 v[16:17], 0
  v_smfmac_f32_16x16x64_bf16 v[62:65], v[22:25], a[216:223], v122
  s_waitcnt lgkmcnt(3)
  buffer_load_dwordx4 v115, s[4:7], s86 offen offset:2048 sc1 lds
  ds_read_b128 v[78:81], v116 offset:35840
  v_add_f32 v38, v38, v50
  v_add_f32 v39, v39, v51
  v_add_f32 v40, v40, v52
  v_add_f32 v41, v41, v53
  v_pk_add_f32 v[38:39], v[38:39], v[54:55]
  v_pk_add_f32 v[40:41], v[40:41], v[56:57]
  v_pk_add_f32 v[38:39], v[38:39], v[86:87]
  v_pk_add_f32 v[40:41], v[40:41], v[88:89]
  v_max3_f32 v125, v38, v39, v40
  v_max_f32 v125, v125, v41
  v_pk_add_f32 v[94:95], v[94:95], v[96:97]
  v_pk_add_f32 v[90:91], v[90:91], v[92:93]
  v_max_f32_dpp v125, v125, v125 row_ror:8 row_mask:0xf bank_mask:0xf
  v_pk_add_f32 v[94:95], v[94:95], v[90:91]
  v_max3_f32 v127, v125, v94, v95
  v_max3_f32 v125, v125, v94, v95
  v_smfmac_f32_16x16x64_bf16 v[58:61], v[26:29], a[224:231], v122
  buffer_load_dwordx4 v115, s[4:7], s86 offen offset:3072 sc1 lds
  v_permlane16_swap_b32 v125, v127
  v_max_f32 v126, v125, v127
  v_max_f32 v125, v125, v127
  v_smfmac_f32_16x16x64_bf16 v[62:65], v[26:29], a[232:239], v122
  ds_read_b128 v[82:85], v116 offset:49152
  v_permlane32_swap_b32 v125, v126
  v_max_f32 v125, v125, v126
  v_mul_f32 v126, s85, v125
  v_pk_fma_f32 v[38:39], v[38:39], s[90:91], v[126:127] op_sel_hi:[1,1,0] neg_lo:[0,0,1] neg_hi:[0,0,1]
  v_pk_fma_f32 v[40:41], v[40:41], s[90:91], v[126:127] op_sel_hi:[1,1,0] neg_lo:[0,0,1] neg_hi:[0,0,1]
  v_pk_fma_f32 v[94:95], v[94:95], s[90:91], v[126:127] op_sel_hi:[1,1,0] neg_lo:[0,0,1] neg_hi:[0,0,1]
  v_exp_f32 v38, v38
  v_exp_f32 v39, v39
  v_exp_f32 v40, v40
  v_exp_f32 v41, v41
  v_cvt_pk_bf16_f32 v42, v38, v39
  v_cvt_pk_bf16_f32 v43, v40, v41
  v_exp_f32 v94, v94
  v_mov_b32_dpp v50, v42 row_shl:8 row_mask:0xf bank_mask:0xf bound_ctrl:0
  v_mov_b32_dpp v51, v43 row_shl:8 row_mask:0xf bank_mask:0xf bound_ctrl:0
  v_mov_b32_dpp v52, v42 row_shr:8 row_mask:0xf bank_mask:0xf bound_ctrl:0
  v_mov_b32_dpp v53, v43 row_shr:8 row_mask:0xf bank_mask:0xf bound_ctrl:0
  v_exp_f32 v95, v95
  v_cndmask_b32_e64 v54, v42, 0, vcc
  v_mfma_f32_16x16x32_bf16 v[34:37], v[2:5], v[50:53], 0
  v_cndmask_b32_e64 v55, v43, 0, vcc
  v_cvt_pk_bf16_f32 v98, v58, v59
  v_cvt_pk_bf16_f32 v99, v60, v61
  v_cvt_pk_bf16_f32 v127, v94, v95
  v_cndmask_b32_e64 v44, v127, 0, vcc
  v_cndmask_b32_e64 v45, v127, 0, vcc
  v_cndmask_b32 v46, 0, v127, vcc
  v_cndmask_b32 v47, 0, v127, vcc
  v_mfma_f32_16x16x32_bf16 v[38:41], v[110:113], v[42:45], 0
  v_cvt_pk_bf16_f32 v100, v62, v63
  v_cvt_pk_bf16_f32 v101, v64, v65
  s_nop 1
  v_mfma_f32_16x16x32_bf16 v[34:37], v[98:101], v[44:47], v[34:37]
  ds_read_b128 v[86:89], v116 offset:50176
  v_cndmask_b32 v56, 0, v42, vcc
  v_cndmask_b32 v57, 0, v43, vcc
  v_mov_b64 v[18:19], 0
  v_mov_b64 v[20:21], 0
  v_mfma_f32_16x16x32_bf16 v[34:37], v[6:9], v[54:57], v[34:37]
  ds_read_b128 v[90:93], v116 offset:51200
  ds_read_b128 v[94:97], v116 offset:52224
  v_add_f32_dpp v125, v38, v38 row_ror:8 row_mask:0xf bank_mask:0xf
  v_rcp_f32 v125, v125
  v_mov_b64 v[22:23], 0
  v_mov_b64 v[24:25], 0
  s_nop 1
  v_pk_mul_f32 v[34:35], v[34:35], v[124:125] op_sel:[0,1] op_sel_hi:[1,1]
  v_pk_mul_f32 v[36:37], v[36:37], v[124:125] op_sel:[0,1] op_sel_hi:[1,1]
  v_cvt_pk_bf16_f32 v34, v34, v35
  v_cvt_pk_bf16_f32 v35, v36, v37
  s_add_u32 s81, s80, 0x0
  ds_write_b64 v119, v[34:35] offset:14336
  v_cndmask_b32_dpp v36, v34, v34, vcc row_ror:8 row_mask:0xf bank_mask:0xf
  v_cndmask_b32_dpp v37, v35, v35, vcc row_ror:8 row_mask:0xf bank_mask:0xf
  v_mov_b32_dpp v34, v34 row_shr:8 row_mask:0xf bank_mask:0xc
  v_mov_b32_dpp v35, v35 row_shr:8 row_mask:0xf bank_mask:0xc
  s_waitcnt lgkmcnt(1)
  s_nop 0
  v_smfmac_f32_16x16x64_bf16 v[10:13], v[34:37], v[160:167], v114
  v_smfmac_f32_16x16x64_bf16 v[14:17], v[34:37], v[168:175], v114
  s_waitcnt lgkmcnt(0)
  s_barrier
  ds_read_b128 v[38:41], v118 offset:14848
  ds_read_b128 v[42:45], v118 offset:15360
  ds_read_b128 v[46:49], v118 offset:15872
  v_smfmac_f32_16x16x64_bf16 v[18:21], v[34:37], v[176:183], v114
  v_smfmac_f32_16x16x64_bf16 v[22:25], v[34:37], v[184:191], v114
  s_waitcnt lgkmcnt(2)
  v_smfmac_f32_16x16x64_bf16 v[10:13], v[38:41], v[192:199], v114
  v_smfmac_f32_16x16x64_bf16 v[14:17], v[38:41], v[200:207], v114
  s_waitcnt lgkmcnt(1)
  v_smfmac_f32_16x16x64_bf16 v[10:13], v[42:45], v[224:231], v114
  v_smfmac_f32_16x16x64_bf16 v[14:17], v[42:45], v[232:239], v114
  s_waitcnt lgkmcnt(0)
  v_smfmac_f32_16x16x64_bf16 v[10:13], v[46:49], v[66:73], v114
  v_smfmac_f32_16x16x64_bf16 v[14:17], v[46:49], v[74:81], v114
  v_smfmac_f32_16x16x64_bf16 v[18:21], v[38:41], v[208:215], v114
  v_smfmac_f32_16x16x64_bf16 v[22:25], v[38:41], v[216:223], v114
  v_cvt_pk_bf16_f32 v10, v10, v11
  v_cvt_pk_bf16_f32 v11, v12, v13
  v_bfi_b32 v10, 1, s79, v10
  v_smfmac_f32_16x16x64_bf16 v[18:21], v[42:45], v[240:247], v114
  v_cvt_pk_bf16_f32 v12, v14, v15
  v_cvt_pk_bf16_f32 v13, v16, v17
  v_smfmac_f32_16x16x64_bf16 v[22:25], v[42:45], v[248:255], v114
  buffer_store_dwordx4 v[10:13], v121, s[4:7], s76 offen
  v_smfmac_f32_16x16x64_bf16 v[18:21], v[46:49], v[82:89], v114
  v_smfmac_f32_16x16x64_bf16 v[22:25], v[46:49], v[90:97], v114
  s_nop 3
  v_cvt_pk_bf16_f32 v18, v18, v19
  v_cvt_pk_bf16_f32 v19, v20, v21
  v_bfi_b32 v18, 1, s79, v18
  s_nop 0
  v_cvt_pk_bf16_f32 v20, v22, v23
  v_cvt_pk_bf16_f32 v21, v24, v25
  buffer_store_dwordx4 v[18:21], v121, s[4:7], s77 offen
  v_mov_b64 v[34:35], 0
  v_mov_b64 v[36:37], 0
  v_mov_b64 v[38:39], 0
  v_mov_b64 v[40:41], 0
  v_mov_b64 v[42:43], 0
  v_mov_b64 v[44:45], 0
  v_mov_b64 v[46:47], 0
  v_mov_b64 v[48:49], 0
  v_mov_b64 v[58:59], 0
  v_mov_b64 v[60:61], 0
  v_mov_b64 v[62:63], 0
  v_mov_b64 v[64:65], 0
  ds_read_b128 v[66:69], v115 offset:0
  ds_read_b128 v[70:73], v115 offset:1024
  ds_read_b128 v[74:77], v115 offset:2048
  ds_read_b128 v[78:81], v115 offset:3072
  ds_read_b128 v[82:85], v115 offset:16384
  ds_read_b128 v[86:89], v115 offset:17408
  ds_read_b128 v[90:93], v115 offset:18432
  ds_read_b128 v[94:97], v115 offset:19456
  s_waitcnt vmcnt(0)
  buffer_load_dwordx4 v[2:5], v115, s[4:7], s78 offen offset:0 sc1
  buffer_load_dwordx4 v[6:9], v115, s[4:7], s78 offen offset:1024 sc1
  s_add_u32 s70, s70, 1
  s_add_u32 s82, s82, 2048
  s_add_u32 s80, s80, 0x40000
  s_xor_b32 s76, s76, 0x40000
  s_sub_u32 s73, s74, s88
  s_add_u32 s73, s73, 0
c00_rpoll:
  s_waitcnt vmcnt(0)
  v_mfma_f32_16x16x32_bf16 v[18:21], v[2:5], v[102:105], 0
  v_mfma_f32_16x16x32_bf16 v[18:21], v[6:9], v[102:105], v[18:21]
  v_bitop3_b32 v125, v2, v6, s79 bitop3:0x7e
  v_and_b32 v125, 1, v125
  v_cmp_ne_u32 vcc, 0, v125
  s_cbranch_vccz c00_rpoll_ok
  s_mov_b64 exec, vcc
  buffer_load_dwordx4 v[2:5], v115, s[4:7], s78 offen offset:0 sc1
  buffer_load_dwordx4 v[6:9], v115, s[4:7], s78 offen offset:1024 sc1
  s_sub_u32 s51, s51, 1
  s_cbranch_scc0 c00_rpoll
  s_endpgm
c00_rpoll_ok:
  s_mov_b64 exec, -1
  s_nop 1
  v_permlane32_swap_b32 v18, v20
  v_permlane32_swap_b32 v19, v21
  v_add_f32 v18, v18, v20
  v_add_f32 v19, v19, v21
  s_nop 1
  v_permlane16_swap_b32 v18, v19
  v_add_f32 v18, v18, v19
  s_nop 1
  v_mov_b32_dpp v19, v18 row_shl:4 row_mask:0xf bank_mask:0xf
  v_cvt_pk_bf16_f32 v18, v18, v19
  v_min_u32 v18, -2, v18
  buffer_store_dword v18, v123, s[4:7], s74 offen
  s_xor_b32 s78, s78, 0x40000
  s_cmp_eq_u32 s70, 63
  s_cbranch_scc1 c00_last
  s_lshr_b32 s79, s70, 1
  s_add_u32 s77, s76, 0x8000
  s_add_u32 s86, s70, 1
  s_and_b32 s86, s86, 3
  s_lshl_b32 s86, s86, 13
  s_add_u32 s86, s86, s89
  s_add_u32 s74, s86, s88
  s_xor_b32 s75, s74, 0x4000
  s_cmp_eq_u32 s84, 0
  s_cbranch_scc1 c00_have
c00_kpoll:
  s_sub_u32 s51, s51, 1
  s_cbranch_scc1 main_end
  buffer_load_dword v124, off, s[4:7], s82 sc1
  s_waitcnt vmcnt(0)
  v_readfirstlane_b32 s87, v124
  s_cmp_eq_u32 s87, 0
  s_cbranch_scc1 c00_kpoll
  s_mov_b32 m0, 0x24000
  s_nop 0
  buffer_load_dwordx4 v115, s[4:7], s83 offen offset:0 sc1 lds
  buffer_load_dwordx4 v115, s[4:7], s83 offen offset:1024 sc1 lds
  s_add_u32 s86, s83, 0x1fff800
  buffer_load_dwordx4 v115, s[4:7], s86 offen offset:2048 sc1 lds
  buffer_load_dwordx4 v115, s[4:7], s86 offen offset:3072 sc1 lds
  buffer_load_dwordx4 v[2:5], v115, s[4:7], s73 offen offset:0 sc1
  buffer_load_dwordx4 v[6:9], v115, s[4:7], s73 offen offset:1024 sc1
  s_add_u32 s87, s81, 0xfffe0400
  s_waitcnt vmcnt(2)
  ds_read_b128 v[50:53], v117 offset:16384
  ds_read_b128 v[54:57], v117 offset:17408
  s_waitcnt lgkmcnt(0)
  s_branch c00_poll0
  s_waitcnt vmcnt(0)
c00_have:
  ds_read_b128 v[50:53], v117 offset:16384
  ds_read_b128 v[54:57], v117 offset:17408
  s_waitcnt vmcnt(0)
  buffer_load_dwordx4 v[2:5], v115, s[4:7], s73 offen offset:0 sc1
  buffer_load_dwordx4 v[6:9], v115, s[4:7], s73 offen offset:1024 sc1
  s_add_u32 s87, s81, 0xfffe0400
  s_waitcnt lgkmcnt(0)
  s_branch c00_poll0
c00_last:
  s_waitcnt vmcnt(0)
  buffer_load_dwordx4 v[2:5], v115, s[4:7], s73 offen offset:0 sc1
  buffer_load_dwordx4 v[6:9], v115, s[4:7], s73 offen offset:1024 sc1
  s_add_u32 s87, s81, 0xfffe0400
  s_waitcnt lgkmcnt(0)
c00_lpoll:
  s_waitcnt vmcnt(0)
  ds_write_b128 v117, v[2:5] offset:0
  ds_write_b128 v117, v[6:9] offset:1024
  v_max3_u32 v125, v2, v3, v4
  v_max3_u32 v126, v5, v6, v7
  v_max3_u32 v125, v125, v8, v9
  v_max_u32 v125, v125, v126
  v_cmp_eq_u32 vcc, -1, v125
  s_cbranch_vccz c00_lpoll_ok
  s_mov_b64 exec, vcc
  buffer_load_dwordx4 v[2:5], v115, s[4:7], s73 offen offset:0 sc1
  buffer_load_dwordx4 v[6:9], v115, s[4:7], s73 offen offset:1024 sc1
  s_sub_u32 s51, s51, 1
  s_cbranch_scc0 c00_lpoll
  s_endpgm
c00_lpoll_ok:
  s_mov_b64 exec, -1
  buffer_store_dwordx2 v[30:31], v119, s[4:7], s87 offen sc1
  buffer_store_dwordx4 v[98:101], v115, s[4:7], s81 offen sc1
  s_add_u32 s81, s80, 0x0
  s_mov_b64 vcc, s[92:93]
  v_smfmac_f32_16x16x64_bf16 v[58:61], v[2:5], a[128:135], v122
  v_smfmac_f32_16x16x64_bf16 v[62:65], v[2:5], a[136:143], v122
  s_waitcnt lgkmcnt(0)
  s_barrier
  ds_read_b128 v[30:33], v117 offset:7168
  ds_read_b128 v[10:13], v117 offset:2048
  ds_read_b128 v[14:17], v117 offset:3072
  ds_read_b128 v[22:25], v117 offset:5120
  ds_read_b128 v[18:21], v117 offset:4096
  ds_read_b128 v[26:29], v117 offset:6144
  v_smfmac_f32_16x16x64_bf16 v[58:61], v[6:9], a[144:151], v122
  v_smfmac_f32_16x16x64_bf16 v[62:65], v[6:9], a[152:159], v122
  v_smfmac_f32_16x16x64_bf16 v[42:45], v[6:9], v[66:73], v122
  ds_read_b128 v[66:69], v115 offset:32768
  ds_read_b128 v[70:73], v115 offset:33792
  v_smfmac_f32_16x16x64_bf16 v[46:49], v[6:9], v[74:81], v122
  ds_read_b128 v[74:77], v115 offset:34816
  ds_read_b128 v[78:81], v115 offset:35840
  s_waitcnt lgkmcnt(9)
  v_smfmac_f32_16x16x64_bf16 v[58:61], v[30:33], a[240:247], v122
  v_smfmac_f32_16x16x64_bf16 v[62:65], v[30:33], a[248:255], v122
  s_waitcnt lgkmcnt(8)
  v_smfmac_f32_16x16x64_bf16 v[42:45], v[10:13], v[82:89], v122
  ds_read_b128 v[82:85], v115 offset:49152
  ds_read_b128 v[86:89], v115 offset:50176
  v_smfmac_f32_16x16x64_bf16 v[46:49], v[10:13], v[90:97], v122
  ds_read_b128 v[90:93], v115 offset:51200
  ds_read_b128 v[94:97], v115 offset:52224
  v_smfmac_f32_16x16x64_bf16 v[58:61], v[10:13], a[160:167], v122
  v_smfmac_f32_16x16x64_bf16 v[62:65], v[10:13], a[168:175], v122
  s_waitcnt lgkmcnt(6)
  v_smfmac_f32_16x16x64_bf16 v[42:45], v[14:17], v[66:73], v122
  ds_read_b128 v[66:69], v116 offset:0
  ds_read_b128 v[70:73], v116 offset:1024
  s_waitcnt lgkmcnt(6)
  v_smfmac_f32_16x16x64_bf16 v[46:49], v[14:17], v[74:81], v122
  ds_read_b128 v[74:77], v116 offset:2048
  ds_read_b128 v[78:81], v116 offset:3072
  v_smfmac_f32_16x16x64_bf16 v[58:61], v[14:17], a[176:183], v122
  v_smfmac_f32_16x16x64_bf16 v[62:65], v[14:17], a[184:191], v122
  s_waitcnt lgkmcnt(6)
  v_smfmac_f32_16x16x64_bf16 v[42:45], v[22:25], v[82:89], v122
  ds_read_b128 v[82:85], v116 offset:16384
  ds_read_b128 v[86:89], v116 offset:17408
  s_waitcnt lgkmcnt(6)
  v_smfmac_f32_16x16x64_bf16 v[46:49], v[22:25], v[90:97], v122
  ds_read_b128 v[90:93], v116 offset:18432
  ds_read_b128 v[94:97], v116 offset:19456
  v_smfmac_f32_16x16x64_bf16 v[58:61], v[18:21], a[192:199], v122
  v_smfmac_f32_16x16x64_bf16 v[62:65], v[18:21], a[200:207], v122
  v_smfmac_f32_16x16x64_bf16 v[42:45], v[2:5], v[128:135], v122
  v_smfmac_f32_16x16x64_bf16 v[46:49], v[2:5], v[136:143], v122
  v_smfmac_f32_16x16x64_bf16 v[42:45], v[18:21], v[144:151], v122
  v_smfmac_f32_16x16x64_bf16 v[46:49], v[18:21], v[152:159], v122
  s_waitcnt lgkmcnt(6)
  v_smfmac_f32_16x16x64_bf16 v[42:45], v[26:29], v[66:73], v122
  s_waitcnt lgkmcnt(4)
  v_smfmac_f32_16x16x64_bf16 v[46:49], v[26:29], v[74:81], v122
  v_smfmac_f32_16x16x64_bf16 v[58:61], v[22:25], a[208:215], v122
  v_smfmac_f32_16x16x64_bf16 v[62:65], v[22:25], a[216:223], v122
  s_waitcnt lgkmcnt(2)
  v_smfmac_f32_16x16x64_bf16 v[42:45], v[30:33], v[82:89], v122
  s_waitcnt lgkmcnt(0)
  v_smfmac_f32_16x16x64_bf16 v[46:49], v[30:33], v[90:97], v122
  v_smfmac_f32_16x16x64_bf16 v[58:61], v[26:29], a[224:231], v122
  v_smfmac_f32_16x16x64_bf16 v[62:65], v[26:29], a[232:239], v122
  v_cvt_pk_bf16_f32 v98, v42, v43
  v_cvt_pk_bf16_f32 v99, v44, v45
  v_cvt_pk_bf16_f32 v100, v46, v47
  v_cvt_pk_bf16_f32 v101, v48, v49
  s_nop 1
  v_mfma_f32_16x16x32_bf16 v[42:45], v[98:101], v[106:109], 0
  v_mfma_f32_16x16x32_bf16 v[46:49], v[100:103], v[106:109], 0
  s_add_u32 s87, s81, 0xfffe0400
  s_nop 2
  v_cvt_pk_bf16_f32 v42, v42, v43
  v_cvt_pk_bf16_f32 v43, v44, v45
  s_nop 1
  v_cvt_pk_bf16_f32 v44, v46, v47
  v_cvt_pk_bf16_f32 v45, v48, v49
  v_cndmask_b32 v30, v42, v44, vcc
  v_cndmask_b32 v31, v43, v45, vcc
  s_cmp_eq_u32 s84, 0
  s_cbranch_scc1 c00_lgo
c00_lfl:
  s_sub_u32 s51, s51, 1
  s_cbranch_scc1 main_end
  buffer_load_dword v124, off, s[4:7], s82 sc1
  s_waitcnt vmcnt(0)
  v_readfirstlane_b32 s86, v124
  s_cmp_eq_u32 s86, 0
  s_cbranch_scc1 c00_lfl
c00_lgo:
  buffer_store_dwordx2 v[30:31], v119, s[4:7], s87 offen sc1
  v_cvt_pk_bf16_f32 v98, v58, v59
  v_cvt_pk_bf16_f32 v99, v60, v61
  v_cvt_pk_bf16_f32 v100, v62, v63
  v_cvt_pk_bf16_f32 v101, v64, v65
  buffer_store_dwordx4 v[98:101], v115, s[4:7], s81 offen sc1
  s_endpgm
c00_tail:
  s_mov_b32 s72, s52
  ds_read_b128 v[66:69], v115 offset:0
  ds_read_b128 v[70:73], v115 offset:1024
  ds_read_b128 v[74:77], v115 offset:2048
  ds_read_b128 v[78:81], v115 offset:3072
  ds_read_b128 v[82:85], v115 offset:16384
  ds_read_b128 v[86:89], v115 offset:17408
  ds_read_b128 v[90:93], v115 offset:18432
  ds_read_b128 v[94:97], v115 offset:19456
  s_add_u32 s73, s89, 0
  s_lshr_b32 s79, s70, 1
  s_add_u32 s77, s76, 0x8000
  s_add_u32 s86, s70, 1
  s_and_b32 s86, s86, 3
  s_lshl_b32 s86, s86, 13
  s_add_u32 s86, s86, s89
  s_add_u32 s74, s86, s88
  s_xor_b32 s75, s74, 0x4000
  s_cmp_eq_u32 s94, 0
  s_cbranch_scc1 c00_kpoll
  s_waitcnt vmcnt(0)
  ds_read_b128 v[50:53], v117 offset:16384
  ds_read_b128 v[54:57], v117 offset:17408
  v_mov_b64 v[2:3], v[12:13]
  v_mov_b64 v[4:5], v[14:15]
  v_mov_b64 v[6:7], v[16:17]
  v_mov_b64 v[8:9], v[18:19]
  s_add_u32 s87, s81, 0xfffe0400
  s_waitcnt lgkmcnt(0)
  s_branch c00_poll0
c10_entry:
  s_branch c10_tail
c10_poll0:
c10_poll:
  s_waitcnt vmcnt(0)
  ds_write_b128 v117, v[2:5] offset:2048
  ds_write_b128 v117, v[6:9] offset:3072
  v_max3_u32 v125, v2, v3, v4
  v_max3_u32 v126, v5, v6, v7
  v_max3_u32 v125, v125, v8, v9
  v_max_u32 v125, v125, v126
  v_cmp_eq_u32 vcc, -1, v125
  s_cbranch_vccz c10_poll_ok
  s_mov_b64 exec, vcc
  buffer_load_dwordx4 v[2:5], v115, s[4:7], s73 offen offset:0 sc1
  buffer_load_dwordx4 v[6:9], v115, s[4:7], s73 offen offset:1024 sc1
  s_sub_u32 s51, s51, 1
  s_cbranch_scc0 c10_poll
  s_endpgm
c10_poll_ok:
  s_mov_b64 exec, -1
  v_smfmac_f32_16x16x64_bf16 v[42:45], v[2:5], v[66:73], v122
  v_smfmac_f32_16x16x64_bf16 v[46:49], v[2:5], v[74:81], v122
  s_waitcnt lgkmcnt(0)
  s_barrier
  buffer_load_dword v124, off, s[4:7], s82 offset:2048 sc1
  v_smfmac_f32_16x16x64_bf16 v[42:45], v[6:9], v[82:89], v122
  ds_read_b128 v[10:13], v117 offset:4096
  v_smfmac_f32_16x16x64_bf16 v[46:49], v[6:9], v[90:97], v122
  buffer_store_dwordx2 v[30:31], v119, s[4:7], s87 offen sc1
  ds_read_b128 v[14:17], v117 offset:5120
  v_smfmac_f32_16x16x64_bf16 v[34:37], v[2:5], a[32:39], v122
  ds_read_b128 v[18:21], v117 offset:6144
  v_smfmac_f32_16x16x64_bf16 v[38:41], v[2:5], a[40:47], v122
  ds_read_b128 v[22:25], v117 offset:7168
  v_smfmac_f32_16x16x64_bf16 v[34:37], v[6:9], a[48:55], v122
  ds_read_b128 v[26:29], v117 offset:0
  v_smfmac_f32_16x16x64_bf16 v[38:41], v[6:9], a[56:63], v122
  ds_read_b128 v[30:33], v117 offset:1024
  s_waitcnt lgkmcnt(5)
  v_smfmac_f32_16x16x64_bf16 v[34:37], v[10:13], a[64:71], v122
  buffer_store_dwordx4 v[98:101], v115, s[4:7], s81 offen sc1
  ds_read_b128 v[66:69], v115 offset:53248
  v_smfmac_f32_16x16x64_bf16 v[38:41], v[10:13], a[72:79], v122
  ds_read_b128 v[70:73], v115 offset:54272
  s_waitcnt lgkmcnt(6)
  v_smfmac_f32_16x16x64_bf16 v[34:37], v[14:17], a[80:87], v122
  ds_read_b128 v[74:77], v115 offset:55296
  v_smfmac_f32_16x16x64_bf16 v[38:41], v[14:17], a[88:95], v122
  ds_read_b128 v[78:81], v115 offset:56320
  s_waitcnt lgkmcnt(7)
  v_mov_b32 v126, -1
  v_smfmac_f32_16x16x64_bf16 v[34:37], v[18:21], a[96:103], v122
  buffer_store_dword v126, v123, s[4:7], s75 offen
  ds_read_b128 v[82:85], v116 offset:4096
  v_smfmac_f32_16x16x64_bf16 v[38:41], v[18:21], a[104:111], v122
  ds_read_b128 v[86:89], v116 offset:5120
  s_waitcnt lgkmcnt(8)
  v_smfmac_f32_16x16x64_bf16 v[34:37], v[22:25], a[112:119], v122
  ds_read_b128 v[90:93], v116 offset:6144
  v_smfmac_f32_16x16x64_bf16 v[38:41], v[22:25], a[120:127], v122
  s_add_u32 s83, s83, 0x40000
  ds_read_b128 v[94:97], v116 offset:7168
  s_waitcnt lgkmcnt(9)
  v_smfmac_f32_16x16x64_bf16 v[34:37], v[26:29], a[0:7], v122
  s_mov_b32 m0, 0x25000
  s_add_u32 s86, s83, 0x1fff800
  v_smfmac_f32_16x16x64_bf16 v[38:41], v[26:29], a[8:15], v122
  s_mov_b64 vcc, s[92:93]
  s_waitcnt lgkmcnt(8)
  v_smfmac_f32_16x16x64_bf16 v[34:37], v[30:33], a[16:23], v122
  v_smfmac_f32_16x16x64_bf16 v[38:41], v[30:33], a[24:31], v122
  s_waitcnt lgkmcnt(6)
  v_smfmac_f32_16x16x64_bf16 v[42:45], v[14:17], v[66:73], v122
  ds_read_b128 v[66:69], v116 offset:20480
  s_waitcnt lgkmcnt(5)
  v_cvt_pk_bf16_f32 v98, v34, v35
  v_cvt_pk_bf16_f32 v99, v36, v37
  v_smfmac_f32_16x16x64_bf16 v[46:49], v[14:17], v[74:81], v122
  ds_read_b128 v[70:73], v116 offset:21504
  v_mfma_f32_16x16x32_bf16 v[34:37], v[98:101], v[106:109], 0
  ds_read_b128 v[74:77], v116 offset:22528
  s_waitcnt lgkmcnt(5)
  v_cvt_pk_bf16_f32 v100, v38, v39
  v_cvt_pk_bf16_f32 v101, v40, v41
  v_smfmac_f32_16x16x64_bf16 v[42:45], v[18:21], v[82:89], v122
  ds_read_b128 v[78:81], v116 offset:23552
  v_mfma_f32_16x16x32_bf16 v[38:41], v[100:103], v[106:109], 0
  ds_read_b128 v[82:85], v115 offset:4096
  s_waitcnt lgkmcnt(5)
  v_cvt_pk_bf16_f32 v34, v34, v35
  v_cvt_pk_bf16_f32 v35, v36, v37
  v_smfmac_f32_16x16x64_bf16 v[46:49], v[18:21], v[90:97], v122
  ds_read_b128 v[86:89], v115 offset:5120
  v_smfmac_f32_16x16x64_bf16 v[42:45], v[10:13], v[144:151], v122
  ds_read_b128 v[90:93], v115 offset:6144
  ds_read_b128 v[94:97], v115 offset:7168
  v_cvt_pk_bf16_f32 v36, v38, v39
  v_cvt_pk_bf16_f32 v37, v40, v41
  v_smfmac_f32_16x16x64_bf16 v[42:45], v[26:29], v[128:135], v122
  s_nop 0
  v_mfma_f32_16x16x32_bf16 v[38:41], v[50:53], v[34:37], 0
  v_mfma_f32_16x16x32_bf16 v[50:53], v[54:57], v[34:37], 0
  s_waitcnt lgkmcnt(6)
  v_smfmac_f32_16x16x64_bf16 v[42:45], v[22:25], v[66:73], v122
  s_waitcnt lgkmcnt(2)
  v_smfmac_f32_16x16x64_bf16 v[42:45], v[30:33], v[82:89], v122
  v_cndmask_b32 v38, v38, v50, vcc
  v_smfmac_f32_16x16x64_bf16 v[46:49], v[10:13], v[152:159], v122
  v_cndmask_b32 v39, v39, v51, vcc
  v_smfmac_f32_16x16x64_bf16 v[46:49], v[26:29], v[136:143], v122
  v_cvt_pk_bf16_f32 v98, v42, v43
  v_smfmac_f32_16x16x64_bf16 v[46:49], v[22:25], v[74:81], v122
  s_waitcnt lgkmcnt(0)
  v_cvt_pk_bf16_f32 v99, v44, v45
  v_smfmac_f32_16x16x64_bf16 v[46:49], v[30:33], v[90:97], v122
  v_cndmask_b32 v40, v40, v52, vcc
  v_mfma_f32_16x16x32_bf16 v[42:45], v[98:101], v[106:109], 0
  v_cndmask_b32 v41, v41, v53, vcc
  s_nop 1
  v_cvt_pk_bf16_f32 v100, v46, v47
  v_cvt_pk_bf16_f32 v101, v48, v49
  s_nop 1
  v_mfma_f32_16x16x32_bf16 v[46:49], v[100:103], v[106:109], 0
  v_cvt_pk_bf16_f32 v42, v42, v43
  v_cvt_pk_bf16_f32 v43, v44, v45
  v_smfmac_f32_16x16x64_bf16 v[58:61], v[2:5], a[160:167], v122
  ds_write_b128 v117, v[38:41] offset:9216
  s_nop 2
  v_cvt_pk_bf16_f32 v44, v46, v47
  v_cvt_pk_bf16_f32 v45, v48, v49
  s_nop 1
  v_mfma_f32_16x16x32_bf16 v[46:49], v[42:45], v[34:37], 0
  v_smfmac_f32_16x16x64_bf16 v[62:65], v[2:5], a[168:175], v122
  s_nop 3
  v_cndmask_b32 v46, v46, v48, vcc
  v_cndmask_b32 v47, v47, v49, vcc
  v_smfmac_f32_16x16x64_bf16 v[58:61], v[6:9], a[176:183], v122
  ds_write_b64 v119, v[46:47] offset:12800
  v_smfmac_f32_16x16x64_bf16 v[62:65], v[6:9], a[184:191], v122
  ds_read_b64 v[94:95], v120 offset:12800
  v_smfmac_f32_16x16x64_bf16 v[58:61], v[30:33], a[144:151], v122
  ds_read_b64 v[2:3], v117 offset:22536
  ds_read_b64 v[4:5], v117 offset:23552
  s_waitcnt vmcnt(3)
  buffer_load_dwordx4 v115, s[4:7], s83 offen offset:0 sc1 lds
  v_smfmac_f32_16x16x64_bf16 v[62:65], v[30:33], a[152:159], v122
  ds_read_b64 v[6:7], v117 offset:22528
  ds_read_b64 v[8:9], v117 offset:23560
  v_readfirstlane_b32 s84, v124
  v_smfmac_f32_16x16x64_bf16 v[58:61], v[10:13], a[192:199], v122
  s_waitcnt lgkmcnt(5)
  s_barrier
  v_smfmac_f32_16x16x64_bf16 v[62:65], v[10:13], a[200:207], v122
  ds_read_b128 v[50:53], v117 offset:10240
  ds_read_b128 v[54:57], v117 offset:11264
  v_cndmask_b32 v30, v42, v44, vcc
  v_smfmac_f32_16x16x64_bf16 v[58:61], v[14:17], a[208:215], v122
  ds_read_b128 v[86:89], v117 offset:8192
  ds_read_b64 v[96:97], v120 offset:13312
  v_cndmask_b32 v31, v43, v45, vcc
  v_smfmac_f32_16x16x64_bf16 v[62:65], v[14:17], a[216:223], v122
  ds_read_b64 v[90:91], v120 offset:13824
  ds_read_b64 v[92:93], v120 offset:12288
  v_mov_b64 v[10:11], 0
  v_smfmac_f32_16x16x64_bf16 v[58:61], v[18:21], a[224:231], v122
  ds_read_b128 v[66:69], v116 offset:36864
  buffer_load_dwordx4 v115, s[4:7], s83 offen offset:1024 sc1 lds
  v_mov_b64 v[12:13], 0
  v_smfmac_f32_16x16x64_bf16 v[62:65], v[18:21], a[232:239], v122
  ds_read_b128 v[70:73], v116 offset:37888
  s_xor_b32 s84, s84, 1
  v_mov_b64 v[14:15], 0
  v_smfmac_f32_16x16x64_bf16 v[58:61], v[22:25], a[240:247], v122
  ds_read_b128 v[74:77], v116 offset:38912
  v_mov_b64 v[16:17], 0
  v_smfmac_f32_16x16x64_bf16 v[62:65], v[22:25], a[248:255], v122
  s_waitcnt lgkmcnt(3)
  buffer_load_dwordx4 v115, s[4:7], s86 offen offset:2048 sc1 lds
  ds_read_b128 v[78:81], v116 offset:39936
  v_add_f32 v38, v38, v50
  v_add_f32 v39, v39, v51
  v_add_f32 v40, v40, v52
  v_add_f32 v41, v41, v53
  v_pk_add_f32 v[38:39], v[38:39], v[54:55]
  v_pk_add_f32 v[40:41], v[40:41], v[56:57]
  v_pk_add_f32 v[38:39], v[38:39], v[86:87]
  v_pk_add_f32 v[40:41], v[40:41], v[88:89]
  v_max3_f32 v125, v38, v39, v40
  v_max_f32 v125, v125, v41
  v_pk_add_f32 v[94:95], v[94:95], v[96:97]
  v_pk_add_f32 v[90:91], v[90:91], v[92:93]
  v_max_f32_dpp v125, v125, v125 row_ror:8 row_mask:0xf bank_mask:0xf
  v_pk_add_f32 v[94:95], v[94:95], v[90:91]
  v_max3_f32 v127, v125, v94, v95
  v_max3_f32 v125, v125, v94, v95
  v_smfmac_f32_16x16x64_bf16 v[58:61], v[26:29], a[128:135], v122
  buffer_load_dwordx4 v115, s[4:7], s86 offen offset:3072 sc1 lds
  v_permlane16_swap_b32 v125, v127
  v_max_f32 v126, v125, v127
  v_max_f32 v125, v125, v127
  v_smfmac_f32_16x16x64_bf16 v[62:65], v[26:29], a[136:143], v122
  ds_read_b128 v[82:85], v116 offset:53248
  v_permlane32_swap_b32 v125, v126
  v_max_f32 v125, v125, v126
  v_mul_f32 v126, s85, v125
  v_pk_fma_f32 v[38:39], v[38:39], s[90:91], v[126:127] op_sel_hi:[1,1,0] neg_lo:[0,0,1] neg_hi:[0,0,1]
  v_pk_fma_f32 v[40:41], v[40:41], s[90:91], v[126:127] op_sel_hi:[1,1,0] neg_lo:[0,0,1] neg_hi:[0,0,1]
  v_pk_fma_f32 v[94:95], v[94:95], s[90:91], v[126:127] op_sel_hi:[1,1,0] neg_lo:[0,0,1] neg_hi:[0,0,1]
  v_exp_f32 v38, v38
  v_exp_f32 v39, v39
  v_exp_f32 v40, v40
  v_exp_f32 v41, v41
  v_cvt_pk_bf16_f32 v42, v38, v39
  v_cvt_pk_bf16_f32 v43, v40, v41
  v_exp_f32 v94, v94
  v_mov_b32_dpp v50, v42 row_shl:8 row_mask:0xf bank_mask:0xf bound_ctrl:0
  v_mov_b32_dpp v51, v43 row_shl:8 row_mask:0xf bank_mask:0xf bound_ctrl:0
  v_mov_b32_dpp v52, v42 row_shr:8 row_mask:0xf bank_mask:0xf bound_ctrl:0
  v_mov_b32_dpp v53, v43 row_shr:8 row_mask:0xf bank_mask:0xf bound_ctrl:0
  v_exp_f32 v95, v95
  v_cndmask_b32_e64 v54, v42, 0, vcc
  v_mfma_f32_16x16x32_bf16 v[34:37], v[2:5], v[50:53], 0
  v_cndmask_b32_e64 v55, v43, 0, vcc
  v_cvt_pk_bf16_f32 v98, v58, v59
  v_cvt_pk_bf16_f32 v99, v60, v61
  v_cvt_pk_bf16_f32 v127, v94, v95
  v_cndmask_b32_e64 v44, v127, 0, vcc
  v_cndmask_b32_e64 v45, v127, 0, vcc
  v_cndmask_b32 v46, 0, v127, vcc
  v_cndmask_b32 v47, 0, v127, vcc
  v_mfma_f32_16x16x32_bf16 v[38:41], v[110:113], v[42:45], 0
  v_cvt_pk_bf16_f32 v100, v62, v63
  v_cvt_pk_bf16_f32 v101, v64, v65
  s_nop 1
  v_mfma_f32_16x16x32_bf16 v[34:37], v[98:101], v[44:47], v[34:37]
  ds_read_b128 v[86:89], v116 offset:54272
  v_cndmask_b32 v56, 0, v42, vcc
  v_cndmask_b32 v57, 0, v43, vcc
  v_mov_b64 v[18:19], 0
  v_mov_b64 v[20:21], 0
  v_mfma_f32_16x16x32_bf16 v[34:37], v[6:9], v[54:57], v[34:37]
  ds_read_b128 v[90:93], v116 offset:55296
  ds_read_b128 v[94:97], v116 offset:56320
  v_add_f32_dpp v125, v38, v38 row_ror:8 row_mask:0xf bank_mask:0xf
  v_rcp_f32 v125, v125
  v_mov_b64 v[22:23], 0
  v_mov_b64 v[24:25], 0
  s_nop 1
  v_pk_mul_f32 v[34:35], v[34:35], v[124:125] op_sel:[0,1] op_sel_hi:[1,1]
  v_pk_mul_f32 v[36:37], v[36:37], v[124:125] op_sel:[0,1] op_sel_hi:[1,1]
  v_cvt_pk_bf16_f32 v34, v34, v35
  v_cvt_pk_bf16_f32 v35, v36, v37
  s_add_u32 s81, s80, 0x800
  ds_write_b64 v119, v[34:35] offset:14848
  v_cndmask_b32_dpp v36, v34, v34, vcc row_ror:8 row_mask:0xf bank_mask:0xf
  v_cndmask_b32_dpp v37, v35, v35, vcc row_ror:8 row_mask:0xf bank_mask:0xf
  v_mov_b32_dpp v34, v34 row_shr:8 row_mask:0xf bank_mask:0xc
  v_mov_b32_dpp v35, v35 row_shr:8 row_mask:0xf bank_mask:0xc
  s_waitcnt lgkmcnt(1)
  s_nop 0
  v_smfmac_f32_16x16x64_bf16 v[10:13], v[34:37], v[192:199], v114
  v_smfmac_f32_16x16x64_bf16 v[14:17], v[34:37], v[200:207], v114
  s_waitcnt lgkmcnt(0)
  s_barrier
  ds_read_b128 v[38:41], v118 offset:15360
  ds_read_b128 v[42:45], v118 offset:15872
  ds_read_b128 v[46:49], v118 offset:14336
  v_smfmac_f32_16x16x64_bf16 v[18:21], v[34:37], v[208:215], v114
  v_smfmac_f32_16x16x64_bf16 v[22:25], v[34:37], v[216:223], v114
  s_waitcnt lgkmcnt(2)
  v_smfmac_f32_16x16x64_bf16 v[10:13], v[38:41], v[224:231], v114
  v_smfmac_f32_16x16x64_bf16 v[14:17], v[38:41], v[232:239], v114
  s_waitcnt lgkmcnt(1)
  v_smfmac_f32_16x16x64_bf16 v[10:13], v[42:45], v[66:73], v114
  v_smfmac_f32_16x16x64_bf16 v[14:17], v[42:45], v[74:81], v114
  s_waitcnt lgkmcnt(0)
  v_smfmac_f32_16x16x64_bf16 v[10:13], v[46:49], v[160:167], v114
  v_smfmac_f32_16x16x64_bf16 v[14:17], v[46:49], v[168:175], v114
  v_smfmac_f32_16x16x64_bf16 v[18:21], v[38:41], v[240:247], v114
  v_smfmac_f32_16x16x64_bf16 v[22:25], v[38:41], v[248:255], v114
  v_cvt_pk_bf16_f32 v10, v10, v11
  v_cvt_pk_bf16_f32 v11, v12, v13
  v_bfi_b32 v10, 1, s79, v10
  v_smfmac_f32_16x16x64_bf16 v[18:21], v[42:45], v[82:89], v114
  v_cvt_pk_bf16_f32 v12, v14, v15
  v_cvt_pk_bf16_f32 v13, v16, v17
  v_smfmac_f32_16x16x64_bf16 v[22:25], v[42:45], v[90:97], v114
  buffer_store_dwordx4 v[10:13], v121, s[4:7], s76 offen
  v_smfmac_f32_16x16x64_bf16 v[18:21], v[46:49], v[176:183], v114
  v_smfmac_f32_16x16x64_bf16 v[22:25], v[46:49], v[184:191], v114
  s_nop 3
  v_cvt_pk_bf16_f32 v18, v18, v19
  v_cvt_pk_bf16_f32 v19, v20, v21
  v_bfi_b32 v18, 1, s79, v18
  s_nop 0
  v_cvt_pk_bf16_f32 v20, v22, v23
  v_cvt_pk_bf16_f32 v21, v24, v25
  buffer_store_dwordx4 v[18:21], v121, s[4:7], s77 offen
  v_mov_b64 v[34:35], 0
  v_mov_b64 v[36:37], 0
  v_mov_b64 v[38:39], 0
  v_mov_b64 v[40:41], 0
  v_mov_b64 v[42:43], 0
  v_mov_b64 v[44:45], 0
  v_mov_b64 v[46:47], 0
  v_mov_b64 v[48:49], 0
  v_mov_b64 v[58:59], 0
  v_mov_b64 v[60:61], 0
  v_mov_b64 v[62:63], 0
  v_mov_b64 v[64:65], 0
  ds_read_b128 v[66:69], v115 offset:20480
  ds_read_b128 v[70:73], v115 offset:21504
  ds_read_b128 v[74:77], v115 offset:22528
  ds_read_b128 v[78:81], v115 offset:23552
  ds_read_b128 v[82:85], v115 offset:36864
  ds_read_b128 v[86:89], v115 offset:37888
  ds_read_b128 v[90:93], v115 offset:38912
  ds_read_b128 v[94:97], v115 offset:39936
  s_waitcnt vmcnt(0)
  buffer_load_dwordx4 v[2:5], v115, s[4:7], s78 offen offset:0 sc1
  buffer_load_dwordx4 v[6:9], v115, s[4:7], s78 offen offset:1024 sc1
  s_add_u32 s70, s70, 1
  s_add_u32 s82, s82, 2048
  s_add_u32 s80, s80, 0x40000
  s_xor_b32 s76, s76, 0x40000
  s_sub_u32 s73, s74, s88
  s_add_u32 s73, s73, 2048
c10_rpoll:
  s_waitcnt vmcnt(0)
  v_mfma_f32_16x16x32_bf16 v[18:21], v[2:5], v[102:105], 0
  v_mfma_f32_16x16x32_bf16 v[18:21], v[6:9], v[102:105], v[18:21]
  v_bitop3_b32 v125, v2, v6, s79 bitop3:0x7e
  v_and_b32 v125, 1, v125
  v_cmp_ne_u32 vcc, 0, v125
  s_cbranch_vccz c10_rpoll_ok
  s_mov_b64 exec, vcc
  buffer_load_dwordx4 v[2:5], v115, s[4:7], s78 offen offset:0 sc1
  buffer_load_dwordx4 v[6:9], v115, s[4:7], s78 offen offset:1024 sc1
  s_sub_u32 s51, s51, 1
  s_cbranch_scc0 c10_rpoll
  s_endpgm
c10_rpoll_ok:
  s_mov_b64 exec, -1
  s_nop 1
  v_permlane32_swap_b32 v18, v20
  v_permlane32_swap_b32 v19, v21
  v_add_f32 v18, v18, v20
  v_add_f32 v19, v19, v21
  s_nop 1
  v_permlane16_swap_b32 v18, v19
  v_add_f32 v18, v18, v19
  s_nop 1
  v_mov_b32_dpp v19, v18 row_shl:4 row_mask:0xf bank_mask:0xf
  v_cvt_pk_bf16_f32 v18, v18, v19
  v_min_u32 v18, -2, v18
  buffer_store_dword v18, v123, s[4:7], s74 offen
  s_xor_b32 s78, s78, 0x40000
  s_cmp_eq_u32 s70, 63
  s_cbranch_scc1 c10_last
  s_lshr_b32 s79, s70, 1
  s_add_u32 s77, s76, 0x8000
  s_add_u32 s86, s70, 1
  s_and_b32 s86, s86, 3
  s_lshl_b32 s86, s86, 13
  s_add_u32 s86, s86, s89
  s_add_u32 s74, s86, s88
  s_xor_b32 s75, s74, 0x4000
  s_cmp_eq_u32 s84, 0
  s_cbranch_scc1 c10_have
c10_kpoll:
  s_sub_u32 s51, s51, 1
  s_cbranch_scc1 main_end
  buffer_load_dword v124, off, s[4:7], s82 sc1
  s_waitcnt vmcnt(0)
  v_readfirstlane_b32 s87, v124
  s_cmp_eq_u32 s87, 0
  s_cbranch_scc1 c10_kpoll
  s_mov_b32 m0, 0x25000
  s_nop 0
  buffer_load_dwordx4 v115, s[4:7], s83 offen offset:0 sc1 lds
  buffer_load_dwordx4 v115, s[4:7], s83 offen offset:1024 sc1 lds
  s_add_u32 s86, s83, 0x1fff800
  buffer_load_dwordx4 v115, s[4:7], s86 offen offset:2048 sc1 lds
  buffer_load_dwordx4 v115, s[4:7], s86 offen offset:3072 sc1 lds
  buffer_load_dwordx4 v[2:5], v115, s[4:7], s73 offen offset:0 sc1
  buffer_load_dwordx4 v[6:9], v115, s[4:7], s73 offen offset:1024 sc1
  s_add_u32 s87, s81, 0xfffe0400
  s_waitcnt vmcnt(2)
  ds_read_b128 v[50:53], v117 offset:20480
  ds_read_b128 v[54:57], v117 offset:21504
  s_waitcnt lgkmcnt(0)
  s_branch c10_poll0
  s_waitcnt vmcnt(0)
c10_have:
  ds_read_b128 v[50:53], v117 offset:20480
  ds_read_b128 v[54:57], v117 offset:21504
  s_waitcnt vmcnt(0)
  buffer_load_dwordx4 v[2:5], v115, s[4:7], s73 offen offset:0 sc1
  buffer_load_dwordx4 v[6:9], v115, s[4:7], s73 offen offset:1024 sc1
  s_add_u32 s87, s81, 0xfffe0400
  s_waitcnt lgkmcnt(0)
  s_branch c10_poll0
c10_last:
  s_waitcnt vmcnt(0)
  buffer_load_dwordx4 v[2:5], v115, s[4:7], s73 offen offset:0 sc1
  buffer_load_dwordx4 v[6:9], v115, s[4:7], s73 offen offset:1024 sc1
  s_add_u32 s87, s81, 0xfffe0400
  s_waitcnt lgkmcnt(0)
c10_lpoll:
  s_waitcnt vmcnt(0)
  ds_write_b128 v117, v[2:5] offset:2048
  ds_write_b128 v117, v[6:9] offset:3072
  v_max3_u32 v125, v2, v3, v4
  v_max3_u32 v126, v5, v6, v7
  v_max3_u32 v125, v125, v8, v9
  v_max_u32 v125, v125, v126
  v_cmp_eq_u32 vcc, -1, v125
  s_cbranch_vccz c10_lpoll_ok
  s_mov_b64 exec, vcc
  buffer_load_dwordx4 v[2:5], v115, s[4:7], s73 offen offset:0 sc1
  buffer_load_dwordx4 v[6:9], v115, s[4:7], s73 offen offset:1024 sc1
  s_sub_u32 s51, s51, 1
  s_cbranch_scc0 c10_lpoll
  s_endpgm
c10_lpoll_ok:
  s_mov_b64 exec, -1
  buffer_store_dwordx2 v[30:31], v119, s[4:7], s87 offen sc1
  buffer_store_dwordx4 v[98:101], v115, s[4:7], s81 offen sc1
  s_add_u32 s81, s80, 0x800
  s_mov_b64 vcc, s[92:93]
  v_smfmac_f32_16x16x64_bf16 v[58:61], v[2:5], a[160:167], v122
  v_smfmac_f32_16x16x64_bf16 v[62:65], v[2:5], a[168:175], v122
  s_waitcnt lgkmcnt(0)
  s_barrier
  ds_read_b128 v[30:33], v117 offset:1024
  ds_read_b128 v[10:13], v117 offset:4096
  ds_read_b128 v[14:17], v117 offset:5120
  ds_read_b128 v[18:21], v117 offset:6144
  ds_read_b128 v[26:29], v117 offset:0
  ds_read_b128 v[22:25], v117 offset:7168
  v_smfmac_f32_16x16x64_bf16 v[58:61], v[6:9], a[176:183], v122
  v_smfmac_f32_16x16x64_bf16 v[62:65], v[6:9], a[184:191], v122
  v_smfmac_f32_16x16x64_bf16 v[42:45], v[2:5], v[66:73], v122
  ds_read_b128 v[66:69], v115 offset:53248
  ds_read_b128 v[70:73], v115 offset:54272
  v_smfmac_f32_16x16x64_bf16 v[46:49], v[2:5], v[74:81], v122
  ds_read_b128 v[74:77], v115 offset:55296
  ds_read_b128 v[78:81], v115 offset:56320
  s_waitcnt lgkmcnt(9)
  v_smfmac_f32_16x16x64_bf16 v[58:61], v[30:33], a[144:151], v122
  v_smfmac_f32_16x16x64_bf16 v[62:65], v[30:33], a[152:159], v122
  v_smfmac_f32_16x16x64_bf16 v[42:45], v[6:9], v[82:89], v122
  ds_read_b128 v[82:85], v116 offset:4096
  ds_read_b128 v[86:89], v116 offset:5120
  v_smfmac_f32_16x16x64_bf16 v[46:49], v[6:9], v[90:97], v122
  ds_read_b128 v[90:93], v116 offset:6144
  ds_read_b128 v[94:97], v116 offset:7168
  s_waitcnt lgkmcnt(12)
  v_smfmac_f32_16x16x64_bf16 v[58:61], v[10:13], a[192:199], v122
  v_smfmac_f32_16x16x64_bf16 v[62:65], v[10:13], a[200:207], v122
  s_waitcnt lgkmcnt(6)
  v_smfmac_f32_16x16x64_bf16 v[42:45], v[14:17], v[66:73], v122
  ds_read_b128 v[66:69], v116 offset:20480
  ds_read_b128 v[70:73], v116 offset:21504
  s_waitcnt lgkmcnt(6)
  v_smfmac_f32_16x16x64_bf16 v[46:49], v[14:17], v[74:81], v122
  ds_read_b128 v[74:77], v116 offset:22528
  ds_read_b128 v[78:81], v116 offset:23552
  v_smfmac_f32_16x16x64_bf16 v[58:61], v[14:17], a[208:215], v122
  v_smfmac_f32_16x16x64_bf16 v[62:65], v[14:17], a[216:223], v122
  s_waitcnt lgkmcnt(6)
  v_smfmac_f32_16x16x64_bf16 v[42:45], v[18:21], v[82:89], v122
  ds_read_b128 v[82:85], v115 offset:4096
  ds_read_b128 v[86:89], v115 offset:5120
  s_waitcnt lgkmcnt(6)
  v_smfmac_f32_16x16x64_bf16 v[46:49], v[18:21], v[90:97], v122
  ds_read_b128 v[90:93], v115 offset:6144
  ds_read_b128 v[94:97], v115 offset:7168
  v_smfmac_f32_16x16x64_bf16 v[58:61], v[18:21], a[224:231], v122
  v_smfmac_f32_16x16x64_bf16 v[62:65], v[18:21], a[232:239], v122
  v_smfmac_f32_16x16x64_bf16 v[42:45], v[10:13], v[144:151], v122
  v_smfmac_f32_16x16x64_bf16 v[46:49], v[10:13], v[152:159], v122
  v_smfmac_f32_16x16x64_bf16 v[42:45], v[26:29], v[128:135], v122
  v_smfmac_f32_16x16x64_bf16 v[46:49], v[26:29], v[136:143], v122
  s_waitcnt lgkmcnt(6)
  v_smfmac_f32_16x16x64_bf16 v[42:45], v[22:25], v[66:73], v122
  s_waitcnt lgkmcnt(4)
  v_smfmac_f32_16x16x64_bf16 v[46:49], v[22:25], v[74:81], v122
  v_smfmac_f32_16x16x64_bf16 v[58:61], v[22:25], a[240:247], v122
  v_smfmac_f32_16x16x64_bf16 v[62:65], v[22:25], a[248:255], v122
  s_waitcnt lgkmcnt(2)
  v_smfmac_f32_16x16x64_bf16 v[42:45], v[30:33], v[82:89], v122
  s_waitcnt lgkmcnt(0)
  v_smfmac_f32_16x16x64_bf16 v[46:49], v[30:33], v[90:97], v122
  v_smfmac_f32_16x16x64_bf16 v[58:61], v[26:29], a[128:135], v122
  v_smfmac_f32_16x16x64_bf16 v[62:65], v[26:29], a[136:143], v122
  v_cvt_pk_bf16_f32 v98, v42, v43
  v_cvt_pk_bf16_f32 v99, v44, v45
  v_cvt_pk_bf16_f32 v100, v46, v47
  v_cvt_pk_bf16_f32 v101, v48, v49
  s_nop 1
  v_mfma_f32_16x16x32_bf16 v[42:45], v[98:101], v[106:109], 0
  v_mfma_f32_16x16x32_bf16 v[46:49], v[100:103], v[106:109], 0
  s_add_u32 s87, s81, 0xfffe0400
  s_nop 2
  v_cvt_pk_bf16_f32 v42, v42, v43
  v_cvt_pk_bf16_f32 v43, v44, v45
  s_nop 1
  v_cvt_pk_bf16_f32 v44, v46, v47
  v_cvt_pk_bf16_f32 v45, v48, v49
  v_cndmask_b32 v30, v42, v44, vcc
  v_cndmask_b32 v31, v43, v45, vcc
  s_cmp_eq_u32 s84, 0
  s_cbranch_scc1 c10_lgo
c10_lfl:
  s_sub_u32 s51, s51, 1
  s_cbranch_scc1 main_end
  buffer_load_dword v124, off, s[4:7], s82 sc1
  s_waitcnt vmcnt(0)
  v_readfirstlane_b32 s86, v124
  s_cmp_eq_u32 s86, 0
  s_cbranch_scc1 c10_lfl
c10_lgo:
  buffer_store_dwordx2 v[30:31], v119, s[4:7], s87 offen sc1
  v_cvt_pk_bf16_f32 v98, v58, v59
  v_cvt_pk_bf16_f32 v99, v60, v61
  v_cvt_pk_bf16_f32 v100, v62, v63
  v_cvt_pk_bf16_f32 v101, v64, v65
  buffer_store_dwordx4 v[98:101], v115, s[4:7], s81 offen sc1
  s_endpgm
c10_tail:
  s_mov_b32 s72, s52
  ds_read_b128 v[66:69], v115 offset:20480
  ds_read_b128 v[70:73], v115 offset:21504
  ds_read_b128 v[74:77], v115 offset:22528
  ds_read_b128 v[78:81], v115 offset:23552
  ds_read_b128 v[82:85], v115 offset:36864
  ds_read_b128 v[86:89], v115 offset:37888
  ds_read_b128 v[90:93], v115 offset:38912
  ds_read_b128 v[94:97], v115 offset:39936
  s_add_u32 s73, s89, 2048
  s_lshr_b32 s79, s70, 1
  s_add_u32 s77, s76, 0x8000
  s_add_u32 s86, s70, 1
  s_and_b32 s86, s86, 3
  s_lshl_b32 s86, s86, 13
  s_add_u32 s86, s86, s89
  s_add_u32 s74, s86, s88
  s_xor_b32 s75, s74, 0x4000
  s_cmp_eq_u32 s94, 0
  s_cbranch_scc1 c10_kpoll
  s_waitcnt vmcnt(0)
  ds_read_b128 v[50:53], v117 offset:20480
  ds_read_b128 v[54:57], v117 offset:21504
  v_mov_b64 v[2:3], v[12:13]
  v_mov_b64 v[4:5], v[14:15]
  v_mov_b64 v[6:7], v[16:17]
  v_mov_b64 v[8:9], v[18:19]
  s_add_u32 s87, s81, 0xfffe0400
  s_waitcnt lgkmcnt(0)
  s_branch c10_poll0
c20_entry:
  s_branch c20_tail
c20_poll0:
c20_poll:
  s_waitcnt vmcnt(0)
  ds_write_b128 v117, v[2:5] offset:4096
  ds_write_b128 v117, v[6:9] offset:5120
  v_max3_u32 v125, v2, v3, v4
  v_max3_u32 v126, v5, v6, v7
  v_max3_u32 v125, v125, v8, v9
  v_max_u32 v125, v125, v126
  v_cmp_eq_u32 vcc, -1, v125
  s_cbranch_vccz c20_poll_ok
  s_mov_b64 exec, vcc
  buffer_load_dwordx4 v[2:5], v115, s[4:7], s73 offen offset:0 sc1
  buffer_load_dwordx4 v[6:9], v115, s[4:7], s73 offen offset:1024 sc1
  s_sub_u32 s51, s51, 1
  s_cbranch_scc0 c20_poll
  s_endpgm
c20_poll_ok:
  s_mov_b64 exec, -1
  v_smfmac_f32_16x16x64_bf16 v[42:45], v[6:9], v[66:73], v122
  v_smfmac_f32_16x16x64_bf16 v[46:49], v[6:9], v[74:81], v122
  s_waitcnt lgkmcnt(0)
  s_barrier
  buffer_load_dword v124, off, s[4:7], s82 offset:2048 sc1
  v_smfmac_f32_16x16x64_bf16 v[34:37], v[2:5], a[64:71], v122
  ds_read_b128 v[10:13], v117 offset:6144
  v_smfmac_f32_16x16x64_bf16 v[38:41], v[2:5], a[72:79], v122
  buffer_store_dwordx2 v[30:31], v119, s[4:7], s87 offen sc1
  ds_read_b128 v[14:17], v117 offset:7168
  v_smfmac_f32_16x16x64_bf16 v[34:37], v[6:9], a[80:87], v122
  ds_read_b128 v[18:21], v117 offset:0
  v_smfmac_f32_16x16x64_bf16 v[38:41], v[6:9], a[88:95], v122
  ds_read_b128 v[22:25], v117 offset:1024
  s_waitcnt lgkmcnt(3)
  v_smfmac_f32_16x16x64_bf16 v[42:45], v[10:13], v[82:89], v122
  ds_read_b128 v[26:29], v117 offset:2048
  v_smfmac_f32_16x16x64_bf16 v[46:49], v[10:13], v[90:97], v122
  ds_read_b128 v[30:33], v117 offset:3072
  v_smfmac_f32_16x16x64_bf16 v[34:37], v[10:13], a[96:103], v122
  buffer_store_dwordx4 v[98:101], v115, s[4:7], s81 offen sc1
  ds_read_b128 v[66:69], v116 offset:24576
  v_smfmac_f32_16x16x64_bf16 v[38:41], v[10:13], a[104:111], v122
  ds_read_b128 v[70:73], v116 offset:25600
  s_waitcnt lgkmcnt(6)
  v_smfmac_f32_16x16x64_bf16 v[34:37], v[14:17], a[112:119], v122
  ds_read_b128 v[74:77], v116 offset:26624
  v_smfmac_f32_16x16x64_bf16 v[38:41], v[14:17], a[120:127], v122
  ds_read_b128 v[78:81], v116 offset:27648
  s_waitcnt lgkmcnt(7)
  v_mov_b32 v126, -1
  v_smfmac_f32_16x16x64_bf16 v[34:37], v[18:21], a[0:7], v122
  buffer_store_dword v126, v123, s[4:7], s75 offen
  ds_read_b128 v[82:85], v115 offset:8192
  v_smfmac_f32_16x16x64_bf16 v[38:41], v[18:21], a[8:15], v122
  ds_read_b128 v[86:89], v115 offset:9216
  s_waitcnt lgkmcnt(8)
  v_smfmac_f32_16x16x64_bf16 v[34:37], v[22:25], a[16:23], v122
  ds_read_b128 v[90:93], v115 offset:10240
  v_smfmac_f32_16x16x64_bf16 v[38:41], v[22:25], a[24:31], v122
  s_add_u32 s83, s83, 0x40000
  ds_read_b128 v[94:97], v115 offset:11264
  s_waitcnt lgkmcnt(9)
  v_smfmac_f32_16x16x64_bf16 v[34:37], v[26:29], a[32:39], v122
  s_mov_b32 m0, 0x26000
  s_add_u32 s86, s83, 0x1fff800
  v_smfmac_f32_16x16x64_bf16 v[38:41], v[26:29], a[40:47], v122
  s_mov_b64 vcc, s[92:93]
  s_waitcnt lgkmcnt(8)
  v_smfmac_f32_16x16x64_bf16 v[34:37], v[30:33], a[48:55], v122
  v_smfmac_f32_16x16x64_bf16 v[38:41], v[30:33], a[56:63], v122
  s_waitcnt lgkmcnt(6)
  v_smfmac_f32_16x16x64_bf16 v[42:45], v[14:17], v[66:73], v122
  ds_read_b128 v[66:69], v115 offset:24576
  s_waitcnt lgkmcnt(5)
  v_cvt_pk_bf16_f32 v98, v34, v35
  v_cvt_pk_bf16_f32 v99, v36, v37
  v_smfmac_f32_16x16x64_bf16 v[46:49], v[14:17], v[74:81], v122
  ds_read_b128 v[70:73], v115 offset:25600
  v_mfma_f32_16x16x32_bf16 v[34:37], v[98:101], v[106:109], 0
  ds_read_b128 v[74:77], v115 offset:26624
  s_waitcnt lgkmcnt(5)
  v_cvt_pk_bf16_f32 v100, v38, v39
  v_cvt_pk_bf16_f32 v101, v40, v41
  v_smfmac_f32_16x16x64_bf16 v[42:45], v[22:25], v[82:89], v122
  ds_read_b128 v[78:81], v115 offset:27648
  v_mfma_f32_16x16x32_bf16 v[38:41], v[100:103], v[106:109], 0
  ds_read_b128 v[82:85], v115 offset:40960
  s_waitcnt lgkmcnt(5)
  v_cvt_pk_bf16_f32 v34, v34, v35
  v_cvt_pk_bf16_f32 v35, v36, v37
  v_smfmac_f32_16x16x64_bf16 v[46:49], v[22:25], v[90:97], v122
  ds_read_b128 v[86:89], v115 offset:41984
  v_smfmac_f32_16x16x64_bf16 v[42:45], v[2:5], v[144:151], v122
  ds_read_b128 v[90:93], v115 offset:43008
  ds_read_b128 v[94:97], v115 offset:44032
  v_cvt_pk_bf16_f32 v36, v38, v39
  v_cvt_pk_bf16_f32 v37, v40, v41
  v_smfmac_f32_16x16x64_bf16 v[42:45], v[18:21], v[128:135], v122
  s_nop 0
  v_mfma_f32_16x16x32_bf16 v[38:41], v[50:53], v[34:37], 0
  v_mfma_f32_16x16x32_bf16 v[50:53], v[54:57], v[34:37], 0
  s_waitcnt lgkmcnt(6)
  v_smfmac_f32_16x16x64_bf16 v[42:45], v[26:29], v[66:73], v122
  s_waitcnt lgkmcnt(2)
  v_smfmac_f32_16x16x64_bf16 v[42:45], v[30:33], v[82:89], v122
  v_cndmask_b32 v38, v38, v50, vcc
  v_smfmac_f32_16x16x64_bf16 v[46:49], v[2:5], v[152:159], v122
  v_cndmask_b32 v39, v39, v51, vcc
  v_smfmac_f32_16x16x64_bf16 v[46:49], v[18:21], v[136:143], v122
  v_cvt_pk_bf16_f32 v98, v42, v43
  v_smfmac_f32_16x16x64_bf16 v[46:49], v[26:29], v[74:81], v122
  s_waitcnt lgkmcnt(0)
  v_cvt_pk_bf16_f32 v99, v44, v45
  v_smfmac_f32_16x16x64_bf16 v[46:49], v[30:33], v[90:97], v122
  v_cndmask_b32 v40, v40, v52, vcc
  v_mfma_f32_16x16x32_bf16 v[42:45], v[98:101], v[106:109], 0
  v_cndmask_b32 v41, v41, v53, vcc
  s_nop 1
  v_cvt_pk_bf16_f32 v100, v46, v47
  v_cvt_pk_bf16_f32 v101, v48, v49
  s_nop 1
  v_mfma_f32_16x16x32_bf16 v[46:49], v[100:103], v[106:109], 0
  v_cvt_pk_bf16_f32 v42, v42, v43
  v_cvt_pk_bf16_f32 v43, v44, v45
  v_smfmac_f32_16x16x64_bf16 v[58:61], v[2:5], a[192:199], v122
  ds_write_b128 v117, v[38:41] offset:10240
  s_nop 2
  v_cvt_pk_bf16_f32 v44, v46, v47
  v_cvt_pk_bf16_f32 v45, v48, v49
  s_nop 1
  v_mfma_f32_16x16x32_bf16 v[46:49], v[42:45], v[34:37], 0
  v_smfmac_f32_16x16x64_bf16 v[62:65], v[2:5], a[200:207], v122
  s_nop 3
  v_cndmask_b32 v46, v46, v48, vcc
  v_cndmask_b32 v47, v47, v49, vcc
  v_smfmac_f32_16x16x64_bf16 v[58:61], v[6:9], a[208:215], v122
  ds_write_b64 v119, v[46:47] offset:13312
  v_smfmac_f32_16x16x64_bf16 v[62:65], v[6:9], a[216:223], v122
  ds_read_b64 v[94:95], v120 offset:13312
  v_smfmac_f32_16x16x64_bf16 v[58:61], v[30:33], a[176:183], v122
  ds_read_b64 v[2:3], v117 offset:26632
  ds_read_b64 v[4:5], v117 offset:27648
  s_waitcnt vmcnt(3)
  buffer_load_dwordx4 v115, s[4:7], s83 offen offset:0 sc1 lds
  v_smfmac_f32_16x16x64_bf16 v[62:65], v[30:33], a[184:191], v122
  ds_read_b64 v[6:7], v117 offset:26624
  ds_read_b64 v[8:9], v117 offset:27656
  v_readfirstlane_b32 s84, v124
  v_smfmac_f32_16x16x64_bf16 v[58:61], v[10:13], a[224:231], v122
  s_waitcnt lgkmcnt(5)
  s_barrier
  v_smfmac_f32_16x16x64_bf16 v[62:65], v[10:13], a[232:239], v122
  ds_read_b128 v[50:53], v117 offset:11264
  ds_read_b128 v[54:57], v117 offset:8192
  v_cndmask_b32 v30, v42, v44, vcc
  v_smfmac_f32_16x16x64_bf16 v[58:61], v[14:17], a[240:247], v122
  ds_read_b128 v[86:89], v117 offset:9216
  ds_read_b64 v[96:97], v120 offset:13824
  v_cndmask_b32 v31, v43, v45, vcc
  v_smfmac_f32_16x16x64_bf16 v[62:65], v[14:17], a[248:255], v122
  ds_read_b64 v[90:91], v120 offset:12288
  ds_read_b64 v[92:93], v120 offset:12800
  v_mov_b64 v[10:11], 0
  v_smfmac_f32_16x16x64_bf16 v[58:61], v[18:21], a[128:135], v122
  ds_read_b128 v[66:69], v116 offset:40960
  buffer_load_dwordx4 v115, s[4:7], s83 offen offset:1024 sc1 lds
  v_mov_b64 v[12:13], 0
  v_smfmac_f32_16x16x64_bf16 v[62:65], v[18:21], a[136:143], v122
  ds_read_b128 v[70:73], v116 offset:41984
  s_xor_b32 s84, s84, 1
  v_mov_b64 v[14:15], 0
  v_smfmac_f32_16x16x64_bf16 v[58:61], v[22:25], a[144:151], v122
  ds_read_b128 v[74:77], v116 offset:43008
  v_mov_b64 v[16:17], 0
  v_smfmac_f32_16x16x64_bf16 v[62:65], v[22:25], a[152:159], v122
  s_waitcnt lgkmcnt(3)
  buffer_load_dwordx4 v115, s[4:7], s86 offen offset:2048 sc1 lds
  ds_read_b128 v[78:81], v116 offset:44032
  v_add_f32 v38, v38, v50
  v_add_f32 v39, v39, v51
  v_add_f32 v40, v40, v52
  v_add_f32 v41, v41, v53
  v_pk_add_f32 v[38:39], v[38:39], v[54:55]
  v_pk_add_f32 v[40:41], v[40:41], v[56:57]
  v_pk_add_f32 v[38:39], v[38:39], v[86:87]
  v_pk_add_f32 v[40:41], v[40:41], v[88:89]
  v_max3_f32 v125, v38, v39, v40
  v_max_f32 v125, v125, v41
  v_pk_add_f32 v[94:95], v[94:95], v[96:97]
  v_pk_add_f32 v[90:91], v[90:91], v[92:93]
  v_max_f32_dpp v125, v125, v125 row_ror:8 row_mask:0xf bank_mask:0xf
  v_pk_add_f32 v[94:95], v[94:95], v[90:91]
  v_max3_f32 v127, v125, v94, v95
  v_max3_f32 v125, v125, v94, v95
  v_smfmac_f32_16x16x64_bf16 v[58:61], v[26:29], a[160:167], v122
  buffer_load_dwordx4 v115, s[4:7], s86 offen offset:3072 sc1 lds
  v_permlane16_swap_b32 v125, v127
  v_max_f32 v126, v125, v127
  v_max_f32 v125, v125, v127
  v_smfmac_f32_16x16x64_bf16 v[62:65], v[26:29], a[168:175], v122
  ds_read_b128 v[82:85], v116 offset:57344
  v_permlane32_swap_b32 v125, v126
  v_max_f32 v125, v125, v126
  v_mul_f32 v126, s85, v125
  v_pk_fma_f32 v[38:39], v[38:39], s[90:91], v[126:127] op_sel_hi:[1,1,0] neg_lo:[0,0,1] neg_hi:[0,0,1]
  v_pk_fma_f32 v[40:41], v[40:41], s[90:91], v[126:127] op_sel_hi:[1,1,0] neg_lo:[0,0,1] neg_hi:[0,0,1]
  v_pk_fma_f32 v[94:95], v[94:95], s[90:91], v[126:127] op_sel_hi:[1,1,0] neg_lo:[0,0,1] neg_hi:[0,0,1]
  v_exp_f32 v38, v38
  v_exp_f32 v39, v39
  v_exp_f32 v40, v40
  v_exp_f32 v41, v41
  v_cvt_pk_bf16_f32 v42, v38, v39
  v_cvt_pk_bf16_f32 v43, v40, v41
  v_exp_f32 v94, v94
  v_mov_b32_dpp v50, v42 row_shl:8 row_mask:0xf bank_mask:0xf bound_ctrl:0
  v_mov_b32_dpp v51, v43 row_shl:8 row_mask:0xf bank_mask:0xf bound_ctrl:0
  v_mov_b32_dpp v52, v42 row_shr:8 row_mask:0xf bank_mask:0xf bound_ctrl:0
  v_mov_b32_dpp v53, v43 row_shr:8 row_mask:0xf bank_mask:0xf bound_ctrl:0
  v_exp_f32 v95, v95
  v_cndmask_b32_e64 v54, v42, 0, vcc
  v_mfma_f32_16x16x32_bf16 v[34:37], v[2:5], v[50:53], 0
  v_cndmask_b32_e64 v55, v43, 0, vcc
  v_cvt_pk_bf16_f32 v98, v58, v59
  v_cvt_pk_bf16_f32 v99, v60, v61
  v_cvt_pk_bf16_f32 v127, v94, v95
  v_cndmask_b32_e64 v44, v127, 0, vcc
  v_cndmask_b32_e64 v45, v127, 0, vcc
  v_cndmask_b32 v46, 0, v127, vcc
  v_cndmask_b32 v47, 0, v127, vcc
  v_mfma_f32_16x16x32_bf16 v[38:41], v[110:113], v[42:45], 0
  v_cvt_pk_bf16_f32 v100, v62, v63
  v_cvt_pk_bf16_f32 v101, v64, v65
  s_nop 1
  v_mfma_f32_16x16x32_bf16 v[34:37], v[98:101], v[44:47], v[34:37]
  ds_read_b128 v[86:89], v116 offset:58368
  v_cndmask_b32 v56, 0, v42, vcc
  v_cndmask_b32 v57, 0, v43, vcc
  v_mov_b64 v[18:19], 0
  v_mov_b64 v[20:21], 0
  v_mfma_f32_16x16x32_bf16 v[34:37], v[6:9], v[54:57], v[34:37]
  ds_read_b128 v[90:93], v116 offset:59392
  ds_read_b128 v[94:97], v116 offset:60416
  v_add_f32_dpp v125, v38, v38 row_ror:8 row_mask:0xf bank_mask:0xf
  v_rcp_f32 v125, v125
  v_mov_b64 v[22:23], 0
  v_mov_b64 v[24:25], 0
  s_nop 1
  v_pk_mul_f32 v[34:35], v[34:35], v[124:125] op_sel:[0,1] op_sel_hi:[1,1]
  v_pk_mul_f32 v[36:37], v[36:37], v[124:125] op_sel:[0,1] op_sel_hi:[1,1]
  v_cvt_pk_bf16_f32 v34, v34, v35
  v_cvt_pk_bf16_f32 v35, v36, v37
  s_add_u32 s81, s80, 0x1000
  ds_write_b64 v119, v[34:35] offset:15360
  v_cndmask_b32_dpp v36, v34, v34, vcc row_ror:8 row_mask:0xf bank_mask:0xf
  v_cndmask_b32_dpp v37, v35, v35, vcc row_ror:8 row_mask:0xf bank_mask:0xf
  v_mov_b32_dpp v34, v34 row_shr:8 row_mask:0xf bank_mask:0xc
  v_mov_b32_dpp v35, v35 row_shr:8 row_mask:0xf bank_mask:0xc
  s_waitcnt lgkmcnt(1)
  s_nop 0
  v_smfmac_f32_16x16x64_bf16 v[10:13], v[34:37], v[224:231], v114
  v_smfmac_f32_16x16x64_bf16 v[14:17], v[34:37], v[232:239], v114
  s_waitcnt lgkmcnt(0)
  s_barrier
  ds_read_b128 v[38:41], v118 offset:15872
  ds_read_b128 v[42:45], v118 offset:14336
  ds_read_b128 v[46:49], v118 offset:14848
  v_smfmac_f32_16x16x64_bf16 v[18:21], v[34:37], v[240:247], v114
  v_smfmac_f32_16x16x64_bf16 v[22:25], v[34:37], v[248:255], v114
  s_waitcnt lgkmcnt(2)
  v_smfmac_f32_16x16x64_bf16 v[10:13], v[38:41], v[66:73], v114
  v_smfmac_f32_16x16x64_bf16 v[14:17], v[38:41], v[74:81], v114
  s_waitcnt lgkmcnt(1)
  v_smfmac_f32_16x16x64_bf16 v[10:13], v[42:45], v[160:167], v114
  v_smfmac_f32_16x16x64_bf16 v[14:17], v[42:45], v[168:175], v114
  s_waitcnt lgkmcnt(0)
  v_smfmac_f32_16x16x64_bf16 v[10:13], v[46:49], v[192:199], v114
  v_smfmac_f32_16x16x64_bf16 v[14:17], v[46:49], v[200:207], v114
  v_smfmac_f32_16x16x64_bf16 v[18:21], v[38:41], v[82:89], v114
  v_smfmac_f32_16x16x64_bf16 v[22:25], v[38:41], v[90:97], v114
  v_cvt_pk_bf16_f32 v10, v10, v11
  v_cvt_pk_bf16_f32 v11, v12, v13
  v_bfi_b32 v10, 1, s79, v10
  v_smfmac_f32_16x16x64_bf16 v[18:21], v[42:45], v[176:183], v114
  v_cvt_pk_bf16_f32 v12, v14, v15
  v_cvt_pk_bf16_f32 v13, v16, v17
  v_smfmac_f32_16x16x64_bf16 v[22:25], v[42:45], v[184:191], v114
  buffer_store_dwordx4 v[10:13], v121, s[4:7], s76 offen
  v_smfmac_f32_16x16x64_bf16 v[18:21], v[46:49], v[208:215], v114
  v_smfmac_f32_16x16x64_bf16 v[22:25], v[46:49], v[216:223], v114
  s_nop 3
  v_cvt_pk_bf16_f32 v18, v18, v19
  v_cvt_pk_bf16_f32 v19, v20, v21
  v_bfi_b32 v18, 1, s79, v18
  s_nop 0
  v_cvt_pk_bf16_f32 v20, v22, v23
  v_cvt_pk_bf16_f32 v21, v24, v25
  buffer_store_dwordx4 v[18:21], v121, s[4:7], s77 offen
  v_mov_b64 v[34:35], 0
  v_mov_b64 v[36:37], 0
  v_mov_b64 v[38:39], 0
  v_mov_b64 v[40:41], 0
  v_mov_b64 v[42:43], 0
  v_mov_b64 v[44:45], 0
  v_mov_b64 v[46:47], 0
  v_mov_b64 v[48:49], 0
  v_mov_b64 v[58:59], 0
  v_mov_b64 v[60:61], 0
  v_mov_b64 v[62:63], 0
  v_mov_b64 v[64:65], 0
  ds_read_b128 v[66:69], v115 offset:57344
  ds_read_b128 v[70:73], v115 offset:58368
  ds_read_b128 v[74:77], v115 offset:59392
  ds_read_b128 v[78:81], v115 offset:60416
  ds_read_b128 v[82:85], v116 offset:8192
  ds_read_b128 v[86:89], v116 offset:9216
  ds_read_b128 v[90:93], v116 offset:10240
  ds_read_b128 v[94:97], v116 offset:11264
  s_waitcnt vmcnt(0)
  buffer_load_dwordx4 v[2:5], v115, s[4:7], s78 offen offset:0 sc1
  buffer_load_dwordx4 v[6:9], v115, s[4:7], s78 offen offset:1024 sc1
  s_add_u32 s70, s70, 1
  s_add_u32 s82, s82, 2048
  s_add_u32 s80, s80, 0x40000
  s_xor_b32 s76, s76, 0x40000
  s_sub_u32 s73, s74, s88
  s_add_u32 s73, s73, 4096
c20_rpoll:
  s_waitcnt vmcnt(0)
  v_mfma_f32_16x16x32_bf16 v[18:21], v[2:5], v[102:105], 0
  v_mfma_f32_16x16x32_bf16 v[18:21], v[6:9], v[102:105], v[18:21]
  v_bitop3_b32 v125, v2, v6, s79 bitop3:0x7e
  v_and_b32 v125, 1, v125
  v_cmp_ne_u32 vcc, 0, v125
  s_cbranch_vccz c20_rpoll_ok
  s_mov_b64 exec, vcc
  buffer_load_dwordx4 v[2:5], v115, s[4:7], s78 offen offset:0 sc1
  buffer_load_dwordx4 v[6:9], v115, s[4:7], s78 offen offset:1024 sc1
  s_sub_u32 s51, s51, 1
  s_cbranch_scc0 c20_rpoll
  s_endpgm
c20_rpoll_ok:
  s_mov_b64 exec, -1
  s_nop 1
  v_permlane32_swap_b32 v18, v20
  v_permlane32_swap_b32 v19, v21
  v_add_f32 v18, v18, v20
  v_add_f32 v19, v19, v21
  s_nop 1
  v_permlane16_swap_b32 v18, v19
  v_add_f32 v18, v18, v19
  s_nop 1
  v_mov_b32_dpp v19, v18 row_shl:4 row_mask:0xf bank_mask:0xf
  v_cvt_pk_bf16_f32 v18, v18, v19
  v_min_u32 v18, -2, v18
  buffer_store_dword v18, v123, s[4:7], s74 offen
  s_xor_b32 s78, s78, 0x40000
  s_cmp_eq_u32 s70, 63
  s_cbranch_scc1 c20_last
  s_lshr_b32 s79, s70, 1
  s_add_u32 s77, s76, 0x8000
  s_add_u32 s86, s70, 1
  s_and_b32 s86, s86, 3
  s_lshl_b32 s86, s86, 13
  s_add_u32 s86, s86, s89
  s_add_u32 s74, s86, s88
  s_xor_b32 s75, s74, 0x4000
  s_cmp_eq_u32 s84, 0
  s_cbranch_scc1 c20_have
c20_kpoll:
  s_sub_u32 s51, s51, 1
  s_cbranch_scc1 main_end
  buffer_load_dword v124, off, s[4:7], s82 sc1
  s_waitcnt vmcnt(0)
  v_readfirstlane_b32 s87, v124
  s_cmp_eq_u32 s87, 0
  s_cbranch_scc1 c20_kpoll
  s_mov_b32 m0, 0x26000
  s_nop 0
  buffer_load_dwordx4 v115, s[4:7], s83 offen offset:0 sc1 lds
  buffer_load_dwordx4 v115, s[4:7], s83 offen offset:1024 sc1 lds
  s_add_u32 s86, s83, 0x1fff800
  buffer_load_dwordx4 v115, s[4:7], s86 offen offset:2048 sc1 lds
  buffer_load_dwordx4 v115, s[4:7], s86 offen offset:3072 sc1 lds
  buffer_load_dwordx4 v[2:5], v115, s[4:7], s73 offen offset:0 sc1
  buffer_load_dwordx4 v[6:9], v115, s[4:7], s73 offen offset:1024 sc1
  s_add_u32 s87, s81, 0xfffe0400
  s_waitcnt vmcnt(2)
  ds_read_b128 v[50:53], v117 offset:24576
  ds_read_b128 v[54:57], v117 offset:25600
  s_waitcnt lgkmcnt(0)
  s_branch c20_poll0
  s_waitcnt vmcnt(0)
c20_have:
  ds_read_b128 v[50:53], v117 offset:24576
  ds_read_b128 v[54:57], v117 offset:25600
  s_waitcnt vmcnt(0)
  buffer_load_dwordx4 v[2:5], v115, s[4:7], s73 offen offset:0 sc1
  buffer_load_dwordx4 v[6:9], v115, s[4:7], s73 offen offset:1024 sc1
  s_add_u32 s87, s81, 0xfffe0400
  s_waitcnt lgkmcnt(0)
  s_branch c20_poll0
c20_last:
  s_waitcnt vmcnt(0)
  buffer_load_dwordx4 v[2:5], v115, s[4:7], s73 offen offset:0 sc1
  buffer_load_dwordx4 v[6:9], v115, s[4:7], s73 offen offset:1024 sc1
  s_add_u32 s87, s81, 0xfffe0400
  s_waitcnt lgkmcnt(0)
c20_lpoll:
  s_waitcnt vmcnt(0)
  ds_write_b128 v117, v[2:5] offset:4096
  ds_write_b128 v117, v[6:9] offset:5120
  v_max3_u32 v125, v2, v3, v4
  v_max3_u32 v126, v5, v6, v7
  v_max3_u32 v125, v125, v8, v9
  v_max_u32 v125, v125, v126
  v_cmp_eq_u32 vcc, -1, v125
  s_cbranch_vccz c20_lpoll_ok
  s_mov_b64 exec, vcc
  buffer_load_dwordx4 v[2:5], v115, s[4:7], s73 offen offset:0 sc1
  buffer_load_dwordx4 v[6:9], v115, s[4:7], s73 offen offset:1024 sc1
  s_sub_u32 s51, s51, 1
  s_cbranch_scc0 c20_lpoll
  s_endpgm
c20_lpoll_ok:
  s_mov_b64 exec, -1
  buffer_store_dwordx2 v[30:31], v119, s[4:7], s87 offen sc1
  buffer_store_dwordx4 v[98:101], v115, s[4:7], s81 offen sc1
  s_add_u32 s81, s80, 0x1000
  s_mov_b64 vcc, s[92:93]
  v_smfmac_f32_16x16x64_bf16 v[58:61], v[2:5], a[192:199], v122
  v_smfmac_f32_16x16x64_bf16 v[62:65], v[2:5], a[200:207], v122
  s_waitcnt lgkmcnt(0)
  s_barrier
  ds_read_b128 v[30:33], v117 offset:3072
  ds_read_b128 v[10:13], v117 offset:6144
  ds_read_b128 v[14:17], v117 offset:7168
  ds_read_b128 v[22:25], v117 offset:1024
  ds_read_b128 v[18:21], v117 offset:0
  ds_read_b128 v[26:29], v117 offset:2048
  v_smfmac_f32_16x16x64_bf16 v[58:61], v[6:9], a[208:215], v122
  v_smfmac_f32_16x16x64_bf16 v[62:65], v[6:9], a[216:223], v122
  v_smfmac_f32_16x16x64_bf16 v[42:45], v[6:9], v[66:73], v122
  ds_read_b128 v[66:69], v116 offset:24576
  ds_read_b128 v[70:73], v116 offset:25600
  v_smfmac_f32_16x16x64_bf16 v[46:49], v[6:9], v[74:81], v122
  ds_read_b128 v[74:77], v116 offset:26624
  ds_read_b128 v[78:81], v116 offset:27648
  s_waitcnt lgkmcnt(9)
  v_smfmac_f32_16x16x64_bf16 v[58:61], v[30:33], a[176:183], v122
  v_smfmac_f32_16x16x64_bf16 v[62:65], v[30:33], a[184:191], v122
  s_waitcnt lgkmcnt(8)
  v_smfmac_f32_16x16x64_bf16 v[42:45], v[10:13], v[82:89], v122
  ds_read_b128 v[82:85], v115 offset:8192
  ds_read_b128 v[86:89], v115 offset:9216
  v_smfmac_f32_16x16x64_bf16 v[46:49], v[10:13], v[90:97], v122
  ds_read_b128 v[90:93], v115 offset:10240
  ds_read_b128 v[94:97], v115 offset:11264
  v_smfmac_f32_16x16x64_bf16 v[58:61], v[10:13], a[224:231], v122
  v_smfmac_f32_16x16x64_bf16 v[62:65], v[10:13], a[232:239], v122
  s_waitcnt lgkmcnt(6)
  v_smfmac_f32_16x16x64_bf16 v[42:45], v[14:17], v[66:73], v122
  ds_read_b128 v[66:69], v115 offset:24576
  ds_read_b128 v[70:73], v115 offset:25600
  s_waitcnt lgkmcnt(6)
  v_smfmac_f32_16x16x64_bf16 v[46:49], v[14:17], v[74:81], v122
  ds_read_b128 v[74:77], v115 offset:26624
  ds_read_b128 v[78:81], v115 offset:27648
  v_smfmac_f32_16x16x64_bf16 v[58:61], v[14:17], a[240:247], v122
  v_smfmac_f32_16x16x64_bf16 v[62:65], v[14:17], a[248:255], v122
  s_waitcnt lgkmcnt(6)
  v_smfmac_f32_16x16x64_bf16 v[42:45], v[22:25], v[82:89], v122
  ds_read_b128 v[82:85], v115 offset:40960
  ds_read_b128 v[86:89], v115 offset:41984
  s_waitcnt lgkmcnt(6)
  v_smfmac_f32_16x16x64_bf16 v[46:49], v[22:25], v[90:97], v122
  ds_read_b128 v[90:93], v115 offset:43008
  ds_read_b128 v[94:97], v115 offset:44032
  v_smfmac_f32_16x16x64_bf16 v[58:61], v[18:21], a[128:135], v122
  v_smfmac_f32_16x16x64_bf16 v[62:65], v[18:21], a[136:143], v122
  v_smfmac_f32_16x16x64_bf16 v[42:45], v[2:5], v[144:151], v122
  v_smfmac_f32_16x16x64_bf16 v[46:49], v[2:5], v[152:159], v122
  v_smfmac_f32_16x16x64_bf16 v[42:45], v[18:21], v[128:135], v122
  v_smfmac_f32_16x16x64_bf16 v[46:49], v[18:21], v[136:143], v122
  s_waitcnt lgkmcnt(6)
  v_smfmac_f32_16x16x64_bf16 v[42:45], v[26:29], v[66:73], v122
  s_waitcnt lgkmcnt(4)
  v_smfmac_f32_16x16x64_bf16 v[46:49], v[26:29], v[74:81], v122
  v_smfmac_f32_16x16x64_bf16 v[58:61], v[22:25], a[144:151], v122
  v_smfmac_f32_16x16x64_bf16 v[62:65], v[22:25], a[152:159], v122
  s_waitcnt lgkmcnt(2)
  v_smfmac_f32_16x16x64_bf16 v[42:45], v[30:33], v[82:89], v122
  s_waitcnt lgkmcnt(0)
  v_smfmac_f32_16x16x64_bf16 v[46:49], v[30:33], v[90:97], v122
  v_smfmac_f32_16x16x64_bf16 v[58:61], v[26:29], a[160:167], v122
  v_smfmac_f32_16x16x64_bf16 v[62:65], v[26:29], a[168:175], v122
  v_cvt_pk_bf16_f32 v98, v42, v43
  v_cvt_pk_bf16_f32 v99, v44, v45
  v_cvt_pk_bf16_f32 v100, v46, v47
  v_cvt_pk_bf16_f32 v101, v48, v49
  s_nop 1
  v_mfma_f32_16x16x32_bf16 v[42:45], v[98:101], v[106:109], 0
  v_mfma_f32_16x16x32_bf16 v[46:49], v[100:103], v[106:109], 0
  s_add_u32 s87, s81, 0xfffe0400
  s_nop 2
  v_cvt_pk_bf16_f32 v42, v42, v43
  v_cvt_pk_bf16_f32 v43, v44, v45
  s_nop 1
  v_cvt_pk_bf16_f32 v44, v46, v47
  v_cvt_pk_bf16_f32 v45, v48, v49
  v_cndmask_b32 v30, v42, v44, vcc
  v_cndmask_b32 v31, v43, v45, vcc
  s_cmp_eq_u32 s84, 0
  s_cbranch_scc1 c20_lgo
c20_lfl:
  s_sub_u32 s51, s51, 1
  s_cbranch_scc1 main_end
  buffer_load_dword v124, off, s[4:7], s82 sc1
  s_waitcnt vmcnt(0)
  v_readfirstlane_b32 s86, v124
  s_cmp_eq_u32 s86, 0
  s_cbranch_scc1 c20_lfl
c20_lgo:
  buffer_store_dwordx2 v[30:31], v119, s[4:7], s87 offen sc1
  v_cvt_pk_bf16_f32 v98, v58, v59
  v_cvt_pk_bf16_f32 v99, v60, v61
  v_cvt_pk_bf16_f32 v100, v62, v63
  v_cvt_pk_bf16_f32 v101, v64, v65
  buffer_store_dwordx4 v[98:101], v115, s[4:7], s81 offen sc1
  s_endpgm
c20_tail:
  s_mov_b32 s72, s52
  ds_read_b128 v[66:69], v115 offset:57344
  ds_read_b128 v[70:73], v115 offset:58368
  ds_read_b128 v[74:77], v115 offset:59392
  ds_read_b128 v[78:81], v115 offset:60416
  ds_read_b128 v[82:85], v116 offset:8192
  ds_read_b128 v[86:89], v116 offset:9216
  ds_read_b128 v[90:93], v116 offset:10240
  ds_read_b128 v[94:97], v116 offset:11264
  s_add_u32 s73, s89, 4096
  s_lshr_b32 s79, s70, 1
  s_add_u32 s77, s76, 0x8000
  s_add_u32 s86, s70, 1
  s_and_b32 s86, s86, 3
  s_lshl_b32 s86, s86, 13
  s_add_u32 s86, s86, s89
  s_add_u32 s74, s86, s88
  s_xor_b32 s75, s74, 0x4000
  s_cmp_eq_u32 s94, 0
  s_cbranch_scc1 c20_kpoll
  s_waitcnt vmcnt(0)
  ds_read_b128 v[50:53], v117 offset:24576
  ds_read_b128 v[54:57], v117 offset:25600
  v_mov_b64 v[2:3], v[12:13]
  v_mov_b64 v[4:5], v[14:15]
  v_mov_b64 v[6:7], v[16:17]
  v_mov_b64 v[8:9], v[18:19]
  s_add_u32 s87, s81, 0xfffe0400
  s_waitcnt lgkmcnt(0)
  s_branch c20_poll0
c30_entry:
  s_branch c30_tail
c30_poll0:
c30_poll:
  s_waitcnt vmcnt(0)
  ds_write_b128 v117, v[2:5] offset:6144
  ds_write_b128 v117, v[6:9] offset:7168
  v_max3_u32 v125, v2, v3, v4
  v_max3_u32 v126, v5, v6, v7
  v_max3_u32 v125, v125, v8, v9
  v_max_u32 v125, v125, v126
  v_cmp_eq_u32 vcc, -1, v125
  s_cbranch_vccz c30_poll_ok
  s_mov_b64 exec, vcc
  buffer_load_dwordx4 v[2:5], v115, s[4:7], s73 offen offset:0 sc1
  buffer_load_dwordx4 v[6:9], v115, s[4:7], s73 offen offset:1024 sc1
  s_sub_u32 s51, s51, 1
  s_cbranch_scc0 c30_poll
  s_endpgm
c30_poll_ok:
  s_mov_b64 exec, -1
  v_smfmac_f32_16x16x64_bf16 v[42:45], v[2:5], v[66:73], v122
  v_smfmac_f32_16x16x64_bf16 v[46:49], v[2:5], v[74:81], v122
  s_waitcnt lgkmcnt(0)
  s_barrier
  buffer_load_dword v124, off, s[4:7], s82 offset:2048 sc1
  v_smfmac_f32_16x16x64_bf16 v[42:45], v[6:9], v[82:89], v122
  ds_read_b128 v[10:13], v117 offset:0
  v_smfmac_f32_16x16x64_bf16 v[46:49], v[6:9], v[90:97], v122
  buffer_store_dwordx2 v[30:31], v119, s[4:7], s87 offen sc1
  ds_read_b128 v[14:17], v117 offset:1024
  v_smfmac_f32_16x16x64_bf16 v[34:37], v[2:5], a[96:103], v122
  ds_read_b128 v[18:21], v117 offset:2048
  v_smfmac_f32_16x16x64_bf16 v[38:41], v[2:5], a[104:111], v122
  ds_read_b128 v[22:25], v117 offset:3072
  v_smfmac_f32_16x16x64_bf16 v[34:37], v[6:9], a[112:119], v122
  ds_read_b128 v[26:29], v117 offset:4096
  v_smfmac_f32_16x16x64_bf16 v[38:41], v[6:9], a[120:127], v122
  ds_read_b128 v[30:33], v117 offset:5120
  s_waitcnt lgkmcnt(5)
  v_smfmac_f32_16x16x64_bf16 v[34:37], v[10:13], a[0:7], v122
  buffer_store_dwordx4 v[98:101], v115, s[4:7], s81 offen sc1
  ds_read_b128 v[66:69], v115 offset:12288
  v_smfmac_f32_16x16x64_bf16 v[38:41], v[10:13], a[8:15], v122
  ds_read_b128 v[70:73], v115 offset:13312
  s_waitcnt lgkmcnt(6)
  v_smfmac_f32_16x16x64_bf16 v[34:37], v[14:17], a[16:23], v122
  ds_read_b128 v[74:77], v115 offset:14336
  v_smfmac_f32_16x16x64_bf16 v[38:41], v[14:17], a[24:31], v122
  ds_read_b128 v[78:81], v115 offset:15360
  s_waitcnt lgkmcnt(7)
  v_mov_b32 v126, -1
  v_smfmac_f32_16x16x64_bf16 v[34:37], v[18:21], a[32:39], v122
  buffer_store_dword v126, v123, s[4:7], s75 offen
  ds_read_b128 v[82:85], v115 offset:28672
  v_smfmac_f32_16x16x64_bf16 v[38:41], v[18:21], a[40:47], v122
  ds_read_b128 v[86:89], v115 offset:29696
  s_waitcnt lgkmcnt(8)
  v_smfmac_f32_16x16x64_bf16 v[34:37], v[22:25], a[48:55], v122
  ds_read_b128 v[90:93], v115 offset:30720
  v_smfmac_f32_16x16x64_bf16 v[38:41], v[22:25], a[56:63], v122
  s_add_u32 s83, s83, 0x40000
  ds_read_b128 v[94:97], v115 offset:31744
  s_waitcnt lgkmcnt(9)
  v_smfmac_f32_16x16x64_bf16 v[34:37], v[26:29], a[64:71], v122
  s_mov_b32 m0, 0x27000
  s_add_u32 s86, s83, 0x1fff800
  v_smfmac_f32_16x16x64_bf16 v[38:41], v[26:29], a[72:79], v122
  s_mov_b64 vcc, s[92:93]
  s_waitcnt lgkmcnt(8)
  v_smfmac_f32_16x16x64_bf16 v[34:37], v[30:33], a[80:87], v122
  v_smfmac_f32_16x16x64_bf16 v[38:41], v[30:33], a[88:95], v122
  s_waitcnt lgkmcnt(6)
  v_smfmac_f32_16x16x64_bf16 v[42:45], v[14:17], v[66:73], v122
  ds_read_b128 v[66:69], v115 offset:45056
  s_waitcnt lgkmcnt(5)
  v_cvt_pk_bf16_f32 v98, v34, v35
  v_cvt_pk_bf16_f32 v99, v36, v37
  v_smfmac_f32_16x16x64_bf16 v[46:49], v[14:17], v[74:81], v122
  ds_read_b128 v[70:73], v115 offset:46080
  v_mfma_f32_16x16x32_bf16 v[34:37], v[98:101], v[106:109], 0
  ds_read_b128 v[74:77], v115 offset:47104
  s_waitcnt lgkmcnt(5)
  v_cvt_pk_bf16_f32 v100, v38, v39
  v_cvt_pk_bf16_f32 v101, v40, v41
  v_smfmac_f32_16x16x64_bf16 v[42:45], v[18:21], v[82:89], v122
  ds_read_b128 v[78:81], v115 offset:48128
  v_mfma_f32_16x16x32_bf16 v[38:41], v[100:103], v[106:109], 0
  ds_read_b128 v[82:85], v115 offset:61440
  s_waitcnt lgkmcnt(5)
  v_cvt_pk_bf16_f32 v34, v34, v35
  v_cvt_pk_bf16_f32 v35, v36, v37
  v_smfmac_f32_16x16x64_bf16 v[46:49], v[18:21], v[90:97], v122
  ds_read_b128 v[86:89], v115 offset:62464
  v_smfmac_f32_16x16x64_bf16 v[42:45], v[10:13], v[128:135], v122
  ds_read_b128 v[90:93], v115 offset:63488
  ds_read_b128 v[94:97], v115 offset:64512
  v_cvt_pk_bf16_f32 v36, v38, v39
  v_cvt_pk_bf16_f32 v37, v40, v41
  v_smfmac_f32_16x16x64_bf16 v[42:45], v[26:29], v[144:151], v122
  s_nop 0
  v_mfma_f32_16x16x32_bf16 v[38:41], v[50:53], v[34:37], 0
  v_mfma_f32_16x16x32_bf16 v[50:53], v[54:57], v[34:37], 0
  s_waitcnt lgkmcnt(6)
  v_smfmac_f32_16x16x64_bf16 v[42:45], v[22:25], v[66:73], v122
  s_waitcnt lgkmcnt(2)
  v_smfmac_f32_16x16x64_bf16 v[42:45], v[30:33], v[82:89], v122
  v_cndmask_b32 v38, v38, v50, vcc
  v_smfmac_f32_16x16x64_bf16 v[46:49], v[10:13], v[136:143], v122
  v_cndmask_b32 v39, v39, v51, vcc
  v_smfmac_f32_16x16x64_bf16 v[46:49], v[26:29], v[152:159], v122
  v_cvt_pk_bf16_f32 v98, v42, v43
  v_smfmac_f32_16x16x64_bf16 v[46:49], v[22:25], v[74:81], v122
  s_waitcnt lgkmcnt(0)
  v_cvt_pk_bf16_f32 v99, v44, v45
  v_smfmac_f32_16x16x64_bf16 v[46:49], v[30:33], v[90:97], v122
  v_cndmask_b32 v40, v40, v52, vcc
  v_mfma_f32_16x16x32_bf16 v[42:45], v[98:101], v[106:109], 0
  v_cndmask_b32 v41, v41, v53, vcc
  s_nop 1
  v_cvt_pk_bf16_f32 v100, v46, v47
  v_cvt_pk_bf16_f32 v101, v48, v49
  s_nop 1
  v_mfma_f32_16x16x32_bf16 v[46:49], v[100:103], v[106:109], 0
  v_cvt_pk_bf16_f32 v42, v42, v43
  v_cvt_pk_bf16_f32 v43, v44, v45
  v_smfmac_f32_16x16x64_bf16 v[58:61], v[2:5], a[224:231], v122
  ds_write_b128 v117, v[38:41] offset:11264
  s_nop 2
  v_cvt_pk_bf16_f32 v44, v46, v47
  v_cvt_pk_bf16_f32 v45, v48, v49
  s_nop 1
  v_mfma_f32_16x16x32_bf16 v[46:49], v[42:45], v[34:37], 0
  v_smfmac_f32_16x16x64_bf16 v[62:65], v[2:5], a[232:239], v122
  s_nop 3
  v_cndmask_b32 v46, v46, v48, vcc
  v_cndmask_b32 v47, v47, v49, vcc
  v_smfmac_f32_16x16x64_bf16 v[58:61], v[6:9], a[240:247], v122
  ds_write_b64 v119, v[46:47] offset:13824
  v_smfmac_f32_16x16x64_bf16 v[62:65], v[6:9], a[248:255], v122
  ds_read_b64 v[94:95], v120 offset:13824
  v_smfmac_f32_16x16x64_bf16 v[58:61], v[30:33], a[208:215], v122
  ds_read_b64 v[2:3], v117 offset:30728
  ds_read_b64 v[4:5], v117 offset:31744
  s_waitcnt vmcnt(3)
  buffer_load_dwordx4 v115, s[4:7], s83 offen offset:0 sc1 lds
  v_smfmac_f32_16x16x64_bf16 v[62:65], v[30:33], a[216:223], v122
  ds_read_b64 v[6:7], v117 offset:30720
  ds_read_b64 v[8:9], v117 offset:31752
  v_readfirstlane_b32 s84, v124
  v_smfmac_f32_16x16x64_bf16 v[58:61], v[10:13], a[128:135], v122
  s_waitcnt lgkmcnt(5)
  s_barrier
  v_smfmac_f32_16x16x64_bf16 v[62:65], v[10:13], a[136:143], v122
  ds_read_b128 v[50:53], v117 offset:8192
  ds_read_b128 v[54:57], v117 offset:9216
  v_cndmask_b32 v30, v42, v44, vcc
  v_smfmac_f32_16x16x64_bf16 v[58:61], v[14:17], a[144:151], v122
  ds_read_b128 v[86:89], v117 offset:10240
  ds_read_b64 v[96:97], v120 offset:12288
  v_cndmask_b32 v31, v43, v45, vcc
  v_smfmac_f32_16x16x64_bf16 v[62:65], v[14:17], a[152:159], v122
  ds_read_b64 v[90:91], v120 offset:12800
  ds_read_b64 v[92:93], v120 offset:13312
  v_mov_b64 v[10:11], 0
  v_smfmac_f32_16x16x64_bf16 v[58:61], v[18:21], a[160:167], v122
  ds_read_b128 v[66:69], v116 offset:45056
  buffer_load_dwordx4 v115, s[4:7], s83 offen offset:1024 sc1 lds
  v_mov_b64 v[12:13], 0
  v_smfmac_f32_16x16x64_bf16 v[62:65], v[18:21], a[168:175], v122
  ds_read_b128 v[70:73], v116 offset:46080
  s_xor_b32 s84, s84, 1
  v_mov_b64 v[14:15], 0
  v_smfmac_f32_16x16x64_bf16 v[58:61], v[22:25], a[176:183], v122
  ds_read_b128 v[74:77], v116 offset:47104
  v_mov_b64 v[16:17], 0
  v_smfmac_f32_16x16x64_bf16 v[62:65], v[22:25], a[184:191], v122
  s_waitcnt lgkmcnt(3)
  buffer_load_dwordx4 v115, s[4:7], s86 offen offset:2048 sc1 lds
  ds_read_b128 v[78:81], v116 offset:48128
  v_add_f32 v38, v38, v50
  v_add_f32 v39, v39, v51
  v_add_f32 v40, v40, v52
  v_add_f32 v41, v41, v53
  v_pk_add_f32 v[38:39], v[38:39], v[54:55]
  v_pk_add_f32 v[40:41], v[40:41], v[56:57]
  v_pk_add_f32 v[38:39], v[38:39], v[86:87]
  v_pk_add_f32 v[40:41], v[40:41], v[88:89]
  v_max3_f32 v125, v38, v39, v40
  v_max_f32 v125, v125, v41
  v_pk_add_f32 v[94:95], v[94:95], v[96:97]
  v_pk_add_f32 v[90:91], v[90:91], v[92:93]
  v_max_f32_dpp v125, v125, v125 row_ror:8 row_mask:0xf bank_mask:0xf
  v_pk_add_f32 v[94:95], v[94:95], v[90:91]
  v_max3_f32 v127, v125, v94, v95
  v_max3_f32 v125, v125, v94, v95
  v_smfmac_f32_16x16x64_bf16 v[58:61], v[26:29], a[192:199], v122
  buffer_load_dwordx4 v115, s[4:7], s86 offen offset:3072 sc1 lds
  v_permlane16_swap_b32 v125, v127
  v_max_f32 v126, v125, v127
  v_max_f32 v125, v125, v127
  v_smfmac_f32_16x16x64_bf16 v[62:65], v[26:29], a[200:207], v122
  ds_read_b128 v[82:85], v116 offset:61440
  v_permlane32_swap_b32 v125, v126
  v_max_f32 v125, v125, v126
  v_mul_f32 v126, s85, v125
  v_pk_fma_f32 v[38:39], v[38:39], s[90:91], v[126:127] op_sel_hi:[1,1,0] neg_lo:[0,0,1] neg_hi:[0,0,1]
  v_pk_fma_f32 v[40:41], v[40:41], s[90:91], v[126:127] op_sel_hi:[1,1,0] neg_lo:[0,0,1] neg_hi:[0,0,1]
  v_pk_fma_f32 v[94:95], v[94:95], s[90:91], v[126:127] op_sel_hi:[1,1,0] neg_lo:[0,0,1] neg_hi:[0,0,1]
  v_exp_f32 v38, v38
  v_exp_f32 v39, v39
  v_exp_f32 v40, v40
  v_exp_f32 v41, v41
  v_cvt_pk_bf16_f32 v42, v38, v39
  v_cvt_pk_bf16_f32 v43, v40, v41
  v_exp_f32 v94, v94
  v_mov_b32_dpp v50, v42 row_shl:8 row_mask:0xf bank_mask:0xf bound_ctrl:0
  v_mov_b32_dpp v51, v43 row_shl:8 row_mask:0xf bank_mask:0xf bound_ctrl:0
  v_mov_b32_dpp v52, v42 row_shr:8 row_mask:0xf bank_mask:0xf bound_ctrl:0
  v_mov_b32_dpp v53, v43 row_shr:8 row_mask:0xf bank_mask:0xf bound_ctrl:0
  v_exp_f32 v95, v95
  v_cndmask_b32_e64 v54, v42, 0, vcc
  v_mfma_f32_16x16x32_bf16 v[34:37], v[2:5], v[50:53], 0
  v_cndmask_b32_e64 v55, v43, 0, vcc
  v_cvt_pk_bf16_f32 v98, v58, v59
  v_cvt_pk_bf16_f32 v99, v60, v61
  v_cvt_pk_bf16_f32 v127, v94, v95
  v_cndmask_b32_e64 v44, v127, 0, vcc
  v_cndmask_b32_e64 v45, v127, 0, vcc
  v_cndmask_b32 v46, 0, v127, vcc
  v_cndmask_b32 v47, 0, v127, vcc
  v_mfma_f32_16x16x32_bf16 v[38:41], v[110:113], v[42:45], 0
  v_cvt_pk_bf16_f32 v100, v62, v63
  v_cvt_pk_bf16_f32 v101, v64, v65
  s_nop 1
  v_mfma_f32_16x16x32_bf16 v[34:37], v[98:101], v[44:47], v[34:37]
  ds_read_b128 v[86:89], v116 offset:62464
  v_cndmask_b32 v56, 0, v42, vcc
  v_cndmask_b32 v57, 0, v43, vcc
  v_mov_b64 v[18:19], 0
  v_mov_b64 v[20:21], 0
  v_mfma_f32_16x16x32_bf16 v[34:37], v[6:9], v[54:57], v[34:37]
  ds_read_b128 v[90:93], v116 offset:63488
  ds_read_b128 v[94:97], v116 offset:64512
  v_add_f32_dpp v125, v38, v38 row_ror:8 row_mask:0xf bank_mask:0xf
  v_rcp_f32 v125, v125
  v_mov_b64 v[22:23], 0
  v_mov_b64 v[24:25], 0
  s_nop 1
  v_pk_mul_f32 v[34:35], v[34:35], v[124:125] op_sel:[0,1] op_sel_hi:[1,1]
  v_pk_mul_f32 v[36:37], v[36:37], v[124:125] op_sel:[0,1] op_sel_hi:[1,1]
  v_cvt_pk_bf16_f32 v34, v34, v35
  v_cvt_pk_bf16_f32 v35, v36, v37
  s_add_u32 s81, s80, 0x1800
  ds_write_b64 v119, v[34:35] offset:15872
  v_cndmask_b32_dpp v36, v34, v34, vcc row_ror:8 row_mask:0xf bank_mask:0xf
  v_cndmask_b32_dpp v37, v35, v35, vcc row_ror:8 row_mask:0xf bank_mask:0xf
  v_mov_b32_dpp v34, v34 row_shr:8 row_mask:0xf bank_mask:0xc
  v_mov_b32_dpp v35, v35 row_shr:8 row_mask:0xf bank_mask:0xc
  s_waitcnt lgkmcnt(1)
  s_nop 0
  v_smfmac_f32_16x16x64_bf16 v[10:13], v[34:37], v[66:73], v114
  v_smfmac_f32_16x16x64_bf16 v[14:17], v[34:37], v[74:81], v114
  s_waitcnt lgkmcnt(0)
  s_barrier
  ds_read_b128 v[38:41], v118 offset:14336
  ds_read_b128 v[42:45], v118 offset:14848
  ds_read_b128 v[46:49], v118 offset:15360
  v_smfmac_f32_16x16x64_bf16 v[18:21], v[34:37], v[82:89], v114
  v_smfmac_f32_16x16x64_bf16 v[22:25], v[34:37], v[90:97], v114
  s_waitcnt lgkmcnt(2)
  v_smfmac_f32_16x16x64_bf16 v[10:13], v[38:41], v[160:167], v114
  v_smfmac_f32_16x16x64_bf16 v[14:17], v[38:41], v[168:175], v114
  s_waitcnt lgkmcnt(1)
  v_smfmac_f32_16x16x64_bf16 v[10:13], v[42:45], v[192:199], v114
  v_smfmac_f32_16x16x64_bf16 v[14:17], v[42:45], v[200:207], v114
  s_waitcnt lgkmcnt(0)
  v_smfmac_f32_16x16x64_bf16 v[10:13], v[46:49], v[224:231], v114
  v_smfmac_f32_16x16x64_bf16 v[14:17], v[46:49], v[232:239], v114
  v_smfmac_f32_16x16x64_bf16 v[18:21], v[38:41], v[176:183], v114
  v_smfmac_f32_16x16x64_bf16 v[22:25], v[38:41], v[184:191], v114
  v_cvt_pk_bf16_f32 v10, v10, v11
  v_cvt_pk_bf16_f32 v11, v12, v13
  v_bfi_b32 v10, 1, s79, v10
  v_smfmac_f32_16x16x64_bf16 v[18:21], v[42:45], v[208:215], v114
  v_cvt_pk_bf16_f32 v12, v14, v15
  v_cvt_pk_bf16_f32 v13, v16, v17
  v_smfmac_f32_16x16x64_bf16 v[22:25], v[42:45], v[216:223], v114
  buffer_store_dwordx4 v[10:13], v121, s[4:7], s76 offen
  v_smfmac_f32_16x16x64_bf16 v[18:21], v[46:49], v[240:247], v114
  v_smfmac_f32_16x16x64_bf16 v[22:25], v[46:49], v[248:255], v114
  s_nop 3
  v_cvt_pk_bf16_f32 v18, v18, v19
  v_cvt_pk_bf16_f32 v19, v20, v21
  v_bfi_b32 v18, 1, s79, v18
  s_nop 0
  v_cvt_pk_bf16_f32 v20, v22, v23
  v_cvt_pk_bf16_f32 v21, v24, v25
  buffer_store_dwordx4 v[18:21], v121, s[4:7], s77 offen
  v_mov_b64 v[34:35], 0
  v_mov_b64 v[36:37], 0
  v_mov_b64 v[38:39], 0
  v_mov_b64 v[40:41], 0
  v_mov_b64 v[42:43], 0
  v_mov_b64 v[44:45], 0
  v_mov_b64 v[46:47], 0
  v_mov_b64 v[48:49], 0
  v_mov_b64 v[58:59], 0
  v_mov_b64 v[60:61], 0
  v_mov_b64 v[62:63], 0
  v_mov_b64 v[64:65], 0
  ds_read_b128 v[66:69], v116 offset:12288
  ds_read_b128 v[70:73], v116 offset:13312
  ds_read_b128 v[74:77], v116 offset:14336
  ds_read_b128 v[78:81], v116 offset:15360
  ds_read_b128 v[82:85], v116 offset:28672
  ds_read_b128 v[86:89], v116 offset:29696
  ds_read_b128 v[90:93], v116 offset:30720
  ds_read_b128 v[94:97], v116 offset:31744
  s_waitcnt vmcnt(0)
  buffer_load_dwordx4 v[2:5], v115, s[4:7], s78 offen offset:0 sc1
  buffer_load_dwordx4 v[6:9], v115, s[4:7], s78 offen offset:1024 sc1
  s_add_u32 s70, s70, 1
  s_add_u32 s82, s82, 2048
  s_add_u32 s80, s80, 0x40000
  s_xor_b32 s76, s76, 0x40000
  s_sub_u32 s73, s74, s88
  s_add_u32 s73, s73, 6144
c30_rpoll:
  s_waitcnt vmcnt(0)
  v_mfma_f32_16x16x32_bf16 v[18:21], v[2:5], v[102:105], 0
  v_mfma_f32_16x16x32_bf16 v[18:21], v[6:9], v[102:105], v[18:21]
  v_bitop3_b32 v125, v2, v6, s79 bitop3:0x7e
  v_and_b32 v125, 1, v125
  v_cmp_ne_u32 vcc, 0, v125
  s_cbranch_vccz c30_rpoll_ok
  s_mov_b64 exec, vcc
  buffer_load_dwordx4 v[2:5], v115, s[4:7], s78 offen offset:0 sc1
  buffer_load_dwordx4 v[6:9], v115, s[4:7], s78 offen offset:1024 sc1
  s_sub_u32 s51, s51, 1
  s_cbranch_scc0 c30_rpoll
  s_endpgm
c30_rpoll_ok:
  s_mov_b64 exec, -1
  s_nop 1
  v_permlane32_swap_b32 v18, v20
  v_permlane32_swap_b32 v19, v21
  v_add_f32 v18, v18, v20
  v_add_f32 v19, v19, v21
  s_nop 1
  v_permlane16_swap_b32 v18, v19
  v_add_f32 v18, v18, v19
  s_nop 1
  v_mov_b32_dpp v19, v18 row_shl:4 row_mask:0xf bank_mask:0xf
  v_cvt_pk_bf16_f32 v18, v18, v19
  v_min_u32 v18, -2, v18
  buffer_store_dword v18, v123, s[4:7], s74 offen
  s_xor_b32 s78, s78, 0x40000
  s_cmp_eq_u32 s70, 63
  s_cbranch_scc1 c30_last
  s_lshr_b32 s79, s70, 1
  s_add_u32 s77, s76, 0x8000
  s_add_u32 s86, s70, 1
  s_and_b32 s86, s86, 3
  s_lshl_b32 s86, s86, 13
  s_add_u32 s86, s86, s89
  s_add_u32 s74, s86, s88
  s_xor_b32 s75, s74, 0x4000
  s_cmp_eq_u32 s84, 0
  s_cbranch_scc1 c30_have
c30_kpoll:
  s_sub_u32 s51, s51, 1
  s_cbranch_scc1 main_end
  buffer_load_dword v124, off, s[4:7], s82 sc1
  s_waitcnt vmcnt(0)
  v_readfirstlane_b32 s87, v124
  s_cmp_eq_u32 s87, 0
  s_cbranch_scc1 c30_kpoll
  s_mov_b32 m0, 0x27000
  s_nop 0
  buffer_load_dwordx4 v115, s[4:7], s83 offen offset:0 sc1 lds
  buffer_load_dwordx4 v115, s[4:7], s83 offen offset:1024 sc1 lds
  s_add_u32 s86, s83, 0x1fff800
  buffer_load_dwordx4 v115, s[4:7], s86 offen offset:2048 sc1 lds
  buffer_load_dwordx4 v115, s[4:7], s86 offen offset:3072 sc1 lds
  buffer_load_dwordx4 v[2:5], v115, s[4:7], s73 offen offset:0 sc1
  buffer_load_dwordx4 v[6:9], v115, s[4:7], s73 offen offset:1024 sc1
  s_add_u32 s87, s81, 0xfffe0400
  s_waitcnt vmcnt(2)
  ds_read_b128 v[50:53], v117 offset:28672
  ds_read_b128 v[54:57], v117 offset:29696
  s_waitcnt lgkmcnt(0)
  s_branch c30_poll0
  s_waitcnt vmcnt(0)
c30_have:
  ds_read_b128 v[50:53], v117 offset:28672
  ds_read_b128 v[54:57], v117 offset:29696
  s_waitcnt vmcnt(0)
  buffer_load_dwordx4 v[2:5], v115, s[4:7], s73 offen offset:0 sc1
  buffer_load_dwordx4 v[6:9], v115, s[4:7], s73 offen offset:1024 sc1
  s_add_u32 s87, s81, 0xfffe0400
  s_waitcnt lgkmcnt(0)
  s_branch c30_poll0
c30_last:
  s_waitcnt vmcnt(0)
  buffer_load_dwordx4 v[2:5], v115, s[4:7], s73 offen offset:0 sc1
  buffer_load_dwordx4 v[6:9], v115, s[4:7], s73 offen offset:1024 sc1
  s_add_u32 s87, s81, 0xfffe0400
  s_waitcnt lgkmcnt(0)
c30_lpoll:
  s_waitcnt vmcnt(0)
  ds_write_b128 v117, v[2:5] offset:6144
  ds_write_b128 v117, v[6:9] offset:7168
  v_max3_u32 v125, v2, v3, v4
  v_max3_u32 v126, v5, v6, v7
  v_max3_u32 v125, v125, v8, v9
  v_max_u32 v125, v125, v126
  v_cmp_eq_u32 vcc, -1, v125
  s_cbranch_vccz c30_lpoll_ok
  s_mov_b64 exec, vcc
  buffer_load_dwordx4 v[2:5], v115, s[4:7], s73 offen offset:0 sc1
  buffer_load_dwordx4 v[6:9], v115, s[4:7], s73 offen offset:1024 sc1
  s_sub_u32 s51, s51, 1
  s_cbranch_scc0 c30_lpoll
  s_endpgm
c30_lpoll_ok:
  s_mov_b64 exec, -1
  buffer_store_dwordx2 v[30:31], v119, s[4:7], s87 offen sc1
  buffer_store_dwordx4 v[98:101], v115, s[4:7], s81 offen sc1
  s_add_u32 s81, s80, 0x1800
  s_mov_b64 vcc, s[92:93]
  v_smfmac_f32_16x16x64_bf16 v[58:61], v[2:5], a[224:231], v122
  v_smfmac_f32_16x16x64_bf16 v[62:65], v[2:5], a[232:239], v122
  s_waitcnt lgkmcnt(0)
  s_barrier
  ds_read_b128 v[30:33], v117 offset:5120
  ds_read_b128 v[10:13], v117 offset:0
  ds_read_b128 v[14:17], v117 offset:1024
  ds_read_b128 v[18:21], v117 offset:2048
  ds_read_b128 v[26:29], v117 offset:4096
  ds_read_b128 v[22:25], v117 offset:3072
  v_smfmac_f32_16x16x64_bf16 v[58:61], v[6:9], a[240:247], v122
  v_smfmac_f32_16x16x64_bf16 v[62:65], v[6:9], a[248:255], v122
  v_smfmac_f32_16x16x64_bf16 v[42:45], v[2:5], v[66:73], v122
  ds_read_b128 v[66:69], v115 offset:12288
  ds_read_b128 v[70:73], v115 offset:13312
  v_smfmac_f32_16x16x64_bf16 v[46:49], v[2:5], v[74:81], v122
  ds_read_b128 v[74:77], v115 offset:14336
  ds_read_b128 v[78:81], v115 offset:15360
  s_waitcnt lgkmcnt(9)
  v_smfmac_f32_16x16x64_bf16 v[58:61], v[30:33], a[208:215], v122
  v_smfmac_f32_16x16x64_bf16 v[62:65], v[30:33], a[216:223], v122
  v_smfmac_f32_16x16x64_bf16 v[42:45], v[6:9], v[82:89], v122
  ds_read_b128 v[82:85], v115 offset:28672
  ds_read_b128 v[86:89], v115 offset:29696
  v_smfmac_f32_16x16x64_bf16 v[46:49], v[6:9], v[90:97], v122
  ds_read_b128 v[90:93], v115 offset:30720
  ds_read_b128 v[94:97], v115 offset:31744
  s_waitcnt lgkmcnt(12)
  v_smfmac_f32_16x16x64_bf16 v[58:61], v[10:13], a[128:135], v122
  v_smfmac_f32_16x16x64_bf16 v[62:65], v[10:13], a[136:143], v122
  s_waitcnt lgkmcnt(6)
  v_smfmac_f32_16x16x64_bf16 v[42:45], v[14:17], v[66:73], v122
  ds_read_b128 v[66:69], v115 offset:45056
  ds_read_b128 v[70:73], v115 offset:46080
  s_waitcnt lgkmcnt(6)
  v_smfmac_f32_16x16x64_bf16 v[46:49], v[14:17], v[74:81], v122
  ds_read_b128 v[74:77], v115 offset:47104
  ds_read_b128 v[78:81], v115 offset:48128
  v_smfmac_f32_16x16x64_bf16 v[58:61], v[14:17], a[144:151], v122
  v_smfmac_f32_16x16x64_bf16 v[62:65], v[14:17], a[152:159], v122
  s_waitcnt lgkmcnt(6)
  v_smfmac_f32_16x16x64_bf16 v[42:45], v[18:21], v[82:89], v122
  ds_read_b128 v[82:85], v115 offset:61440
  ds_read_b128 v[86:89], v115 offset:62464
  s_waitcnt lgkmcnt(6)
  v_smfmac_f32_16x16x64_bf16 v[46:49], v[18:21], v[90:97], v122
  ds_read_b128 v[90:93], v115 offset:63488
  ds_read_b128 v[94:97], v115 offset:64512
  v_smfmac_f32_16x16x64_bf16 v[58:61], v[18:21], a[160:167], v122
  v_smfmac_f32_16x16x64_bf16 v[62:65], v[18:21], a[168:175], v122
  v_smfmac_f32_16x16x64_bf16 v[42:45], v[10:13], v[128:135], v122
  v_smfmac_f32_16x16x64_bf16 v[46:49], v[10:13], v[136:143], v122
  v_smfmac_f32_16x16x64_bf16 v[42:45], v[26:29], v[144:151], v122
  v_smfmac_f32_16x16x64_bf16 v[46:49], v[26:29], v[152:159], v122
  s_waitcnt lgkmcnt(6)
  v_smfmac_f32_16x16x64_bf16 v[42:45], v[22:25], v[66:73], v122
  s_waitcnt lgkmcnt(4)
  v_smfmac_f32_16x16x64_bf16 v[46:49], v[22:25], v[74:81], v122
  v_smfmac_f32_16x16x64_bf16 v[58:61], v[22:25], a[176:183], v122
  v_smfmac_f32_16x16x64_bf16 v[62:65], v[22:25], a[184:191], v122
  s_waitcnt lgkmcnt(2)
  v_smfmac_f32_16x16x64_bf16 v[42:45], v[30:33], v[82:89], v122
  s_waitcnt lgkmcnt(0)
  v_smfmac_f32_16x16x64_bf16 v[46:49], v[30:33], v[90:97], v122
  v_smfmac_f32_16x16x64_bf16 v[58:61], v[26:29], a[192:199], v122
  v_smfmac_f32_16x16x64_bf16 v[62:65], v[26:29], a[200:207], v122
  v_cvt_pk_bf16_f32 v98, v42, v43
  v_cvt_pk_bf16_f32 v99, v44, v45
  v_cvt_pk_bf16_f32 v100, v46, v47
  v_cvt_pk_bf16_f32 v101, v48, v49
  s_nop 1
  v_mfma_f32_16x16x32_bf16 v[42:45], v[98:101], v[106:109], 0
  v_mfma_f32_16x16x32_bf16 v[46:49], v[100:103], v[106:109], 0
  s_add_u32 s87, s81, 0xfffe0400
  s_nop 2
  v_cvt_pk_bf16_f32 v42, v42, v43
  v_cvt_pk_bf16_f32 v43, v44, v45
  s_nop 1
  v_cvt_pk_bf16_f32 v44, v46, v47
  v_cvt_pk_bf16_f32 v45, v48, v49
  v_cndmask_b32 v30, v42, v44, vcc
  v_cndmask_b32 v31, v43, v45, vcc
  s_cmp_eq_u32 s84, 0
  s_cbranch_scc1 c30_lgo
c30_lfl:
  s_sub_u32 s51, s51, 1
  s_cbranch_scc1 main_end
  buffer_load_dword v124, off, s[4:7], s82 sc1
  s_waitcnt vmcnt(0)
  v_readfirstlane_b32 s86, v124
  s_cmp_eq_u32 s86, 0
  s_cbranch_scc1 c30_lfl
c30_lgo:
  buffer_store_dwordx2 v[30:31], v119, s[4:7], s87 offen sc1
  v_cvt_pk_bf16_f32 v98, v58, v59
  v_cvt_pk_bf16_f32 v99, v60, v61
  v_cvt_pk_bf16_f32 v100, v62, v63
  v_cvt_pk_bf16_f32 v101, v64, v65
  buffer_store_dwordx4 v[98:101], v115, s[4:7], s81 offen sc1
  s_endpgm
c30_tail:
  s_mov_b32 s72, s52
  ds_read_b128 v[66:69], v116 offset:12288
  ds_read_b128 v[70:73], v116 offset:13312
  ds_read_b128 v[74:77], v116 offset:14336
  ds_read_b128 v[78:81], v116 offset:15360
  ds_read_b128 v[82:85], v116 offset:28672
  ds_read_b128 v[86:89], v116 offset:29696
  ds_read_b128 v[90:93], v116 offset:30720
  ds_read_b128 v[94:97], v116 offset:31744
  s_add_u32 s73, s89, 6144
  s_lshr_b32 s79, s70, 1
  s_add_u32 s77, s76, 0x8000
  s_add_u32 s86, s70, 1
  s_and_b32 s86, s86, 3
  s_lshl_b32 s86, s86, 13
  s_add_u32 s86, s86, s89
  s_add_u32 s74, s86, s88
  s_xor_b32 s75, s74, 0x4000
  s_cmp_eq_u32 s94, 0
  s_cbranch_scc1 c30_kpoll
  s_waitcnt vmcnt(0)
  ds_read_b128 v[50:53], v117 offset:28672
  ds_read_b128 v[54:57], v117 offset:29696
  v_mov_b64 v[2:3], v[12:13]
  v_mov_b64 v[4:5], v[14:15]
  v_mov_b64 v[6:7], v[16:17]
  v_mov_b64 v[8:9], v[18:19]
  s_add_u32 s87, s81, 0xfffe0400
  s_waitcnt lgkmcnt(0)
  s_branch c30_poll0
c01_entry:
  s_branch c01_tail
c01_poll0:
c01_poll:
  s_waitcnt vmcnt(0)
  ds_write_b128 v117, v[2:5] offset:0
  ds_write_b128 v117, v[6:9] offset:1024
  v_max3_u32 v125, v2, v3, v4
  v_max3_u32 v126, v5, v6, v7
  v_max3_u32 v125, v125, v8, v9
  v_max_u32 v125, v125, v126
  v_cmp_eq_u32 vcc, -1, v125
  s_cbranch_vccz c01_poll_ok
  s_mov_b64 exec, vcc
  buffer_load_dwordx4 v[2:5], v115, s[4:7], s73 offen offset:0 sc1
  buffer_load_dwordx4 v[6:9], v115, s[4:7], s73 offen offset:1024 sc1
  s_sub_u32 s51, s51, 1
  s_cbranch_scc0 c01_poll
  s_endpgm
c01_poll_ok:
  s_mov_b64 exec, -1
  v_smfmac_f32_16x16x64_bf16 v[42:45], v[6:9], v[66:73], v122
  v_smfmac_f32_16x16x64_bf16 v[46:49], v[6:9], v[74:81], v122
  s_waitcnt lgkmcnt(0)
  s_barrier
  buffer_load_dword v124, off, s[4:7], s82 offset:2048 sc1
  v_smfmac_f32_16x16x64_bf16 v[34:37], v[2:5], a[0:7], v122
  ds_read_b128 v[10:13], v117 offset:2048
  v_smfmac_f32_16x16x64_bf16 v[38:41], v[2:5], a[8:15], v122
  buffer_store_dwordx2 v[30:31], v119, s[4:7], s87 offen sc1
  ds_read_b128 v[14:17], v117 offset:3072
  v_smfmac_f32_16x16x64_bf16 v[34:37], v[6:9], a[16:23], v122
  ds_read_b128 v[18:21], v117 offset:4096
  v_smfmac_f32_16x16x64_bf16 v[38:41], v[6:9], a[24:31], v122
  ds_read_b128 v[22:25], v117 offset:5120
  s_waitcnt lgkmcnt(3)
  v_smfmac_f32_16x16x64_bf16 v[42:45], v[10:13], v[82:89], v122
  ds_read_b128 v[26:29], v117 offset:6144
  v_smfmac_f32_16x16x64_bf16 v[46:49], v[10:13], v[90:97], v122
  ds_read_b128 v[30:33], v117 offset:7168
  v_smfmac_f32_16x16x64_bf16 v[34:37], v[10:13], a[32:39], v122
  buffer_store_dwordx4 v[98:101], v115, s[4:7], s81 offen sc1
  ds_read_b128 v[66:69], v115 offset:32768
  v_smfmac_f32_16x16x64_bf16 v[38:41], v[10:13], a[40:47], v122
  ds_read_b128 v[70:73], v115 offset:33792
  s_waitcnt lgkmcnt(6)
  v_smfmac_f32_16x16x64_bf16 v[34:37], v[14:17], a[48:55], v122
  ds_read_b128 v[74:77], v115 offset:34816
  v_smfmac_f32_16x16x64_bf16 v[38:41], v[14:17], a[56:63], v122
  ds_read_b128 v[78:81], v115 offset:35840
  s_waitcnt lgkmcnt(7)
  v_mov_b32 v126, -1
  v_smfmac_f32_16x16x64_bf16 v[34:37], v[18:21], a[64:71], v122
  buffer_store_dword v126, v123, s[4:7], s75 offen sc1
  ds_read_b128 v[82:85], v115 offset:49152
  v_smfmac_f32_16x16x64_bf16 v[38:41], v[18:21], a[72:79], v122
  ds_read_b128 v[86:89], v115 offset:50176
  s_waitcnt lgkmcnt(8)
  v_smfmac_f32_16x16x64_bf16 v[34:37], v[22:25], a[80:87], v122
  ds_read_b128 v[90:93], v115 offset:51200
  v_smfmac_f32_16x16x64_bf16 v[38:41], v[22:25], a[88:95], v122
  s_add_u32 s83, s83, 0x40000
  ds_read_b128 v[94:97], v115 offset:52224
  s_waitcnt lgkmcnt(9)
  v_smfmac_f32_16x16x64_bf16 v[34:37], v[26:29], a[96:103], v122
  s_mov_b32 m0, 0x24000
  s_add_u32 s86, s83, 0x1fff800
  v_smfmac_f32_16x16x64_bf16 v[38:41], v[26:29], a[104:111], v122
  s_mov_b64 vcc, s[92:93]
  s_waitcnt lgkmcnt(8)
  v_smfmac_f32_16x16x64_bf16 v[34:37], v[30:33], a[112:119], v122
  v_smfmac_f32_16x16x64_bf16 v[38:41], v[30:33], a[120:127], v122
  s_waitcnt lgkmcnt(6)
  v_smfmac_f32_16x16x64_bf16 v[42:45], v[14:17], v[66:73], v122
  ds_read_b128 v[66:69], v116 offset:0
  s_waitcnt lgkmcnt(5)
  v_cvt_pk_bf16_f32 v98, v34, v35
  v_cvt_pk_bf16_f32 v99, v36, v37
  v_smfmac_f32_16x16x64_bf16 v[46:49], v[14:17], v[74:81], v122
  ds_read_b128 v[70:73], v116 offset:1024
  v_mfma_f32_16x16x32_bf16 v[34:37], v[98:101], v[106:109], 0
  ds_read_b128 v[74:77], v116 offset:2048
  s_waitcnt lgkmcnt(5)
  v_cvt_pk_bf16_f32 v100, v38, v39
  v_cvt_pk_bf16_f32 v101, v40, v41
  v_smfmac_f32_16x16x64_bf16 v[42:45], v[22:25], v[82:89], v122
  ds_read_b128 v[78:81], v116 offset:3072
  v_mfma_f32_16x16x32_bf16 v[38:41], v[100:103], v[106:109], 0
  ds_read_b128 v[82:85], v116 offset:16384
  s_waitcnt lgkmcnt(5)
  v_cvt_pk_bf16_f32 v34, v34, v35
  v_cvt_pk_bf16_f32 v35, v36, v37
  v_smfmac_f32_16x16x64_bf16 v[46:49], v[22:25], v[90:97], v122
  ds_read_b128 v[86:89], v116 offset:17408
  v_smfmac_f32_16x16x64_bf16 v[42:45], v[2:5], v[128:135], v122
  ds_read_b128 v[90:93], v116 offset:18432
  ds_read_b128 v[94:97], v116 offset:19456
  v_cvt_pk_bf16_f32 v36, v38, v39
  v_cvt_pk_bf16_f32 v37, v40, v41
  v_smfmac_f32_16x16x64_bf16 v[42:45], v[18:21], v[144:151], v122
  s_nop 0
  v_mfma_f32_16x16x32_bf16 v[38:41], v[50:53], v[34:37], 0
  v_mfma_f32_16x16x32_bf16 v[50:53], v[54:57], v[34:37], 0
  s_waitcnt lgkmcnt(6)
  v_smfmac_f32_16x16x64_bf16 v[42:45], v[26:29], v[66:73], v122
  s_waitcnt lgkmcnt(2)
  v_smfmac_f32_16x16x64_bf16 v[42:45], v[30:33], v[82:89], v122
  v_cndmask_b32 v38, v38, v50, vcc
  v_smfmac_f32_16x16x64_bf16 v[46:49], v[2:5], v[136:143], v122
  v_cndmask_b32 v39, v39, v51, vcc
  v_smfmac_f32_16x16x64_bf16 v[46:49], v[18:21], v[152:159], v122
  v_cvt_pk_bf16_f32 v98, v42, v43
  v_smfmac_f32_16x16x64_bf16 v[46:49], v[26:29], v[74:81], v122
  s_waitcnt lgkmcnt(0)
  v_cvt_pk_bf16_f32 v99, v44, v45
  v_smfmac_f32_16x16x64_bf16 v[46:49], v[30:33], v[90:97], v122
  v_cndmask_b32 v40, v40, v52, vcc
  v_mfma_f32_16x16x32_bf16 v[42:45], v[98:101], v[106:109], 0
  v_cndmask_b32 v41, v41, v53, vcc
  s_nop 1
  v_cvt_pk_bf16_f32 v100, v46, v47
  v_cvt_pk_bf16_f32 v101, v48, v49
  s_nop 1
  v_mfma_f32_16x16x32_bf16 v[46:49], v[100:103], v[106:109], 0
  v_cvt_pk_bf16_f32 v42, v42, v43
  v_cvt_pk_bf16_f32 v43, v44, v45
  v_smfmac_f32_16x16x64_bf16 v[58:61], v[2:5], a[128:135], v122
  ds_write_b128 v117, v[38:41] offset:8192
  s_nop 2
  v_cvt_pk_bf16_f32 v44, v46, v47
  v_cvt_pk_bf16_f32 v45, v48, v49
  s_nop 1
  v_mfma_f32_16x16x32_bf16 v[46:49], v[42:45], v[34:37], 0
  v_smfmac_f32_16x16x64_bf16 v[62:65], v[2:5], a[136:143], v122
  s_nop 3
  v_cndmask_b32 v46, v46, v48, vcc
  v_cndmask_b32 v47, v47, v49, vcc
  v_smfmac_f32_16x16x64_bf16 v[58:61], v[6:9], a[144:151], v122
  ds_write_b64 v119, v[46:47] offset:12288
  v_smfmac_f32_16x16x64_bf16 v[62:65], v[6:9], a[152:159], v122
  ds_read_b64 v[94:95], v120 offset:12288
  v_smfmac_f32_16x16x64_bf16 v[58:61], v[30:33], a[240:247], v122
  ds_read_b64 v[2:3], v117 offset:18440
  ds_read_b64 v[4:5], v117 offset:19456
  s_waitcnt vmcnt(3)
  buffer_load_dwordx4 v115, s[4:7], s83 offen offset:0 sc1 lds
  v_smfmac_f32_16x16x64_bf16 v[62:65], v[30:33], a[248:255], v122
  ds_read_b64 v[6:7], v117 offset:18432
  ds_read_b64 v[8:9], v117 offset:19464
  v_readfirstlane_b32 s84, v124
  v_smfmac_f32_16x16x64_bf16 v[58:61], v[10:13], a[160:167], v122
  s_waitcnt lgkmcnt(5)
  s_barrier
  v_smfmac_f32_16x16x64_bf16 v[62:65], v[10:13], a[168:175], v122
  ds_read_b128 v[50:53], v117 offset:9216
  ds_read_b128 v[54:57], v117 offset:10240
  v_cndmask_b32 v30, v42, v44, vcc
  v_smfmac_f32_16x16x64_bf16 v[58:61], v[14:17], a[176:183], v122
  ds_read_b128 v[86:89], v117 offset:11264
  ds_read_b64 v[96:97], v120 offset:12800
  v_cndmask_b32 v31, v43, v45, vcc
  v_smfmac_f32_16x16x64_bf16 v[62:65], v[14:17], a[184:191], v122
  ds_read_b64 v[90:91], v120 offset:13312
  ds_read_b64 v[92:93], v120 offset:13824
  v_mov_b64 v[10:11], 0
  v_smfmac_f32_16x16x64_bf16 v[58:61], v[18:21], a[192:199], v122
  ds_read_b128 v[66:69], v116 offset:32768
  buffer_load_dwordx4 v115, s[4:7], s83 offen offset:1024 sc1 lds
  v_mov_b64 v[12:13], 0
  v_smfmac_f32_16x16x64_bf16 v[62:65], v[18:21], a[200:207], v122
  ds_read_b128 v[70:73], v116 offset:33792
  s_xor_b32 s84, s84, 1
  v_mov_b64 v[14:15], 0
  v_smfmac_f32_16x16x64_bf16 v[58:61], v[22:25], a[208:215], v122
  ds_read_b128 v[74:77], v116 offset:34816
  v_mov_b64 v[16:17], 0
  v_smfmac_f32_16x16x64_bf16 v[62:65], v[22:25], a[216:223], v122
  s_waitcnt lgkmcnt(3)
  buffer_load_dwordx4 v115, s[4:7], s86 offen offset:2048 sc1 lds
  ds_read_b128 v[78:81], v116 offset:35840
  v_add_f32 v38, v38, v50
  v_add_f32 v39, v39, v51
  v_add_f32 v40, v40, v52
  v_add_f32 v41, v41, v53
  v_pk_add_f32 v[38:39], v[38:39], v[54:55]
  v_pk_add_f32 v[40:41], v[40:41], v[56:57]
  v_pk_add_f32 v[38:39], v[38:39], v[86:87]
  v_pk_add_f32 v[40:41], v[40:41], v[88:89]
  v_max3_f32 v125, v38, v39, v40
  v_max_f32 v125, v125, v41
  v_pk_add_f32 v[94:95], v[94:95], v[96:97]
  v_pk_add_f32 v[90:91], v[90:91], v[92:93]
  v_max_f32_dpp v125, v125, v125 row_ror:8 row_mask:0xf bank_mask:0xf
  v_pk_add_f32 v[94:95], v[94:95], v[90:91]
  v_max3_f32 v127, v125, v94, v95
  v_max3_f32 v125, v125, v94, v95
  v_smfmac_f32_16x16x64_bf16 v[58:61], v[26:29], a[224:231], v122
  buffer_load_dwordx4 v115, s[4:7], s86 offen offset:3072 sc1 lds
  v_permlane16_swap_b32 v125, v127
  v_max_f32 v126, v125, v127
  v_max_f32 v125, v125, v127
  v_smfmac_f32_16x16x64_bf16 v[62:65], v[26:29], a[232:239], v122
  ds_read_b128 v[82:85], v116 offset:49152
  v_permlane32_swap_b32 v125, v126
  v_max_f32 v125, v125, v126
  v_mul_f32 v126, s85, v125
  v_pk_fma_f32 v[38:39], v[38:39], s[90:91], v[126:127] op_sel_hi:[1,1,0] neg_lo:[0,0,1] neg_hi:[0,0,1]
  v_pk_fma_f32 v[40:41], v[40:41], s[90:91], v[126:127] op_sel_hi:[1,1,0] neg_lo:[0,0,1] neg_hi:[0,0,1]
  v_pk_fma_f32 v[94:95], v[94:95], s[90:91], v[126:127] op_sel_hi:[1,1,0] neg_lo:[0,0,1] neg_hi:[0,0,1]
  v_exp_f32 v38, v38
  v_exp_f32 v39, v39
  v_exp_f32 v40, v40
  v_exp_f32 v41, v41
  v_cvt_pk_bf16_f32 v42, v38, v39
  v_cvt_pk_bf16_f32 v43, v40, v41
  v_exp_f32 v94, v94
  v_mov_b32_dpp v50, v42 row_shl:8 row_mask:0xf bank_mask:0xf bound_ctrl:0
  v_mov_b32_dpp v51, v43 row_shl:8 row_mask:0xf bank_mask:0xf bound_ctrl:0
  v_mov_b32_dpp v52, v42 row_shr:8 row_mask:0xf bank_mask:0xf bound_ctrl:0
  v_mov_b32_dpp v53, v43 row_shr:8 row_mask:0xf bank_mask:0xf bound_ctrl:0
  v_exp_f32 v95, v95
  v_cndmask_b32_e64 v54, v42, 0, vcc
  v_mfma_f32_16x16x32_bf16 v[34:37], v[2:5], v[50:53], 0
  v_cndmask_b32_e64 v55, v43, 0, vcc
  v_cvt_pk_bf16_f32 v98, v58, v59
  v_cvt_pk_bf16_f32 v99, v60, v61
  v_cvt_pk_bf16_f32 v127, v94, v95
  v_cndmask_b32_e64 v44, v127, 0, vcc
  v_cndmask_b32_e64 v45, v127, 0, vcc
  v_cndmask_b32 v46, 0, v127, vcc
  v_cndmask_b32 v47, 0, v127, vcc
  v_mfma_f32_16x16x32_bf16 v[38:41], v[110:113], v[42:45], 0
  v_cvt_pk_bf16_f32 v100, v62, v63
  v_cvt_pk_bf16_f32 v101, v64, v65
  s_nop 1
  v_mfma_f32_16x16x32_bf16 v[34:37], v[98:101], v[44:47], v[34:37]
  ds_read_b128 v[86:89], v116 offset:50176
  v_cndmask_b32 v56, 0, v42, vcc
  v_cndmask_b32 v57, 0, v43, vcc
  v_mov_b64 v[18:19], 0
  v_mov_b64 v[20:21], 0
  v_mfma_f32_16x16x32_bf16 v[34:37], v[6:9], v[54:57], v[34:37]
  ds_read_b128 v[90:93], v116 offset:51200
  ds_read_b128 v[94:97], v116 offset:52224
  v_add_f32_dpp v125, v38, v38 row_ror:8 row_mask:0xf bank_mask:0xf
  v_rcp_f32 v125, v125
  v_mov_b64 v[22:23], 0
  v_mov_b64 v[24:25], 0
  s_nop 1
  v_pk_mul_f32 v[34:35], v[34:35], v[124:125] op_sel:[0,1] op_sel_hi:[1,1]
  v_pk_mul_f32 v[36:37], v[36:37], v[124:125] op_sel:[0,1] op_sel_hi:[1,1]
  v_cvt_pk_bf16_f32 v34, v34, v35
  v_cvt_pk_bf16_f32 v35, v36, v37
  s_add_u32 s81, s80, 0x0
  ds_write_b64 v119, v[34:35] offset:14336
  v_cndmask_b32_dpp v36, v34, v34, vcc row_ror:8 row_mask:0xf bank_mask:0xf
  v_cndmask_b32_dpp v37, v35, v35, vcc row_ror:8 row_mask:0xf bank_mask:0xf
  v_mov_b32_dpp v34, v34 row_shr:8 row_mask:0xf bank_mask:0xc
  v_mov_b32_dpp v35, v35 row_shr:8 row_mask:0xf bank_mask:0xc
  s_waitcnt lgkmcnt(1)
  s_nop 0
  v_smfmac_f32_16x16x64_bf16 v[10:13], v[34:37], v[160:167], v114
  v_smfmac_f32_16x16x64_bf16 v[14:17], v[34:37], v[168:175], v114
  s_waitcnt lgkmcnt(0)
  s_barrier
  ds_read_b128 v[38:41], v118 offset:14848
  ds_read_b128 v[42:45], v118 offset:15360
  ds_read_b128 v[46:49], v118 offset:15872
  v_smfmac_f32_16x16x64_bf16 v[18:21], v[34:37], v[176:183], v114
  v_smfmac_f32_16x16x64_bf16 v[22:25], v[34:37], v[184:191], v114
  s_waitcnt lgkmcnt(2)
  v_smfmac_f32_16x16x64_bf16 v[10:13], v[38:41], v[192:199], v114
  v_smfmac_f32_16x16x64_bf16 v[14:17], v[38:41], v[200:207], v114
  s_waitcnt lgkmcnt(1)
  v_smfmac_f32_16x16x64_bf16 v[10:13], v[42:45], v[224:231], v114
  v_smfmac_f32_16x16x64_bf16 v[14:17], v[42:45], v[232:239], v114
  s_waitcnt lgkmcnt(0)
  v_smfmac_f32_16x16x64_bf16 v[10:13], v[46:49], v[66:73], v114
  v_smfmac_f32_16x16x64_bf16 v[14:17], v[46:49], v[74:81], v114
  v_smfmac_f32_16x16x64_bf16 v[18:21], v[38:41], v[208:215], v114
  v_smfmac_f32_16x16x64_bf16 v[22:25], v[38:41], v[216:223], v114
  v_cvt_pk_bf16_f32 v10, v10, v11
  v_cvt_pk_bf16_f32 v11, v12, v13
  v_bfi_b32 v10, 1, s79, v10
  v_smfmac_f32_16x16x64_bf16 v[18:21], v[42:45], v[240:247], v114
  v_cvt_pk_bf16_f32 v12, v14, v15
  v_cvt_pk_bf16_f32 v13, v16, v17
  v_smfmac_f32_16x16x64_bf16 v[22:25], v[42:45], v[248:255], v114
  buffer_store_dwordx4 v[10:13], v121, s[4:7], s76 offen sc1
  v_smfmac_f32_16x16x64_bf16 v[18:21], v[46:49], v[82:89], v114
  v_smfmac_f32_16x16x64_bf16 v[22:25], v[46:49], v[90:97], v114
  s_nop 3
  v_cvt_pk_bf16_f32 v18, v18, v19
  v_cvt_pk_bf16_f32 v19, v20, v21
  v_bfi_b32 v18, 1, s79, v18
  s_nop 0
  v_cvt_pk_bf16_f32 v20, v22, v23
  v_cvt_pk_bf16_f32 v21, v24, v25
  buffer_store_dwordx4 v[18:21], v121, s[4:7], s77 offen sc1
  v_mov_b64 v[34:35], 0
  v_mov_b64 v[36:37], 0
  v_mov_b64 v[38:39], 0
  v_mov_b64 v[40:41], 0
  v_mov_b64 v[42:43], 0
  v_mov_b64 v[44:45], 0
  v_mov_b64 v[46:47], 0
  v_mov_b64 v[48:49], 0
  v_mov_b64 v[58:59], 0
  v_mov_b64 v[60:61], 0
  v_mov_b64 v[62:63], 0
  v_mov_b64 v[64:65], 0
  ds_read_b128 v[66:69], v115 offset:0
  ds_read_b128 v[70:73], v115 offset:1024
  ds_read_b128 v[74:77], v115 offset:2048
  ds_read_b128 v[78:81], v115 offset:3072
  ds_read_b128 v[82:85], v115 offset:16384
  ds_read_b128 v[86:89], v115 offset:17408
  ds_read_b128 v[90:93], v115 offset:18432
  ds_read_b128 v[94:97], v115 offset:19456
  s_waitcnt vmcnt(0)
  buffer_load_dwordx4 v[2:5], v115, s[4:7], s78 offen offset:0 sc1
  buffer_load_dwordx4 v[6:9], v115, s[4:7], s78 offen offset:1024 sc1
  s_add_u32 s70, s70, 1
  s_add_u32 s82, s82, 2048
  s_add_u32 s80, s80, 0x40000
  s_xor_b32 s76, s76, 0x40000
  s_sub_u32 s73, s74, s88
  s_add_u32 s73, s73, 0
c01_rpoll:
  s_waitcnt vmcnt(0)
  v_mfma_f32_16x16x32_bf16 v[18:21], v[2:5], v[102:105], 0
  v_mfma_f32_16x16x32_bf16 v[18:21], v[6:9], v[102:105], v[18:21]
  v_bitop3_b32 v125, v2, v6, s79 bitop3:0x7e
  v_and_b32 v125, 1, v125
  v_cmp_ne_u32 vcc, 0, v125
  s_cbranch_vccz c01_rpoll_ok
  s_mov_b64 exec, vcc
  buffer_load_dwordx4 v[2:5], v115, s[4:7], s78 offen offset:0 sc1
  buffer_load_dwordx4 v[6:9], v115, s[4:7], s78 offen offset:1024 sc1
  s_sub_u32 s51, s51, 1
  s_cbranch_scc0 c01_rpoll
  s_endpgm
c01_rpoll_ok:
  s_mov_b64 exec, -1
  s_nop 1
  v_permlane32_swap_b32 v18, v20
  v_permlane32_swap_b32 v19, v21
  v_add_f32 v18, v18, v20
  v_add_f32 v19, v19, v21
  s_nop 1
  v_permlane16_swap_b32 v18, v19
  v_add_f32 v18, v18, v19
  s_nop 1
  v_mov_b32_dpp v19, v18 row_shl:4 row_mask:0xf bank_mask:0xf
  v_cvt_pk_bf16_f32 v18, v18, v19
  v_min_u32 v18, -2, v18
  buffer_store_dword v18, v123, s[4:7], s74 offen sc1
  s_xor_b32 s78, s78, 0x40000
  s_cmp_eq_u32 s70, 63
  s_cbranch_scc1 c01_last
  s_lshr_b32 s79, s70, 1
  s_add_u32 s77, s76, 0x8000
  s_add_u32 s86, s70, 1
  s_and_b32 s86, s86, 3
  s_lshl_b32 s86, s86, 13
  s_add_u32 s86, s86, s89
  s_add_u32 s74, s86, s88
  s_xor_b32 s75, s74, 0x4000
  s_cmp_eq_u32 s84, 0
  s_cbranch_scc1 c01_have
c01_kpoll:
  s_sub_u32 s51, s51, 1
  s_cbranch_scc1 main_end
  buffer_load_dword v124, off, s[4:7], s82 sc1
  s_waitcnt vmcnt(0)
  v_readfirstlane_b32 s87, v124
  s_cmp_eq_u32 s87, 0
  s_cbranch_scc1 c01_kpoll
  s_mov_b32 m0, 0x24000
  s_nop 0
  buffer_load_dwordx4 v115, s[4:7], s83 offen offset:0 sc1 lds
  buffer_load_dwordx4 v115, s[4:7], s83 offen offset:1024 sc1 lds
  s_add_u32 s86, s83, 0x1fff800
  buffer_load_dwordx4 v115, s[4:7], s86 offen offset:2048 sc1 lds
  buffer_load_dwordx4 v115, s[4:7], s86 offen offset:3072 sc1 lds
  buffer_load_dwordx4 v[2:5], v115, s[4:7], s73 offen offset:0 sc1
  buffer_load_dwordx4 v[6:9], v115, s[4:7], s73 offen offset:1024 sc1
  s_add_u32 s87, s81, 0xfffe0400
  s_waitcnt vmcnt(2)
  ds_read_b128 v[50:53], v117 offset:16384
  ds_read_b128 v[54:57], v117 offset:17408
  s_waitcnt lgkmcnt(0)
  s_branch c01_poll0
  s_waitcnt vmcnt(0)
c01_have:
  ds_read_b128 v[50:53], v117 offset:16384
  ds_read_b128 v[54:57], v117 offset:17408
  s_waitcnt vmcnt(0)
  buffer_load_dwordx4 v[2:5], v115, s[4:7], s73 offen offset:0 sc1
  buffer_load_dwordx4 v[6:9], v115, s[4:7], s73 offen offset:1024 sc1
  s_add_u32 s87, s81, 0xfffe0400
  s_waitcnt lgkmcnt(0)
  s_branch c01_poll0
c01_last:
  s_waitcnt vmcnt(0)
  buffer_load_dwordx4 v[2:5], v115, s[4:7], s73 offen offset:0 sc1
  buffer_load_dwordx4 v[6:9], v115, s[4:7], s73 offen offset:1024 sc1
  s_add_u32 s87, s81, 0xfffe0400
  s_waitcnt lgkmcnt(0)
c01_lpoll:
  s_waitcnt vmcnt(0)
  ds_write_b128 v117, v[2:5] offset:0
  ds_write_b128 v117, v[6:9] offset:1024
  v_max3_u32 v125, v2, v3, v4
  v_max3_u32 v126, v5, v6, v7
  v_max3_u32 v125, v125, v8, v9
  v_max_u32 v125, v125, v126
  v_cmp_eq_u32 vcc, -1, v125
  s_cbranch_vccz c01_lpoll_ok
  s_mov_b64 exec, vcc
  buffer_load_dwordx4 v[2:5], v115, s[4:7], s73 offen offset:0 sc1
  buffer_load_dwordx4 v[6:9], v115, s[4:7], s73 offen offset:1024 sc1
  s_sub_u32 s51, s51, 1
  s_cbranch_scc0 c01_lpoll
  s_endpgm
c01_lpoll_ok:
  s_mov_b64 exec, -1
  buffer_store_dwordx2 v[30:31], v119, s[4:7], s87 offen sc1
  buffer_store_dwordx4 v[98:101], v115, s[4:7], s81 offen sc1
  s_add_u32 s81, s80, 0x0
  s_mov_b64 vcc, s[92:93]
  v_smfmac_f32_16x16x64_bf16 v[58:61], v[2:5], a[128:135], v122
  v_smfmac_f32_16x16x64_bf16 v[62:65], v[2:5], a[136:143], v122
  s_waitcnt lgkmcnt(0)
  s_barrier
  ds_read_b128 v[30:33], v117 offset:7168
  ds_read_b128 v[10:13], v117 offset:2048
  ds_read_b128 v[14:17], v117 offset:3072
  ds_read_b128 v[22:25], v117 offset:5120
  ds_read_b128 v[18:21], v117 offset:4096
  ds_read_b128 v[26:29], v117 offset:6144
  v_smfmac_f32_16x16x64_bf16 v[58:61], v[6:9], a[144:151], v122
  v_smfmac_f32_16x16x64_bf16 v[62:65], v[6:9], a[152:159], v122
  v_smfmac_f32_16x16x64_bf16 v[42:45], v[6:9], v[66:73], v122
  ds_read_b128 v[66:69], v115 offset:32768
  ds_read_b128 v[70:73], v115 offset:33792
  v_smfmac_f32_16x16x64_bf16 v[46:49], v[6:9], v[74:81], v122
  ds_read_b128 v[74:77], v115 offset:34816
  ds_read_b128 v[78:81], v115 offset:35840
  s_waitcnt lgkmcnt(9)
  v_smfmac_f32_16x16x64_bf16 v[58:61], v[30:33], a[240:247], v122
  v_smfmac_f32_16x16x64_bf16 v[62:65], v[30:33], a[248:255], v122
  s_waitcnt lgkmcnt(8)
  v_smfmac_f32_16x16x64_bf16 v[42:45], v[10:13], v[82:89], v122
  ds_read_b128 v[82:85], v115 offset:49152
  ds_read_b128 v[86:89], v115 offset:50176
  v_smfmac_f32_16x16x64_bf16 v[46:49], v[10:13], v[90:97], v122
  ds_read_b128 v[90:93], v115 offset:51200
  ds_read_b128 v[94:97], v115 offset:52224
  v_smfmac_f32_16x16x64_bf16 v[58:61], v[10:13], a[160:167], v122
  v_smfmac_f32_16x16x64_bf16 v[62:65], v[10:13], a[168:175], v122
  s_waitcnt lgkmcnt(6)
  v_smfmac_f32_16x16x64_bf16 v[42:45], v[14:17], v[66:73], v122
  ds_read_b128 v[66:69], v116 offset:0
  ds_read_b128 v[70:73], v116 offset:1024
  s_waitcnt lgkmcnt(6)
  v_smfmac_f32_16x16x64_bf16 v[46:49], v[14:17], v[74:81], v122
  ds_read_b128 v[74:77], v116 offset:2048
  ds_read_b128 v[78:81], v116 offset:3072
  v_smfmac_f32_16x16x64_bf16 v[58:61], v[14:17], a[176:183], v122
  v_smfmac_f32_16x16x64_bf16 v[62:65], v[14:17], a[184:191], v122
  s_waitcnt lgkmcnt(6)
  v_smfmac_f32_16x16x64_bf16 v[42:45], v[22:25], v[82:89], v122
  ds_read_b128 v[82:85], v116 offset:16384
  ds_read_b128 v[86:89], v116 offset:17408
  s_waitcnt lgkmcnt(6)
  v_smfmac_f32_16x16x64_bf16 v[46:49], v[22:25], v[90:97], v122
  ds_read_b128 v[90:93], v116 offset:18432
  ds_read_b128 v[94:97], v116 offset:19456
  v_smfmac_f32_16x16x64_bf16 v[58:61], v[18:21], a[192:199], v122
  v_smfmac_f32_16x16x64_bf16 v[62:65], v[18:21], a[200:207], v122
  v_smfmac_f32_16x16x64_bf16 v[42:45], v[2:5], v[128:135], v122
  v_smfmac_f32_16x16x64_bf16 v[46:49], v[2:5], v[136:143], v122
  v_smfmac_f32_16x16x64_bf16 v[42:45], v[18:21], v[144:151], v122
  v_smfmac_f32_16x16x64_bf16 v[46:49], v[18:21], v[152:159], v122
  s_waitcnt lgkmcnt(6)
  v_smfmac_f32_16x16x64_bf16 v[42:45], v[26:29], v[66:73], v122
  s_waitcnt lgkmcnt(4)
  v_smfmac_f32_16x16x64_bf16 v[46:49], v[26:29], v[74:81], v122
  v_smfmac_f32_16x16x64_bf16 v[58:61], v[22:25], a[208:215], v122
  v_smfmac_f32_16x16x64_bf16 v[62:65], v[22:25], a[216:223], v122
  s_waitcnt lgkmcnt(2)
  v_smfmac_f32_16x16x64_bf16 v[42:45], v[30:33], v[82:89], v122
  s_waitcnt lgkmcnt(0)
  v_smfmac_f32_16x16x64_bf16 v[46:49], v[30:33], v[90:97], v122
  v_smfmac_f32_16x16x64_bf16 v[58:61], v[26:29], a[224:231], v122
  v_smfmac_f32_16x16x64_bf16 v[62:65], v[26:29], a[232:239], v122
  v_cvt_pk_bf16_f32 v98, v42, v43
  v_cvt_pk_bf16_f32 v99, v44, v45
  v_cvt_pk_bf16_f32 v100, v46, v47
  v_cvt_pk_bf16_f32 v101, v48, v49
  s_nop 1
  v_mfma_f32_16x16x32_bf16 v[42:45], v[98:101], v[106:109], 0
  v_mfma_f32_16x16x32_bf16 v[46:49], v[100:103], v[106:109], 0
  s_add_u32 s87, s81, 0xfffe0400
  s_nop 2
  v_cvt_pk_bf16_f32 v42, v42, v43
  v_cvt_pk_bf16_f32 v43, v44, v45
  s_nop 1
  v_cvt_pk_bf16_f32 v44, v46, v47
  v_cvt_pk_bf16_f32 v45, v48, v49
  v_cndmask_b32 v30, v42, v44, vcc
  v_cndmask_b32 v31, v43, v45, vcc
  s_cmp_eq_u32 s84, 0
  s_cbranch_scc1 c01_lgo
c01_lfl:
  s_sub_u32 s51, s51, 1
  s_cbranch_scc1 main_end
  buffer_load_dword v124, off, s[4:7], s82 sc1
  s_waitcnt vmcnt(0)
  v_readfirstlane_b32 s86, v124
  s_cmp_eq_u32 s86, 0
  s_cbranch_scc1 c01_lfl
c01_lgo:
  buffer_store_dwordx2 v[30:31], v119, s[4:7], s87 offen sc1
  v_cvt_pk_bf16_f32 v98, v58, v59
  v_cvt_pk_bf16_f32 v99, v60, v61
  v_cvt_pk_bf16_f32 v100, v62, v63
  v_cvt_pk_bf16_f32 v101, v64, v65
  buffer_store_dwordx4 v[98:101], v115, s[4:7], s81 offen sc1
  s_endpgm
c01_tail:
  s_mov_b32 s72, s52
  ds_read_b128 v[66:69], v115 offset:0
  ds_read_b128 v[70:73], v115 offset:1024
  ds_read_b128 v[74:77], v115 offset:2048
  ds_read_b128 v[78:81], v115 offset:3072
  ds_read_b128 v[82:85], v115 offset:16384
  ds_read_b128 v[86:89], v115 offset:17408
  ds_read_b128 v[90:93], v115 offset:18432
  ds_read_b128 v[94:97], v115 offset:19456
  s_add_u32 s73, s89, 0
  s_lshr_b32 s79, s70, 1
  s_add_u32 s77, s76, 0x8000
  s_add_u32 s86, s70, 1
  s_and_b32 s86, s86, 3
  s_lshl_b32 s86, s86, 13
  s_add_u32 s86, s86, s89
  s_add_u32 s74, s86, s88
  s_xor_b32 s75, s74, 0x4000
  s_cmp_eq_u32 s94, 0
  s_cbranch_scc1 c01_kpoll
  s_waitcnt vmcnt(0)
  ds_read_b128 v[50:53], v117 offset:16384
  ds_read_b128 v[54:57], v117 offset:17408
  v_mov_b64 v[2:3], v[12:13]
  v_mov_b64 v[4:5], v[14:15]
  v_mov_b64 v[6:7], v[16:17]
  v_mov_b64 v[8:9], v[18:19]
  s_add_u32 s87, s81, 0xfffe0400
  s_waitcnt lgkmcnt(0)
  s_branch c01_poll0
c11_entry:
  s_branch c11_tail
c11_poll0:
c11_poll:
  s_waitcnt vmcnt(0)
  ds_write_b128 v117, v[2:5] offset:2048
  ds_write_b128 v117, v[6:9] offset:3072
  v_max3_u32 v125, v2, v3, v4
  v_max3_u32 v126, v5, v6, v7
  v_max3_u32 v125, v125, v8, v9
  v_max_u32 v125, v125, v126
  v_cmp_eq_u32 vcc, -1, v125
  s_cbranch_vccz c11_poll_ok
  s_mov_b64 exec, vcc
  buffer_load_dwordx4 v[2:5], v115, s[4:7], s73 offen offset:0 sc1
  buffer_load_dwordx4 v[6:9], v115, s[4:7], s73 offen offset:1024 sc1
  s_sub_u32 s51, s51, 1
  s_cbranch_scc0 c11_poll
  s_endpgm
c11_poll_ok:
  s_mov_b64 exec, -1
  v_smfmac_f32_16x16x64_bf16 v[42:45], v[2:5], v[66:73], v122
  v_smfmac_f32_16x16x64_bf16 v[46:49], v[2:5], v[74:81], v122
  s_waitcnt lgkmcnt(0)
  s_barrier
  buffer_load_dword v124, off, s[4:7], s82 offset:2048 sc1
  v_smfmac_f32_16x16x64_bf16 v[42:45], v[6:9], v[82:89], v122
  ds_read_b128 v[10:13], v117 offset:4096
  v_smfmac_f32_16x16x64_bf16 v[46:49], v[6:9], v[90:97], v122
  buffer_store_dwordx2 v[30:31], v119, s[4:7], s87 offen sc1
  ds_read_b128 v[14:17], v117 offset:5120
  v_smfmac_f32_16x16x64_bf16 v[34:37], v[2:5], a[32:39], v122
  ds_read_b128 v[18:21], v117 offset:6144
  v_smfmac_f32_16x16x64_bf16 v[38:41], v[2:5], a[40:47], v122
  ds_read_b128 v[22:25], v117 offset:7168
  v_smfmac_f32_16x16x64_bf16 v[34:37], v[6:9], a[48:55], v122
  ds_read_b128 v[26:29], v117 offset:0
  v_smfmac_f32_16x16x64_bf16 v[38:41], v[6:9], a[56:63], v122
  ds_read_b128 v[30:33], v117 offset:1024
  s_waitcnt lgkmcnt(5)
  v_smfmac_f32_16x16x64_bf16 v[34:37], v[10:13], a[64:71], v122
  buffer_store_dwordx4 v[98:101], v115, s[4:7], s81 offen sc1
  ds_read_b128 v[66:69], v115 offset:53248
  v_smfmac_f32_16x16x64_bf16 v[38:41], v[10:13], a[72:79], v122
  ds_read_b128 v[70:73], v115 offset:54272
  s_waitcnt lgkmcnt(6)
  v_smfmac_f32_16x16x64_bf16 v[34:37], v[14:17], a[80:87], v122
  ds_read_b128 v[74:77], v115 offset:55296
  v_smfmac_f32_16x16x64_bf16 v[38:41], v[14:17], a[88:95], v122
  ds_read_b128 v[78:81], v115 offset:56320
  s_waitcnt lgkmcnt(7)
  v_mov_b32 v126, -1
  v_smfmac_f32_16x16x64_bf16 v[34:37], v[18:21], a[96:103], v122
  buffer_store_dword v126, v123, s[4:7], s75 offen sc1
  ds_read_b128 v[82:85], v116 offset:4096
  v_smfmac_f32_16x16x64_bf16 v[38:41], v[18:21], a[104:111], v122
  ds_read_b128 v[86:89], v116 offset:5120
  s_waitcnt lgkmcnt(8)
  v_smfmac_f32_16x16x64_bf16 v[34:37], v[22:25], a[112:119], v122
  ds_read_b128 v[90:93], v116 offset:6144
  v_smfmac_f32_16x16x64_bf16 v[38:41], v[22:25], a[120:127], v122
  s_add_u32 s83, s83, 0x40000
  ds_read_b128 v[94:97], v116 offset:7168
  s_waitcnt lgkmcnt(9)
  v_smfmac_f32_16x16x64_bf16 v[34:37], v[26:29], a[0:7], v122
  s_mov_b32 m0, 0x25000
  s_add_u32 s86, s83, 0x1fff800
  v_smfmac_f32_16x16x64_bf16 v[38:41], v[26:29], a[8:15], v122
  s_mov_b64 vcc, s[92:93]
  s_waitcnt lgkmcnt(8)
  v_smfmac_f32_16x16x64_bf16 v[34:37], v[30:33], a[16:23], v122
  v_smfmac_f32_16x16x64_bf16 v[38:41], v[30:33], a[24:31], v122
  s_waitcnt lgkmcnt(6)
  v_smfmac_f32_16x16x64_bf16 v[42:45], v[14:17], v[66:73], v122
  ds_read_b128 v[66:69], v116 offset:20480
  s_waitcnt lgkmcnt(5)
  v_cvt_pk_bf16_f32 v98, v34, v35
  v_cvt_pk_bf16_f32 v99, v36, v37
  v_smfmac_f32_16x16x64_bf16 v[46:49], v[14:17], v[74:81], v122
  ds_read_b128 v[70:73], v116 offset:21504
  v_mfma_f32_16x16x32_bf16 v[34:37], v[98:101], v[106:109], 0
  ds_read_b128 v[74:77], v116 offset:22528
  s_waitcnt lgkmcnt(5)
  v_cvt_pk_bf16_f32 v100, v38, v39
  v_cvt_pk_bf16_f32 v101, v40, v41
  v_smfmac_f32_16x16x64_bf16 v[42:45], v[18:21], v[82:89], v122
  ds_read_b128 v[78:81], v116 offset:23552
  v_mfma_f32_16x16x32_bf16 v[38:41], v[100:103], v[106:109], 0
  ds_read_b128 v[82:85], v115 offset:4096
  s_waitcnt lgkmcnt(5)
  v_cvt_pk_bf16_f32 v34, v34, v35
  v_cvt_pk_bf16_f32 v35, v36, v37
  v_smfmac_f32_16x16x64_bf16 v[46:49], v[18:21], v[90:97], v122
  ds_read_b128 v[86:89], v115 offset:5120
  v_smfmac_f32_16x16x64_bf16 v[42:45], v[10:13], v[144:151], v122
  ds_read_b128 v[90:93], v115 offset:6144
  ds_read_b128 v[94:97], v115 offset:7168
  v_cvt_pk_bf16_f32 v36, v38, v39
  v_cvt_pk_bf16_f32 v37, v40, v41
  v_smfmac_f32_16x16x64_bf16 v[42:45], v[26:29], v[128:135], v122
  s_nop 0
  v_mfma_f32_16x16x32_bf16 v[38:41], v[50:53], v[34:37], 0
  v_mfma_f32_16x16x32_bf16 v[50:53], v[54:57], v[34:37], 0
  s_waitcnt lgkmcnt(6)
  v_smfmac_f32_16x16x64_bf16 v[42:45], v[22:25], v[66:73], v122
  s_waitcnt lgkmcnt(2)
  v_smfmac_f32_16x16x64_bf16 v[42:45], v[30:33], v[82:89], v122
  v_cndmask_b32 v38, v38, v50, vcc
  v_smfmac_f32_16x16x64_bf16 v[46:49], v[10:13], v[152:159], v122
  v_cndmask_b32 v39, v39, v51, vcc
  v_smfmac_f32_16x16x64_bf16 v[46:49], v[26:29], v[136:143], v122
  v_cvt_pk_bf16_f32 v98, v42, v43
  v_smfmac_f32_16x16x64_bf16 v[46:49], v[22:25], v[74:81], v122
  s_waitcnt lgkmcnt(0)
  v_cvt_pk_bf16_f32 v99, v44, v45
  v_smfmac_f32_16x16x64_bf16 v[46:49], v[30:33], v[90:97], v122
  v_cndmask_b32 v40, v40, v52, vcc
  v_mfma_f32_16x16x32_bf16 v[42:45], v[98:101], v[106:109], 0
  v_cndmask_b32 v41, v41, v53, vcc
  s_nop 1
  v_cvt_pk_bf16_f32 v100, v46, v47
  v_cvt_pk_bf16_f32 v101, v48, v49
  s_nop 1
  v_mfma_f32_16x16x32_bf16 v[46:49], v[100:103], v[106:109], 0
  v_cvt_pk_bf16_f32 v42, v42, v43
  v_cvt_pk_bf16_f32 v43, v44, v45
  v_smfmac_f32_16x16x64_bf16 v[58:61], v[2:5], a[160:167], v122
  ds_write_b128 v117, v[38:41] offset:9216
  s_nop 2
  v_cvt_pk_bf16_f32 v44, v46, v47
  v_cvt_pk_bf16_f32 v45, v48, v49
  s_nop 1
  v_mfma_f32_16x16x32_bf16 v[46:49], v[42:45], v[34:37], 0
  v_smfmac_f32_16x16x64_bf16 v[62:65], v[2:5], a[168:175], v122
  s_nop 3
  v_cndmask_b32 v46, v46, v48, vcc
  v_cndmask_b32 v47, v47, v49, vcc
  v_smfmac_f32_16x16x64_bf16 v[58:61], v[6:9], a[176:183], v122
  ds_write_b64 v119, v[46:47] offset:12800
  v_smfmac_f32_16x16x64_bf16 v[62:65], v[6:9], a[184:191], v122
  ds_read_b64 v[94:95], v120 offset:12800
  v_smfmac_f32_16x16x64_bf16 v[58:61], v[30:33], a[144:151], v122
  ds_read_b64 v[2:3], v117 offset:22536
  ds_read_b64 v[4:5], v117 offset:23552
  s_waitcnt vmcnt(3)
  buffer_load_dwordx4 v115, s[4:7], s83 offen offset:0 sc1 lds
  v_smfmac_f32_16x16x64_bf16 v[62:65], v[30:33], a[152:159], v122
  ds_read_b64 v[6:7], v117 offset:22528
  ds_read_b64 v[8:9], v117 offset:23560
  v_readfirstlane_b32 s84, v124
  v_smfmac_f32_16x16x64_bf16 v[58:61], v[10:13], a[192:199], v122
  s_waitcnt lgkmcnt(5)
  s_barrier
  v_smfmac_f32_16x16x64_bf16 v[62:65], v[10:13], a[200:207], v122
  ds_read_b128 v[50:53], v117 offset:10240
  ds_read_b128 v[54:57], v117 offset:11264
  v_cndmask_b32 v30, v42, v44, vcc
  v_smfmac_f32_16x16x64_bf16 v[58:61], v[14:17], a[208:215], v122
  ds_read_b128 v[86:89], v117 offset:8192
  ds_read_b64 v[96:97], v120 offset:13312
  v_cndmask_b32 v31, v43, v45, vcc
  v_smfmac_f32_16x16x64_bf16 v[62:65], v[14:17], a[216:223], v122
  ds_read_b64 v[90:91], v120 offset:13824
  ds_read_b64 v[92:93], v120 offset:12288
  v_mov_b64 v[10:11], 0
  v_smfmac_f32_16x16x64_bf16 v[58:61], v[18:21], a[224:231], v122
  ds_read_b128 v[66:69], v116 offset:36864
  buffer_load_dwordx4 v115, s[4:7], s83 offen offset:1024 sc1 lds
  v_mov_b64 v[12:13], 0
  v_smfmac_f32_16x16x64_bf16 v[62:65], v[18:21], a[232:239], v122
  ds_read_b128 v[70:73], v116 offset:37888
  s_xor_b32 s84, s84, 1
  v_mov_b64 v[14:15], 0
  v_smfmac_f32_16x16x64_bf16 v[58:61], v[22:25], a[240:247], v122
  ds_read_b128 v[74:77], v116 offset:38912
  v_mov_b64 v[16:17], 0
  v_smfmac_f32_16x16x64_bf16 v[62:65], v[22:25], a[248:255], v122
  s_waitcnt lgkmcnt(3)
  buffer_load_dwordx4 v115, s[4:7], s86 offen offset:2048 sc1 lds
  ds_read_b128 v[78:81], v116 offset:39936
  v_add_f32 v38, v38, v50
  v_add_f32 v39, v39, v51
  v_add_f32 v40, v40, v52
  v_add_f32 v41, v41, v53
  v_pk_add_f32 v[38:39], v[38:39], v[54:55]
  v_pk_add_f32 v[40:41], v[40:41], v[56:57]
  v_pk_add_f32 v[38:39], v[38:39], v[86:87]
  v_pk_add_f32 v[40:41], v[40:41], v[88:89]
  v_max3_f32 v125, v38, v39, v40
  v_max_f32 v125, v125, v41
  v_pk_add_f32 v[94:95], v[94:95], v[96:97]
  v_pk_add_f32 v[90:91], v[90:91], v[92:93]
  v_max_f32_dpp v125, v125, v125 row_ror:8 row_mask:0xf bank_mask:0xf
  v_pk_add_f32 v[94:95], v[94:95], v[90:91]
  v_max3_f32 v127, v125, v94, v95
  v_max3_f32 v125, v125, v94, v95
  v_smfmac_f32_16x16x64_bf16 v[58:61], v[26:29], a[128:135], v122
  buffer_load_dwordx4 v115, s[4:7], s86 offen offset:3072 sc1 lds
  v_permlane16_swap_b32 v125, v127
  v_max_f32 v126, v125, v127
  v_max_f32 v125, v125, v127
  v_smfmac_f32_16x16x64_bf16 v[62:65], v[26:29], a[136:143], v122
  ds_read_b128 v[82:85], v116 offset:53248
  v_permlane32_swap_b32 v125, v126
  v_max_f32 v125, v125, v126
  v_mul_f32 v126, s85, v125
  v_pk_fma_f32 v[38:39], v[38:39], s[90:91], v[126:127] op_sel_hi:[1,1,0] neg_lo:[0,0,1] neg_hi:[0,0,1]
  v_pk_fma_f32 v[40:41], v[40:41], s[90:91], v[126:127] op_sel_hi:[1,1,0] neg_lo:[0,0,1] neg_hi:[0,0,1]
  v_pk_fma_f32 v[94:95], v[94:95], s[90:91], v[126:127] op_sel_hi:[1,1,0] neg_lo:[0,0,1] neg_hi:[0,0,1]
  v_exp_f32 v38, v38
  v_exp_f32 v39, v39
  v_exp_f32 v40, v40
  v_exp_f32 v41, v41
  v_cvt_pk_bf16_f32 v42, v38, v39
  v_cvt_pk_bf16_f32 v43, v40, v41
  v_exp_f32 v94, v94
  v_mov_b32_dpp v50, v42 row_shl:8 row_mask:0xf bank_mask:0xf bound_ctrl:0
  v_mov_b32_dpp v51, v43 row_shl:8 row_mask:0xf bank_mask:0xf bound_ctrl:0
  v_mov_b32_dpp v52, v42 row_shr:8 row_mask:0xf bank_mask:0xf bound_ctrl:0
  v_mov_b32_dpp v53, v43 row_shr:8 row_mask:0xf bank_mask:0xf bound_ctrl:0
  v_exp_f32 v95, v95
  v_cndmask_b32_e64 v54, v42, 0, vcc
  v_mfma_f32_16x16x32_bf16 v[34:37], v[2:5], v[50:53], 0
  v_cndmask_b32_e64 v55, v43, 0, vcc
  v_cvt_pk_bf16_f32 v98, v58, v59
  v_cvt_pk_bf16_f32 v99, v60, v61
  v_cvt_pk_bf16_f32 v127, v94, v95
  v_cndmask_b32_e64 v44, v127, 0, vcc
  v_cndmask_b32_e64 v45, v127, 0, vcc
  v_cndmask_b32 v46, 0, v127, vcc
  v_cndmask_b32 v47, 0, v127, vcc
  v_mfma_f32_16x16x32_bf16 v[38:41], v[110:113], v[42:45], 0
  v_cvt_pk_bf16_f32 v100, v62, v63
  v_cvt_pk_bf16_f32 v101, v64, v65
  s_nop 1
  v_mfma_f32_16x16x32_bf16 v[34:37], v[98:101], v[44:47], v[34:37]
  ds_read_b128 v[86:89], v116 offset:54272
  v_cndmask_b32 v56, 0, v42, vcc
  v_cndmask_b32 v57, 0, v43, vcc
  v_mov_b64 v[18:19], 0
  v_mov_b64 v[20:21], 0
  v_mfma_f32_16x16x32_bf16 v[34:37], v[6:9], v[54:57], v[34:37]
  ds_read_b128 v[90:93], v116 offset:55296
  ds_read_b128 v[94:97], v116 offset:56320
  v_add_f32_dpp v125, v38, v38 row_ror:8 row_mask:0xf bank_mask:0xf
  v_rcp_f32 v125, v125
  v_mov_b64 v[22:23], 0
  v_mov_b64 v[24:25], 0
  s_nop 1
  v_pk_mul_f32 v[34:35], v[34:35], v[124:125] op_sel:[0,1] op_sel_hi:[1,1]
  v_pk_mul_f32 v[36:37], v[36:37], v[124:125] op_sel:[0,1] op_sel_hi:[1,1]
  v_cvt_pk_bf16_f32 v34, v34, v35
  v_cvt_pk_bf16_f32 v35, v36, v37
  s_add_u32 s81, s80, 0x800
  ds_write_b64 v119, v[34:35] offset:14848
  v_cndmask_b32_dpp v36, v34, v34, vcc row_ror:8 row_mask:0xf bank_mask:0xf
  v_cndmask_b32_dpp v37, v35, v35, vcc row_ror:8 row_mask:0xf bank_mask:0xf
  v_mov_b32_dpp v34, v34 row_shr:8 row_mask:0xf bank_mask:0xc
  v_mov_b32_dpp v35, v35 row_shr:8 row_mask:0xf bank_mask:0xc
  s_waitcnt lgkmcnt(1)
  s_nop 0
  v_smfmac_f32_16x16x64_bf16 v[10:13], v[34:37], v[192:199], v114
  v_smfmac_f32_16x16x64_bf16 v[14:17], v[34:37], v[200:207], v114
  s_waitcnt lgkmcnt(0)
  s_barrier
  ds_read_b128 v[38:41], v118 offset:15360
  ds_read_b128 v[42:45], v118 offset:15872
  ds_read_b128 v[46:49], v118 offset:14336
  v_smfmac_f32_16x16x64_bf16 v[18:21], v[34:37], v[208:215], v114
  v_smfmac_f32_16x16x64_bf16 v[22:25], v[34:37], v[216:223], v114
  s_waitcnt lgkmcnt(2)
  v_smfmac_f32_16x16x64_bf16 v[10:13], v[38:41], v[224:231], v114
  v_smfmac_f32_16x16x64_bf16 v[14:17], v[38:41], v[232:239], v114
  s_waitcnt lgkmcnt(1)
  v_smfmac_f32_16x16x64_bf16 v[10:13], v[42:45], v[66:73], v114
  v_smfmac_f32_16x16x64_bf16 v[14:17], v[42:45], v[74:81], v114
  s_waitcnt lgkmcnt(0)
  v_smfmac_f32_16x16x64_bf16 v[10:13], v[46:49], v[160:167], v114
  v_smfmac_f32_16x16x64_bf16 v[14:17], v[46:49], v[168:175], v114
  v_smfmac_f32_16x16x64_bf16 v[18:21], v[38:41], v[240:247], v114
  v_smfmac_f32_16x16x64_bf16 v[22:25], v[38:41], v[248:255], v114
  v_cvt_pk_bf16_f32 v10, v10, v11
  v_cvt_pk_bf16_f32 v11, v12, v13
  v_bfi_b32 v10, 1, s79, v10
  v_smfmac_f32_16x16x64_bf16 v[18:21], v[42:45], v[82:89], v114
  v_cvt_pk_bf16_f32 v12, v14, v15
  v_cvt_pk_bf16_f32 v13, v16, v17
  v_smfmac_f32_16x16x64_bf16 v[22:25], v[42:45], v[90:97], v114
  buffer_store_dwordx4 v[10:13], v121, s[4:7], s76 offen sc1
  v_smfmac_f32_16x16x64_bf16 v[18:21], v[46:49], v[176:183], v114
  v_smfmac_f32_16x16x64_bf16 v[22:25], v[46:49], v[184:191], v114
  s_nop 3
  v_cvt_pk_bf16_f32 v18, v18, v19
  v_cvt_pk_bf16_f32 v19, v20, v21
  v_bfi_b32 v18, 1, s79, v18
  s_nop 0
  v_cvt_pk_bf16_f32 v20, v22, v23
  v_cvt_pk_bf16_f32 v21, v24, v25
  buffer_store_dwordx4 v[18:21], v121, s[4:7], s77 offen sc1
  v_mov_b64 v[34:35], 0
  v_mov_b64 v[36:37], 0
  v_mov_b64 v[38:39], 0
  v_mov_b64 v[40:41], 0
  v_mov_b64 v[42:43], 0
  v_mov_b64 v[44:45], 0
  v_mov_b64 v[46:47], 0
  v_mov_b64 v[48:49], 0
  v_mov_b64 v[58:59], 0
  v_mov_b64 v[60:61], 0
  v_mov_b64 v[62:63], 0
  v_mov_b64 v[64:65], 0
  ds_read_b128 v[66:69], v115 offset:20480
  ds_read_b128 v[70:73], v115 offset:21504
  ds_read_b128 v[74:77], v115 offset:22528
  ds_read_b128 v[78:81], v115 offset:23552
  ds_read_b128 v[82:85], v115 offset:36864
  ds_read_b128 v[86:89], v115 offset:37888
  ds_read_b128 v[90:93], v115 offset:38912
  ds_read_b128 v[94:97], v115 offset:39936
  s_waitcnt vmcnt(0)
  buffer_load_dwordx4 v[2:5], v115, s[4:7], s78 offen offset:0 sc1
  buffer_load_dwordx4 v[6:9], v115, s[4:7], s78 offen offset:1024 sc1
  s_add_u32 s70, s70, 1
  s_add_u32 s82, s82, 2048
  s_add_u32 s80, s80, 0x40000
  s_xor_b32 s76, s76, 0x40000
  s_sub_u32 s73, s74, s88
  s_add_u32 s73, s73, 2048
c11_rpoll:
  s_waitcnt vmcnt(0)
  v_mfma_f32_16x16x32_bf16 v[18:21], v[2:5], v[102:105], 0
  v_mfma_f32_16x16x32_bf16 v[18:21], v[6:9], v[102:105], v[18:21]
  v_bitop3_b32 v125, v2, v6, s79 bitop3:0x7e
  v_and_b32 v125, 1, v125
  v_cmp_ne_u32 vcc, 0, v125
  s_cbranch_vccz c11_rpoll_ok
  s_mov_b64 exec, vcc
  buffer_load_dwordx4 v[2:5], v115, s[4:7], s78 offen offset:0 sc1
  buffer_load_dwordx4 v[6:9], v115, s[4:7], s78 offen offset:1024 sc1
  s_sub_u32 s51, s51, 1
  s_cbranch_scc0 c11_rpoll
  s_endpgm
c11_rpoll_ok:
  s_mov_b64 exec, -1
  s_nop 1
  v_permlane32_swap_b32 v18, v20
  v_permlane32_swap_b32 v19, v21
  v_add_f32 v18, v18, v20
  v_add_f32 v19, v19, v21
  s_nop 1
  v_permlane16_swap_b32 v18, v19
  v_add_f32 v18, v18, v19
  s_nop 1
  v_mov_b32_dpp v19, v18 row_shl:4 row_mask:0xf bank_mask:0xf
  v_cvt_pk_bf16_f32 v18, v18, v19
  v_min_u32 v18, -2, v18
  buffer_store_dword v18, v123, s[4:7], s74 offen sc1
  s_xor_b32 s78, s78, 0x40000
  s_cmp_eq_u32 s70, 63
  s_cbranch_scc1 c11_last
  s_lshr_b32 s79, s70, 1
  s_add_u32 s77, s76, 0x8000
  s_add_u32 s86, s70, 1
  s_and_b32 s86, s86, 3
  s_lshl_b32 s86, s86, 13
  s_add_u32 s86, s86, s89
  s_add_u32 s74, s86, s88
  s_xor_b32 s75, s74, 0x4000
  s_cmp_eq_u32 s84, 0
  s_cbranch_scc1 c11_have
c11_kpoll:
  s_sub_u32 s51, s51, 1
  s_cbranch_scc1 main_end
  buffer_load_dword v124, off, s[4:7], s82 sc1
  s_waitcnt vmcnt(0)
  v_readfirstlane_b32 s87, v124
  s_cmp_eq_u32 s87, 0
  s_cbranch_scc1 c11_kpoll
  s_mov_b32 m0, 0x25000
  s_nop 0
  buffer_load_dwordx4 v115, s[4:7], s83 offen offset:0 sc1 lds
  buffer_load_dwordx4 v115, s[4:7], s83 offen offset:1024 sc1 lds
  s_add_u32 s86, s83, 0x1fff800
  buffer_load_dwordx4 v115, s[4:7], s86 offen offset:2048 sc1 lds
  buffer_load_dwordx4 v115, s[4:7], s86 offen offset:3072 sc1 lds
  buffer_load_dwordx4 v[2:5], v115, s[4:7], s73 offen offset:0 sc1
  buffer_load_dwordx4 v[6:9], v115, s[4:7], s73 offen offset:1024 sc1
  s_add_u32 s87, s81, 0xfffe0400
  s_waitcnt vmcnt(2)
  ds_read_b128 v[50:53], v117 offset:20480
  ds_read_b128 v[54:57], v117 offset:21504
  s_waitcnt lgkmcnt(0)
  s_branch c11_poll0
  s_waitcnt vmcnt(0)
c11_have:
  ds_read_b128 v[50:53], v117 offset:20480
  ds_read_b128 v[54:57], v117 offset:21504
  s_waitcnt vmcnt(0)
  buffer_load_dwordx4 v[2:5], v115, s[4:7], s73 offen offset:0 sc1
  buffer_load_dwordx4 v[6:9], v115, s[4:7], s73 offen offset:1024 sc1
  s_add_u32 s87, s81, 0xfffe0400
  s_waitcnt lgkmcnt(0)
  s_branch c11_poll0
c11_last:
  s_waitcnt vmcnt(0)
  buffer_load_dwordx4 v[2:5], v115, s[4:7], s73 offen offset:0 sc1
  buffer_load_dwordx4 v[6:9], v115, s[4:7], s73 offen offset:1024 sc1
  s_add_u32 s87, s81, 0xfffe0400
  s_waitcnt lgkmcnt(0)
c11_lpoll:
  s_waitcnt vmcnt(0)
  ds_write_b128 v117, v[2:5] offset:2048
  ds_write_b128 v117, v[6:9] offset:3072
  v_max3_u32 v125, v2, v3, v4
  v_max3_u32 v126, v5, v6, v7
  v_max3_u32 v125, v125, v8, v9
  v_max_u32 v125, v125, v126
  v_cmp_eq_u32 vcc, -1, v125
  s_cbranch_vccz c11_lpoll_ok
  s_mov_b64 exec, vcc
  buffer_load_dwordx4 v[2:5], v115, s[4:7], s73 offen offset:0 sc1
  buffer_load_dwordx4 v[6:9], v115, s[4:7], s73 offen offset:1024 sc1
  s_sub_u32 s51, s51, 1
  s_cbranch_scc0 c11_lpoll
  s_endpgm
c11_lpoll_ok:
  s_mov_b64 exec, -1
  buffer_store_dwordx2 v[30:31], v119, s[4:7], s87 offen sc1
  buffer_store_dwordx4 v[98:101], v115, s[4:7], s81 offen sc1
  s_add_u32 s81, s80, 0x800
  s_mov_b64 vcc, s[92:93]
  v_smfmac_f32_16x16x64_bf16 v[58:61], v[2:5], a[160:167], v122
  v_smfmac_f32_16x16x64_bf16 v[62:65], v[2:5], a[168:175], v122
  s_waitcnt lgkmcnt(0)
  s_barrier
  ds_read_b128 v[30:33], v117 offset:1024
  ds_read_b128 v[10:13], v117 offset:4096
  ds_read_b128 v[14:17], v117 offset:5120
  ds_read_b128 v[18:21], v117 offset:6144
  ds_read_b128 v[26:29], v117 offset:0
  ds_read_b128 v[22:25], v117 offset:7168
  v_smfmac_f32_16x16x64_bf16 v[58:61], v[6:9], a[176:183], v122
  v_smfmac_f32_16x16x64_bf16 v[62:65], v[6:9], a[184:191], v122
  v_smfmac_f32_16x16x64_bf16 v[42:45], v[2:5], v[66:73], v122
  ds_read_b128 v[66:69], v115 offset:53248
  ds_read_b128 v[70:73], v115 offset:54272
  v_smfmac_f32_16x16x64_bf16 v[46:49], v[2:5], v[74:81], v122
  ds_read_b128 v[74:77], v115 offset:55296
  ds_read_b128 v[78:81], v115 offset:56320
  s_waitcnt lgkmcnt(9)
  v_smfmac_f32_16x16x64_bf16 v[58:61], v[30:33], a[144:151], v122
  v_smfmac_f32_16x16x64_bf16 v[62:65], v[30:33], a[152:159], v122
  v_smfmac_f32_16x16x64_bf16 v[42:45], v[6:9], v[82:89], v122
  ds_read_b128 v[82:85], v116 offset:4096
  ds_read_b128 v[86:89], v116 offset:5120
  v_smfmac_f32_16x16x64_bf16 v[46:49], v[6:9], v[90:97], v122
  ds_read_b128 v[90:93], v116 offset:6144
  ds_read_b128 v[94:97], v116 offset:7168
  s_waitcnt lgkmcnt(12)
  v_smfmac_f32_16x16x64_bf16 v[58:61], v[10:13], a[192:199], v122
  v_smfmac_f32_16x16x64_bf16 v[62:65], v[10:13], a[200:207], v122
  s_waitcnt lgkmcnt(6)
  v_smfmac_f32_16x16x64_bf16 v[42:45], v[14:17], v[66:73], v122
  ds_read_b128 v[66:69], v116 offset:20480
  ds_read_b128 v[70:73], v116 offset:21504
  s_waitcnt lgkmcnt(6)
  v_smfmac_f32_16x16x64_bf16 v[46:49], v[14:17], v[74:81], v122
  ds_read_b128 v[74:77], v116 offset:22528
  ds_read_b128 v[78:81], v116 offset:23552
  v_smfmac_f32_16x16x64_bf16 v[58:61], v[14:17], a[208:215], v122
  v_smfmac_f32_16x16x64_bf16 v[62:65], v[14:17], a[216:223], v122
  s_waitcnt lgkmcnt(6)
  v_smfmac_f32_16x16x64_bf16 v[42:45], v[18:21], v[82:89], v122
  ds_read_b128 v[82:85], v115 offset:4096
  ds_read_b128 v[86:89], v115 offset:5120
  s_waitcnt lgkmcnt(6)
  v_smfmac_f32_16x16x64_bf16 v[46:49], v[18:21], v[90:97], v122
  ds_read_b128 v[90:93], v115 offset:6144
  ds_read_b128 v[94:97], v115 offset:7168
  v_smfmac_f32_16x16x64_bf16 v[58:61], v[18:21], a[224:231], v122
  v_smfmac_f32_16x16x64_bf16 v[62:65], v[18:21], a[232:239], v122
  v_smfmac_f32_16x16x64_bf16 v[42:45], v[10:13], v[144:151], v122
  v_smfmac_f32_16x16x64_bf16 v[46:49], v[10:13], v[152:159], v122
  v_smfmac_f32_16x16x64_bf16 v[42:45], v[26:29], v[128:135], v122
  v_smfmac_f32_16x16x64_bf16 v[46:49], v[26:29], v[136:143], v122
  s_waitcnt lgkmcnt(6)
  v_smfmac_f32_16x16x64_bf16 v[42:45], v[22:25], v[66:73], v122
  s_waitcnt lgkmcnt(4)
  v_smfmac_f32_16x16x64_bf16 v[46:49], v[22:25], v[74:81], v122
  v_smfmac_f32_16x16x64_bf16 v[58:61], v[22:25], a[240:247], v122
  v_smfmac_f32_16x16x64_bf16 v[62:65], v[22:25], a[248:255], v122
  s_waitcnt lgkmcnt(2)
  v_smfmac_f32_16x16x64_bf16 v[42:45], v[30:33], v[82:89], v122
  s_waitcnt lgkmcnt(0)
  v_smfmac_f32_16x16x64_bf16 v[46:49], v[30:33], v[90:97], v122
  v_smfmac_f32_16x16x64_bf16 v[58:61], v[26:29], a[128:135], v122
  v_smfmac_f32_16x16x64_bf16 v[62:65], v[26:29], a[136:143], v122
  v_cvt_pk_bf16_f32 v98, v42, v43
  v_cvt_pk_bf16_f32 v99, v44, v45
  v_cvt_pk_bf16_f32 v100, v46, v47
  v_cvt_pk_bf16_f32 v101, v48, v49
  s_nop 1
  v_mfma_f32_16x16x32_bf16 v[42:45], v[98:101], v[106:109], 0
  v_mfma_f32_16x16x32_bf16 v[46:49], v[100:103], v[106:109], 0
  s_add_u32 s87, s81, 0xfffe0400
  s_nop 2
  v_cvt_pk_bf16_f32 v42, v42, v43
  v_cvt_pk_bf16_f32 v43, v44, v45
  s_nop 1
  v_cvt_pk_bf16_f32 v44, v46, v47
  v_cvt_pk_bf16_f32 v45, v48, v49
  v_cndmask_b32 v30, v42, v44, vcc
  v_cndmask_b32 v31, v43, v45, vcc
  s_cmp_eq_u32 s84, 0
  s_cbranch_scc1 c11_lgo
c11_lfl:
  s_sub_u32 s51, s51, 1
  s_cbranch_scc1 main_end
  buffer_load_dword v124, off, s[4:7], s82 sc1
  s_waitcnt vmcnt(0)
  v_readfirstlane_b32 s86, v124
  s_cmp_eq_u32 s86, 0
  s_cbranch_scc1 c11_lfl
c11_lgo:
  buffer_store_dwordx2 v[30:31], v119, s[4:7], s87 offen sc1
  v_cvt_pk_bf16_f32 v98, v58, v59
  v_cvt_pk_bf16_f32 v99, v60, v61
  v_cvt_pk_bf16_f32 v100, v62, v63
  v_cvt_pk_bf16_f32 v101, v64, v65
  buffer_store_dwordx4 v[98:101], v115, s[4:7], s81 offen sc1
  s_endpgm
c11_tail:
  s_mov_b32 s72, s52
  ds_read_b128 v[66:69], v115 offset:20480
  ds_read_b128 v[70:73], v115 offset:21504
  ds_read_b128 v[74:77], v115 offset:22528
  ds_read_b128 v[78:81], v115 offset:23552
  ds_read_b128 v[82:85], v115 offset:36864
  ds_read_b128 v[86:89], v115 offset:37888
  ds_read_b128 v[90:93], v115 offset:38912
  ds_read_b128 v[94:97], v115 offset:39936
  s_add_u32 s73, s89, 2048
  s_lshr_b32 s79, s70, 1
  s_add_u32 s77, s76, 0x8000
  s_add_u32 s86, s70, 1
  s_and_b32 s86, s86, 3
  s_lshl_b32 s86, s86, 13
  s_add_u32 s86, s86, s89
  s_add_u32 s74, s86, s88
  s_xor_b32 s75, s74, 0x4000
  s_cmp_eq_u32 s94, 0
  s_cbranch_scc1 c11_kpoll
  s_waitcnt vmcnt(0)
  ds_read_b128 v[50:53], v117 offset:20480
  ds_read_b128 v[54:57], v117 offset:21504
  v_mov_b64 v[2:3], v[12:13]
  v_mov_b64 v[4:5], v[14:15]
  v_mov_b64 v[6:7], v[16:17]
  v_mov_b64 v[8:9], v[18:19]
  s_add_u32 s87, s81, 0xfffe0400
  s_waitcnt lgkmcnt(0)
  s_branch c11_poll0
c21_entry:
  s_branch c21_tail
c21_poll0:
c21_poll:
  s_waitcnt vmcnt(0)
  ds_write_b128 v117, v[2:5] offset:4096
  ds_write_b128 v117, v[6:9] offset:5120
  v_max3_u32 v125, v2, v3, v4
  v_max3_u32 v126, v5, v6, v7
  v_max3_u32 v125, v125, v8, v9
  v_max_u32 v125, v125, v126
  v_cmp_eq_u32 vcc, -1, v125
  s_cbranch_vccz c21_poll_ok
  s_mov_b64 exec, vcc
  buffer_load_dwordx4 v[2:5], v115, s[4:7], s73 offen offset:0 sc1
  buffer_load_dwordx4 v[6:9], v115, s[4:7], s73 offen offset:1024 sc1
  s_sub_u32 s51, s51, 1
  s_cbranch_scc0 c21_poll
  s_endpgm
c21_poll_ok:
  s_mov_b64 exec, -1
  v_smfmac_f32_16x16x64_bf16 v[42:45], v[6:9], v[66:73], v122
  v_smfmac_f32_16x16x64_bf16 v[46:49], v[6:9], v[74:81], v122
  s_waitcnt lgkmcnt(0)
  s_barrier
  buffer_load_dword v124, off, s[4:7], s82 offset:2048 sc1
  v_smfmac_f32_16x16x64_bf16 v[34:37], v[2:5], a[64:71], v122
  ds_read_b128 v[10:13], v117 offset:6144
  v_smfmac_f32_16x16x64_bf16 v[38:41], v[2:5], a[72:79], v122
  buffer_store_dwordx2 v[30:31], v119, s[4:7], s87 offen sc1
  ds_read_b128 v[14:17], v117 offset:7168
  v_smfmac_f32_16x16x64_bf16 v[34:37], v[6:9], a[80:87], v122
  ds_read_b128 v[18:21], v117 offset:0
  v_smfmac_f32_16x16x64_bf16 v[38:41], v[6:9], a[88:95], v122
  ds_read_b128 v[22:25], v117 offset:1024
  s_waitcnt lgkmcnt(3)
  v_smfmac_f32_16x16x64_bf16 v[42:45], v[10:13], v[82:89], v122
  ds_read_b128 v[26:29], v117 offset:2048
  v_smfmac_f32_16x16x64_bf16 v[46:49], v[10:13], v[90:97], v122
  ds_read_b128 v[30:33], v117 offset:3072
  v_smfmac_f32_16x16x64_bf16 v[34:37], v[10:13], a[96:103], v122
  buffer_store_dwordx4 v[98:101], v115, s[4:7], s81 offen sc1
  ds_read_b128 v[66:69], v116 offset:24576
  v_smfmac_f32_16x16x64_bf16 v[38:41], v[10:13], a[104:111], v122
  ds_read_b128 v[70:73], v116 offset:25600
  s_waitcnt lgkmcnt(6)
  v_smfmac_f32_16x16x64_bf16 v[34:37], v[14:17], a[112:119], v122
  ds_read_b128 v[74:77], v116 offset:26624
  v_smfmac_f32_16x16x64_bf16 v[38:41], v[14:17], a[120:127], v122
  ds_read_b128 v[78:81], v116 offset:27648
  s_waitcnt lgkmcnt(7)
  v_mov_b32 v126, -1
  v_smfmac_f32_16x16x64_bf16 v[34:37], v[18:21], a[0:7], v122
  buffer_store_dword v126, v123, s[4:7], s75 offen sc1
  ds_read_b128 v[82:85], v115 offset:8192
  v_smfmac_f32_16x16x64_bf16 v[38:41], v[18:21], a[8:15], v122
  ds_read_b128 v[86:89], v115 offset:9216
  s_waitcnt lgkmcnt(8)
  v_smfmac_f32_16x16x64_bf16 v[34:37], v[22:25], a[16:23], v122
  ds_read_b128 v[90:93], v115 offset:10240
  v_smfmac_f32_16x16x64_bf16 v[38:41], v[22:25], a[24:31], v122
  s_add_u32 s83, s83, 0x40000
  ds_read_b128 v[94:97], v115 offset:11264
  s_waitcnt lgkmcnt(9)
  v_smfmac_f32_16x16x64_bf16 v[34:37], v[26:29], a[32:39], v122
  s_mov_b32 m0, 0x26000
  s_add_u32 s86, s83, 0x1fff800
  v_smfmac_f32_16x16x64_bf16 v[38:41], v[26:29], a[40:47], v122
  s_mov_b64 vcc, s[92:93]
  s_waitcnt lgkmcnt(8)
  v_smfmac_f32_16x16x64_bf16 v[34:37], v[30:33], a[48:55], v122
  v_smfmac_f32_16x16x64_bf16 v[38:41], v[30:33], a[56:63], v122
  s_waitcnt lgkmcnt(6)
  v_smfmac_f32_16x16x64_bf16 v[42:45], v[14:17], v[66:73], v122
  ds_read_b128 v[66:69], v115 offset:24576
  s_waitcnt lgkmcnt(5)
  v_cvt_pk_bf16_f32 v98, v34, v35
  v_cvt_pk_bf16_f32 v99, v36, v37
  v_smfmac_f32_16x16x64_bf16 v[46:49], v[14:17], v[74:81], v122
  ds_read_b128 v[70:73], v115 offset:25600
  v_mfma_f32_16x16x32_bf16 v[34:37], v[98:101], v[106:109], 0
  ds_read_b128 v[74:77], v115 offset:26624
  s_waitcnt lgkmcnt(5)
  v_cvt_pk_bf16_f32 v100, v38, v39
  v_cvt_pk_bf16_f32 v101, v40, v41
  v_smfmac_f32_16x16x64_bf16 v[42:45], v[22:25], v[82:89], v122
  ds_read_b128 v[78:81], v115 offset:27648
  v_mfma_f32_16x16x32_bf16 v[38:41], v[100:103], v[106:109], 0
  ds_read_b128 v[82:85], v115 offset:40960
  s_waitcnt lgkmcnt(5)
  v_cvt_pk_bf16_f32 v34, v34, v35
  v_cvt_pk_bf16_f32 v35, v36, v37
  v_smfmac_f32_16x16x64_bf16 v[46:49], v[22:25], v[90:97], v122
  ds_read_b128 v[86:89], v115 offset:41984
  v_smfmac_f32_16x16x64_bf16 v[42:45], v[2:5], v[144:151], v122
  ds_read_b128 v[90:93], v115 offset:43008
  ds_read_b128 v[94:97], v115 offset:44032
  v_cvt_pk_bf16_f32 v36, v38, v39
  v_cvt_pk_bf16_f32 v37, v40, v41
  v_smfmac_f32_16x16x64_bf16 v[42:45], v[18:21], v[128:135], v122
  s_nop 0
  v_mfma_f32_16x16x32_bf16 v[38:41], v[50:53], v[34:37], 0
  v_mfma_f32_16x16x32_bf16 v[50:53], v[54:57], v[34:37], 0
  s_waitcnt lgkmcnt(6)
  v_smfmac_f32_16x16x64_bf16 v[42:45], v[26:29], v[66:73], v122
  s_waitcnt lgkmcnt(2)
  v_smfmac_f32_16x16x64_bf16 v[42:45], v[30:33], v[82:89], v122
  v_cndmask_b32 v38, v38, v50, vcc
  v_smfmac_f32_16x16x64_bf16 v[46:49], v[2:5], v[152:159], v122
  v_cndmask_b32 v39, v39, v51, vcc
  v_smfmac_f32_16x16x64_bf16 v[46:49], v[18:21], v[136:143], v122
  v_cvt_pk_bf16_f32 v98, v42, v43
  v_smfmac_f32_16x16x64_bf16 v[46:49], v[26:29], v[74:81], v122
  s_waitcnt lgkmcnt(0)
  v_cvt_pk_bf16_f32 v99, v44, v45
  v_smfmac_f32_16x16x64_bf16 v[46:49], v[30:33], v[90:97], v122
  v_cndmask_b32 v40, v40, v52, vcc
  v_mfma_f32_16x16x32_bf16 v[42:45], v[98:101], v[106:109], 0
  v_cndmask_b32 v41, v41, v53, vcc
  s_nop 1
  v_cvt_pk_bf16_f32 v100, v46, v47
  v_cvt_pk_bf16_f32 v101, v48, v49
  s_nop 1
  v_mfma_f32_16x16x32_bf16 v[46:49], v[100:103], v[106:109], 0
  v_cvt_pk_bf16_f32 v42, v42, v43
  v_cvt_pk_bf16_f32 v43, v44, v45
  v_smfmac_f32_16x16x64_bf16 v[58:61], v[2:5], a[192:199], v122
  ds_write_b128 v117, v[38:41] offset:10240
  s_nop 2
  v_cvt_pk_bf16_f32 v44, v46, v47
  v_cvt_pk_bf16_f32 v45, v48, v49
  s_nop 1
  v_mfma_f32_16x16x32_bf16 v[46:49], v[42:45], v[34:37], 0
  v_smfmac_f32_16x16x64_bf16 v[62:65], v[2:5], a[200:207], v122
  s_nop 3
  v_cndmask_b32 v46, v46, v48, vcc
  v_cndmask_b32 v47, v47, v49, vcc
  v_smfmac_f32_16x16x64_bf16 v[58:61], v[6:9], a[208:215], v122
  ds_write_b64 v119, v[46:47] offset:13312
  v_smfmac_f32_16x16x64_bf16 v[62:65], v[6:9], a[216:223], v122
  ds_read_b64 v[94:95], v120 offset:13312
  v_smfmac_f32_16x16x64_bf16 v[58:61], v[30:33], a[176:183], v122
  ds_read_b64 v[2:3], v117 offset:26632
  ds_read_b64 v[4:5], v117 offset:27648
  s_waitcnt vmcnt(3)
  buffer_load_dwordx4 v115, s[4:7], s83 offen offset:0 sc1 lds
  v_smfmac_f32_16x16x64_bf16 v[62:65], v[30:33], a[184:191], v122
  ds_read_b64 v[6:7], v117 offset:26624
  ds_read_b64 v[8:9], v117 offset:27656
  v_readfirstlane_b32 s84, v124
  v_smfmac_f32_16x16x64_bf16 v[58:61], v[10:13], a[224:231], v122
  s_waitcnt lgkmcnt(5)
  s_barrier
  v_smfmac_f32_16x16x64_bf16 v[62:65], v[10:13], a[232:239], v122
  ds_read_b128 v[50:53], v117 offset:11264
  ds_read_b128 v[54:57], v117 offset:8192
  v_cndmask_b32 v30, v42, v44, vcc
  v_smfmac_f32_16x16x64_bf16 v[58:61], v[14:17], a[240:247], v122
  ds_read_b128 v[86:89], v117 offset:9216
  ds_read_b64 v[96:97], v120 offset:13824
  v_cndmask_b32 v31, v43, v45, vcc
  v_smfmac_f32_16x16x64_bf16 v[62:65], v[14:17], a[248:255], v122
  ds_read_b64 v[90:91], v120 offset:12288
  ds_read_b64 v[92:93], v120 offset:12800
  v_mov_b64 v[10:11], 0
  v_smfmac_f32_16x16x64_bf16 v[58:61], v[18:21], a[128:135], v122
  ds_read_b128 v[66:69], v116 offset:40960
  buffer_load_dwordx4 v115, s[4:7], s83 offen offset:1024 sc1 lds
  v_mov_b64 v[12:13], 0
  v_smfmac_f32_16x16x64_bf16 v[62:65], v[18:21], a[136:143], v122
  ds_read_b128 v[70:73], v116 offset:41984
  s_xor_b32 s84, s84, 1
  v_mov_b64 v[14:15], 0
  v_smfmac_f32_16x16x64_bf16 v[58:61], v[22:25], a[144:151], v122
  ds_read_b128 v[74:77], v116 offset:43008
  v_mov_b64 v[16:17], 0
  v_smfmac_f32_16x16x64_bf16 v[62:65], v[22:25], a[152:159], v122
  s_waitcnt lgkmcnt(3)
  buffer_load_dwordx4 v115, s[4:7], s86 offen offset:2048 sc1 lds
  ds_read_b128 v[78:81], v116 offset:44032
  v_add_f32 v38, v38, v50
  v_add_f32 v39, v39, v51
  v_add_f32 v40, v40, v52
  v_add_f32 v41, v41, v53
  v_pk_add_f32 v[38:39], v[38:39], v[54:55]
  v_pk_add_f32 v[40:41], v[40:41], v[56:57]
  v_pk_add_f32 v[38:39], v[38:39], v[86:87]
  v_pk_add_f32 v[40:41], v[40:41], v[88:89]
  v_max3_f32 v125, v38, v39, v40
  v_max_f32 v125, v125, v41
  v_pk_add_f32 v[94:95], v[94:95], v[96:97]
  v_pk_add_f32 v[90:91], v[90:91], v[92:93]
  v_max_f32_dpp v125, v125, v125 row_ror:8 row_mask:0xf bank_mask:0xf
  v_pk_add_f32 v[94:95], v[94:95], v[90:91]
  v_max3_f32 v127, v125, v94, v95
  v_max3_f32 v125, v125, v94, v95
  v_smfmac_f32_16x16x64_bf16 v[58:61], v[26:29], a[160:167], v122
  buffer_load_dwordx4 v115, s[4:7], s86 offen offset:3072 sc1 lds
  v_permlane16_swap_b32 v125, v127
  v_max_f32 v126, v125, v127
  v_max_f32 v125, v125, v127
  v_smfmac_f32_16x16x64_bf16 v[62:65], v[26:29], a[168:175], v122
  ds_read_b128 v[82:85], v116 offset:57344
  v_permlane32_swap_b32 v125, v126
  v_max_f32 v125, v125, v126
  v_mul_f32 v126, s85, v125
  v_pk_fma_f32 v[38:39], v[38:39], s[90:91], v[126:127] op_sel_hi:[1,1,0] neg_lo:[0,0,1] neg_hi:[0,0,1]
  v_pk_fma_f32 v[40:41], v[40:41], s[90:91], v[126:127] op_sel_hi:[1,1,0] neg_lo:[0,0,1] neg_hi:[0,0,1]
  v_pk_fma_f32 v[94:95], v[94:95], s[90:91], v[126:127] op_sel_hi:[1,1,0] neg_lo:[0,0,1] neg_hi:[0,0,1]
  v_exp_f32 v38, v38
  v_exp_f32 v39, v39
  v_exp_f32 v40, v40
  v_exp_f32 v41, v41
  v_cvt_pk_bf16_f32 v42, v38, v39
  v_cvt_pk_bf16_f32 v43, v40, v41
  v_exp_f32 v94, v94
  v_mov_b32_dpp v50, v42 row_shl:8 row_mask:0xf bank_mask:0xf bound_ctrl:0
  v_mov_b32_dpp v51, v43 row_shl:8 row_mask:0xf bank_mask:0xf bound_ctrl:0
  v_mov_b32_dpp v52, v42 row_shr:8 row_mask:0xf bank_mask:0xf bound_ctrl:0
  v_mov_b32_dpp v53, v43 row_shr:8 row_mask:0xf bank_mask:0xf bound_ctrl:0
  v_exp_f32 v95, v95
  v_cndmask_b32_e64 v54, v42, 0, vcc
  v_mfma_f32_16x16x32_bf16 v[34:37], v[2:5], v[50:53], 0
  v_cndmask_b32_e64 v55, v43, 0, vcc
  v_cvt_pk_bf16_f32 v98, v58, v59
  v_cvt_pk_bf16_f32 v99, v60, v61
  v_cvt_pk_bf16_f32 v127, v94, v95
  v_cndmask_b32_e64 v44, v127, 0, vcc
  v_cndmask_b32_e64 v45, v127, 0, vcc
  v_cndmask_b32 v46, 0, v127, vcc
  v_cndmask_b32 v47, 0, v127, vcc
  v_mfma_f32_16x16x32_bf16 v[38:41], v[110:113], v[42:45], 0
  v_cvt_pk_bf16_f32 v100, v62, v63
  v_cvt_pk_bf16_f32 v101, v64, v65
  s_nop 1
  v_mfma_f32_16x16x32_bf16 v[34:37], v[98:101], v[44:47], v[34:37]
  ds_read_b128 v[86:89], v116 offset:58368
  v_cndmask_b32 v56, 0, v42, vcc
  v_cndmask_b32 v57, 0, v43, vcc
  v_mov_b64 v[18:19], 0
  v_mov_b64 v[20:21], 0
  v_mfma_f32_16x16x32_bf16 v[34:37], v[6:9], v[54:57], v[34:37]
  ds_read_b128 v[90:93], v116 offset:59392
  ds_read_b128 v[94:97], v116 offset:60416
  v_add_f32_dpp v125, v38, v38 row_ror:8 row_mask:0xf bank_mask:0xf
  v_rcp_f32 v125, v125
  v_mov_b64 v[22:23], 0
  v_mov_b64 v[24:25], 0
  s_nop 1
  v_pk_mul_f32 v[34:35], v[34:35], v[124:125] op_sel:[0,1] op_sel_hi:[1,1]
  v_pk_mul_f32 v[36:37], v[36:37], v[124:125] op_sel:[0,1] op_sel_hi:[1,1]
  v_cvt_pk_bf16_f32 v34, v34, v35
  v_cvt_pk_bf16_f32 v35, v36, v37
  s_add_u32 s81, s80, 0x1000
  ds_write_b64 v119, v[34:35] offset:15360
  v_cndmask_b32_dpp v36, v34, v34, vcc row_ror:8 row_mask:0xf bank_mask:0xf
  v_cndmask_b32_dpp v37, v35, v35, vcc row_ror:8 row_mask:0xf bank_mask:0xf
  v_mov_b32_dpp v34, v34 row_shr:8 row_mask:0xf bank_mask:0xc
  v_mov_b32_dpp v35, v35 row_shr:8 row_mask:0xf bank_mask:0xc
  s_waitcnt lgkmcnt(1)
  s_nop 0
  v_smfmac_f32_16x16x64_bf16 v[10:13], v[34:37], v[224:231], v114
  v_smfmac_f32_16x16x64_bf16 v[14:17], v[34:37], v[232:239], v114
  s_waitcnt lgkmcnt(0)
  s_barrier
  ds_read_b128 v[38:41], v118 offset:15872
  ds_read_b128 v[42:45], v118 offset:14336
  ds_read_b128 v[46:49], v118 offset:14848
  v_smfmac_f32_16x16x64_bf16 v[18:21], v[34:37], v[240:247], v114
  v_smfmac_f32_16x16x64_bf16 v[22:25], v[34:37], v[248:255], v114
  s_waitcnt lgkmcnt(2)
  v_smfmac_f32_16x16x64_bf16 v[10:13], v[38:41], v[66:73], v114
  v_smfmac_f32_16x16x64_bf16 v[14:17], v[38:41], v[74:81], v114
  s_waitcnt lgkmcnt(1)
  v_smfmac_f32_16x16x64_bf16 v[10:13], v[42:45], v[160:167], v114
  v_smfmac_f32_16x16x64_bf16 v[14:17], v[42:45], v[168:175], v114
  s_waitcnt lgkmcnt(0)
  v_smfmac_f32_16x16x64_bf16 v[10:13], v[46:49], v[192:199], v114
  v_smfmac_f32_16x16x64_bf16 v[14:17], v[46:49], v[200:207], v114
  v_smfmac_f32_16x16x64_bf16 v[18:21], v[38:41], v[82:89], v114
  v_smfmac_f32_16x16x64_bf16 v[22:25], v[38:41], v[90:97], v114
  v_cvt_pk_bf16_f32 v10, v10, v11
  v_cvt_pk_bf16_f32 v11, v12, v13
  v_bfi_b32 v10, 1, s79, v10
  v_smfmac_f32_16x16x64_bf16 v[18:21], v[42:45], v[176:183], v114
  v_cvt_pk_bf16_f32 v12, v14, v15
  v_cvt_pk_bf16_f32 v13, v16, v17
  v_smfmac_f32_16x16x64_bf16 v[22:25], v[42:45], v[184:191], v114
  buffer_store_dwordx4 v[10:13], v121, s[4:7], s76 offen sc1
  v_smfmac_f32_16x16x64_bf16 v[18:21], v[46:49], v[208:215], v114
  v_smfmac_f32_16x16x64_bf16 v[22:25], v[46:49], v[216:223], v114
  s_nop 3
  v_cvt_pk_bf16_f32 v18, v18, v19
  v_cvt_pk_bf16_f32 v19, v20, v21
  v_bfi_b32 v18, 1, s79, v18
  s_nop 0
  v_cvt_pk_bf16_f32 v20, v22, v23
  v_cvt_pk_bf16_f32 v21, v24, v25
  buffer_store_dwordx4 v[18:21], v121, s[4:7], s77 offen sc1
  v_mov_b64 v[34:35], 0
  v_mov_b64 v[36:37], 0
  v_mov_b64 v[38:39], 0
  v_mov_b64 v[40:41], 0
  v_mov_b64 v[42:43], 0
  v_mov_b64 v[44:45], 0
  v_mov_b64 v[46:47], 0
  v_mov_b64 v[48:49], 0
  v_mov_b64 v[58:59], 0
  v_mov_b64 v[60:61], 0
  v_mov_b64 v[62:63], 0
  v_mov_b64 v[64:65], 0
  ds_read_b128 v[66:69], v115 offset:57344
  ds_read_b128 v[70:73], v115 offset:58368
  ds_read_b128 v[74:77], v115 offset:59392
  ds_read_b128 v[78:81], v115 offset:60416
  ds_read_b128 v[82:85], v116 offset:8192
  ds_read_b128 v[86:89], v116 offset:9216
  ds_read_b128 v[90:93], v116 offset:10240
  ds_read_b128 v[94:97], v116 offset:11264
  s_waitcnt vmcnt(0)
  buffer_load_dwordx4 v[2:5], v115, s[4:7], s78 offen offset:0 sc1
  buffer_load_dwordx4 v[6:9], v115, s[4:7], s78 offen offset:1024 sc1
  s_add_u32 s70, s70, 1
  s_add_u32 s82, s82, 2048
  s_add_u32 s80, s80, 0x40000
  s_xor_b32 s76, s76, 0x40000
  s_sub_u32 s73, s74, s88
  s_add_u32 s73, s73, 4096
c21_rpoll:
  s_waitcnt vmcnt(0)
  v_mfma_f32_16x16x32_bf16 v[18:21], v[2:5], v[102:105], 0
  v_mfma_f32_16x16x32_bf16 v[18:21], v[6:9], v[102:105], v[18:21]
  v_bitop3_b32 v125, v2, v6, s79 bitop3:0x7e
  v_and_b32 v125, 1, v125
  v_cmp_ne_u32 vcc, 0, v125
  s_cbranch_vccz c21_rpoll_ok
  s_mov_b64 exec, vcc
  buffer_load_dwordx4 v[2:5], v115, s[4:7], s78 offen offset:0 sc1
  buffer_load_dwordx4 v[6:9], v115, s[4:7], s78 offen offset:1024 sc1
  s_sub_u32 s51, s51, 1
  s_cbranch_scc0 c21_rpoll
  s_endpgm
c21_rpoll_ok:
  s_mov_b64 exec, -1
  s_nop 1
  v_permlane32_swap_b32 v18, v20
  v_permlane32_swap_b32 v19, v21
  v_add_f32 v18, v18, v20
  v_add_f32 v19, v19, v21
  s_nop 1
  v_permlane16_swap_b32 v18, v19
  v_add_f32 v18, v18, v19
  s_nop 1
  v_mov_b32_dpp v19, v18 row_shl:4 row_mask:0xf bank_mask:0xf
  v_cvt_pk_bf16_f32 v18, v18, v19
  v_min_u32 v18, -2, v18
  buffer_store_dword v18, v123, s[4:7], s74 offen sc1
  s_xor_b32 s78, s78, 0x40000
  s_cmp_eq_u32 s70, 63
  s_cbranch_scc1 c21_last
  s_lshr_b32 s79, s70, 1
  s_add_u32 s77, s76, 0x8000
  s_add_u32 s86, s70, 1
  s_and_b32 s86, s86, 3
  s_lshl_b32 s86, s86, 13
  s_add_u32 s86, s86, s89
  s_add_u32 s74, s86, s88
  s_xor_b32 s75, s74, 0x4000
  s_cmp_eq_u32 s84, 0
  s_cbranch_scc1 c21_have
c21_kpoll:
  s_sub_u32 s51, s51, 1
  s_cbranch_scc1 main_end
  buffer_load_dword v124, off, s[4:7], s82 sc1
  s_waitcnt vmcnt(0)
  v_readfirstlane_b32 s87, v124
  s_cmp_eq_u32 s87, 0
  s_cbranch_scc1 c21_kpoll
  s_mov_b32 m0, 0x26000
  s_nop 0
  buffer_load_dwordx4 v115, s[4:7], s83 offen offset:0 sc1 lds
  buffer_load_dwordx4 v115, s[4:7], s83 offen offset:1024 sc1 lds
  s_add_u32 s86, s83, 0x1fff800
  buffer_load_dwordx4 v115, s[4:7], s86 offen offset:2048 sc1 lds
  buffer_load_dwordx4 v115, s[4:7], s86 offen offset:3072 sc1 lds
  buffer_load_dwordx4 v[2:5], v115, s[4:7], s73 offen offset:0 sc1
  buffer_load_dwordx4 v[6:9], v115, s[4:7], s73 offen offset:1024 sc1
  s_add_u32 s87, s81, 0xfffe0400
  s_waitcnt vmcnt(2)
  ds_read_b128 v[50:53], v117 offset:24576
  ds_read_b128 v[54:57], v117 offset:25600
  s_waitcnt lgkmcnt(0)
  s_branch c21_poll0
  s_waitcnt vmcnt(0)
c21_have:
  ds_read_b128 v[50:53], v117 offset:24576
  ds_read_b128 v[54:57], v117 offset:25600
  s_waitcnt vmcnt(0)
  buffer_load_dwordx4 v[2:5], v115, s[4:7], s73 offen offset:0 sc1
  buffer_load_dwordx4 v[6:9], v115, s[4:7], s73 offen offset:1024 sc1
  s_add_u32 s87, s81, 0xfffe0400
  s_waitcnt lgkmcnt(0)
  s_branch c21_poll0
c21_last:
  s_waitcnt vmcnt(0)
  buffer_load_dwordx4 v[2:5], v115, s[4:7], s73 offen offset:0 sc1
  buffer_load_dwordx4 v[6:9], v115, s[4:7], s73 offen offset:1024 sc1
  s_add_u32 s87, s81, 0xfffe0400
  s_waitcnt lgkmcnt(0)
c21_lpoll:
  s_waitcnt vmcnt(0)
  ds_write_b128 v117, v[2:5] offset:4096
  ds_write_b128 v117, v[6:9] offset:5120
  v_max3_u32 v125, v2, v3, v4
  v_max3_u32 v126, v5, v6, v7
  v_max3_u32 v125, v125, v8, v9
  v_max_u32 v125, v125, v126
  v_cmp_eq_u32 vcc, -1, v125
  s_cbranch_vccz c21_lpoll_ok
  s_mov_b64 exec, vcc
  buffer_load_dwordx4 v[2:5], v115, s[4:7], s73 offen offset:0 sc1
  buffer_load_dwordx4 v[6:9], v115, s[4:7], s73 offen offset:1024 sc1
  s_sub_u32 s51, s51, 1
  s_cbranch_scc0 c21_lpoll
  s_endpgm
c21_lpoll_ok:
  s_mov_b64 exec, -1
  buffer_store_dwordx2 v[30:31], v119, s[4:7], s87 offen sc1
  buffer_store_dwordx4 v[98:101], v115, s[4:7], s81 offen sc1
  s_add_u32 s81, s80, 0x1000
  s_mov_b64 vcc, s[92:93]
  v_smfmac_f32_16x16x64_bf16 v[58:61], v[2:5], a[192:199], v122
  v_smfmac_f32_16x16x64_bf16 v[62:65], v[2:5], a[200:207], v122
  s_waitcnt lgkmcnt(0)
  s_barrier
  ds_read_b128 v[30:33], v117 offset:3072
  ds_read_b128 v[10:13], v117 offset:6144
  ds_read_b128 v[14:17], v117 offset:7168
  ds_read_b128 v[22:25], v117 offset:1024
  ds_read_b128 v[18:21], v117 offset:0
  ds_read_b128 v[26:29], v117 offset:2048
  v_smfmac_f32_16x16x64_bf16 v[58:61], v[6:9], a[208:215], v122
  v_smfmac_f32_16x16x64_bf16 v[62:65], v[6:9], a[216:223], v122
  v_smfmac_f32_16x16x64_bf16 v[42:45], v[6:9], v[66:73], v122
  ds_read_b128 v[66:69], v116 offset:24576
  ds_read_b128 v[70:73], v116 offset:25600
  v_smfmac_f32_16x16x64_bf16 v[46:49], v[6:9], v[74:81], v122
  ds_read_b128 v[74:77], v116 offset:26624
  ds_read_b128 v[78:81], v116 offset:27648
  s_waitcnt lgkmcnt(9)
  v_smfmac_f32_16x16x64_bf16 v[58:61], v[30:33], a[176:183], v122
  v_smfmac_f32_16x16x64_bf16 v[62:65], v[30:33], a[184:191], v122
  s_waitcnt lgkmcnt(8)
  v_smfmac_f32_16x16x64_bf16 v[42:45], v[10:13], v[82:89], v122
  ds_read_b128 v[82:85], v115 offset:8192
  ds_read_b128 v[86:89], v115 offset:9216
  v_smfmac_f32_16x16x64_bf16 v[46:49], v[10:13], v[90:97], v122
  ds_read_b128 v[90:93], v115 offset:10240
  ds_read_b128 v[94:97], v115 offset:11264
  v_smfmac_f32_16x16x64_bf16 v[58:61], v[10:13], a[224:231], v122
  v_smfmac_f32_16x16x64_bf16 v[62:65], v[10:13], a[232:239], v122
  s_waitcnt lgkmcnt(6)
  v_smfmac_f32_16x16x64_bf16 v[42:45], v[14:17], v[66:73], v122
  ds_read_b128 v[66:69], v115 offset:24576
  ds_read_b128 v[70:73], v115 offset:25600
  s_waitcnt lgkmcnt(6)
  v_smfmac_f32_16x16x64_bf16 v[46:49], v[14:17], v[74:81], v122
  ds_read_b128 v[74:77], v115 offset:26624
  ds_read_b128 v[78:81], v115 offset:27648
  v_smfmac_f32_16x16x64_bf16 v[58:61], v[14:17], a[240:247], v122
  v_smfmac_f32_16x16x64_bf16 v[62:65], v[14:17], a[248:255], v122
  s_waitcnt lgkmcnt(6)
  v_smfmac_f32_16x16x64_bf16 v[42:45], v[22:25], v[82:89], v122
  ds_read_b128 v[82:85], v115 offset:40960
  ds_read_b128 v[86:89], v115 offset:41984
  s_waitcnt lgkmcnt(6)
  v_smfmac_f32_16x16x64_bf16 v[46:49], v[22:25], v[90:97], v122
  ds_read_b128 v[90:93], v115 offset:43008
  ds_read_b128 v[94:97], v115 offset:44032
  v_smfmac_f32_16x16x64_bf16 v[58:61], v[18:21], a[128:135], v122
  v_smfmac_f32_16x16x64_bf16 v[62:65], v[18:21], a[136:143], v122
  v_smfmac_f32_16x16x64_bf16 v[42:45], v[2:5], v[144:151], v122
  v_smfmac_f32_16x16x64_bf16 v[46:49], v[2:5], v[152:159], v122
  v_smfmac_f32_16x16x64_bf16 v[42:45], v[18:21], v[128:135], v122
  v_smfmac_f32_16x16x64_bf16 v[46:49], v[18:21], v[136:143], v122
  s_waitcnt lgkmcnt(6)
  v_smfmac_f32_16x16x64_bf16 v[42:45], v[26:29], v[66:73], v122
  s_waitcnt lgkmcnt(4)
  v_smfmac_f32_16x16x64_bf16 v[46:49], v[26:29], v[74:81], v122
  v_smfmac_f32_16x16x64_bf16 v[58:61], v[22:25], a[144:151], v122
  v_smfmac_f32_16x16x64_bf16 v[62:65], v[22:25], a[152:159], v122
  s_waitcnt lgkmcnt(2)
  v_smfmac_f32_16x16x64_bf16 v[42:45], v[30:33], v[82:89], v122
  s_waitcnt lgkmcnt(0)
  v_smfmac_f32_16x16x64_bf16 v[46:49], v[30:33], v[90:97], v122
  v_smfmac_f32_16x16x64_bf16 v[58:61], v[26:29], a[160:167], v122
  v_smfmac_f32_16x16x64_bf16 v[62:65], v[26:29], a[168:175], v122
  v_cvt_pk_bf16_f32 v98, v42, v43
  v_cvt_pk_bf16_f32 v99, v44, v45
  v_cvt_pk_bf16_f32 v100, v46, v47
  v_cvt_pk_bf16_f32 v101, v48, v49
  s_nop 1
  v_mfma_f32_16x16x32_bf16 v[42:45], v[98:101], v[106:109], 0
  v_mfma_f32_16x16x32_bf16 v[46:49], v[100:103], v[106:109], 0
  s_add_u32 s87, s81, 0xfffe0400
  s_nop 2
  v_cvt_pk_bf16_f32 v42, v42, v43
  v_cvt_pk_bf16_f32 v43, v44, v45
  s_nop 1
  v_cvt_pk_bf16_f32 v44, v46, v47
  v_cvt_pk_bf16_f32 v45, v48, v49
  v_cndmask_b32 v30, v42, v44, vcc
  v_cndmask_b32 v31, v43, v45, vcc
  s_cmp_eq_u32 s84, 0
  s_cbranch_scc1 c21_lgo
c21_lfl:
  s_sub_u32 s51, s51, 1
  s_cbranch_scc1 main_end
  buffer_load_dword v124, off, s[4:7], s82 sc1
  s_waitcnt vmcnt(0)
  v_readfirstlane_b32 s86, v124
  s_cmp_eq_u32 s86, 0
  s_cbranch_scc1 c21_lfl
c21_lgo:
  buffer_store_dwordx2 v[30:31], v119, s[4:7], s87 offen sc1
  v_cvt_pk_bf16_f32 v98, v58, v59
  v_cvt_pk_bf16_f32 v99, v60, v61
  v_cvt_pk_bf16_f32 v100, v62, v63
  v_cvt_pk_bf16_f32 v101, v64, v65
  buffer_store_dwordx4 v[98:101], v115, s[4:7], s81 offen sc1
  s_endpgm
c21_tail:
  s_mov_b32 s72, s52
  ds_read_b128 v[66:69], v115 offset:57344
  ds_read_b128 v[70:73], v115 offset:58368
  ds_read_b128 v[74:77], v115 offset:59392
  ds_read_b128 v[78:81], v115 offset:60416
  ds_read_b128 v[82:85], v116 offset:8192
  ds_read_b128 v[86:89], v116 offset:9216
  ds_read_b128 v[90:93], v116 offset:10240
  ds_read_b128 v[94:97], v116 offset:11264
  s_add_u32 s73, s89, 4096
  s_lshr_b32 s79, s70, 1
  s_add_u32 s77, s76, 0x8000
  s_add_u32 s86, s70, 1
  s_and_b32 s86, s86, 3
  s_lshl_b32 s86, s86, 13
  s_add_u32 s86, s86, s89
  s_add_u32 s74, s86, s88
  s_xor_b32 s75, s74, 0x4000
  s_cmp_eq_u32 s94, 0
  s_cbranch_scc1 c21_kpoll
  s_waitcnt vmcnt(0)
  ds_read_b128 v[50:53], v117 offset:24576
  ds_read_b128 v[54:57], v117 offset:25600
  v_mov_b64 v[2:3], v[12:13]
  v_mov_b64 v[4:5], v[14:15]
  v_mov_b64 v[6:7], v[16:17]
  v_mov_b64 v[8:9], v[18:19]
  s_add_u32 s87, s81, 0xfffe0400
  s_waitcnt lgkmcnt(0)
  s_branch c21_poll0
c31_entry:
  s_branch c31_tail
c31_poll0:
c31_poll:
  s_waitcnt vmcnt(0)
  ds_write_b128 v117, v[2:5] offset:6144
  ds_write_b128 v117, v[6:9] offset:7168
  v_max3_u32 v125, v2, v3, v4
  v_max3_u32 v126, v5, v6, v7
  v_max3_u32 v125, v125, v8, v9
  v_max_u32 v125, v125, v126
  v_cmp_eq_u32 vcc, -1, v125
  s_cbranch_vccz c31_poll_ok
  s_mov_b64 exec, vcc
  buffer_load_dwordx4 v[2:5], v115, s[4:7], s73 offen offset:0 sc1
  buffer_load_dwordx4 v[6:9], v115, s[4:7], s73 offen offset:1024 sc1
  s_sub_u32 s51, s51, 1
  s_cbranch_scc0 c31_poll
  s_endpgm
c31_poll_ok:
  s_mov_b64 exec, -1
  v_smfmac_f32_16x16x64_bf16 v[42:45], v[2:5], v[66:73], v122
  v_smfmac_f32_16x16x64_bf16 v[46:49], v[2:5], v[74:81], v122
  s_waitcnt lgkmcnt(0)
  s_barrier
  buffer_load_dword v124, off, s[4:7], s82 offset:2048 sc1
  v_smfmac_f32_16x16x64_bf16 v[42:45], v[6:9], v[82:89], v122
  ds_read_b128 v[10:13], v117 offset:0
  v_smfmac_f32_16x16x64_bf16 v[46:49], v[6:9], v[90:97], v122
  buffer_store_dwordx2 v[30:31], v119, s[4:7], s87 offen sc1
  ds_read_b128 v[14:17], v117 offset:1024
  v_smfmac_f32_16x16x64_bf16 v[34:37], v[2:5], a[96:103], v122
  ds_read_b128 v[18:21], v117 offset:2048
  v_smfmac_f32_16x16x64_bf16 v[38:41], v[2:5], a[104:111], v122
  ds_read_b128 v[22:25], v117 offset:3072
  v_smfmac_f32_16x16x64_bf16 v[34:37], v[6:9], a[112:119], v122
  ds_read_b128 v[26:29], v117 offset:4096
  v_smfmac_f32_16x16x64_bf16 v[38:41], v[6:9], a[120:127], v122
  ds_read_b128 v[30:33], v117 offset:5120
  s_waitcnt lgkmcnt(5)
  v_smfmac_f32_16x16x64_bf16 v[34:37], v[10:13], a[0:7], v122
  buffer_store_dwordx4 v[98:101], v115, s[4:7], s81 offen sc1
  ds_read_b128 v[66:69], v115 offset:12288
  v_smfmac_f32_16x16x64_bf16 v[38:41], v[10:13], a[8:15], v122
  ds_read_b128 v[70:73], v115 offset:13312
  s_waitcnt lgkmcnt(6)
  v_smfmac_f32_16x16x64_bf16 v[34:37], v[14:17], a[16:23], v122
  ds_read_b128 v[74:77], v115 offset:14336
  v_smfmac_f32_16x16x64_bf16 v[38:41], v[14:17], a[24:31], v122
  ds_read_b128 v[78:81], v115 offset:15360
  s_waitcnt lgkmcnt(7)
  v_mov_b32 v126, -1
  v_smfmac_f32_16x16x64_bf16 v[34:37], v[18:21], a[32:39], v122
  buffer_store_dword v126, v123, s[4:7], s75 offen sc1
  ds_read_b128 v[82:85], v115 offset:28672
  v_smfmac_f32_16x16x64_bf16 v[38:41], v[18:21], a[40:47], v122
  ds_read_b128 v[86:89], v115 offset:29696
  s_waitcnt lgkmcnt(8)
  v_smfmac_f32_16x16x64_bf16 v[34:37], v[22:25], a[48:55], v122
  ds_read_b128 v[90:93], v115 offset:30720
  v_smfmac_f32_16x16x64_bf16 v[38:41], v[22:25], a[56:63], v122
  s_add_u32 s83, s83, 0x40000
  ds_read_b128 v[94:97], v115 offset:31744
  s_waitcnt lgkmcnt(9)
  v_smfmac_f32_16x16x64_bf16 v[34:37], v[26:29], a[64:71], v122
  s_mov_b32 m0, 0x27000
  s_add_u32 s86, s83, 0x1fff800
  v_smfmac_f32_16x16x64_bf16 v[38:41], v[26:29], a[72:79], v122
  s_mov_b64 vcc, s[92:93]
  s_waitcnt lgkmcnt(8)
  v_smfmac_f32_16x16x64_bf16 v[34:37], v[30:33], a[80:87], v122
  v_smfmac_f32_16x16x64_bf16 v[38:41], v[30:33], a[88:95], v122
  s_waitcnt lgkmcnt(6)
  v_smfmac_f32_16x16x64_bf16 v[42:45], v[14:17], v[66:73], v122
  ds_read_b128 v[66:69], v115 offset:45056
  s_waitcnt lgkmcnt(5)
  v_cvt_pk_bf16_f32 v98, v34, v35
  v_cvt_pk_bf16_f32 v99, v36, v37
  v_smfmac_f32_16x16x64_bf16 v[46:49], v[14:17], v[74:81], v122
  ds_read_b128 v[70:73], v115 offset:46080
  v_mfma_f32_16x16x32_bf16 v[34:37], v[98:101], v[106:109], 0
  ds_read_b128 v[74:77], v115 offset:47104
  s_waitcnt lgkmcnt(5)
  v_cvt_pk_bf16_f32 v100, v38, v39
  v_cvt_pk_bf16_f32 v101, v40, v41
  v_smfmac_f32_16x16x64_bf16 v[42:45], v[18:21], v[82:89], v122
  ds_read_b128 v[78:81], v115 offset:48128
  v_mfma_f32_16x16x32_bf16 v[38:41], v[100:103], v[106:109], 0
  ds_read_b128 v[82:85], v115 offset:61440
  s_waitcnt lgkmcnt(5)
  v_cvt_pk_bf16_f32 v34, v34, v35
  v_cvt_pk_bf16_f32 v35, v36, v37
  v_smfmac_f32_16x16x64_bf16 v[46:49], v[18:21], v[90:97], v122
  ds_read_b128 v[86:89], v115 offset:62464
  v_smfmac_f32_16x16x64_bf16 v[42:45], v[10:13], v[128:135], v122
  ds_read_b128 v[90:93], v115 offset:63488
  ds_read_b128 v[94:97], v115 offset:64512
  v_cvt_pk_bf16_f32 v36, v38, v39
  v_cvt_pk_bf16_f32 v37, v40, v41
  v_smfmac_f32_16x16x64_bf16 v[42:45], v[26:29], v[144:151], v122
  s_nop 0
  v_mfma_f32_16x16x32_bf16 v[38:41], v[50:53], v[34:37], 0
  v_mfma_f32_16x16x32_bf16 v[50:53], v[54:57], v[34:37], 0
  s_waitcnt lgkmcnt(6)
  v_smfmac_f32_16x16x64_bf16 v[42:45], v[22:25], v[66:73], v122
  s_waitcnt lgkmcnt(2)
  v_smfmac_f32_16x16x64_bf16 v[42:45], v[30:33], v[82:89], v122
  v_cndmask_b32 v38, v38, v50, vcc
  v_smfmac_f32_16x16x64_bf16 v[46:49], v[10:13], v[136:143], v122
  v_cndmask_b32 v39, v39, v51, vcc
  v_smfmac_f32_16x16x64_bf16 v[46:49], v[26:29], v[152:159], v122
  v_cvt_pk_bf16_f32 v98, v42, v43
  v_smfmac_f32_16x16x64_bf16 v[46:49], v[22:25], v[74:81], v122
  s_waitcnt lgkmcnt(0)
  v_cvt_pk_bf16_f32 v99, v44, v45
  v_smfmac_f32_16x16x64_bf16 v[46:49], v[30:33], v[90:97], v122
  v_cndmask_b32 v40, v40, v52, vcc
  v_mfma_f32_16x16x32_bf16 v[42:45], v[98:101], v[106:109], 0
  v_cndmask_b32 v41, v41, v53, vcc
  s_nop 1
  v_cvt_pk_bf16_f32 v100, v46, v47
  v_cvt_pk_bf16_f32 v101, v48, v49
  s_nop 1
  v_mfma_f32_16x16x32_bf16 v[46:49], v[100:103], v[106:109], 0
  v_cvt_pk_bf16_f32 v42, v42, v43
  v_cvt_pk_bf16_f32 v43, v44, v45
  v_smfmac_f32_16x16x64_bf16 v[58:61], v[2:5], a[224:231], v122
  ds_write_b128 v117, v[38:41] offset:11264
  s_nop 2
  v_cvt_pk_bf16_f32 v44, v46, v47
  v_cvt_pk_bf16_f32 v45, v48, v49
  s_nop 1
  v_mfma_f32_16x16x32_bf16 v[46:49], v[42:45], v[34:37], 0
  v_smfmac_f32_16x16x64_bf16 v[62:65], v[2:5], a[232:239], v122
  s_nop 3
  v_cndmask_b32 v46, v46, v48, vcc
  v_cndmask_b32 v47, v47, v49, vcc
  v_smfmac_f32_16x16x64_bf16 v[58:61], v[6:9], a[240:247], v122
  ds_write_b64 v119, v[46:47] offset:13824
  v_smfmac_f32_16x16x64_bf16 v[62:65], v[6:9], a[248:255], v122
  ds_read_b64 v[94:95], v120 offset:13824
  v_smfmac_f32_16x16x64_bf16 v[58:61], v[30:33], a[208:215], v122
  ds_read_b64 v[2:3], v117 offset:30728
  ds_read_b64 v[4:5], v117 offset:31744
  s_waitcnt vmcnt(3)
  buffer_load_dwordx4 v115, s[4:7], s83 offen offset:0 sc1 lds
  v_smfmac_f32_16x16x64_bf16 v[62:65], v[30:33], a[216:223], v122
  ds_read_b64 v[6:7], v117 offset:30720
  ds_read_b64 v[8:9], v117 offset:31752
  v_readfirstlane_b32 s84, v124
  v_smfmac_f32_16x16x64_bf16 v[58:61], v[10:13], a[128:135], v122
  s_waitcnt lgkmcnt(5)
  s_barrier
  v_smfmac_f32_16x16x64_bf16 v[62:65], v[10:13], a[136:143], v122
  ds_read_b128 v[50:53], v117 offset:8192
  ds_read_b128 v[54:57], v117 offset:9216
  v_cndmask_b32 v30, v42, v44, vcc
  v_smfmac_f32_16x16x64_bf16 v[58:61], v[14:17], a[144:151], v122
  ds_read_b128 v[86:89], v117 offset:10240
  ds_read_b64 v[96:97], v120 offset:12288
  v_cndmask_b32 v31, v43, v45, vcc
  v_smfmac_f32_16x16x64_bf16 v[62:65], v[14:17], a[152:159], v122
  ds_read_b64 v[90:91], v120 offset:12800
  ds_read_b64 v[92:93], v120 offset:13312
  v_mov_b64 v[10:11], 0
  v_smfmac_f32_16x16x64_bf16 v[58:61], v[18:21], a[160:167], v122
  ds_read_b128 v[66:69], v116 offset:45056
  buffer_load_dwordx4 v115, s[4:7], s83 offen offset:1024 sc1 lds
  v_mov_b64 v[12:13], 0
  v_smfmac_f32_16x16x64_bf16 v[62:65], v[18:21], a[168:175], v122
  ds_read_b128 v[70:73], v116 offset:46080
  s_xor_b32 s84, s84, 1
  v_mov_b64 v[14:15], 0
  v_smfmac_f32_16x16x64_bf16 v[58:61], v[22:25], a[176:183], v122
  ds_read_b128 v[74:77], v116 offset:47104
  v_mov_b64 v[16:17], 0
  v_smfmac_f32_16x16x64_bf16 v[62:65], v[22:25], a[184:191], v122
  s_waitcnt lgkmcnt(3)
  buffer_load_dwordx4 v115, s[4:7], s86 offen offset:2048 sc1 lds
  ds_read_b128 v[78:81], v116 offset:48128
  v_add_f32 v38, v38, v50
  v_add_f32 v39, v39, v51
  v_add_f32 v40, v40, v52
  v_add_f32 v41, v41, v53
  v_pk_add_f32 v[38:39], v[38:39], v[54:55]
  v_pk_add_f32 v[40:41], v[40:41], v[56:57]
  v_pk_add_f32 v[38:39], v[38:39], v[86:87]
  v_pk_add_f32 v[40:41], v[40:41], v[88:89]
  v_max3_f32 v125, v38, v39, v40
  v_max_f32 v125, v125, v41
  v_pk_add_f32 v[94:95], v[94:95], v[96:97]
  v_pk_add_f32 v[90:91], v[90:91], v[92:93]
  v_max_f32_dpp v125, v125, v125 row_ror:8 row_mask:0xf bank_mask:0xf
  v_pk_add_f32 v[94:95], v[94:95], v[90:91]
  v_max3_f32 v127, v125, v94, v95
  v_max3_f32 v125, v125, v94, v95
  v_smfmac_f32_16x16x64_bf16 v[58:61], v[26:29], a[192:199], v122
  buffer_load_dwordx4 v115, s[4:7], s86 offen offset:3072 sc1 lds
  v_permlane16_swap_b32 v125, v127
  v_max_f32 v126, v125, v127
  v_max_f32 v125, v125, v127
  v_smfmac_f32_16x16x64_bf16 v[62:65], v[26:29], a[200:207], v122
  ds_read_b128 v[82:85], v116 offset:61440
  v_permlane32_swap_b32 v125, v126
  v_max_f32 v125, v125, v126
  v_mul_f32 v126, s85, v125
  v_pk_fma_f32 v[38:39], v[38:39], s[90:91], v[126:127] op_sel_hi:[1,1,0] neg_lo:[0,0,1] neg_hi:[0,0,1]
  v_pk_fma_f32 v[40:41], v[40:41], s[90:91], v[126:127] op_sel_hi:[1,1,0] neg_lo:[0,0,1] neg_hi:[0,0,1]
  v_pk_fma_f32 v[94:95], v[94:95], s[90:91], v[126:127] op_sel_hi:[1,1,0] neg_lo:[0,0,1] neg_hi:[0,0,1]
  v_exp_f32 v38, v38
  v_exp_f32 v39, v39
  v_exp_f32 v40, v40
  v_exp_f32 v41, v41
  v_cvt_pk_bf16_f32 v42, v38, v39
  v_cvt_pk_bf16_f32 v43, v40, v41
  v_exp_f32 v94, v94
  v_mov_b32_dpp v50, v42 row_shl:8 row_mask:0xf bank_mask:0xf bound_ctrl:0
  v_mov_b32_dpp v51, v43 row_shl:8 row_mask:0xf bank_mask:0xf bound_ctrl:0
  v_mov_b32_dpp v52, v42 row_shr:8 row_mask:0xf bank_mask:0xf bound_ctrl:0
  v_mov_b32_dpp v53, v43 row_shr:8 row_mask:0xf bank_mask:0xf bound_ctrl:0
  v_exp_f32 v95, v95
  v_cndmask_b32_e64 v54, v42, 0, vcc
  v_mfma_f32_16x16x32_bf16 v[34:37], v[2:5], v[50:53], 0
  v_cndmask_b32_e64 v55, v43, 0, vcc
  v_cvt_pk_bf16_f32 v98, v58, v59
  v_cvt_pk_bf16_f32 v99, v60, v61
  v_cvt_pk_bf16_f32 v127, v94, v95
  v_cndmask_b32_e64 v44, v127, 0, vcc
  v_cndmask_b32_e64 v45, v127, 0, vcc
  v_cndmask_b32 v46, 0, v127, vcc
  v_cndmask_b32 v47, 0, v127, vcc
  v_mfma_f32_16x16x32_bf16 v[38:41], v[110:113], v[42:45], 0
  v_cvt_pk_bf16_f32 v100, v62, v63
  v_cvt_pk_bf16_f32 v101, v64, v65
  s_nop 1
  v_mfma_f32_16x16x32_bf16 v[34:37], v[98:101], v[44:47], v[34:37]
  ds_read_b128 v[86:89], v116 offset:62464
  v_cndmask_b32 v56, 0, v42, vcc
  v_cndmask_b32 v57, 0, v43, vcc
  v_mov_b64 v[18:19], 0
  v_mov_b64 v[20:21], 0
  v_mfma_f32_16x16x32_bf16 v[34:37], v[6:9], v[54:57], v[34:37]
  ds_read_b128 v[90:93], v116 offset:63488
  ds_read_b128 v[94:97], v116 offset:64512
  v_add_f32_dpp v125, v38, v38 row_ror:8 row_mask:0xf bank_mask:0xf
  v_rcp_f32 v125, v125
  v_mov_b64 v[22:23], 0
  v_mov_b64 v[24:25], 0
  s_nop 1
  v_pk_mul_f32 v[34:35], v[34:35], v[124:125] op_sel:[0,1] op_sel_hi:[1,1]
  v_pk_mul_f32 v[36:37], v[36:37], v[124:125] op_sel:[0,1] op_sel_hi:[1,1]
  v_cvt_pk_bf16_f32 v34, v34, v35
  v_cvt_pk_bf16_f32 v35, v36, v37
  s_add_u32 s81, s80, 0x1800
  ds_write_b64 v119, v[34:35] offset:15872
  v_cndmask_b32_dpp v36, v34, v34, vcc row_ror:8 row_mask:0xf bank_mask:0xf
  v_cndmask_b32_dpp v37, v35, v35, vcc row_ror:8 row_mask:0xf bank_mask:0xf
  v_mov_b32_dpp v34, v34 row_shr:8 row_mask:0xf bank_mask:0xc
  v_mov_b32_dpp v35, v35 row_shr:8 row_mask:0xf bank_mask:0xc
  s_waitcnt lgkmcnt(1)
  s_nop 0
  v_smfmac_f32_16x16x64_bf16 v[10:13], v[34:37], v[66:73], v114
  v_smfmac_f32_16x16x64_bf16 v[14:17], v[34:37], v[74:81], v114
  s_waitcnt lgkmcnt(0)
  s_barrier
  ds_read_b128 v[38:41], v118 offset:14336
  ds_read_b128 v[42:45], v118 offset:14848
  ds_read_b128 v[46:49], v118 offset:15360
  v_smfmac_f32_16x16x64_bf16 v[18:21], v[34:37], v[82:89], v114
  v_smfmac_f32_16x16x64_bf16 v[22:25], v[34:37], v[90:97], v114
  s_waitcnt lgkmcnt(2)
  v_smfmac_f32_16x16x64_bf16 v[10:13], v[38:41], v[160:167], v114
  v_smfmac_f32_16x16x64_bf16 v[14:17], v[38:41], v[168:175], v114
  s_waitcnt lgkmcnt(1)
  v_smfmac_f32_16x16x64_bf16 v[10:13], v[42:45], v[192:199], v114
  v_smfmac_f32_16x16x64_bf16 v[14:17], v[42:45], v[200:207], v114
  s_waitcnt lgkmcnt(0)
  v_smfmac_f32_16x16x64_bf16 v[10:13], v[46:49], v[224:231], v114
  v_smfmac_f32_16x16x64_bf16 v[14:17], v[46:49], v[232:239], v114
  v_smfmac_f32_16x16x64_bf16 v[18:21], v[38:41], v[176:183], v114
  v_smfmac_f32_16x16x64_bf16 v[22:25], v[38:41], v[184:191], v114
  v_cvt_pk_bf16_f32 v10, v10, v11
  v_cvt_pk_bf16_f32 v11, v12, v13
  v_bfi_b32 v10, 1, s79, v10
  v_smfmac_f32_16x16x64_bf16 v[18:21], v[42:45], v[208:215], v114
  v_cvt_pk_bf16_f32 v12, v14, v15
  v_cvt_pk_bf16_f32 v13, v16, v17
  v_smfmac_f32_16x16x64_bf16 v[22:25], v[42:45], v[216:223], v114
  buffer_store_dwordx4 v[10:13], v121, s[4:7], s76 offen sc1
  v_smfmac_f32_16x16x64_bf16 v[18:21], v[46:49], v[240:247], v114
  v_smfmac_f32_16x16x64_bf16 v[22:25], v[46:49], v[248:255], v114
  s_nop 3
  v_cvt_pk_bf16_f32 v18, v18, v19
  v_cvt_pk_bf16_f32 v19, v20, v21
  v_bfi_b32 v18, 1, s79, v18
  s_nop 0
  v_cvt_pk_bf16_f32 v20, v22, v23
  v_cvt_pk_bf16_f32 v21, v24, v25
  buffer_store_dwordx4 v[18:21], v121, s[4:7], s77 offen sc1
  v_mov_b64 v[34:35], 0
  v_mov_b64 v[36:37], 0
  v_mov_b64 v[38:39], 0
  v_mov_b64 v[40:41], 0
  v_mov_b64 v[42:43], 0
  v_mov_b64 v[44:45], 0
  v_mov_b64 v[46:47], 0
  v_mov_b64 v[48:49], 0
  v_mov_b64 v[58:59], 0
  v_mov_b64 v[60:61], 0
  v_mov_b64 v[62:63], 0
  v_mov_b64 v[64:65], 0
  ds_read_b128 v[66:69], v116 offset:12288
  ds_read_b128 v[70:73], v116 offset:13312
  ds_read_b128 v[74:77], v116 offset:14336
  ds_read_b128 v[78:81], v116 offset:15360
  ds_read_b128 v[82:85], v116 offset:28672
  ds_read_b128 v[86:89], v116 offset:29696
  ds_read_b128 v[90:93], v116 offset:30720
  ds_read_b128 v[94:97], v116 offset:31744
  s_waitcnt vmcnt(0)
  buffer_load_dwordx4 v[2:5], v115, s[4:7], s78 offen offset:0 sc1
  buffer_load_dwordx4 v[6:9], v115, s[4:7], s78 offen offset:1024 sc1
  s_add_u32 s70, s70, 1
  s_add_u32 s82, s82, 2048
  s_add_u32 s80, s80, 0x40000
  s_xor_b32 s76, s76, 0x40000
  s_sub_u32 s73, s74, s88
  s_add_u32 s73, s73, 6144
c31_rpoll:
  s_waitcnt vmcnt(0)
  v_mfma_f32_16x16x32_bf16 v[18:21], v[2:5], v[102:105], 0
  v_mfma_f32_16x16x32_bf16 v[18:21], v[6:9], v[102:105], v[18:21]
  v_bitop3_b32 v125, v2, v6, s79 bitop3:0x7e
  v_and_b32 v125, 1, v125
  v_cmp_ne_u32 vcc, 0, v125
  s_cbranch_vccz c31_rpoll_ok
  s_mov_b64 exec, vcc
  buffer_load_dwordx4 v[2:5], v115, s[4:7], s78 offen offset:0 sc1
  buffer_load_dwordx4 v[6:9], v115, s[4:7], s78 offen offset:1024 sc1
  s_sub_u32 s51, s51, 1
  s_cbranch_scc0 c31_rpoll
  s_endpgm
c31_rpoll_ok:
  s_mov_b64 exec, -1
  s_nop 1
  v_permlane32_swap_b32 v18, v20
  v_permlane32_swap_b32 v19, v21
  v_add_f32 v18, v18, v20
  v_add_f32 v19, v19, v21
  s_nop 1
  v_permlane16_swap_b32 v18, v19
  v_add_f32 v18, v18, v19
  s_nop 1
  v_mov_b32_dpp v19, v18 row_shl:4 row_mask:0xf bank_mask:0xf
  v_cvt_pk_bf16_f32 v18, v18, v19
  v_min_u32 v18, -2, v18
  buffer_store_dword v18, v123, s[4:7], s74 offen sc1
  s_xor_b32 s78, s78, 0x40000
  s_cmp_eq_u32 s70, 63
  s_cbranch_scc1 c31_last
  s_lshr_b32 s79, s70, 1
  s_add_u32 s77, s76, 0x8000
  s_add_u32 s86, s70, 1
  s_and_b32 s86, s86, 3
  s_lshl_b32 s86, s86, 13
  s_add_u32 s86, s86, s89
  s_add_u32 s74, s86, s88
  s_xor_b32 s75, s74, 0x4000
  s_cmp_eq_u32 s84, 0
  s_cbranch_scc1 c31_have
c31_kpoll:
  s_sub_u32 s51, s51, 1
  s_cbranch_scc1 main_end
  buffer_load_dword v124, off, s[4:7], s82 sc1
  s_waitcnt vmcnt(0)
  v_readfirstlane_b32 s87, v124
  s_cmp_eq_u32 s87, 0
  s_cbranch_scc1 c31_kpoll
  s_mov_b32 m0, 0x27000
  s_nop 0
  buffer_load_dwordx4 v115, s[4:7], s83 offen offset:0 sc1 lds
  buffer_load_dwordx4 v115, s[4:7], s83 offen offset:1024 sc1 lds
  s_add_u32 s86, s83, 0x1fff800
  buffer_load_dwordx4 v115, s[4:7], s86 offen offset:2048 sc1 lds
  buffer_load_dwordx4 v115, s[4:7], s86 offen offset:3072 sc1 lds
  buffer_load_dwordx4 v[2:5], v115, s[4:7], s73 offen offset:0 sc1
  buffer_load_dwordx4 v[6:9], v115, s[4:7], s73 offen offset:1024 sc1
  s_add_u32 s87, s81, 0xfffe0400
  s_waitcnt vmcnt(2)
  ds_read_b128 v[50:53], v117 offset:28672
  ds_read_b128 v[54:57], v117 offset:29696
  s_waitcnt lgkmcnt(0)
  s_branch c31_poll0
  s_waitcnt vmcnt(0)
c31_have:
  ds_read_b128 v[50:53], v117 offset:28672
  ds_read_b128 v[54:57], v117 offset:29696
  s_waitcnt vmcnt(0)
  buffer_load_dwordx4 v[2:5], v115, s[4:7], s73 offen offset:0 sc1
  buffer_load_dwordx4 v[6:9], v115, s[4:7], s73 offen offset:1024 sc1
  s_add_u32 s87, s81, 0xfffe0400
  s_waitcnt lgkmcnt(0)
  s_branch c31_poll0
c31_last:
  s_waitcnt vmcnt(0)
  buffer_load_dwordx4 v[2:5], v115, s[4:7], s73 offen offset:0 sc1
  buffer_load_dwordx4 v[6:9], v115, s[4:7], s73 offen offset:1024 sc1
  s_add_u32 s87, s81, 0xfffe0400
  s_waitcnt lgkmcnt(0)
c31_lpoll:
  s_waitcnt vmcnt(0)
  ds_write_b128 v117, v[2:5] offset:6144
  ds_write_b128 v117, v[6:9] offset:7168
  v_max3_u32 v125, v2, v3, v4
  v_max3_u32 v126, v5, v6, v7
  v_max3_u32 v125, v125, v8, v9
  v_max_u32 v125, v125, v126
  v_cmp_eq_u32 vcc, -1, v125
  s_cbranch_vccz c31_lpoll_ok
  s_mov_b64 exec, vcc
  buffer_load_dwordx4 v[2:5], v115, s[4:7], s73 offen offset:0 sc1
  buffer_load_dwordx4 v[6:9], v115, s[4:7], s73 offen offset:1024 sc1
  s_sub_u32 s51, s51, 1
  s_cbranch_scc0 c31_lpoll
  s_endpgm
c31_lpoll_ok:
  s_mov_b64 exec, -1
  buffer_store_dwordx2 v[30:31], v119, s[4:7], s87 offen sc1
  buffer_store_dwordx4 v[98:101], v115, s[4:7], s81 offen sc1
  s_add_u32 s81, s80, 0x1800
  s_mov_b64 vcc, s[92:93]
  v_smfmac_f32_16x16x64_bf16 v[58:61], v[2:5], a[224:231], v122
  v_smfmac_f32_16x16x64_bf16 v[62:65], v[2:5], a[232:239], v122
  s_waitcnt lgkmcnt(0)
  s_barrier
  ds_read_b128 v[30:33], v117 offset:5120
  ds_read_b128 v[10:13], v117 offset:0
  ds_read_b128 v[14:17], v117 offset:1024
  ds_read_b128 v[18:21], v117 offset:2048
  ds_read_b128 v[26:29], v117 offset:4096
  ds_read_b128 v[22:25], v117 offset:3072
  v_smfmac_f32_16x16x64_bf16 v[58:61], v[6:9], a[240:247], v122
  v_smfmac_f32_16x16x64_bf16 v[62:65], v[6:9], a[248:255], v122
  v_smfmac_f32_16x16x64_bf16 v[42:45], v[2:5], v[66:73], v122
  ds_read_b128 v[66:69], v115 offset:12288
  ds_read_b128 v[70:73], v115 offset:13312
  v_smfmac_f32_16x16x64_bf16 v[46:49], v[2:5], v[74:81], v122
  ds_read_b128 v[74:77], v115 offset:14336
  ds_read_b128 v[78:81], v115 offset:15360
  s_waitcnt lgkmcnt(9)
  v_smfmac_f32_16x16x64_bf16 v[58:61], v[30:33], a[208:215], v122
  v_smfmac_f32_16x16x64_bf16 v[62:65], v[30:33], a[216:223], v122
  v_smfmac_f32_16x16x64_bf16 v[42:45], v[6:9], v[82:89], v122
  ds_read_b128 v[82:85], v115 offset:28672
  ds_read_b128 v[86:89], v115 offset:29696
  v_smfmac_f32_16x16x64_bf16 v[46:49], v[6:9], v[90:97], v122
  ds_read_b128 v[90:93], v115 offset:30720
  ds_read_b128 v[94:97], v115 offset:31744
  s_waitcnt lgkmcnt(12)
  v_smfmac_f32_16x16x64_bf16 v[58:61], v[10:13], a[128:135], v122
  v_smfmac_f32_16x16x64_bf16 v[62:65], v[10:13], a[136:143], v122
  s_waitcnt lgkmcnt(6)
  v_smfmac_f32_16x16x64_bf16 v[42:45], v[14:17], v[66:73], v122
  ds_read_b128 v[66:69], v115 offset:45056
  ds_read_b128 v[70:73], v115 offset:46080
  s_waitcnt lgkmcnt(6)
  v_smfmac_f32_16x16x64_bf16 v[46:49], v[14:17], v[74:81], v122
  ds_read_b128 v[74:77], v115 offset:47104
  ds_read_b128 v[78:81], v115 offset:48128
  v_smfmac_f32_16x16x64_bf16 v[58:61], v[14:17], a[144:151], v122
  v_smfmac_f32_16x16x64_bf16 v[62:65], v[14:17], a[152:159], v122
  s_waitcnt lgkmcnt(6)
  v_smfmac_f32_16x16x64_bf16 v[42:45], v[18:21], v[82:89], v122
  ds_read_b128 v[82:85], v115 offset:61440
  ds_read_b128 v[86:89], v115 offset:62464
  s_waitcnt lgkmcnt(6)
  v_smfmac_f32_16x16x64_bf16 v[46:49], v[18:21], v[90:97], v122
  ds_read_b128 v[90:93], v115 offset:63488
  ds_read_b128 v[94:97], v115 offset:64512
  v_smfmac_f32_16x16x64_bf16 v[58:61], v[18:21], a[160:167], v122
  v_smfmac_f32_16x16x64_bf16 v[62:65], v[18:21], a[168:175], v122
  v_smfmac_f32_16x16x64_bf16 v[42:45], v[10:13], v[128:135], v122
  v_smfmac_f32_16x16x64_bf16 v[46:49], v[10:13], v[136:143], v122
  v_smfmac_f32_16x16x64_bf16 v[42:45], v[26:29], v[144:151], v122
  v_smfmac_f32_16x16x64_bf16 v[46:49], v[26:29], v[152:159], v122
  s_waitcnt lgkmcnt(6)
  v_smfmac_f32_16x16x64_bf16 v[42:45], v[22:25], v[66:73], v122
  s_waitcnt lgkmcnt(4)
  v_smfmac_f32_16x16x64_bf16 v[46:49], v[22:25], v[74:81], v122
  v_smfmac_f32_16x16x64_bf16 v[58:61], v[22:25], a[176:183], v122
  v_smfmac_f32_16x16x64_bf16 v[62:65], v[22:25], a[184:191], v122
  s_waitcnt lgkmcnt(2)
  v_smfmac_f32_16x16x64_bf16 v[42:45], v[30:33], v[82:89], v122
  s_waitcnt lgkmcnt(0)
  v_smfmac_f32_16x16x64_bf16 v[46:49], v[30:33], v[90:97], v122
  v_smfmac_f32_16x16x64_bf16 v[58:61], v[26:29], a[192:199], v122
  v_smfmac_f32_16x16x64_bf16 v[62:65], v[26:29], a[200:207], v122
  v_cvt_pk_bf16_f32 v98, v42, v43
  v_cvt_pk_bf16_f32 v99, v44, v45
  v_cvt_pk_bf16_f32 v100, v46, v47
  v_cvt_pk_bf16_f32 v101, v48, v49
  s_nop 1
  v_mfma_f32_16x16x32_bf16 v[42:45], v[98:101], v[106:109], 0
  v_mfma_f32_16x16x32_bf16 v[46:49], v[100:103], v[106:109], 0
  s_add_u32 s87, s81, 0xfffe0400
  s_nop 2
  v_cvt_pk_bf16_f32 v42, v42, v43
  v_cvt_pk_bf16_f32 v43, v44, v45
  s_nop 1
  v_cvt_pk_bf16_f32 v44, v46, v47
  v_cvt_pk_bf16_f32 v45, v48, v49
  v_cndmask_b32 v30, v42, v44, vcc
  v_cndmask_b32 v31, v43, v45, vcc
  s_cmp_eq_u32 s84, 0
  s_cbranch_scc1 c31_lgo
c31_lfl:
  s_sub_u32 s51, s51, 1
  s_cbranch_scc1 main_end
  buffer_load_dword v124, off, s[4:7], s82 sc1
  s_waitcnt vmcnt(0)
  v_readfirstlane_b32 s86, v124
  s_cmp_eq_u32 s86, 0
  s_cbranch_scc1 c31_lfl
c31_lgo:
  buffer_store_dwordx2 v[30:31], v119, s[4:7], s87 offen sc1
  v_cvt_pk_bf16_f32 v98, v58, v59
  v_cvt_pk_bf16_f32 v99, v60, v61
  v_cvt_pk_bf16_f32 v100, v62, v63
  v_cvt_pk_bf16_f32 v101, v64, v65
  buffer_store_dwordx4 v[98:101], v115, s[4:7], s81 offen sc1
  s_endpgm
c31_tail:
  s_mov_b32 s72, s52
  ds_read_b128 v[66:69], v116 offset:12288
  ds_read_b128 v[70:73], v116 offset:13312
  ds_read_b128 v[74:77], v116 offset:14336
  ds_read_b128 v[78:81], v116 offset:15360
  ds_read_b128 v[82:85], v116 offset:28672
  ds_read_b128 v[86:89], v116 offset:29696
  ds_read_b128 v[90:93], v116 offset:30720
  ds_read_b128 v[94:97], v116 offset:31744
  s_add_u32 s73, s89, 6144
  s_lshr_b32 s79, s70, 1
  s_add_u32 s77, s76, 0x8000
  s_add_u32 s86, s70, 1
  s_and_b32 s86, s86, 3
  s_lshl_b32 s86, s86, 13
  s_add_u32 s86, s86, s89
  s_add_u32 s74, s86, s88
  s_xor_b32 s75, s74, 0x4000
  s_cmp_eq_u32 s94, 0
  s_cbranch_scc1 c31_kpoll
  s_waitcnt vmcnt(0)
  ds_read_b128 v[50:53], v117 offset:28672
  ds_read_b128 v[54:57], v117 offset:29696
  v_mov_b64 v[2:3], v[12:13]
  v_mov_b64 v[4:5], v[14:15]
  v_mov_b64 v[6:7], v[16:17]
  v_mov_b64 v[8:9], v[18:19]
  s_add_u32 s87, s81, 0xfffe0400
  s_waitcnt lgkmcnt(0)
  s_branch c31_poll0
role_kv:
  s_lshl_b32 s70, s57, 0
  s_lshl_b32 s71, s55, 6
  s_add_u32 s72, s71, 63
  s_lshl_b32 s73, s55, 23
  s_add_u32 s73, s73, 0x1000000
  s_add_u32 s81, s73, 0x3f0000
  v_bfe_u32 v125, v0, 2, 2
  v_lshrrev_b32 v126, 5, v0
  v_lshl_add_u32 v10, v126, 3, v125
  v_lshlrev_b32 v10, 8, v10
  v_xor_b32 v125, s48, v125
  v_lshl_add_u32 v10, v125, 6, v10
  v_bfe_u32 v125, v0, 4, 1
  v_lshl_add_u32 v10, v125, 5, v10
  v_and_b32 v125, 1, v0
  v_lshl_add_u32 v10, v125, 4, v10
  v_bfe_u32 v125, v0, 1, 1
  v_lshl_add_u32 v10, v125, 3, v10
  v_bfe_u32 v125, v0, 2, 2
  v_lshrrev_b32 v126, 5, v0
  v_lshl_add_u32 v13, v126, 3, v125
  v_lshlrev_b32 v13, 8, v13
  v_xor_b32 v125, s48, v125
  v_lshl_add_u32 v13, v125, 6, v13
  v_bfe_u32 v125, v0, 4, 1
  v_lshl_add_u32 v13, v125, 3, v13
  v_and_b32 v125, 3, v0
  v_lshl_add_u32 v13, v125, 4, v13
  v_add_u32 v11, 0x10000, v10
  v_add_u32 v12, 0x20000, v10
  v_add_u32 v14, 0x10000, v13
  v_add_u32 v15, 0x20000, v13
  v_lshrrev_b32 v125, 4, v0
  v_lshlrev_b32 v126, 2, v125
  v_and_b32 v16, 15, v0
  v_xor_b32 v16, v16, v126
  v_lshlrev_b32 v16, 4, v16
  s_lshl_b32 s54, s48, 4
  v_add_u32 v125, s54, v125
  v_mul_u32_u24 v125, 8192, v125
  v_add_u32 v16, v16, v125
  s_lshl_b32 s80, s48, 12
  s_lshl_b32 s78, s70, 8
  s_add_u32 m0, s80, 0x0
  s_add_u32 s79, s78, 0x0
  buffer_load_dwordx4 v16, s[12:15], s79 offen lds
  s_add_u32 m0, s80, 0x400
  s_add_u32 s79, s78, 0x8000
  buffer_load_dwordx4 v16, s[12:15], s79 offen lds
  s_add_u32 m0, s80, 0x800
  s_add_u32 s79, s78, 0x10000
  buffer_load_dwordx4 v16, s[12:15], s79 offen lds
  s_add_u32 m0, s80, 0xc00
  s_add_u32 s79, s78, 0x18000
  buffer_load_dwordx4 v16, s[12:15], s79 offen lds
  s_add_u32 m0, s80, 0x4000
  s_add_u32 s79, s78, 0x80000
  buffer_load_dwordx4 v16, s[12:15], s79 offen lds
  s_add_u32 m0, s80, 0x4400
  s_add_u32 s79, s78, 0x88000
  buffer_load_dwordx4 v16, s[12:15], s79 offen lds
  s_add_u32 m0, s80, 0x4800
  s_add_u32 s79, s78, 0x90000
  buffer_load_dwordx4 v16, s[12:15], s79 offen lds
  s_add_u32 m0, s80, 0x4c00
  s_add_u32 s79, s78, 0x98000
  buffer_load_dwordx4 v16, s[12:15], s79 offen lds
  s_add_u32 m0, s80, 0x8000
  s_add_u32 s79, s78, 0x100000
  buffer_load_dwordx4 v16, s[12:15], s79 offen lds
  s_add_u32 m0, s80, 0x8400
  s_add_u32 s79, s78, 0x108000
  buffer_load_dwordx4 v16, s[12:15], s79 offen lds
  s_add_u32 m0, s80, 0x8800
  s_add_u32 s79, s78, 0x110000
  buffer_load_dwordx4 v16, s[12:15], s79 offen lds
  s_add_u32 m0, s80, 0x8c00
  s_add_u32 s79, s78, 0x118000
  buffer_load_dwordx4 v16, s[12:15], s79 offen lds
  s_add_u32 m0, s80, 0xc000
  s_add_u32 s79, s78, 0x180000
  buffer_load_dwordx4 v16, s[12:15], s79 offen lds
  s_add_u32 m0, s80, 0xc400
  s_add_u32 s79, s78, 0x188000
  buffer_load_dwordx4 v16, s[12:15], s79 offen lds
  s_add_u32 m0, s80, 0xc800
  s_add_u32 s79, s78, 0x190000
  buffer_load_dwordx4 v16, s[12:15], s79 offen lds
  s_add_u32 m0, s80, 0xcc00
  s_add_u32 s79, s78, 0x198000
  buffer_load_dwordx4 v16, s[12:15], s79 offen lds
  s_add_u32 m0, s80, 0x10000
  s_add_u32 s79, s78, 0x200000
  buffer_load_dwordx4 v16, s[12:15], s79 offen lds
  s_add_u32 m0, s80, 0x10400
  s_add_u32 s79, s78, 0x208000
  buffer_load_dwordx4 v16, s[12:15], s79 offen lds
  s_add_u32 m0, s80, 0x10800
  s_add_u32 s79, s78, 0x210000
  buffer_load_dwordx4 v16, s[12:15], s79 offen lds
  s_add_u32 m0, s80, 0x10c00
  s_add_u32 s79, s78, 0x218000
  buffer_load_dwordx4 v16, s[12:15], s79 offen lds
  s_add_u32 m0, s80, 0x14000
  s_add_u32 s79, s78, 0x280000
  buffer_load_dwordx4 v16, s[12:15], s79 offen lds
  s_add_u32 m0, s80, 0x14400
  s_add_u32 s79, s78, 0x288000
  buffer_load_dwordx4 v16, s[12:15], s79 offen lds
  s_add_u32 m0, s80, 0x14800
  s_add_u32 s79, s78, 0x290000
  buffer_load_dwordx4 v16, s[12:15], s79 offen lds
  s_add_u32 m0, s80, 0x14c00
  s_add_u32 s79, s78, 0x298000
  buffer_load_dwordx4 v16, s[12:15], s79 offen lds
  s_add_u32 m0, s80, 0x18000
  s_add_u32 s79, s78, 0x300000
  buffer_load_dwordx4 v16, s[12:15], s79 offen lds
  s_add_u32 m0, s80, 0x18400
  s_add_u32 s79, s78, 0x308000
  buffer_load_dwordx4 v16, s[12:15], s79 offen lds
  s_add_u32 m0, s80, 0x18800
  s_add_u32 s79, s78, 0x310000
  buffer_load_dwordx4 v16, s[12:15], s79 offen lds
  s_add_u32 m0, s80, 0x18c00
  s_add_u32 s79, s78, 0x318000
  buffer_load_dwordx4 v16, s[12:15], s79 offen lds
  s_add_u32 m0, s80, 0x1c000
  s_add_u32 s79, s78, 0x380000
  buffer_load_dwordx4 v16, s[12:15], s79 offen lds
  s_add_u32 m0, s80, 0x1c400
  s_add_u32 s79, s78, 0x388000
  buffer_load_dwordx4 v16, s[12:15], s79 offen lds
  s_add_u32 m0, s80, 0x1c800
  s_add_u32 s79, s78, 0x390000
  buffer_load_dwordx4 v16, s[12:15], s79 offen lds
  s_add_u32 m0, s80, 0x1cc00
  s_add_u32 s79, s78, 0x398000
  buffer_load_dwordx4 v16, s[12:15], s79 offen lds
  s_add_u32 m0, s80, 0x20000
  s_add_u32 s79, s78, 0x0
  buffer_load_dwordx4 v16, s[16:19], s79 offen lds
  s_add_u32 m0, s80, 0x20400
  s_add_u32 s79, s78, 0x8000
  buffer_load_dwordx4 v16, s[16:19], s79 offen lds
  s_add_u32 m0, s80, 0x20800
  s_add_u32 s79, s78, 0x10000
  buffer_load_dwordx4 v16, s[16:19], s79 offen lds
  s_add_u32 m0, s80, 0x20c00
  s_add_u32 s79, s78, 0x18000
  buffer_load_dwordx4 v16, s[16:19], s79 offen lds
  s_waitcnt vmcnt(32) lgkmcnt(0)
  s_barrier
  s_add_u32 m0, s80, 0x24000
  s_add_u32 s79, s78, 0x80000
  buffer_load_dwordx4 v16, s[16:19], s79 offen lds
  s_add_u32 m0, s80, 0x24400
  s_add_u32 s79, s78, 0x88000
  buffer_load_dwordx4 v16, s[16:19], s79 offen lds
  s_add_u32 m0, s80, 0x24800
  s_add_u32 s79, s78, 0x90000
  buffer_load_dwordx4 v16, s[16:19], s79 offen lds
  s_add_u32 m0, s80, 0x24c00
  s_add_u32 s79, s78, 0x98000
  buffer_load_dwordx4 v16, s[16:19], s79 offen lds
  ds_read_b64_tr_b16 a[0:1], v10 offset:0
  ds_read_b64_tr_b16 a[2:3], v10 offset:1024
  ds_read_b64_tr_b16 a[4:5], v10 offset:4096
  ds_read_b64_tr_b16 a[6:7], v10 offset:5120
  ds_read_b64_tr_b16 a[8:9], v10 offset:8192
  ds_read_b64_tr_b16 a[10:11], v10 offset:9216
  ds_read_b64_tr_b16 a[12:13], v10 offset:12288
  ds_read_b64_tr_b16 a[14:15], v10 offset:13312
  s_waitcnt vmcnt(32) lgkmcnt(0)
  s_barrier
  s_add_u32 m0, s80, 0x0
  s_add_u32 s79, s78, 0x100000
  buffer_load_dwordx4 v16, s[16:19], s79 offen lds
  s_add_u32 m0, s80, 0x400
  s_add_u32 s79, s78, 0x108000
  buffer_load_dwordx4 v16, s[16:19], s79 offen lds
  s_add_u32 m0, s80, 0x800
  s_add_u32 s79, s78, 0x110000
  buffer_load_dwordx4 v16, s[16:19], s79 offen lds
  s_add_u32 m0, s80, 0xc00
  s_add_u32 s79, s78, 0x118000
  buffer_load_dwordx4 v16, s[16:19], s79 offen lds
  ds_read_b64_tr_b16 a[16:17], v10 offset:16384
  ds_read_b64_tr_b16 a[18:19], v10 offset:17408
  ds_read_b64_tr_b16 a[20:21], v10 offset:20480
  ds_read_b64_tr_b16 a[22:23], v10 offset:21504
  ds_read_b64_tr_b16 a[24:25], v10 offset:24576
  ds_read_b64_tr_b16 a[26:27], v10 offset:25600
  ds_read_b64_tr_b16 a[28:29], v10 offset:28672
  ds_read_b64_tr_b16 a[30:31], v10 offset:29696
  s_waitcnt vmcnt(32) lgkmcnt(0)
  s_barrier
  s_add_u32 m0, s80, 0x4000
  s_add_u32 s79, s78, 0x180000
  buffer_load_dwordx4 v16, s[16:19], s79 offen lds
  s_add_u32 m0, s80, 0x4400
  s_add_u32 s79, s78, 0x188000
  buffer_load_dwordx4 v16, s[16:19], s79 offen lds
  s_add_u32 m0, s80, 0x4800
  s_add_u32 s79, s78, 0x190000
  buffer_load_dwordx4 v16, s[16:19], s79 offen lds
  s_add_u32 m0, s80, 0x4c00
  s_add_u32 s79, s78, 0x198000
  buffer_load_dwordx4 v16, s[16:19], s79 offen lds
  ds_read_b64_tr_b16 a[32:33], v10 offset:32768
  ds_read_b64_tr_b16 a[34:35], v10 offset:33792
  ds_read_b64_tr_b16 a[36:37], v10 offset:36864
  ds_read_b64_tr_b16 a[38:39], v10 offset:37888
  ds_read_b64_tr_b16 a[40:41], v10 offset:40960
  ds_read_b64_tr_b16 a[42:43], v10 offset:41984
  ds_read_b64_tr_b16 a[44:45], v10 offset:45056
  ds_read_b64_tr_b16 a[46:47], v10 offset:46080
  s_waitcnt vmcnt(32) lgkmcnt(0)
  s_barrier
  s_add_u32 m0, s80, 0x8000
  s_add_u32 s79, s78, 0x200000
  buffer_load_dwordx4 v16, s[16:19], s79 offen lds
  s_add_u32 m0, s80, 0x8400
  s_add_u32 s79, s78, 0x208000
  buffer_load_dwordx4 v16, s[16:19], s79 offen lds
  s_add_u32 m0, s80, 0x8800
  s_add_u32 s79, s78, 0x210000
  buffer_load_dwordx4 v16, s[16:19], s79 offen lds
  s_add_u32 m0, s80, 0x8c00
  s_add_u32 s79, s78, 0x218000
  buffer_load_dwordx4 v16, s[16:19], s79 offen lds
  ds_read_b64_tr_b16 a[48:49], v10 offset:49152
  ds_read_b64_tr_b16 a[50:51], v10 offset:50176
  ds_read_b64_tr_b16 a[52:53], v10 offset:53248
  ds_read_b64_tr_b16 a[54:55], v10 offset:54272
  ds_read_b64_tr_b16 a[56:57], v10 offset:57344
  ds_read_b64_tr_b16 a[58:59], v10 offset:58368
  ds_read_b64_tr_b16 a[60:61], v10 offset:61440
  ds_read_b64_tr_b16 a[62:63], v10 offset:62464
  s_waitcnt vmcnt(32) lgkmcnt(0)
  s_barrier
  s_add_u32 m0, s80, 0xc000
  s_add_u32 s79, s78, 0x280000
  buffer_load_dwordx4 v16, s[16:19], s79 offen lds
  s_add_u32 m0, s80, 0xc400
  s_add_u32 s79, s78, 0x288000
  buffer_load_dwordx4 v16, s[16:19], s79 offen lds
  s_add_u32 m0, s80, 0xc800
  s_add_u32 s79, s78, 0x290000
  buffer_load_dwordx4 v16, s[16:19], s79 offen lds
  s_add_u32 m0, s80, 0xcc00
  s_add_u32 s79, s78, 0x298000
  buffer_load_dwordx4 v16, s[16:19], s79 offen lds
  ds_read_b64_tr_b16 a[64:65], v11 offset:0
  ds_read_b64_tr_b16 a[66:67], v11 offset:1024
  ds_read_b64_tr_b16 a[68:69], v11 offset:4096
  ds_read_b64_tr_b16 a[70:71], v11 offset:5120
  ds_read_b64_tr_b16 a[72:73], v11 offset:8192
  ds_read_b64_tr_b16 a[74:75], v11 offset:9216
  ds_read_b64_tr_b16 a[76:77], v11 offset:12288
  ds_read_b64_tr_b16 a[78:79], v11 offset:13312
  s_waitcnt vmcnt(32) lgkmcnt(0)
  s_barrier
  s_add_u32 m0, s80, 0x10000
  s_add_u32 s79, s78, 0x300000
  buffer_load_dwordx4 v16, s[16:19], s79 offen lds
  s_add_u32 m0, s80, 0x10400
  s_add_u32 s79, s78, 0x308000
  buffer_load_dwordx4 v16, s[16:19], s79 offen lds
  s_add_u32 m0, s80, 0x10800
  s_add_u32 s79, s78, 0x310000
  buffer_load_dwordx4 v16, s[16:19], s79 offen lds
  s_add_u32 m0, s80, 0x10c00
  s_add_u32 s79, s78, 0x318000
  buffer_load_dwordx4 v16, s[16:19], s79 offen lds
  ds_read_b64_tr_b16 a[80:81], v11 offset:16384
  ds_read_b64_tr_b16 a[82:83], v11 offset:17408
  ds_read_b64_tr_b16 a[84:85], v11 offset:20480
  ds_read_b64_tr_b16 a[86:87], v11 offset:21504
  ds_read_b64_tr_b16 a[88:89], v11 offset:24576
  ds_read_b64_tr_b16 a[90:91], v11 offset:25600
  ds_read_b64_tr_b16 a[92:93], v11 offset:28672
  ds_read_b64_tr_b16 a[94:95], v11 offset:29696
  s_waitcnt vmcnt(32) lgkmcnt(0)
  s_barrier
  s_add_u32 m0, s80, 0x14000
  s_add_u32 s79, s78, 0x380000
  buffer_load_dwordx4 v16, s[16:19], s79 offen lds
  s_add_u32 m0, s80, 0x14400
  s_add_u32 s79, s78, 0x388000
  buffer_load_dwordx4 v16, s[16:19], s79 offen lds
  s_add_u32 m0, s80, 0x14800
  s_add_u32 s79, s78, 0x390000
  buffer_load_dwordx4 v16, s[16:19], s79 offen lds
  s_add_u32 m0, s80, 0x14c00
  s_add_u32 s79, s78, 0x398000
  buffer_load_dwordx4 v16, s[16:19], s79 offen lds
  ds_read_b64_tr_b16 a[96:97], v11 offset:32768
  ds_read_b64_tr_b16 a[98:99], v11 offset:33792
  ds_read_b64_tr_b16 a[100:101], v11 offset:36864
  ds_read_b64_tr_b16 a[102:103], v11 offset:37888
  ds_read_b64_tr_b16 a[104:105], v11 offset:40960
  ds_read_b64_tr_b16 a[106:107], v11 offset:41984
  ds_read_b64_tr_b16 a[108:109], v11 offset:45056
  ds_read_b64_tr_b16 a[110:111], v11 offset:46080
  s_waitcnt vmcnt(32) lgkmcnt(0)
  s_barrier
  ds_read_b64_tr_b16 a[112:113], v11 offset:49152
  ds_read_b64_tr_b16 a[114:115], v11 offset:50176
  ds_read_b64_tr_b16 a[116:117], v11 offset:53248
  ds_read_b64_tr_b16 a[118:119], v11 offset:54272
  ds_read_b64_tr_b16 a[120:121], v11 offset:57344
  ds_read_b64_tr_b16 a[122:123], v11 offset:58368
  ds_read_b64_tr_b16 a[124:125], v11 offset:61440
  ds_read_b64_tr_b16 a[126:127], v11 offset:62464
  s_waitcnt vmcnt(28) lgkmcnt(0)
  s_barrier
  ds_read_b64_tr_b16 a[128:129], v15 offset:0
  ds_read_b64_tr_b16 a[130:131], v15 offset:1024
  ds_read_b64_tr_b16 a[132:133], v15 offset:4096
  ds_read_b64_tr_b16 a[134:135], v15 offset:5120
  ds_read_b64_tr_b16 a[136:137], v15 offset:8192
  ds_read_b64_tr_b16 a[138:139], v15 offset:9216
  ds_read_b64_tr_b16 a[140:141], v15 offset:12288
  ds_read_b64_tr_b16 a[142:143], v15 offset:13312
  s_waitcnt vmcnt(24) lgkmcnt(0)
  s_barrier
  ds_read_b64_tr_b16 a[144:145], v15 offset:16384
  ds_read_b64_tr_b16 a[146:147], v15 offset:17408
  ds_read_b64_tr_b16 a[148:149], v15 offset:20480
  ds_read_b64_tr_b16 a[150:151], v15 offset:21504
  ds_read_b64_tr_b16 a[152:153], v15 offset:24576
  ds_read_b64_tr_b16 a[154:155], v15 offset:25600
  ds_read_b64_tr_b16 a[156:157], v15 offset:28672
  ds_read_b64_tr_b16 a[158:159], v15 offset:29696
  s_waitcnt vmcnt(20) lgkmcnt(0)
  s_barrier
  ds_read_b64_tr_b16 a[160:161], v13 offset:0
  ds_read_b64_tr_b16 a[162:163], v13 offset:1024
  ds_read_b64_tr_b16 a[164:165], v13 offset:4096
  ds_read_b64_tr_b16 a[166:167], v13 offset:5120
  ds_read_b64_tr_b16 a[168:169], v13 offset:8192
  ds_read_b64_tr_b16 a[170:171], v13 offset:9216
  ds_read_b64_tr_b16 a[172:173], v13 offset:12288
  ds_read_b64_tr_b16 a[174:175], v13 offset:13312
  s_waitcnt vmcnt(16) lgkmcnt(0)
  s_barrier
  ds_read_b64_tr_b16 a[176:177], v13 offset:16384
  ds_read_b64_tr_b16 a[178:179], v13 offset:17408
  ds_read_b64_tr_b16 a[180:181], v13 offset:20480
  ds_read_b64_tr_b16 a[182:183], v13 offset:21504
  ds_read_b64_tr_b16 a[184:185], v13 offset:24576
  ds_read_b64_tr_b16 a[186:187], v13 offset:25600
  ds_read_b64_tr_b16 a[188:189], v13 offset:28672
  ds_read_b64_tr_b16 a[190:191], v13 offset:29696
  s_waitcnt vmcnt(12) lgkmcnt(0)
  s_barrier
  ds_read_b64_tr_b16 a[192:193], v13 offset:32768
  ds_read_b64_tr_b16 a[194:195], v13 offset:33792
  ds_read_b64_tr_b16 a[196:197], v13 offset:36864
  ds_read_b64_tr_b16 a[198:199], v13 offset:37888
  ds_read_b64_tr_b16 a[200:201], v13 offset:40960
  ds_read_b64_tr_b16 a[202:203], v13 offset:41984
  ds_read_b64_tr_b16 a[204:205], v13 offset:45056
  ds_read_b64_tr_b16 a[206:207], v13 offset:46080
  s_waitcnt vmcnt(8) lgkmcnt(0)
  s_barrier
  ds_read_b64_tr_b16 a[208:209], v13 offset:49152
  ds_read_b64_tr_b16 a[210:211], v13 offset:50176
  ds_read_b64_tr_b16 a[212:213], v13 offset:53248
  ds_read_b64_tr_b16 a[214:215], v13 offset:54272
  ds_read_b64_tr_b16 a[216:217], v13 offset:57344
  ds_read_b64_tr_b16 a[218:219], v13 offset:58368
  ds_read_b64_tr_b16 a[220:221], v13 offset:61440
  ds_read_b64_tr_b16 a[222:223], v13 offset:62464
  s_waitcnt vmcnt(4) lgkmcnt(0)
  s_barrier
  ds_read_b64_tr_b16 a[224:225], v14 offset:0
  ds_read_b64_tr_b16 a[226:227], v14 offset:1024
  ds_read_b64_tr_b16 a[228:229], v14 offset:4096
  ds_read_b64_tr_b16 a[230:231], v14 offset:5120
  ds_read_b64_tr_b16 a[232:233], v14 offset:8192
  ds_read_b64_tr_b16 a[234:235], v14 offset:9216
  ds_read_b64_tr_b16 a[236:237], v14 offset:12288
  ds_read_b64_tr_b16 a[238:239], v14 offset:13312
  s_waitcnt vmcnt(0) lgkmcnt(0)
  s_barrier
  ds_read_b64_tr_b16 a[240:241], v14 offset:16384
  ds_read_b64_tr_b16 a[242:243], v14 offset:17408
  ds_read_b64_tr_b16 a[244:245], v14 offset:20480
  ds_read_b64_tr_b16 a[246:247], v14 offset:21504
  ds_read_b64_tr_b16 a[248:249], v14 offset:24576
  ds_read_b64_tr_b16 a[250:251], v14 offset:25600
  ds_read_b64_tr_b16 a[252:253], v14 offset:28672
  ds_read_b64_tr_b16 a[254:255], v14 offset:29696
  s_waitcnt lgkmcnt(0)
  s_barrier
  v_lshlrev_b32 v119, 4, v0
  s_lshl_b32 s54, s48, 13
  v_add_u32 v118, s54, v119
  s_mul_i32 s54, s48, 8320
  s_add_u32 s54, s54, 0x0
  v_add_u32 v119, s54, v119
  v_and_b32 v125, 31, v0
  v_lshrrev_b32 v126, 5, v0
  v_mul_u32_u24 v120, 1040, v125
  v_lshl_add_u32 v120, v126, 4, v120
  v_and_b32 v121, 15, v0
  v_lshlrev_b32 v121, 4, v121
  v_lshrrev_b32 v125, 5, v0
  v_lshl_add_u32 v121, v125, 8, v121
  v_bfe_u32 v125, v0, 4, 1
  v_lshl_add_u32 v121, v125, 10, v121
  s_lshl_b32 s54, s48, 11
  v_add_u32 v121, s54, v121
  v_mov_b32 v122, 0x40000000
  v_cmp_ge_u32 vcc, 0, v0
  s_lshl_b32 s54, s48, 2
  v_lshl_add_u32 v124, v0, 6, s54
  v_cndmask_b32 v122, v122, v124, vcc
  v_mov_b32 v124, 1
  v_mov_b32 v98, -1
  v_mov_b32 v99, -1
  v_mov_b32 v100, -1
  v_mov_b32 v101, -1
  v_xor_b32 v120, 0x10000, v120
  s_mov_b32 s77, 0
  s_lshl_b32 s78, s71, 5
  s_add_u32 s78, s78, s70
  s_lshl_b32 s76, s78, 6
  s_add_u32 s76, s76, 0x1f800
  s_lshl_b32 s78, s78, 13
  s_add_u32 s74, s78, 0x5fc0000
  s_sub_u32 s71, s71, 1
  v_lshlrev_b32 v126, 2, v0
  s_lshr_b32 s58, s50, 5
  s_bitcmp1_b32 0xca, s58
  s_cselect_b32 s58, -1, 0xffff
  s_and_b32 s59, s58, 0x20303040
  s_add_u32 s59, s59, 256
pkv_cnt:
  s_sub_u32 s51, s51, 1
  s_cbranch_scc1 main_end
  buffer_load_dword v125, v126, s[36:39], 0 offen sc1
  s_waitcnt vmcnt(0)
  v_readlane_b32 s60, v125, 0
  v_readlane_b32 s61, v125, 48
  v_readlane_b32 s62, v125, 16
  v_readlane_b32 s63, v125, 49
  v_readlane_b32 s64, v125, 50
  v_readlane_b32 s65, v125, 51
  v_readlane_b32 s66, v125, 32
  v_readlane_b32 s67, v125, 33
  v_readlane_b32 s57, v125, 17
  s_add_u32 s56, s60, s61
  s_add_u32 s56, s56, s62
  s_add_u32 s56, s56, s63
  s_add_u32 s56, s56, s64
  s_add_u32 s56, s56, s65
  s_add_u32 s56, s56, s66
  s_add_u32 s56, s56, s67
  s_and_b32 s57, s57, s58
  s_add_u32 s56, s56, s57
  s_cmp_lt_u32 s56, s59
  s_cbranch_scc1 pkv_cnt
  s_branch kv_first
kv_loop:
  ds_read_b128 v[128:131], v120 offset:0
  ds_read_b128 v[132:135], v120 offset:32
  ds_read_b128 v[136:139], v120 offset:64
  ds_read_b128 v[140:143], v120 offset:96
  s_waitcnt lgkmcnt(3)
  v_mfma_f32_32x32x16_bf16 v[2:17], a[0:3], v[128:131], 0
  ds_read_b128 v[144:147], v120 offset:128
  s_waitcnt lgkmcnt(3)
  v_mfma_f32_32x32x16_bf16 v[2:17], a[4:7], v[132:135], v[2:17]
  ds_read_b128 v[148:151], v120 offset:160
  s_waitcnt lgkmcnt(3)
  v_mfma_f32_32x32x16_bf16 v[2:17], a[8:11], v[136:139], v[2:17]
  ds_read_b128 v[152:155], v120 offset:192
  s_add_u32 s79, s74, 0x4000000
  buffer_store_dwordx4 v[98:101], v121, s[4:7], s79 offen offset:0 sc1
  s_waitcnt lgkmcnt(3)
  v_mfma_f32_32x32x16_bf16 v[2:17], a[12:15], v[140:143], v[2:17]
  ds_read_b128 v[156:159], v120 offset:224
  s_waitcnt lgkmcnt(3)
  v_mfma_f32_32x32x16_bf16 v[2:17], a[16:19], v[144:147], v[2:17]
  ds_read_b128 v[160:163], v120 offset:256
  s_waitcnt lgkmcnt(3)
  v_mfma_f32_32x32x16_bf16 v[2:17], a[20:23], v[148:151], v[2:17]
  ds_read_b128 v[164:167], v120 offset:288
  buffer_store_dwordx4 v[98:101], v121, s[4:7], s79 offen offset:512 sc1
  s_waitcnt lgkmcnt(3)
  v_mfma_f32_32x32x16_bf16 v[2:17], a[24:27], v[152:155], v[2:17]
  ds_read_b128 v[168:171], v120 offset:320
  s_waitcnt lgkmcnt(3)
  v_mfma_f32_32x32x16_bf16 v[2:17], a[28:31], v[156:159], v[2:17]
  ds_read_b128 v[172:175], v120 offset:352
  s_waitcnt lgkmcnt(3)
  v_mfma_f32_32x32x16_bf16 v[2:17], a[32:35], v[160:163], v[2:17]
  v_mfma_f32_32x32x16_bf16 v[18:33], v[128:131], a[128:131], 0
  ds_read_b128 v[128:131], v120 offset:384
  s_waitcnt lgkmcnt(3)
  v_mfma_f32_32x32x16_bf16 v[2:17], a[36:39], v[164:167], v[2:17]
  v_mfma_f32_32x32x16_bf16 v[18:33], v[132:135], a[132:135], v[18:33]
  ds_read_b128 v[132:135], v120 offset:416
  s_waitcnt lgkmcnt(3)
  v_mfma_f32_32x32x16_bf16 v[2:17], a[40:43], v[168:171], v[2:17]
  v_mfma_f32_32x32x16_bf16 v[18:33], v[136:139], a[136:139], v[18:33]
  ds_read_b128 v[136:139], v120 offset:448
  s_waitcnt lgkmcnt(3)
  v_mfma_f32_32x32x16_bf16 v[2:17], a[44:47], v[172:175], v[2:17]
  v_mfma_f32_32x32x16_bf16 v[18:33], v[140:143], a[140:143], v[18:33]
  ds_read_b128 v[140:143], v120 offset:480
  buffer_load_dwordx4 v[66:69], v118, s[4:7], s73 offen offset:0 sc1
  s_waitcnt lgkmcnt(3)
  v_mfma_f32_32x32x16_bf16 v[2:17], a[48:51], v[128:131], v[2:17]
  v_mfma_f32_32x32x16_bf16 v[18:33], v[144:147], a[144:147], v[18:33]
  ds_read_b128 v[144:147], v120 offset:512
  buffer_load_dwordx4 v[70:73], v118, s[4:7], s73 offen offset:1024 sc1
  s_waitcnt lgkmcnt(3)
  v_mfma_f32_32x32x16_bf16 v[2:17], a[52:55], v[132:135], v[2:17]
  v_mfma_f32_32x32x16_bf16 v[18:33], v[148:151], a[148:151], v[18:33]
  ds_read_b128 v[148:151], v120 offset:544
  buffer_load_dwordx4 v[74:77], v118, s[4:7], s73 offen offset:2048 sc1
  s_waitcnt lgkmcnt(3)
  v_mfma_f32_32x32x16_bf16 v[2:17], a[56:59], v[136:139], v[2:17]
  v_mfma_f32_32x32x16_bf16 v[18:33], v[152:155], a[152:155], v[18:33]
  ds_read_b128 v[152:155], v120 offset:576
  buffer_load_dwordx4 v[78:81], v118, s[4:7], s73 offen offset:3072 sc1
  s_waitcnt lgkmcnt(3)
  v_mfma_f32_32x32x16_bf16 v[2:17], a[60:63], v[140:143], v[2:17]
  v_mfma_f32_32x32x16_bf16 v[18:33], v[156:159], a[156:159], v[18:33]
  ds_read_b128 v[156:159], v120 offset:608
  s_add_u32 s78, s73, 4096
  buffer_load_dwordx4 v[82:85], v118, s[4:7], s78 offen offset:0 sc1
  s_waitcnt lgkmcnt(3)
  v_mfma_f32_32x32x16_bf16 v[2:17], a[64:67], v[144:147], v[2:17]
  v_mfma_f32_32x32x16_bf16 v[18:33], v[160:163], a[160:163], v[18:33]
  ds_read_b128 v[160:163], v120 offset:640
  buffer_load_dwordx4 v[86:89], v118, s[4:7], s78 offen offset:1024 sc1
  s_waitcnt lgkmcnt(3)
  v_mfma_f32_32x32x16_bf16 v[2:17], a[68:71], v[148:151], v[2:17]
  v_mfma_f32_32x32x16_bf16 v[18:33], v[164:167], a[164:167], v[18:33]
  ds_read_b128 v[164:167], v120 offset:672
  buffer_load_dwordx4 v[90:93], v118, s[4:7], s78 offen offset:2048 sc1
  s_waitcnt lgkmcnt(3)
  v_mfma_f32_32x32x16_bf16 v[2:17], a[72:75], v[152:155], v[2:17]
  v_mfma_f32_32x32x16_bf16 v[18:33], v[168:171], a[168:171], v[18:33]
  ds_read_b128 v[168:171], v120 offset:704
  buffer_load_dwordx4 v[94:97], v118, s[4:7], s78 offen offset:3072 sc1
  s_waitcnt lgkmcnt(3)
  v_mfma_f32_32x32x16_bf16 v[2:17], a[76:79], v[156:159], v[2:17]
  v_mfma_f32_32x32x16_bf16 v[18:33], v[172:175], a[172:175], v[18:33]
  ds_read_b128 v[172:175], v120 offset:736
  s_waitcnt lgkmcnt(3)
  v_mfma_f32_32x32x16_bf16 v[2:17], a[80:83], v[160:163], v[2:17]
  v_mfma_f32_32x32x16_bf16 v[18:33], v[128:131], a[176:179], v[18:33]
  ds_read_b128 v[128:131], v120 offset:768
  s_waitcnt lgkmcnt(3)
  v_mfma_f32_32x32x16_bf16 v[2:17], a[84:87], v[164:167], v[2:17]
  s_waitcnt vmcnt(10)
  buffer_store_dword v124, v123, s[4:7], s77 offen sc1
  v_mfma_f32_32x32x16_bf16 v[18:33], v[132:135], a[180:183], v[18:33]
  ds_read_b128 v[132:135], v120 offset:800
  s_waitcnt lgkmcnt(3)
  v_mfma_f32_32x32x16_bf16 v[2:17], a[88:91], v[168:171], v[2:17]
  v_mfma_f32_32x32x16_bf16 v[18:33], v[136:139], a[184:187], v[18:33]
  ds_read_b128 v[136:139], v120 offset:832
  s_waitcnt lgkmcnt(3)
  v_mfma_f32_32x32x16_bf16 v[2:17], a[92:95], v[172:175], v[2:17]
  v_mfma_f32_32x32x16_bf16 v[18:33], v[140:143], a[188:191], v[18:33]
  ds_read_b128 v[140:143], v120 offset:864
  s_waitcnt lgkmcnt(3)
  v_mfma_f32_32x32x16_bf16 v[2:17], a[96:99], v[128:131], v[2:17]
  v_mfma_f32_32x32x16_bf16 v[18:33], v[144:147], a[192:195], v[18:33]
  ds_read_b128 v[144:147], v120 offset:896
  s_waitcnt lgkmcnt(3)
  v_mfma_f32_32x32x16_bf16 v[2:17], a[100:103], v[132:135], v[2:17]
  v_mfma_f32_32x32x16_bf16 v[18:33], v[148:151], a[196:199], v[18:33]
  ds_read_b128 v[148:151], v120 offset:928
  s_waitcnt lgkmcnt(3)
  v_mfma_f32_32x32x16_bf16 v[2:17], a[104:107], v[136:139], v[2:17]
  v_mfma_f32_32x32x16_bf16 v[18:33], v[152:155], a[200:203], v[18:33]
  ds_read_b128 v[152:155], v120 offset:960
  s_waitcnt lgkmcnt(3)
  v_mfma_f32_32x32x16_bf16 v[2:17], a[108:111], v[140:143], v[2:17]
  v_mfma_f32_32x32x16_bf16 v[18:33], v[156:159], a[204:207], v[18:33]
  ds_read_b128 v[156:159], v120 offset:992
  s_waitcnt lgkmcnt(3)
  v_mfma_f32_32x32x16_bf16 v[2:17], a[112:115], v[144:147], v[2:17]
  v_mfma_f32_32x32x16_bf16 v[18:33], v[160:163], a[208:211], v[18:33]
  s_waitcnt lgkmcnt(2)
  v_mfma_f32_32x32x16_bf16 v[2:17], a[116:119], v[148:151], v[2:17]
  v_mfma_f32_32x32x16_bf16 v[18:33], v[164:167], a[212:215], v[18:33]
  s_waitcnt lgkmcnt(1)
  v_mfma_f32_32x32x16_bf16 v[2:17], a[120:123], v[152:155], v[2:17]
  s_waitcnt vmcnt(8)
  ds_write_b128 v119, v[66:69] offset:0
  v_mfma_f32_32x32x16_bf16 v[18:33], v[168:171], a[216:219], v[18:33]
  s_waitcnt vmcnt(7)
  ds_write_b128 v119, v[70:73] offset:1040
  s_waitcnt lgkmcnt(2)
  v_mfma_f32_32x32x16_bf16 v[2:17], a[124:127], v[156:159], v[2:17]
  s_waitcnt vmcnt(6)
  ds_write_b128 v119, v[74:77] offset:2080
  v_mfma_f32_32x32x16_bf16 v[18:33], v[172:175], a[220:223], v[18:33]
  s_waitcnt vmcnt(5)
  ds_write_b128 v119, v[78:81] offset:3120
  v_mfma_f32_32x32x16_bf16 v[18:33], v[128:131], a[224:227], v[18:33]
  s_waitcnt vmcnt(4)
  ds_write_b128 v119, v[82:85] offset:4160
  v_mfma_f32_32x32x16_bf16 v[18:33], v[132:135], a[228:231], v[18:33]
  s_waitcnt vmcnt(3)
  ds_write_b128 v119, v[86:89] offset:5200
  v_cvt_pk_bf16_f32 v102, v2, v3
  v_cvt_pk_bf16_f32 v103, v4, v5
  v_cvt_pk_bf16_f32 v104, v6, v7
  v_cvt_pk_bf16_f32 v105, v8, v9
  buffer_store_dwordx4 v[102:105], v121, s[4:7], s74 offen offset:0 sc1
  v_mfma_f32_32x32x16_bf16 v[18:33], v[136:139], a[232:235], v[18:33]
  s_waitcnt vmcnt(3)
  ds_write_b128 v119, v[90:93] offset:6240
  v_mfma_f32_32x32x16_bf16 v[18:33], v[140:143], a[236:239], v[18:33]
  s_waitcnt vmcnt(2)
  ds_write_b128 v119, v[94:97] offset:7280
  v_mfma_f32_32x32x16_bf16 v[18:33], v[144:147], a[240:243], v[18:33]
  v_cvt_pk_bf16_f32 v106, v10, v11
  v_cvt_pk_bf16_f32 v107, v12, v13
  v_cvt_pk_bf16_f32 v108, v14, v15
  v_cvt_pk_bf16_f32 v109, v16, v17
  buffer_store_dwordx4 v[106:109], v121, s[4:7], s74 offen offset:512 sc1
  v_mfma_f32_32x32x16_bf16 v[18:33], v[148:151], a[244:247], v[18:33]
  v_max3_u32 v125, v66, v74, v78
  v_max3_u32 v126, v70, v82, v86
  v_mfma_f32_32x32x16_bf16 v[18:33], v[152:155], a[248:251], v[18:33]
  v_max3_u32 v125, v125, v90, v94
  v_max_u32 v125, v125, v126
  v_mfma_f32_32x32x16_bf16 v[18:33], v[156:159], a[252:255], v[18:33]
  v_cmp_eq_u32 vcc, -1, v125
  s_cbranch_vccnz kv_miss
  s_nop 8
  v_cvt_pk_bf16_f32 v110, v18, v19
  v_cvt_pk_bf16_f32 v111, v20, v21
  v_cvt_pk_bf16_f32 v112, v26, v27
  v_cvt_pk_bf16_f32 v113, v28, v29
  buffer_store_dwordx4 v[110:113], v121, s[4:7], s75 offen offset:0 sc1
  v_cvt_pk_bf16_f32 v114, v22, v23
  v_cvt_pk_bf16_f32 v115, v24, v25
  v_cvt_pk_bf16_f32 v116, v30, v31
  v_cvt_pk_bf16_f32 v117, v32, v33
  buffer_store_dwordx4 v[114:117], v121, s[4:7], s75 offen offset:512 sc1
  s_mov_b32 s77, s76
  s_cmp_eq_u32 s71, s72
  s_cbranch_scc1 kv_drain
  v_mov_b32 v123, v122
  s_cbranch_vccz kv_join
kv_drain:
  s_waitcnt vmcnt(0)
  buffer_store_dword v124, v122, s[4:7], s77 offen sc1
  s_cbranch_scc1 kv_end
kv_first:
  v_mov_b32 v123, 0x40000000
kv_poll:
  s_mul_i32 s78, s48, 8448
  s_add_u32 s78, s78, s73
kv_xpk:
  s_sub_u32 s51, s51, 1
  s_cbranch_scc1 main_end
  buffer_load_dword v125, off, s[4:7], s78 offset:3072 sc1
  s_waitcnt vmcnt(0)
  v_cmp_eq_u32 vcc, -1, v125
  s_cbranch_vccnz kv_xpk
kv_poll2:
  s_waitcnt lgkmcnt(0)
  buffer_load_dwordx4 v[66:69], v118, s[4:7], s73 offen offset:0 sc1
  buffer_load_dwordx4 v[70:73], v118, s[4:7], s73 offen offset:1024 sc1
  buffer_load_dwordx4 v[74:77], v118, s[4:7], s73 offen offset:2048 sc1
  buffer_load_dwordx4 v[78:81], v118, s[4:7], s73 offen offset:3072 sc1
  s_add_u32 s78, s73, 4096
  buffer_load_dwordx4 v[82:85], v118, s[4:7], s78 offen offset:0 sc1
  buffer_load_dwordx4 v[86:89], v118, s[4:7], s78 offen offset:1024 sc1
  buffer_load_dwordx4 v[90:93], v118, s[4:7], s78 offen offset:2048 sc1
  buffer_load_dwordx4 v[94:97], v118, s[4:7], s78 offen offset:3072 sc1
  s_waitcnt vmcnt(7)
  ds_write_b128 v119, v[66:69] offset:0
  s_waitcnt vmcnt(6)
  ds_write_b128 v119, v[70:73] offset:1040
  s_waitcnt vmcnt(5)
  ds_write_b128 v119, v[74:77] offset:2080
  s_waitcnt vmcnt(4)
  ds_write_b128 v119, v[78:81] offset:3120
  s_waitcnt vmcnt(3)
  ds_write_b128 v119, v[82:85] offset:4160
  s_waitcnt vmcnt(2)
  ds_write_b128 v119, v[86:89] offset:5200
  s_waitcnt vmcnt(1)
  ds_write_b128 v119, v[90:93] offset:6240
  s_waitcnt vmcnt(0)
  ds_write_b128 v119, v[94:97] offset:7280
  v_max3_u32 v125, v66, v74, v78
  v_max3_u32 v126, v70, v82, v86
  v_max3_u32 v125, v125, v90, v94
  v_max_u32 v125, v125, v126
  v_cmp_eq_u32 vcc, -1, v125
  s_cbranch_vccnz kv_poll
kv_join:
  s_add_u32 s71, s71, 1
  s_add_u32 s73, s73, 0x10000
  s_min_u32 s73, s73, s81
  s_add_u32 s76, s76, 2048
  s_add_u32 s74, s74, 0x40000
  s_add_u32 s75, s74, 0x2000000
  v_xor_b32 v120, 0x10000, v120
  v_xor_b32 v119, 0x10000, v119
  s_waitcnt lgkmcnt(0)
  s_barrier
  s_branch kv_loop
kv_miss:
  s_waitcnt lgkmcnt(0)
  buffer_load_dwordx4 v[66:69], v118, s[4:7], s73 offen offset:0 sc1
  buffer_load_dwordx4 v[70:73], v118, s[4:7], s73 offen offset:1024 sc1
  buffer_load_dwordx4 v[74:77], v118, s[4:7], s73 offen offset:2048 sc1
  buffer_load_dwordx4 v[78:81], v118, s[4:7], s73 offen offset:3072 sc1
  s_add_u32 s78, s73, 4096
  buffer_load_dwordx4 v[82:85], v118, s[4:7], s78 offen offset:0 sc1
  buffer_load_dwordx4 v[86:89], v118, s[4:7], s78 offen offset:1024 sc1
  buffer_load_dwordx4 v[90:93], v118, s[4:7], s78 offen offset:2048 sc1
  buffer_load_dwordx4 v[94:97], v118, s[4:7], s78 offen offset:3072 sc1
  v_cvt_pk_bf16_f32 v110, v18, v19
  v_cvt_pk_bf16_f32 v111, v20, v21
  v_cvt_pk_bf16_f32 v112, v26, v27
  v_cvt_pk_bf16_f32 v113, v28, v29
  buffer_store_dwordx4 v[110:113], v121, s[4:7], s75 offen offset:0 sc1
  v_cvt_pk_bf16_f32 v114, v22, v23
  v_cvt_pk_bf16_f32 v115, v24, v25
  v_cvt_pk_bf16_f32 v116, v30, v31
  v_cvt_pk_bf16_f32 v117, v32, v33
  buffer_store_dwordx4 v[114:117], v121, s[4:7], s75 offen offset:512 sc1
  s_waitcnt vmcnt(9)
  ds_write_b128 v119, v[66:69] offset:0
  s_waitcnt vmcnt(8)
  ds_write_b128 v119, v[70:73] offset:1040
  s_waitcnt vmcnt(7)
  ds_write_b128 v119, v[74:77] offset:2080
  s_waitcnt vmcnt(6)
  ds_write_b128 v119, v[78:81] offset:3120
  s_waitcnt vmcnt(5)
  ds_write_b128 v119, v[82:85] offset:4160
  s_waitcnt vmcnt(4)
  ds_write_b128 v119, v[86:89] offset:5200
  s_waitcnt vmcnt(3)
  ds_write_b128 v119, v[90:93] offset:6240
  s_waitcnt vmcnt(2)
  ds_write_b128 v119, v[94:97] offset:7280
  v_max3_u32 v125, v66, v74, v78
  v_max3_u32 v126, v70, v82, v86
  v_max3_u32 v125, v125, v90, v94
  v_max_u32 v125, v125, v126
  v_cmp_eq_u32 vcc, -1, v125
  s_waitcnt vmcnt(0)
  buffer_store_dword v124, v122, s[4:7], s76 offen sc1
  v_mov_b32 v123, 0x40000000
  s_cbranch_vccnz kv_poll2
  s_branch kv_join
kv_end:
  s_endpgm
role_r:
  s_mov_b32 s70, s57
  s_mov_b32 s89, s55
  s_lshl_b32 s85, s89, 6
  s_lshl_b32 s73, s89, 23
  s_add_u32 s73, s73, 0x1000000
  s_add_u32 s74, s73, 0x3f0000
  s_add_u32 s86, s73, 0x400000
  s_lshl_b32 s77, s89, 24
  s_add_u32 s77, s77, 0xc000000
  s_mul_i32 s80, s70, 33024
  s_add_u32 s77, s77, s80
  s_cmp_eq_u32 s89, 0
  s_mov_b32 s75, s52
  s_cselect_b32 s87, 0x1800000, s75
  v_lshlrev_b32 v172, 4, v0
  s_lshl_b32 s54, s48, 13
  v_add_u32 v172, s54, v172
  v_and_b32 v1, 15, v0
  v_lshrrev_b32 v2, 4, v0
  v_mul_u32_u24 v179, 132096, v2
  v_lshl_add_u32 v179, v1, 4, v179
  s_lshl_b32 s55, s70, 8
  s_add_u32 s54, s54, s55
  s_add_u32 s56, s54, 528384
  v_add_u32 v180, s56, v179
  v_add_u32 v179, s54, v179
  s_lshl_b32 s54, s70, 10
  s_lshl_b32 s55, s48, 8
  s_add_u32 s54, s54, s55
  v_lshl_add_u32 v176, v1, 4, s54
  v_and_b32 v3, 1, v2
  v_lshrrev_b32 v2, 1, v2
  v_lshl_add_u32 v176, v2, 14, v176
  v_lshl_add_u32 v175, v3, 3, v176
  v_add_u32 v175, 0x8000, v175
  v_lshl_add_u32 v176, v3, 15, v176
  v_lshlrev_b32 v178, 5, v2
  s_lshl_b32 s54, s48, 3
  s_add_u32 s54, s54, 0x8400
  v_add_u32 v177, s54, v178
  v_lshl_add_u32 v177, v3, 2, v177
  s_lshl_b32 s54, s89, 2
  s_add_u32 s54, s54, s48
  s_lshl_b32 s54, s54, 4
  s_add_u32 s54, s54, s70
  s_lshl_b32 s54, s54, 2
  s_add_u32 s54, s54, 0x380000
  v_mov_b32 v184, s54
  v_mov_b32 v182, 0x40000000
  v_cmp_eq_u32 vcc, 0, v0
  s_nop 1
  v_cndmask_b32 v184, v182, v184, vcc
  v_mov_b32 v160, 0
  v_lshlrev_b32 v2, 2, v0
r0_cnt:
  s_sub_u32 s51, s51, 1
  s_cbranch_scc1 main_end
  buffer_load_dword v1, v2, s[36:39], 0 offen sc1
  s_waitcnt vmcnt(0)
  v_readlane_b32 s60, v1, 0
  v_readlane_b32 s61, v1, 48
  v_readlane_b32 s62, v1, 16
  v_readlane_b32 s63, v1, 49
  v_readlane_b32 s64, v1, 50
  v_readlane_b32 s65, v1, 51
  v_readlane_b32 s66, v1, 32
  v_readlane_b32 s67, v1, 33
  s_add_u32 s56, s60, s61
  s_add_u32 s56, s56, s62
  s_add_u32 s56, s56, s63
  s_add_u32 s56, s56, s64
  s_add_u32 s56, s56, s65
  s_add_u32 s56, s56, s66
  s_add_u32 s56, s56, s67
  s_cmp_lt_u32 s56, 256
  s_cbranch_scc1 r0_cnt
  s_cmp_eq_u32 s89, 0
  s_cselect_b32 s84, s65, s67
  s_cmp_lt_u32 s84, 32
  s_cselect_b32 s80, 0x40000000, 0
  s_cselect_b32 s81, 0, 0x40000000
  v_or_b32 v187, s81, v184
  v_or_b32 v184, s80, v184
  buffer_store_dword v160, v184, s[4:7], 0 offen
  buffer_store_dword v160, v187, s[4:7], 0 offen sc1
  v_mov_b32 v4, -1
  v_mov_b32 v5, -1
  v_mov_b32 v6, -1
  v_mov_b32 v7, -1
  buffer_store_dwordx4 v[4:7], v176, s[4:7], s87 offen sc1
  s_add_u32 s55, s87, 0x10000
  buffer_store_dwordx4 v[4:7], v176, s[4:7], s55 offen sc1
  s_cmp_lt_u32 s84, 32
  s_cbranch_scc1 r_ri1
  s_add_u32 s55, s77, 0x0
  buffer_store_dwordx4 v[4:7], v172, s[4:7], s55 offen offset:0
  buffer_store_dwordx4 v[4:7], v172, s[4:7], s55 offen offset:1024
  buffer_store_dwordx4 v[4:7], v172, s[4:7], s55 offen offset:2048
  buffer_store_dwordx4 v[4:7], v172, s[4:7], s55 offen offset:3072
  s_add_u32 s55, s77, 0x81000
  buffer_store_dwordx4 v[4:7], v172, s[4:7], s55 offen offset:0
  buffer_store_dwordx4 v[4:7], v172, s[4:7], s55 offen offset:1024
  buffer_store_dwordx4 v[4:7], v172, s[4:7], s55 offen offset:2048
  buffer_store_dwordx4 v[4:7], v172, s[4:7], s55 offen offset:3072
  s_add_u32 s55, s77, 0x200000
  buffer_store_dwordx4 v[4:7], v172, s[4:7], s55 offen offset:0
  buffer_store_dwordx4 v[4:7], v172, s[4:7], s55 offen offset:1024
  buffer_store_dwordx4 v[4:7], v172, s[4:7], s55 offen offset:2048
  buffer_store_dwordx4 v[4:7], v172, s[4:7], s55 offen offset:3072
  s_add_u32 s55, s77, 0x281000
  buffer_store_dwordx4 v[4:7], v172, s[4:7], s55 offen offset:0
  buffer_store_dwordx4 v[4:7], v172, s[4:7], s55 offen offset:1024
  buffer_store_dwordx4 v[4:7], v172, s[4:7], s55 offen offset:2048
  buffer_store_dwordx4 v[4:7], v172, s[4:7], s55 offen offset:3072
  s_add_u32 s55, s77, 0x400000
  buffer_store_dwordx4 v[4:7], v172, s[4:7], s55 offen offset:0
  buffer_store_dwordx4 v[4:7], v172, s[4:7], s55 offen offset:1024
  buffer_store_dwordx4 v[4:7], v172, s[4:7], s55 offen offset:2048
  buffer_store_dwordx4 v[4:7], v172, s[4:7], s55 offen offset:3072
  s_add_u32 s55, s77, 0x481000
  buffer_store_dwordx4 v[4:7], v172, s[4:7], s55 offen offset:0
  buffer_store_dwordx4 v[4:7], v172, s[4:7], s55 offen offset:1024
  buffer_store_dwordx4 v[4:7], v172, s[4:7], s55 offen offset:2048
  buffer_store_dwordx4 v[4:7], v172, s[4:7], s55 offen offset:3072
  s_add_u32 s55, s77, 0x600000
  buffer_store_dwordx4 v[4:7], v172, s[4:7], s55 offen offset:0
  buffer_store_dwordx4 v[4:7], v172, s[4:7], s55 offen offset:1024
  buffer_store_dwordx4 v[4:7], v172, s[4:7], s55 offen offset:2048
  buffer_store_dwordx4 v[4:7], v172, s[4:7], s55 offen offset:3072
  s_add_u32 s55, s77, 0x681000
  buffer_store_dwordx4 v[4:7], v172, s[4:7], s55 offen offset:0
  buffer_store_dwordx4 v[4:7], v172, s[4:7], s55 offen offset:1024
  buffer_store_dwordx4 v[4:7], v172, s[4:7], s55 offen offset:2048
  buffer_store_dwordx4 v[4:7], v172, s[4:7], s55 offen offset:3072
  s_branch r_ri2
r_ri1:
  s_add_u32 s55, s77, 0x0
  buffer_store_dwordx4 v[4:7], v172, s[4:7], s55 offen offset:0 sc1
  buffer_store_dwordx4 v[4:7], v172, s[4:7], s55 offen offset:1024 sc1
  buffer_store_dwordx4 v[4:7], v172, s[4:7], s55 offen offset:2048 sc1
  buffer_store_dwordx4 v[4:7], v172, s[4:7], s55 offen offset:3072 sc1
  s_add_u32 s55, s77, 0x81000
  buffer_store_dwordx4 v[4:7], v172, s[4:7], s55 offen offset:0 sc1
  buffer_store_dwordx4 v[4:7], v172, s[4:7], s55 offen offset:1024 sc1
  buffer_store_dwordx4 v[4:7], v172, s[4:7], s55 offen offset:2048 sc1
  buffer_store_dwordx4 v[4:7], v172, s[4:7], s55 offen offset:3072 sc1
  s_add_u32 s55, s77, 0x200000
  buffer_store_dwordx4 v[4:7], v172, s[4:7], s55 offen offset:0 sc1
  buffer_store_dwordx4 v[4:7], v172, s[4:7], s55 offen offset:1024 sc1
  buffer_store_dwordx4 v[4:7], v172, s[4:7], s55 offen offset:2048 sc1
  buffer_store_dwordx4 v[4:7], v172, s[4:7], s55 offen offset:3072 sc1
  s_add_u32 s55, s77, 0x281000
  buffer_store_dwordx4 v[4:7], v172, s[4:7], s55 offen offset:0 sc1
  buffer_store_dwordx4 v[4:7], v172, s[4:7], s55 offen offset:1024 sc1
  buffer_store_dwordx4 v[4:7], v172, s[4:7], s55 offen offset:2048 sc1
  buffer_store_dwordx4 v[4:7], v172, s[4:7], s55 offen offset:3072 sc1
  s_add_u32 s55, s77, 0x400000
  buffer_store_dwordx4 v[4:7], v172, s[4:7], s55 offen offset:0 sc1
  buffer_store_dwordx4 v[4:7], v172, s[4:7], s55 offen offset:1024 sc1
  buffer_store_dwordx4 v[4:7], v172, s[4:7], s55 offen offset:2048 sc1
  buffer_store_dwordx4 v[4:7], v172, s[4:7], s55 offen offset:3072 sc1
  s_add_u32 s55, s77, 0x481000
  buffer_store_dwordx4 v[4:7], v172, s[4:7], s55 offen offset:0 sc1
  buffer_store_dwordx4 v[4:7], v172, s[4:7], s55 offen offset:1024 sc1
  buffer_store_dwordx4 v[4:7], v172, s[4:7], s55 offen offset:2048 sc1
  buffer_store_dwordx4 v[4:7], v172, s[4:7], s55 offen offset:3072 sc1
  s_add_u32 s55, s77, 0x600000
  buffer_store_dwordx4 v[4:7], v172, s[4:7], s55 offen offset:0 sc1
  buffer_store_dwordx4 v[4:7], v172, s[4:7], s55 offen offset:1024 sc1
  buffer_store_dwordx4 v[4:7], v172, s[4:7], s55 offen offset:2048 sc1
  buffer_store_dwordx4 v[4:7], v172, s[4:7], s55 offen offset:3072 sc1
  s_add_u32 s55, s77, 0x681000
  buffer_store_dwordx4 v[4:7], v172, s[4:7], s55 offen offset:0 sc1
  buffer_store_dwordx4 v[4:7], v172, s[4:7], s55 offen offset:1024 sc1
  buffer_store_dwordx4 v[4:7], v172, s[4:7], s55 offen offset:2048 sc1
  buffer_store_dwordx4 v[4:7], v172, s[4:7], s55 offen offset:3072 sc1
r_ri2:
  s_lshr_b32 s54, s50, 5
  s_bitcmp1_b32 0xca, s54
  s_cselect_b32 s54, 16, 8
  s_lshl_b32 s54, 1, s54
  v_mov_b32 v1, 0x40000000
  v_cmp_eq_u32 vcc, 0, v0
  s_nop 1
  v_cndmask_b32 v2, v1, 0, vcc
  v_mov_b32 v1, s54
  s_waitcnt vmcnt(0)
  s_barrier
  s_cmp_lg_u32 s48, 0
  s_cbranch_scc1 r_idone
  buffer_atomic_add v1, v2, s[36:39], 0 offen offset:68 sc1
r_idone:
  s_lshr_b32 s56, s50, 4
  s_bitcmp1_b32 0xf000, s56
  s_cbranch_scc0 dlr_go
  s_cmp_lg_u32 s48, 0
  s_cbranch_scc1 dlr_w
  v_lshlrev_b32 v2, 2, v0
  s_mov_b32 s58, 0xff000000
  s_and_b32 s59, s58, 0x20303040
  s_add_u32 s59, s59, 256
dlr_cnt:
  s_sub_u32 s51, s51, 1
  s_cbranch_scc1 main_end
  buffer_load_dword v1, v2, s[36:39], 0 offen sc1
  s_waitcnt vmcnt(0)
  v_readlane_b32 s60, v1, 0
  v_readlane_b32 s61, v1, 48
  v_readlane_b32 s62, v1, 16
  v_readlane_b32 s63, v1, 49
  v_readlane_b32 s64, v1, 50
  v_readlane_b32 s65, v1, 51
  v_readlane_b32 s66, v1, 32
  v_readlane_b32 s67, v1, 33
  v_readlane_b32 s57, v1, 17
  s_add_u32 s56, s60, s61
  s_add_u32 s56, s56, s62
  s_add_u32 s56, s56, s63
  s_add_u32 s56, s56, s64
  s_add_u32 s56, s56, s65
  s_add_u32 s56, s56, s66
  s_add_u32 s56, s56, s67
  s_and_b32 s57, s57, s58
  s_add_u32 s56, s56, s57
  s_cmp_lt_u32 s56, s59
  s_cbranch_scc1 dlr_cnt
dlr_w:
  s_barrier
dlr_go:
  v_bfe_u32 v1, v0, 2, 2
  v_lshrrev_b32 v2, 5, v0
  v_lshl_add_u32 v10, v2, 3, v1
  v_lshlrev_b32 v10, 8, v10
  v_xor_b32 v1, s48, v1
  v_lshl_add_u32 v10, v1, 6, v10
  v_bfe_u32 v1, v0, 4, 1
  v_lshl_add_u32 v10, v1, 5, v10
  v_and_b32 v1, 1, v0
  v_lshl_add_u32 v10, v1, 4, v10
  v_bfe_u32 v1, v0, 1, 1
  v_lshl_add_u32 v10, v1, 3, v10
  v_add_u32 v11, 0x10000, v10
  v_add_u32 v12, 0x20000, v10
  v_lshrrev_b32 v1, 4, v0
  v_lshlrev_b32 v2, 2, v1
  v_and_b32 v16, 15, v0
  v_xor_b32 v16, v16, v2
  v_lshlrev_b32 v16, 4, v16
  s_lshl_b32 s54, s48, 4
  v_add_u32 v1, s54, v1
  v_mul_u32_u24 v1, 8192, v1
  v_add_u32 v16, v16, v1
  s_lshl_b32 s82, s48, 12
  s_lshl_b32 s80, s70, 9
  s_add_u32 m0, s82, 0x0
  s_add_u32 s81, s80, 0x0
  buffer_load_dwordx4 v16, s[8:11], s81 offen lds
  s_add_u32 m0, s82, 0x400
  s_add_u32 s81, s80, 0x8000
  buffer_load_dwordx4 v16, s[8:11], s81 offen lds
  s_add_u32 m0, s82, 0x800
  s_add_u32 s81, s80, 0x10000
  buffer_load_dwordx4 v16, s[8:11], s81 offen lds
  s_add_u32 m0, s82, 0xc00
  s_add_u32 s81, s80, 0x18000
  buffer_load_dwordx4 v16, s[8:11], s81 offen lds
  s_add_u32 m0, s82, 0x4000
  s_add_u32 s81, s80, 0x80000
  buffer_load_dwordx4 v16, s[8:11], s81 offen lds
  s_add_u32 m0, s82, 0x4400
  s_add_u32 s81, s80, 0x88000
  buffer_load_dwordx4 v16, s[8:11], s81 offen lds
  s_add_u32 m0, s82, 0x4800
  s_add_u32 s81, s80, 0x90000
  buffer_load_dwordx4 v16, s[8:11], s81 offen lds
  s_add_u32 m0, s82, 0x4c00
  s_add_u32 s81, s80, 0x98000
  buffer_load_dwordx4 v16, s[8:11], s81 offen lds
  s_add_u32 m0, s82, 0x8000
  s_add_u32 s81, s80, 0x100000
  buffer_load_dwordx4 v16, s[8:11], s81 offen lds
  s_add_u32 m0, s82, 0x8400
  s_add_u32 s81, s80, 0x108000
  buffer_load_dwordx4 v16, s[8:11], s81 offen lds
  s_add_u32 m0, s82, 0x8800
  s_add_u32 s81, s80, 0x110000
  buffer_load_dwordx4 v16, s[8:11], s81 offen lds
  s_add_u32 m0, s82, 0x8c00
  s_add_u32 s81, s80, 0x118000
  buffer_load_dwordx4 v16, s[8:11], s81 offen lds
  s_add_u32 m0, s82, 0xc000
  s_add_u32 s81, s80, 0x180000
  buffer_load_dwordx4 v16, s[8:11], s81 offen lds
  s_add_u32 m0, s82, 0xc400
  s_add_u32 s81, s80, 0x188000
  buffer_load_dwordx4 v16, s[8:11], s81 offen lds
  s_add_u32 m0, s82, 0xc800
  s_add_u32 s81, s80, 0x190000
  buffer_load_dwordx4 v16, s[8:11], s81 offen lds
  s_add_u32 m0, s82, 0xcc00
  s_add_u32 s81, s80, 0x198000
  buffer_load_dwordx4 v16, s[8:11], s81 offen lds
  s_add_u32 m0, s82, 0x10000
  s_add_u32 s81, s80, 0x200000
  buffer_load_dwordx4 v16, s[8:11], s81 offen lds
  s_add_u32 m0, s82, 0x10400
  s_add_u32 s81, s80, 0x208000
  buffer_load_dwordx4 v16, s[8:11], s81 offen lds
  s_add_u32 m0, s82, 0x10800
  s_add_u32 s81, s80, 0x210000
  buffer_load_dwordx4 v16, s[8:11], s81 offen lds
  s_add_u32 m0, s82, 0x10c00
  s_add_u32 s81, s80, 0x218000
  buffer_load_dwordx4 v16, s[8:11], s81 offen lds
  s_add_u32 m0, s82, 0x14000
  s_add_u32 s81, s80, 0x280000
  buffer_load_dwordx4 v16, s[8:11], s81 offen lds
  s_add_u32 m0, s82, 0x14400
  s_add_u32 s81, s80, 0x288000
  buffer_load_dwordx4 v16, s[8:11], s81 offen lds
  s_add_u32 m0, s82, 0x14800
  s_add_u32 s81, s80, 0x290000
  buffer_load_dwordx4 v16, s[8:11], s81 offen lds
  s_add_u32 m0, s82, 0x14c00
  s_add_u32 s81, s80, 0x298000
  buffer_load_dwordx4 v16, s[8:11], s81 offen lds
  s_add_u32 m0, s82, 0x18000
  s_add_u32 s81, s80, 0x300000
  buffer_load_dwordx4 v16, s[8:11], s81 offen lds
  s_add_u32 m0, s82, 0x18400
  s_add_u32 s81, s80, 0x308000
  buffer_load_dwordx4 v16, s[8:11], s81 offen lds
  s_add_u32 m0, s82, 0x18800
  s_add_u32 s81, s80, 0x310000
  buffer_load_dwordx4 v16, s[8:11], s81 offen lds
  s_add_u32 m0, s82, 0x18c00
  s_add_u32 s81, s80, 0x318000
  buffer_load_dwordx4 v16, s[8:11], s81 offen lds
  s_add_u32 m0, s82, 0x1c000
  s_add_u32 s81, s80, 0x380000
  buffer_load_dwordx4 v16, s[8:11], s81 offen lds
  s_add_u32 m0, s82, 0x1c400
  s_add_u32 s81, s80, 0x388000
  buffer_load_dwordx4 v16, s[8:11], s81 offen lds
  s_add_u32 m0, s82, 0x1c800
  s_add_u32 s81, s80, 0x390000
  buffer_load_dwordx4 v16, s[8:11], s81 offen lds
  s_add_u32 m0, s82, 0x1cc00
  s_add_u32 s81, s80, 0x398000
  buffer_load_dwordx4 v16, s[8:11], s81 offen lds
  s_add_u32 m0, s82, 0x20000
  s_add_u32 s81, s80, 0x100
  buffer_load_dwordx4 v16, s[8:11], s81 offen lds
  s_add_u32 m0, s82, 0x20400
  s_add_u32 s81, s80, 0x8100
  buffer_load_dwordx4 v16, s[8:11], s81 offen lds
  s_add_u32 m0, s82, 0x20800
  s_add_u32 s81, s80, 0x10100
  buffer_load_dwordx4 v16, s[8:11], s81 offen lds
  s_add_u32 m0, s82, 0x20c00
  s_add_u32 s81, s80, 0x18100
  buffer_load_dwordx4 v16, s[8:11], s81 offen lds
  s_waitcnt vmcnt(32) lgkmcnt(0)
  s_barrier
  s_add_u32 m0, s82, 0x24000
  s_add_u32 s81, s80, 0x80100
  buffer_load_dwordx4 v16, s[8:11], s81 offen lds
  s_add_u32 m0, s82, 0x24400
  s_add_u32 s81, s80, 0x88100
  buffer_load_dwordx4 v16, s[8:11], s81 offen lds
  s_add_u32 m0, s82, 0x24800
  s_add_u32 s81, s80, 0x90100
  buffer_load_dwordx4 v16, s[8:11], s81 offen lds
  s_add_u32 m0, s82, 0x24c00
  s_add_u32 s81, s80, 0x98100
  buffer_load_dwordx4 v16, s[8:11], s81 offen lds
  ds_read_b64_tr_b16 a[0:1], v10 offset:0
  ds_read_b64_tr_b16 a[2:3], v10 offset:1024
  ds_read_b64_tr_b16 a[4:5], v10 offset:4096
  ds_read_b64_tr_b16 a[6:7], v10 offset:5120
  ds_read_b64_tr_b16 a[8:9], v10 offset:8192
  ds_read_b64_tr_b16 a[10:11], v10 offset:9216
  ds_read_b64_tr_b16 a[12:13], v10 offset:12288
  ds_read_b64_tr_b16 a[14:15], v10 offset:13312
  s_waitcnt vmcnt(32) lgkmcnt(0)
  s_barrier
  s_add_u32 m0, s82, 0x0
  s_add_u32 s81, s80, 0x100100
  buffer_load_dwordx4 v16, s[8:11], s81 offen lds
  s_add_u32 m0, s82, 0x400
  s_add_u32 s81, s80, 0x108100
  buffer_load_dwordx4 v16, s[8:11], s81 offen lds
  s_add_u32 m0, s82, 0x800
  s_add_u32 s81, s80, 0x110100
  buffer_load_dwordx4 v16, s[8:11], s81 offen lds
  s_add_u32 m0, s82, 0xc00
  s_add_u32 s81, s80, 0x118100
  buffer_load_dwordx4 v16, s[8:11], s81 offen lds
  ds_read_b64_tr_b16 a[16:17], v10 offset:16384
  ds_read_b64_tr_b16 a[18:19], v10 offset:17408
  ds_read_b64_tr_b16 a[20:21], v10 offset:20480
  ds_read_b64_tr_b16 a[22:23], v10 offset:21504
  ds_read_b64_tr_b16 a[24:25], v10 offset:24576
  ds_read_b64_tr_b16 a[26:27], v10 offset:25600
  ds_read_b64_tr_b16 a[28:29], v10 offset:28672
  ds_read_b64_tr_b16 a[30:31], v10 offset:29696
  s_waitcnt vmcnt(32) lgkmcnt(0)
  s_barrier
  s_add_u32 m0, s82, 0x4000
  s_add_u32 s81, s80, 0x180100
  buffer_load_dwordx4 v16, s[8:11], s81 offen lds
  s_add_u32 m0, s82, 0x4400
  s_add_u32 s81, s80, 0x188100
  buffer_load_dwordx4 v16, s[8:11], s81 offen lds
  s_add_u32 m0, s82, 0x4800
  s_add_u32 s81, s80, 0x190100
  buffer_load_dwordx4 v16, s[8:11], s81 offen lds
  s_add_u32 m0, s82, 0x4c00
  s_add_u32 s81, s80, 0x198100
  buffer_load_dwordx4 v16, s[8:11], s81 offen lds
  ds_read_b64_tr_b16 a[32:33], v10 offset:32768
  ds_read_b64_tr_b16 a[34:35], v10 offset:33792
  ds_read_b64_tr_b16 a[36:37], v10 offset:36864
  ds_read_b64_tr_b16 a[38:39], v10 offset:37888
  ds_read_b64_tr_b16 a[40:41], v10 offset:40960
  ds_read_b64_tr_b16 a[42:43], v10 offset:41984
  ds_read_b64_tr_b16 a[44:45], v10 offset:45056
  ds_read_b64_tr_b16 a[46:47], v10 offset:46080
  s_waitcnt vmcnt(32) lgkmcnt(0)
  s_barrier
  s_add_u32 m0, s82, 0x8000
  s_add_u32 s81, s80, 0x200100
  buffer_load_dwordx4 v16, s[8:11], s81 offen lds
  s_add_u32 m0, s82, 0x8400
  s_add_u32 s81, s80, 0x208100
  buffer_load_dwordx4 v16, s[8:11], s81 offen lds
  s_add_u32 m0, s82, 0x8800
  s_add_u32 s81, s80, 0x210100
  buffer_load_dwordx4 v16, s[8:11], s81 offen lds
  s_add_u32 m0, s82, 0x8c00
  s_add_u32 s81, s80, 0x218100
  buffer_load_dwordx4 v16, s[8:11], s81 offen lds
  ds_read_b64_tr_b16 a[48:49], v10 offset:49152
  ds_read_b64_tr_b16 a[50:51], v10 offset:50176
  ds_read_b64_tr_b16 a[52:53], v10 offset:53248
  ds_read_b64_tr_b16 a[54:55], v10 offset:54272
  ds_read_b64_tr_b16 a[56:57], v10 offset:57344
  ds_read_b64_tr_b16 a[58:59], v10 offset:58368
  ds_read_b64_tr_b16 a[60:61], v10 offset:61440
  ds_read_b64_tr_b16 a[62:63], v10 offset:62464
  s_waitcnt vmcnt(32) lgkmcnt(0)
  s_barrier
  s_add_u32 m0, s82, 0xc000
  s_add_u32 s81, s80, 0x280100
  buffer_load_dwordx4 v16, s[8:11], s81 offen lds
  s_add_u32 m0, s82, 0xc400
  s_add_u32 s81, s80, 0x288100
  buffer_load_dwordx4 v16, s[8:11], s81 offen lds
  s_add_u32 m0, s82, 0xc800
  s_add_u32 s81, s80, 0x290100
  buffer_load_dwordx4 v16, s[8:11], s81 offen lds
  s_add_u32 m0, s82, 0xcc00
  s_add_u32 s81, s80, 0x298100
  buffer_load_dwordx4 v16, s[8:11], s81 offen lds
  ds_read_b64_tr_b16 a[64:65], v11 offset:0
  ds_read_b64_tr_b16 a[66:67], v11 offset:1024
  ds_read_b64_tr_b16 a[68:69], v11 offset:4096
  ds_read_b64_tr_b16 a[70:71], v11 offset:5120
  ds_read_b64_tr_b16 a[72:73], v11 offset:8192
  ds_read_b64_tr_b16 a[74:75], v11 offset:9216
  ds_read_b64_tr_b16 a[76:77], v11 offset:12288
  ds_read_b64_tr_b16 a[78:79], v11 offset:13312
  s_waitcnt vmcnt(32) lgkmcnt(0)
  s_barrier
  s_add_u32 m0, s82, 0x10000
  s_add_u32 s81, s80, 0x300100
  buffer_load_dwordx4 v16, s[8:11], s81 offen lds
  s_add_u32 m0, s82, 0x10400
  s_add_u32 s81, s80, 0x308100
  buffer_load_dwordx4 v16, s[8:11], s81 offen lds
  s_add_u32 m0, s82, 0x10800
  s_add_u32 s81, s80, 0x310100
  buffer_load_dwordx4 v16, s[8:11], s81 offen lds
  s_add_u32 m0, s82, 0x10c00
  s_add_u32 s81, s80, 0x318100
  buffer_load_dwordx4 v16, s[8:11], s81 offen lds
  ds_read_b64_tr_b16 a[80:81], v11 offset:16384
  ds_read_b64_tr_b16 a[82:83], v11 offset:17408
  ds_read_b64_tr_b16 a[84:85], v11 offset:20480
  ds_read_b64_tr_b16 a[86:87], v11 offset:21504
  ds_read_b64_tr_b16 a[88:89], v11 offset:24576
  ds_read_b64_tr_b16 a[90:91], v11 offset:25600
  ds_read_b64_tr_b16 a[92:93], v11 offset:28672
  ds_read_b64_tr_b16 a[94:95], v11 offset:29696
  s_waitcnt vmcnt(32) lgkmcnt(0)
  s_barrier
  s_add_u32 m0, s82, 0x14000
  s_add_u32 s81, s80, 0x380100
  buffer_load_dwordx4 v16, s[8:11], s81 offen lds
  s_add_u32 m0, s82, 0x14400
  s_add_u32 s81, s80, 0x388100
  buffer_load_dwordx4 v16, s[8:11], s81 offen lds
  s_add_u32 m0, s82, 0x14800
  s_add_u32 s81, s80, 0x390100
  buffer_load_dwordx4 v16, s[8:11], s81 offen lds
  s_add_u32 m0, s82, 0x14c00
  s_add_u32 s81, s80, 0x398100
  buffer_load_dwordx4 v16, s[8:11], s81 offen lds
  ds_read_b64_tr_b16 a[96:97], v11 offset:32768
  ds_read_b64_tr_b16 a[98:99], v11 offset:33792
  ds_read_b64_tr_b16 a[100:101], v11 offset:36864
  ds_read_b64_tr_b16 a[102:103], v11 offset:37888
  ds_read_b64_tr_b16 a[104:105], v11 offset:40960
  ds_read_b64_tr_b16 a[106:107], v11 offset:41984
  ds_read_b64_tr_b16 a[108:109], v11 offset:45056
  ds_read_b64_tr_b16 a[110:111], v11 offset:46080
  s_waitcnt vmcnt(32) lgkmcnt(0)
  s_barrier
  ds_read_b64_tr_b16 a[112:113], v11 offset:49152
  ds_read_b64_tr_b16 a[114:115], v11 offset:50176
  ds_read_b64_tr_b16 a[116:117], v11 offset:53248
  ds_read_b64_tr_b16 a[118:119], v11 offset:54272
  ds_read_b64_tr_b16 a[120:121], v11 offset:57344
  ds_read_b64_tr_b16 a[122:123], v11 offset:58368
  ds_read_b64_tr_b16 a[124:125], v11 offset:61440
  ds_read_b64_tr_b16 a[126:127], v11 offset:62464
  s_waitcnt vmcnt(28) lgkmcnt(0)
  s_barrier
  ds_read_b64_tr_b16 a[128:129], v12 offset:0
  ds_read_b64_tr_b16 a[130:131], v12 offset:1024
  ds_read_b64_tr_b16 a[132:133], v12 offset:4096
  ds_read_b64_tr_b16 a[134:135], v12 offset:5120
  ds_read_b64_tr_b16 a[136:137], v12 offset:8192
  ds_read_b64_tr_b16 a[138:139], v12 offset:9216
  ds_read_b64_tr_b16 a[140:141], v12 offset:12288
  ds_read_b64_tr_b16 a[142:143], v12 offset:13312
  s_waitcnt vmcnt(24) lgkmcnt(0)
  s_barrier
  ds_read_b64_tr_b16 a[144:145], v12 offset:16384
  ds_read_b64_tr_b16 a[146:147], v12 offset:17408
  ds_read_b64_tr_b16 a[148:149], v12 offset:20480
  ds_read_b64_tr_b16 a[150:151], v12 offset:21504
  ds_read_b64_tr_b16 a[152:153], v12 offset:24576
  ds_read_b64_tr_b16 a[154:155], v12 offset:25600
  ds_read_b64_tr_b16 a[156:157], v12 offset:28672
  ds_read_b64_tr_b16 a[158:159], v12 offset:29696
  s_waitcnt vmcnt(20) lgkmcnt(0)
  s_barrier
  ds_read_b64_tr_b16 a[160:161], v10 offset:0
  ds_read_b64_tr_b16 a[162:163], v10 offset:1024
  ds_read_b64_tr_b16 a[164:165], v10 offset:4096
  ds_read_b64_tr_b16 a[166:167], v10 offset:5120
  ds_read_b64_tr_b16 a[168:169], v10 offset:8192
  ds_read_b64_tr_b16 a[170:171], v10 offset:9216
  ds_read_b64_tr_b16 a[172:173], v10 offset:12288
  ds_read_b64_tr_b16 a[174:175], v10 offset:13312
  s_waitcnt vmcnt(16) lgkmcnt(0)
  s_barrier
  ds_read_b64_tr_b16 a[176:177], v10 offset:16384
  ds_read_b64_tr_b16 a[178:179], v10 offset:17408
  ds_read_b64_tr_b16 a[180:181], v10 offset:20480
  ds_read_b64_tr_b16 a[182:183], v10 offset:21504
  ds_read_b64_tr_b16 a[184:185], v10 offset:24576
  ds_read_b64_tr_b16 a[186:187], v10 offset:25600
  ds_read_b64_tr_b16 a[188:189], v10 offset:28672
  ds_read_b64_tr_b16 a[190:191], v10 offset:29696
  s_waitcnt vmcnt(12) lgkmcnt(0)
  s_barrier
  ds_read_b64_tr_b16 a[192:193], v10 offset:32768
  ds_read_b64_tr_b16 a[194:195], v10 offset:33792
  ds_read_b64_tr_b16 a[196:197], v10 offset:36864
  ds_read_b64_tr_b16 a[198:199], v10 offset:37888
  ds_read_b64_tr_b16 a[200:201], v10 offset:40960
  ds_read_b64_tr_b16 a[202:203], v10 offset:41984
  ds_read_b64_tr_b16 a[204:205], v10 offset:45056
  ds_read_b64_tr_b16 a[206:207], v10 offset:46080
  s_waitcnt vmcnt(8) lgkmcnt(0)
  s_barrier
  ds_read_b64_tr_b16 a[208:209], v10 offset:49152
  ds_read_b64_tr_b16 a[210:211], v10 offset:50176
  ds_read_b64_tr_b16 a[212:213], v10 offset:53248
  ds_read_b64_tr_b16 a[214:215], v10 offset:54272
  ds_read_b64_tr_b16 a[216:217], v10 offset:57344
  ds_read_b64_tr_b16 a[218:219], v10 offset:58368
  ds_read_b64_tr_b16 a[220:221], v10 offset:61440
  ds_read_b64_tr_b16 a[222:223], v10 offset:62464
  s_waitcnt vmcnt(4) lgkmcnt(0)
  s_barrier
  ds_read_b64_tr_b16 a[224:225], v11 offset:0
  ds_read_b64_tr_b16 a[226:227], v11 offset:1024
  ds_read_b64_tr_b16 a[228:229], v11 offset:4096
  ds_read_b64_tr_b16 a[230:231], v11 offset:5120
  ds_read_b64_tr_b16 a[232:233], v11 offset:8192
  ds_read_b64_tr_b16 a[234:235], v11 offset:9216
  ds_read_b64_tr_b16 a[236:237], v11 offset:12288
  ds_read_b64_tr_b16 a[238:239], v11 offset:13312
  s_waitcnt vmcnt(0) lgkmcnt(0)
  s_barrier
  ds_read_b64_tr_b16 a[240:241], v11 offset:16384
  ds_read_b64_tr_b16 a[242:243], v11 offset:17408
  ds_read_b64_tr_b16 a[244:245], v11 offset:20480
  ds_read_b64_tr_b16 a[246:247], v11 offset:21504
  ds_read_b64_tr_b16 a[248:249], v11 offset:24576
  ds_read_b64_tr_b16 a[250:251], v11 offset:25600
  ds_read_b64_tr_b16 a[252:253], v11 offset:28672
  ds_read_b64_tr_b16 a[254:255], v11 offset:29696
  s_waitcnt lgkmcnt(0)
  s_barrier
  v_lshlrev_b32 v173, 4, v0
  s_mul_i32 s54, s48, 8320
  s_add_u32 s54, s54, 0x0
  v_add_u32 v173, s54, v173
  v_and_b32 v1, 31, v0
  v_lshrrev_b32 v2, 5, v0
  v_mul_u32_u24 v174, 1040, v1
  v_lshl_add_u32 v174, v2, 4, v174
  v_and_b32 v181, 15, v0
  v_lshlrev_b32 v181, 4, v181
  v_lshrrev_b32 v1, 5, v0
  v_lshl_add_u32 v181, v1, 8, v181
  v_bfe_u32 v1, v0, 4, 1
  v_lshl_add_u32 v181, v1, 10, v181
  s_lshl_b32 s54, s48, 11
  v_add_u32 v181, s54, v181
  v_cmp_ge_u32 vcc, 1, v0
  s_lshl_b32 s54, s48, 2
  v_lshl_add_u32 v183, v0, 6, s54
  v_cndmask_b32 v182, v182, v183, vcc
  v_mov_b32 v183, 1
  v_mov_b32 v2, 0x3f80
  v_mov_b32 v3, 0x3f800000
  v_and_b32 v1, 7, v0
  v_mov_b32 v152, 0
  v_cmp_eq_u32 vcc, 0, v1
  s_nop 1
  v_cndmask_b32 v152, v152, v2, vcc
  v_cmp_eq_u32 vcc, 1, v1
  s_nop 1
  v_cndmask_b32 v152, v152, v3, vcc
  v_mov_b32 v153, 0
  v_cmp_eq_u32 vcc, 2, v1
  s_nop 1
  v_cndmask_b32 v153, v153, v2, vcc
  v_cmp_eq_u32 vcc, 3, v1
  s_nop 1
  v_cndmask_b32 v153, v153, v3, vcc
  v_mov_b32 v154, 0
  v_cmp_eq_u32 vcc, 4, v1
  s_nop 1
  v_cndmask_b32 v154, v154, v2, vcc
  v_cmp_eq_u32 vcc, 5, v1
  s_nop 1
  v_cndmask_b32 v154, v154, v3, vcc
  v_mov_b32 v155, 0
  v_cmp_eq_u32 vcc, 6, v1
  s_nop 1
  v_cndmask_b32 v155, v155, v2, vcc
  v_cmp_eq_u32 vcc, 7, v1
  s_nop 1
  v_cndmask_b32 v155, v155, v3, vcc
  v_and_b32 v1, 8, v0
  v_cmp_eq_u32 vcc, 0, v1
  s_nop 1
  v_cndmask_b32 v156, v152, 0, vcc
  v_cndmask_b32 v152, 0, v152, vcc
  v_cndmask_b32 v157, v153, 0, vcc
  v_cndmask_b32 v153, 0, v153, vcc
  v_cndmask_b32 v158, v154, 0, vcc
  v_cndmask_b32 v154, 0, v154, vcc
  v_cndmask_b32 v159, v155, 0, vcc
  v_cndmask_b32 v155, 0, v155, vcc
  s_lshl_b32 s80, s85, 4
  s_add_u32 s80, s80, s70
  s_lshl_b32 s94, s80, 7
  s_add_u32 s94, s94, 0x1f810
  s_lshl_b32 s90, s80, 14
  s_add_u32 s90, s90, 0x3fc0000
  s_mov_b32 s91, s52
  s_mov_b32 s95, s52
  s_mov_b32 s84, s52
  s_mov_b32 s76, s52
  s_mov_b32 s71, -1
  s_mov_b32 s88, -1
  s_mov_b32 s93, -1
  s_mov_b32 s92, 0
  s_mov_b32 s79, 0
  s_mov_b32 s78, s77
  s_mov_b32 s72, s86
  s_mul_i32 s82, s48, 8320
  v_mov_b32 v186, 0
  v_mov_b32 v185, 0x40000000
  s_sub_u32 s85, s85, 1
  v_lshlrev_b32 v2, 2, v0
  s_lshr_b32 s58, s50, 5
  s_bitcmp1_b32 0xca, s58
  s_cselect_b32 s58, -1, 0xffff
  s_and_b32 s59, s58, 0x20303040
  s_add_u32 s59, s59, 256
r1_cnt:
  s_sub_u32 s51, s51, 1
  s_cbranch_scc1 main_end
  buffer_load_dword v1, v2, s[36:39], 0 offen sc1
  s_waitcnt vmcnt(0)
  v_readlane_b32 s60, v1, 0
  v_readlane_b32 s61, v1, 48
  v_readlane_b32 s62, v1, 16
  v_readlane_b32 s63, v1, 49
  v_readlane_b32 s64, v1, 50
  v_readlane_b32 s65, v1, 51
  v_readlane_b32 s66, v1, 32
  v_readlane_b32 s67, v1, 33
  v_readlane_b32 s57, v1, 17
  s_add_u32 s56, s60, s61
  s_add_u32 s56, s56, s62
  s_add_u32 s56, s56, s63
  s_add_u32 s56, s56, s64
  s_add_u32 s56, s56, s65
  s_add_u32 s56, s56, s66
  s_add_u32 s56, s56, s67
  s_and_b32 s57, s57, s58
  s_add_u32 s56, s56, s57
  s_cmp_lt_u32 s56, s59
  s_cbranch_scc1 r1_cnt
  s_mov_b32 s83, -11
  s_cmp_eq_u32 s89, 0
  s_cbranch_scc1 rw_xpoll
  s_mov_b32 s83, -10
  s_mov_b32 s75, 0
  v_lshlrev_b32 v1, 26, v0
  v_not_b32 v1, v1
  v_and_b32 v1, 0x40000000, v1
  v_and_b32 v176, 0x7fff, v176
  v_or_b32 v176, v176, v1
  s_branch r1_xpoll
r0_top:
  s_barrier
  ds_read_b128 v[36:39], v174 offset:0
  ds_read_b128 v[40:43], v174 offset:32
  ds_read_b128 v[44:47], v174 offset:64
  ds_read_b128 v[48:51], v174 offset:96
  buffer_load_dwordx4 v[96:99], v172, s[4:7], s78 offen offset:0 sc1
  ds_read_b128 v[52:55], v174 offset:128
  s_add_u32 s71, s71, 1
  s_cmp_eq_u32 s71, 63
  s_cselect_b32 s88, 0, -1
  ds_read_b128 v[56:59], v174 offset:160
  s_add_u32 s73, s73, 0x10000
  s_min_u32 s73, s73, s74
  v_xor_b32 v173, 0x10000, v173
  s_xor_b32 s82, s82, 0x10000
  ds_read_b128 v[60:63], v174 offset:192
  ds_read_b128 v[64:67], v174 offset:224
  s_add_u32 s90, s90, 0x40000
  s_add_u32 s94, s94, 2048
  buffer_load_dwordx4 v[100:103], v172, s[4:7], s78 offen offset:1024 sc1
  s_waitcnt lgkmcnt(7)
  v_mfma_f32_32x32x16_bf16 v[4:19], a[0:3], v[36:39], 0
  s_waitcnt lgkmcnt(6)
  s_waitcnt lgkmcnt(5)
  s_waitcnt lgkmcnt(4)
  s_waitcnt lgkmcnt(3)
  s_add_u32 s81, s78, 528384
  v_mfma_f32_32x32x16_bf16 v[4:19], a[4:7], v[40:43], v[4:19]
  buffer_load_dwordx4 v[104:107], v172, s[4:7], s78 offen offset:2048 sc1
  s_waitcnt lgkmcnt(2)
  s_waitcnt lgkmcnt(1)
  v_mfma_f32_32x32x16_bf16 v[4:19], a[8:11], v[44:47], v[4:19]
  v_mfma_f32_32x32x16_bf16 v[4:19], a[12:15], v[48:51], v[4:19]
  buffer_load_dwordx4 v[108:111], v172, s[4:7], s78 offen offset:3072 sc1
  s_waitcnt lgkmcnt(0)
  v_mfma_f32_32x32x16_bf16 v[4:19], a[16:19], v[52:55], v[4:19]
  v_mfma_f32_32x32x16_bf16 v[20:35], a[128:131], v[36:39], 0
  buffer_load_dwordx4 v[112:115], v172, s[4:7], s81 offen offset:0 sc1
  ds_read_b128 v[36:39], v174 offset:256
  v_mfma_f32_32x32x16_bf16 v[4:19], a[20:23], v[56:59], v[4:19]
  v_mfma_f32_32x32x16_bf16 v[20:35], a[132:135], v[40:43], v[20:35]
  buffer_load_dwordx4 v[116:119], v172, s[4:7], s81 offen offset:1024 sc1
  ds_read_b128 v[40:43], v174 offset:288
  v_mfma_f32_32x32x16_bf16 v[4:19], a[24:27], v[60:63], v[4:19]
  s_waitcnt lgkmcnt(1)
  v_mfma_f32_32x32x16_bf16 v[20:35], a[136:139], v[44:47], v[20:35]
  buffer_load_dwordx4 v[120:123], v172, s[4:7], s81 offen offset:2048 sc1
  ds_read_b128 v[44:47], v174 offset:320
  v_mfma_f32_32x32x16_bf16 v[4:19], a[28:31], v[64:67], v[4:19]
  s_waitcnt lgkmcnt(1)
  v_mfma_f32_32x32x16_bf16 v[20:35], a[140:143], v[48:51], v[20:35]
  buffer_load_dwordx4 v[124:127], v172, s[4:7], s81 offen offset:3072 sc1
  ds_read_b128 v[48:51], v174 offset:352
  v_mfma_f32_32x32x16_bf16 v[4:19], a[32:35], v[36:39], v[4:19]
  s_waitcnt lgkmcnt(1)
  v_mfma_f32_32x32x16_bf16 v[20:35], a[144:147], v[52:55], v[20:35]
  ds_read_b128 v[52:55], v174 offset:384
  v_mfma_f32_32x32x16_bf16 v[4:19], a[36:39], v[40:43], v[4:19]
  v_mfma_f32_32x32x16_bf16 v[20:35], a[148:151], v[56:59], v[20:35]
  ds_read_b128 v[56:59], v174 offset:416
  s_waitcnt vmcnt(8)
  v_cmp_lt_u32 vcc, s93, v160
  v_mfma_f32_32x32x16_bf16 v[4:19], a[40:43], v[44:47], v[4:19]
  s_cbranch_vccnz r0_res
r0_res_ok:
  v_lshlrev_b32 v140, 16, v160
  v_and_b32 v141, 0xffff0000, v160
  v_lshlrev_b32 v142, 16, v161
  v_and_b32 v143, 0xffff0000, v161
  v_mfma_f32_32x32x16_bf16 v[20:35], a[152:155], v[60:63], v[20:35]
  s_waitcnt vmcnt(7)
  ds_read_b128 v[60:63], v174 offset:448
  s_waitcnt vmcnt(6)
  v_bitop3_b32 v144, v96, v100, s79 bitop3:0x7e
  s_waitcnt lgkmcnt(3)
  v_mfma_f32_16x16x32_bf16 v[128:131], v[152:155], v[96:99], 0
  s_waitcnt vmcnt(5)
  v_mfma_f32_16x16x32_bf16 v[128:131], v[152:155], v[100:103], v[128:131]
  s_waitcnt vmcnt(4)
  v_bitop3_b32 v145, v104, v108, s79 bitop3:0x7e
  v_mfma_f32_16x16x32_bf16 v[128:131], v[152:155], v[104:107], v[128:131]
  v_mfma_f32_16x16x32_bf16 v[128:131], v[152:155], v[108:111], v[128:131]
  s_waitcnt vmcnt(3)
  v_mfma_f32_32x32x16_bf16 v[4:19], a[44:47], v[48:51], v[4:19]
  s_waitcnt vmcnt(2)
  v_bitop3_b32 v146, v112, v116, s79 bitop3:0x7e
  v_or3_b32 v144, v144, v145, v146
  v_mfma_f32_16x16x32_bf16 v[128:131], v[156:159], v[112:115], v[128:131]
  s_waitcnt vmcnt(1)
  v_mfma_f32_16x16x32_bf16 v[128:131], v[156:159], v[116:119], v[128:131]
  s_waitcnt lgkmcnt(2)
  v_mfma_f32_16x16x32_bf16 v[128:131], v[156:159], v[120:123], v[128:131]
  v_mfma_f32_32x32x16_bf16 v[20:35], a[156:159], v[64:67], v[20:35]
  ds_read_b128 v[64:67], v174 offset:480
  s_waitcnt vmcnt(0)
  v_bitop3_b32 v147, v120, v124, s79 bitop3:0x7e
  v_bitop3_b32 v144, v144, v147, s92 bitop3:0xa8
  v_cmp_ne_u32 vcc, 0, v144
  s_mov_b32 m0, s82
  v_mfma_f32_16x16x32_bf16 v[128:131], v[156:159], v[124:127], v[128:131]
  s_cbranch_vccnz r0_red
r0_red_ok:
  v_mfma_f32_32x32x16_bf16 v[4:19], a[48:51], v[52:55], v[4:19]
  buffer_store_dword v186, v184, s[4:7], 0 offen
  buffer_store_dword v186, v187, s[4:7], 0 offen sc1
  v_mfma_f32_32x32x16_bf16 v[20:35], a[160:163], v[36:39], v[20:35]
  buffer_load_dwordx4 v172, s[4:7], s73 offen offset:0 sc1 lds
  ds_read_b128 v[36:39], v174 offset:512
  s_add_u32 s83, s83, 1
  v_cvt_pk_bf16_f32 v138, v128, v129
  s_waitcnt lgkmcnt(3)
  v_mfma_f32_32x32x16_bf16 v[4:19], a[52:55], v[56:59], v[4:19]
  s_max_i32 s79, s83, 0
  v_cvt_pk_bf16_f32 v139, v130, v131
  v_lshlrev_b32 v132, 16, v138
  v_and_b32 v133, 0xffff0000, v138
  v_lshlrev_b32 v134, 16, v139
  v_and_b32 v135, 0xffff0000, v139
  v_add_f32 v132, v132, v140
  v_add_f32 v133, v133, v141
  v_add_f32 v134, v134, v142
  v_add_f32 v135, v135, v143
  v_cvt_pk_bf16_f32 v138, v132, v133
  v_cvt_pk_bf16_f32 v139, v134, v135
  v_lshlrev_b32 v132, 16, v138
  v_and_b32 v133, 0xffff0000, v138
  v_lshlrev_b32 v134, 16, v139
  v_and_b32 v135, 0xffff0000, v139
  v_mul_f32 v145, v132, v132
  v_add_f32 v144, v132, v133
  s_lshl_b32 s72, s79, 16
  s_waitcnt lgkmcnt(2)
  v_mfma_f32_32x32x16_bf16 v[4:19], a[56:59], v[60:63], v[4:19]
  s_and_b32 s78, s79, 1
  v_fmac_f32 v145, v133, v133
  v_add_f32 v146, v134, v135
  v_fmac_f32 v145, v134, v134
  v_add_f32 v144, v144, v146
  v_fmac_f32 v145, v135, v135
  s_lshl_b32 s78, s78, 21
  s_add_u32 s78, s78, s77
  s_add_u32 s70, s73, 0xfffffff0
  v_mfma_f32_32x32x16_bf16 v[20:35], a[164:167], v[40:43], v[20:35]
  buffer_load_dwordx4 v172, s[4:7], s70 offen offset:1040 sc1 lds
  v_min_u32 v138, -2, v138
  v_permlane16_swap_b32 v144, v145
  v_add_f32 v144, v144, v145
  s_lshr_b32 s79, s79, 1
  s_waitcnt lgkmcnt(1)
  v_mfma_f32_32x32x16_bf16 v[4:19], a[60:63], v[64:67], v[4:19]
  ds_read_b128 v[40:43], v174 offset:544
  v_add_f32_dpp v144, v144, v144 row_ror:8 row_mask:0xf bank_mask:0xf
  s_add_u32 s72, s72, s86
  s_cmp_lt_i32 s83, 0
  s_cselect_b32 s92, 0, 1
  s_cselect_b32 s93, -1, -2
  v_add_u32 v186, s92, v186
  v_add_f32_dpp v144, v144, v144 row_ror:4 row_mask:0xf bank_mask:0xf
  s_waitcnt lgkmcnt(1)
  v_mfma_f32_32x32x16_bf16 v[4:19], a[64:67], v[36:39], v[4:19]
  s_add_u32 s70, s73, 0xffffffe0
  v_add_f32_dpp v144, v144, v144 row_ror:2 row_mask:0xf bank_mask:0xf
  s_nop 1
  v_add_f32_dpp v144, v144, v144 row_ror:1 row_mask:0xf bank_mask:0xf
  v_mfma_f32_32x32x16_bf16 v[20:35], a[168:171], v[44:47], v[20:35]
  buffer_load_dwordx4 v172, s[4:7], s70 offen offset:2080 sc1 lds
  ds_read_b128 v[44:47], v174 offset:576
  ds_write_b32 v177, v144
  s_add_u32 s70, s73, 0xffffffd0
  v_mfma_f32_32x32x16_bf16 v[20:35], a[172:175], v[48:51], v[20:35]
  buffer_load_dwordx4 v172, s[4:7], s70 offen offset:3120 sc1 lds
  ds_read_b128 v[48:51], v174 offset:608
  s_add_u32 m0, s82, 4160
  s_add_u32 s70, s73, 0x1000
  v_mfma_f32_32x32x16_bf16 v[20:35], a[176:179], v[52:55], v[20:35]
  buffer_load_dwordx4 v172, s[4:7], s70 offen offset:0 sc1 lds
  ds_read_b128 v[52:55], v174 offset:640
  s_waitcnt lgkmcnt(2)
  v_mfma_f32_32x32x16_bf16 v[4:19], a[68:71], v[40:43], v[4:19]
  s_barrier
  ds_read_b128 v[144:147], v178 offset:33792
  ds_read_b128 v[148:151], v178 offset:33808
  s_add_u32 s70, s73, 0xff0
  v_mfma_f32_32x32x16_bf16 v[20:35], a[180:183], v[56:59], v[20:35]
  buffer_load_dwordx4 v172, s[4:7], s70 offen offset:1040 sc1 lds
  ds_read_b128 v[56:59], v174 offset:672
  v_mfma_f32_32x32x16_bf16 v[4:19], a[72:75], v[44:47], v[4:19]
  s_waitcnt lgkmcnt(1)
  v_add_f32 v144, v144, v146
  v_add_f32 v145, v145, v147
  v_add_f32 v148, v148, v150
  v_add_f32 v149, v149, v151
  v_add_f32 v144, v144, v148
  v_add_f32 v145, v145, v149
  v_mul_f32 v144, 0x3b000000, v144
  v_mul_f32 v145, 0x3b000000, v145
  v_fma_f32 v145, -v144, v144, v145
  v_max_f32 v145, 0, v145
  v_cvt_pk_bf16_f32 v146, v144, v145
  v_and_b32 v145, 0xffff0000, v146
  v_mfma_f32_32x32x16_bf16 v[4:19], a[76:79], v[48:51], v[4:19]
  s_add_u32 s70, s73, 0xfe0
  v_add_f32 v145, 0x3727c5ac, v145
  v_cvt_pk_bf16_f32 v145, v145, v145
  v_lshlrev_b32 v145, 16, v145
  v_sqrt_f32 v145, v145
  v_lshlrev_b32 v144, 16, v146
  v_mfma_f32_32x32x16_bf16 v[20:35], a[184:187], v[60:63], v[20:35]
  buffer_load_dwordx4 v172, s[4:7], s70 offen offset:2080 sc1 lds
  v_cvt_pk_bf16_f32 v145, v145, v145
  v_sub_f32 v132, v132, v144
  v_lshlrev_b32 v145, 16, v145
  v_sub_f32 v133, v133, v144
  v_rcp_f32 v145, v145
  v_sub_f32 v134, v134, v144
  v_mfma_f32_32x32x16_bf16 v[4:19], a[80:83], v[52:55], v[4:19]
  s_add_u32 s70, s73, 0xfd0
  v_sub_f32 v135, v135, v144
  v_cvt_pk_bf16_f32 v148, v132, v133
  v_cvt_pk_bf16_f32 v149, v134, v135
  v_lshlrev_b32 v132, 16, v148
  v_and_b32 v133, 0xffff0000, v148
  v_lshlrev_b32 v134, 16, v149
  v_and_b32 v135, 0xffff0000, v149
  v_mul_f32 v132, v132, v145
  v_mul_f32 v133, v133, v145
  v_mul_f32 v134, v134, v145
  v_mul_f32 v135, v135, v145
  v_cvt_pk_bf16_f32 v136, v132, v133
  s_waitcnt lgkmcnt(0)
  v_mfma_f32_32x32x16_bf16 v[4:19], a[84:87], v[56:59], v[4:19]
  ds_read_b128 v[60:63], v174 offset:704
  v_cvt_pk_bf16_f32 v137, v134, v135
  v_min_u32 v136, -2, v136
  v_mov_b32 v144, -1
  v_permlane16_swap_b32 v137, v139
  v_permlane16_swap_b32 v136, v138
  v_mfma_f32_32x32x16_bf16 v[20:35], a[188:191], v[64:67], v[20:35]
  buffer_load_dwordx4 v172, s[4:7], s70 offen offset:3120 sc1 lds
  v_mov_b32 v145, -1
  v_mov_b32 v146, -1
  v_mov_b32 v147, -1
  v_mfma_f32_32x32x16_bf16 v[20:35], a[192:195], v[36:39], v[20:35]
  ds_read_b128 v[64:67], v174 offset:736
  ds_read_b128 v[36:39], v174 offset:768
  v_mfma_f32_32x32x16_bf16 v[20:35], a[196:199], v[40:43], v[20:35]
  ds_read_b128 v[40:43], v174 offset:800
  buffer_store_dword v183, v182, s[4:7], s84 offen sc1
  s_waitcnt lgkmcnt(3)
  v_mfma_f32_32x32x16_bf16 v[4:19], a[88:91], v[60:63], v[4:19]
  buffer_store_dwordx4 v[136:139], v176, s[4:7], s75 offen sc1
  s_add_u32 s75, s72, 0x400000
  v_mfma_f32_32x32x16_bf16 v[20:35], a[200:203], v[44:47], v[20:35]
  ds_read_b128 v[44:47], v174 offset:832
  s_waitcnt lgkmcnt(3)
  s_waitcnt lgkmcnt(2)
  v_mfma_f32_32x32x16_bf16 v[4:19], a[92:95], v[64:67], v[4:19]
  s_waitcnt lgkmcnt(1)
  buffer_store_dwordx4 v[144:147], v176, s[4:7], s76 offen sc1
  s_add_u32 s76, s75, 0x20000
  s_cmp_lt_i32 s83, 62
  s_cselect_b32 s76, s76, s52
  s_cmp_lt_i32 s83, 0
  s_cselect_b32 s75, s52, s75
  v_mfma_f32_32x32x16_bf16 v[20:35], a[204:207], v[48:51], v[20:35]
  buffer_store_dwordx4 v[68:71], v181, s[4:7], s91 offen offset:0 sc1
  ds_read_b128 v[48:51], v174 offset:864
  s_add_u32 s80, s91, 8192
  s_waitcnt lgkmcnt(1)
  v_mfma_f32_32x32x16_bf16 v[4:19], a[96:99], v[36:39], v[4:19]
  v_mfma_f32_32x32x16_bf16 v[20:35], a[208:211], v[52:55], v[20:35]
  buffer_store_dwordx4 v[72:75], v181, s[4:7], s91 offen offset:512 sc1
  ds_read_b128 v[52:55], v174 offset:896
  v_mfma_f32_32x32x16_bf16 v[4:19], a[100:103], v[40:43], v[4:19]
  s_waitcnt lgkmcnt(1)
  v_mfma_f32_32x32x16_bf16 v[20:35], a[212:215], v[56:59], v[20:35]
  ds_read_b128 v[56:59], v174 offset:928
  v_mfma_f32_32x32x16_bf16 v[4:19], a[104:107], v[44:47], v[4:19]
  buffer_store_dwordx4 v[76:79], v181, s[4:7], s80 offen offset:0 sc1
  s_waitcnt lgkmcnt(1)
  v_mfma_f32_32x32x16_bf16 v[20:35], a[216:219], v[60:63], v[20:35]
  ds_read_b128 v[60:63], v174 offset:960
  v_mfma_f32_32x32x16_bf16 v[4:19], a[108:111], v[48:51], v[4:19]
  buffer_store_dwordx4 v[80:83], v181, s[4:7], s80 offen offset:512 sc1
  s_waitcnt lgkmcnt(1)
  v_mfma_f32_32x32x16_bf16 v[20:35], a[220:223], v[64:67], v[20:35]
  ds_read_b128 v[64:67], v174 offset:992
  s_waitcnt lgkmcnt(1)
  v_mfma_f32_32x32x16_bf16 v[4:19], a[112:115], v[52:55], v[4:19]
  buffer_load_dwordx2 v[160:161], v175, s[4:7], s72 offen sc1
  v_mfma_f32_32x32x16_bf16 v[20:35], a[224:227], v[36:39], v[20:35]
  v_mfma_f32_32x32x16_bf16 v[4:19], a[116:119], v[56:59], v[4:19]
  s_waitcnt lgkmcnt(0)
  v_mfma_f32_32x32x16_bf16 v[20:35], a[228:231], v[40:43], v[20:35]
  v_mfma_f32_32x32x16_bf16 v[4:19], a[120:123], v[60:63], v[4:19]
  v_mfma_f32_32x32x16_bf16 v[20:35], a[232:235], v[44:47], v[20:35]
  s_waitcnt vmcnt(8)
  ds_read_b32 v164, v173 offset:0
  ds_read_b32 v165, v173 offset:1040
  ds_read_b32 v166, v173 offset:2080
  ds_read_b32 v167, v173 offset:3120
  ds_read_b32 v168, v173 offset:4160
  ds_read_b32 v169, v173 offset:5200
  v_mfma_f32_32x32x16_bf16 v[4:19], a[124:127], v[64:67], v[4:19]
  ds_read_b32 v170, v173 offset:6240
  ds_read_b32 v171, v173 offset:7280
  v_mfma_f32_32x32x16_bf16 v[20:35], a[236:239], v[48:51], v[20:35]
  v_mfma_f32_32x32x16_bf16 v[20:35], a[240:243], v[52:55], v[20:35]
  v_mfma_f32_32x32x16_bf16 v[20:35], a[244:247], v[56:59], v[20:35]
  s_waitcnt lgkmcnt(0)
  v_max3_u32 v1, v164, v166, v167
  v_max3_u32 v2, v165, v168, v169
  v_max3_u32 v1, v1, v170, v171
  v_mfma_f32_32x32x16_bf16 v[20:35], a[248:251], v[60:63], v[20:35]
  v_max_u32 v1, v1, v2
  v_cmp_le_u32 vcc, s88, v1
  v_cvt_pk_bf16_f32 v68, v4, v5
  v_cvt_pk_bf16_f32 v69, v6, v7
  v_cvt_pk_bf16_f32 v70, v8, v9
  v_cvt_pk_bf16_f32 v71, v10, v11
  v_mfma_f32_32x32x16_bf16 v[20:35], a[252:255], v[64:67], v[20:35]
  v_cvt_pk_bf16_f32 v72, v12, v13
  v_cvt_pk_bf16_f32 v73, v14, v15
  v_cvt_pk_bf16_f32 v74, v16, v17
  v_cvt_pk_bf16_f32 v75, v18, v19
  v_xor_b32 v174, 0x10000, v174
  s_mov_b32 s91, s90
  s_mov_b32 s84, s95
  s_mov_b32 s95, s94
  s_nop 2
  v_cvt_pk_bf16_f32 v76, v20, v21
  v_cvt_pk_bf16_f32 v77, v22, v23
  v_cvt_pk_bf16_f32 v78, v24, v25
  v_cvt_pk_bf16_f32 v79, v26, v27
  v_cvt_pk_bf16_f32 v80, v28, v29
  v_cvt_pk_bf16_f32 v81, v30, v31
  v_cvt_pk_bf16_f32 v82, v32, v33
  v_cvt_pk_bf16_f32 v83, v34, v35
  s_cbranch_vccz r0_top
r0_miss:
  s_cmp_eq_u32 s71, 63
  s_cbranch_scc1 r0_drain
  s_mov_b32 m0, s82
  s_nop 0
  buffer_load_dwordx4 v172, s[4:7], s73 offen offset:0 sc1 lds
  s_add_u32 s70, s73, 0xfffffff0
  buffer_load_dwordx4 v172, s[4:7], s70 offen offset:1040 sc1 lds
  s_add_u32 s70, s73, 0xffffffe0
  buffer_load_dwordx4 v172, s[4:7], s70 offen offset:2080 sc1 lds
  s_add_u32 s70, s73, 0xffffffd0
  buffer_load_dwordx4 v172, s[4:7], s70 offen offset:3120 sc1 lds
  s_add_u32 m0, s82, 4160
  s_add_u32 s70, s73, 0x1000
  buffer_load_dwordx4 v172, s[4:7], s70 offen offset:0 sc1 lds
  s_add_u32 s70, s73, 0xff0
  buffer_load_dwordx4 v172, s[4:7], s70 offen offset:1040 sc1 lds
  s_add_u32 s70, s73, 0xfe0
  buffer_load_dwordx4 v172, s[4:7], s70 offen offset:2080 sc1 lds
  s_add_u32 s70, s73, 0xfd0
  buffer_load_dwordx4 v172, s[4:7], s70 offen offset:3120 sc1 lds
  buffer_store_dwordx4 v[68:71], v181, s[4:7], s91 offen offset:0 sc1
  buffer_store_dwordx4 v[72:75], v181, s[4:7], s91 offen offset:512 sc1
  s_add_u32 s80, s91, 8192
  buffer_store_dwordx4 v[76:79], v181, s[4:7], s80 offen offset:0 sc1
  buffer_store_dwordx4 v[80:83], v181, s[4:7], s80 offen offset:512 sc1
  s_waitcnt vmcnt(12)
  buffer_store_dword v183, v182, s[4:7], s84 offen sc1
  s_mov_b32 s84, s95
  s_mov_b32 s91, s52
  s_mov_b32 s95, s52
  s_waitcnt vmcnt(5)
  ds_read_b32 v164, v173 offset:0
  ds_read_b32 v165, v173 offset:1040
  ds_read_b32 v166, v173 offset:2080
  ds_read_b32 v167, v173 offset:3120
  ds_read_b32 v168, v173 offset:4160
  ds_read_b32 v169, v173 offset:5200
  ds_read_b32 v170, v173 offset:6240
  ds_read_b32 v171, v173 offset:7280
  s_waitcnt lgkmcnt(0)
  v_max3_u32 v1, v164, v166, v167
  v_max3_u32 v2, v165, v168, v169
  v_max3_u32 v1, v1, v170, v171
  v_max_u32 v1, v1, v2
  v_cmp_le_u32 vcc, s88, v1
  s_cbranch_vccz r0_top
r0_drain:
  buffer_store_dwordx4 v[68:71], v181, s[4:7], s91 offen offset:0 sc1
  buffer_store_dwordx4 v[72:75], v181, s[4:7], s91 offen offset:512 sc1
  s_add_u32 s80, s91, 8192
  buffer_store_dwordx4 v[76:79], v181, s[4:7], s80 offen offset:0 sc1
  buffer_store_dwordx4 v[80:83], v181, s[4:7], s80 offen offset:512 sc1
  s_waitcnt vmcnt(4)
  buffer_store_dword v183, v182, s[4:7], s84 offen sc1
  s_waitcnt vmcnt(1)
  buffer_store_dword v183, v182, s[4:7], s95 offen sc1
  s_mov_b32 s91, s52
  s_mov_b32 s95, s52
  s_mov_b32 s84, s52
  s_cmp_eq_u32 s71, 63
  s_cbranch_scc1 r0_last
r0_xpoll:
  s_mul_i32 s70, s48, 8448
  s_add_u32 s70, s70, s73
r0_xpk:
  s_sub_u32 s51, s51, 1
  s_cbranch_scc1 main_end
  buffer_load_dword v1, off, s[4:7], s70 offset:3072 sc1
  s_waitcnt vmcnt(0)
  v_cmp_eq_u32 vcc, -1, v1
  s_cbranch_vccnz r0_xpk
  s_mov_b32 m0, s82
  s_nop 0
  buffer_load_dwordx4 v172, s[4:7], s73 offen offset:0 sc1 lds
  s_add_u32 s70, s73, 0xfffffff0
  buffer_load_dwordx4 v172, s[4:7], s70 offen offset:1040 sc1 lds
  s_add_u32 s70, s73, 0xffffffe0
  buffer_load_dwordx4 v172, s[4:7], s70 offen offset:2080 sc1 lds
  s_add_u32 s70, s73, 0xffffffd0
  buffer_load_dwordx4 v172, s[4:7], s70 offen offset:3120 sc1 lds
  s_add_u32 m0, s82, 4160
  s_add_u32 s70, s73, 0x1000
  buffer_load_dwordx4 v172, s[4:7], s70 offen offset:0 sc1 lds
  s_add_u32 s70, s73, 0xff0
  buffer_load_dwordx4 v172, s[4:7], s70 offen offset:1040 sc1 lds
  s_add_u32 s70, s73, 0xfe0
  buffer_load_dwordx4 v172, s[4:7], s70 offen offset:2080 sc1 lds
  s_add_u32 s70, s73, 0xfd0
  buffer_load_dwordx4 v172, s[4:7], s70 offen offset:3120 sc1 lds
  s_waitcnt vmcnt(0)
  ds_read_b32 v164, v173 offset:0
  ds_read_b32 v165, v173 offset:1040
  ds_read_b32 v166, v173 offset:2080
  ds_read_b32 v167, v173 offset:3120
  ds_read_b32 v168, v173 offset:4160
  ds_read_b32 v169, v173 offset:5200
  ds_read_b32 v170, v173 offset:6240
  ds_read_b32 v171, v173 offset:7280
  s_waitcnt lgkmcnt(0)
  v_max3_u32 v1, v164, v166, v167
  v_max3_u32 v2, v165, v168, v169
  v_max3_u32 v1, v1, v170, v171
  v_max_u32 v1, v1, v2
  v_cmp_le_u32 vcc, s88, v1
  s_cbranch_vccnz r0_xpoll
  s_branch r0_top
r0_res:
  s_sub_u32 s51, s51, 1
  s_cbranch_scc1 main_end
  buffer_load_dwordx2 v[160:161], v175, s[4:7], s72 offen sc1
  s_waitcnt vmcnt(0)
  v_cmp_lt_u32 vcc, s93, v160
  s_cbranch_vccnz r0_res
  s_branch r0_res_ok
r0_red:
  s_mov_b64 exec, vcc
  buffer_load_dwordx4 v[96:99], v172, s[4:7], s78 offen offset:0 sc1
  buffer_load_dwordx4 v[100:103], v172, s[4:7], s78 offen offset:1024 sc1
  buffer_load_dwordx4 v[104:107], v172, s[4:7], s78 offen offset:2048 sc1
  buffer_load_dwordx4 v[108:111], v172, s[4:7], s78 offen offset:3072 sc1
  s_add_u32 s81, s78, 528384
  buffer_load_dwordx4 v[112:115], v172, s[4:7], s81 offen offset:0 sc1
  buffer_load_dwordx4 v[116:119], v172, s[4:7], s81 offen offset:1024 sc1
  buffer_load_dwordx4 v[120:123], v172, s[4:7], s81 offen offset:2048 sc1
  buffer_load_dwordx4 v[124:127], v172, s[4:7], s81 offen offset:3072 sc1
  s_sub_u32 s51, s51, 1
  s_cbranch_scc1 main_end
  s_waitcnt vmcnt(0)
  v_bitop3_b32 v144, v96, v100, s79 bitop3:0x7e
  v_bitop3_b32 v145, v104, v108, s79 bitop3:0x7e
  v_bitop3_b32 v146, v112, v116, s79 bitop3:0x7e
  v_bitop3_b32 v147, v120, v124, s79 bitop3:0x7e
  v_or3_b32 v144, v144, v145, v146
  v_bitop3_b32 v144, v144, v147, s92 bitop3:0xa8
  v_cmp_ne_u32 vcc, 0, v144
  s_cbranch_vccnz r0_red
  s_mov_b64 exec, -1
  v_mfma_f32_16x16x32_bf16 v[128:131], v[152:155], v[96:99], 0
  v_mfma_f32_16x16x32_bf16 v[128:131], v[152:155], v[100:103], v[128:131]
  v_mfma_f32_16x16x32_bf16 v[128:131], v[152:155], v[104:107], v[128:131]
  v_mfma_f32_16x16x32_bf16 v[128:131], v[152:155], v[108:111], v[128:131]
  v_mfma_f32_16x16x32_bf16 v[128:131], v[156:159], v[112:115], v[128:131]
  v_mfma_f32_16x16x32_bf16 v[128:131], v[156:159], v[116:119], v[128:131]
  v_mfma_f32_16x16x32_bf16 v[128:131], v[156:159], v[120:123], v[128:131]
  v_mfma_f32_16x16x32_bf16 v[128:131], v[156:159], v[124:127], v[128:131]
  s_branch r0_red_ok
r0_rese:
  s_sub_u32 s51, s51, 1
  s_cbranch_scc1 main_end
  buffer_load_dwordx2 v[160:161], v175, s[4:7], s72 offen sc1
  s_waitcnt vmcnt(0)
  v_cmp_lt_u32 vcc, s93, v160
  s_cbranch_vccnz r0_rese
  s_branch r0_rese_ok
r0_rede:
  s_mov_b64 exec, vcc
  buffer_load_dwordx4 v[96:99], v172, s[4:7], s78 offen offset:0 sc1
  buffer_load_dwordx4 v[100:103], v172, s[4:7], s78 offen offset:1024 sc1
  buffer_load_dwordx4 v[104:107], v172, s[4:7], s78 offen offset:2048 sc1
  buffer_load_dwordx4 v[108:111], v172, s[4:7], s78 offen offset:3072 sc1
  s_add_u32 s81, s78, 528384
  buffer_load_dwordx4 v[112:115], v172, s[4:7], s81 offen offset:0 sc1
  buffer_load_dwordx4 v[116:119], v172, s[4:7], s81 offen offset:1024 sc1
  buffer_load_dwordx4 v[120:123], v172, s[4:7], s81 offen offset:2048 sc1
  buffer_load_dwordx4 v[124:127], v172, s[4:7], s81 offen offset:3072 sc1
  s_sub_u32 s51, s51, 1
  s_cbranch_scc1 main_end
  s_waitcnt vmcnt(0)
  v_bitop3_b32 v144, v96, v100, s79 bitop3:0x7e
  v_bitop3_b32 v145, v104, v108, s79 bitop3:0x7e
  v_bitop3_b32 v146, v112, v116, s79 bitop3:0x7e
  v_bitop3_b32 v147, v120, v124, s79 bitop3:0x7e
  v_or3_b32 v144, v144, v145, v146
  v_bitop3_b32 v144, v144, v147, s92 bitop3:0xa8
  v_cmp_ne_u32 vcc, 0, v144
  s_cbranch_vccnz r0_rede
  s_mov_b64 exec, -1
  v_mfma_f32_16x16x32_bf16 v[128:131], v[152:155], v[96:99], 0
  v_mfma_f32_16x16x32_bf16 v[128:131], v[152:155], v[100:103], v[128:131]
  v_mfma_f32_16x16x32_bf16 v[128:131], v[152:155], v[104:107], v[128:131]
  v_mfma_f32_16x16x32_bf16 v[128:131], v[152:155], v[108:111], v[128:131]
  v_mfma_f32_16x16x32_bf16 v[128:131], v[156:159], v[112:115], v[128:131]
  v_mfma_f32_16x16x32_bf16 v[128:131], v[156:159], v[116:119], v[128:131]
  v_mfma_f32_16x16x32_bf16 v[128:131], v[156:159], v[120:123], v[128:131]
  v_mfma_f32_16x16x32_bf16 v[128:131], v[156:159], v[124:127], v[128:131]
  s_branch r0_rede_ok
r0_last:
r0_last2:
  s_barrier
  buffer_load_dwordx4 v[96:99], v172, s[4:7], s78 offen offset:0 sc1
  buffer_load_dwordx4 v[100:103], v172, s[4:7], s78 offen offset:1024 sc1
  buffer_load_dwordx4 v[104:107], v172, s[4:7], s78 offen offset:2048 sc1
  buffer_load_dwordx4 v[108:111], v172, s[4:7], s78 offen offset:3072 sc1
  s_add_u32 s81, s78, 528384
  buffer_load_dwordx4 v[112:115], v172, s[4:7], s81 offen offset:0 sc1
  buffer_load_dwordx4 v[116:119], v172, s[4:7], s81 offen offset:1024 sc1
  buffer_load_dwordx4 v[120:123], v172, s[4:7], s81 offen offset:2048 sc1
  buffer_load_dwordx4 v[124:127], v172, s[4:7], s81 offen offset:3072 sc1
  s_waitcnt vmcnt(10)
  v_cmp_lt_u32 vcc, s93, v160
  s_cbranch_vccnz r0_rese
r0_rese_ok:
  v_lshlrev_b32 v140, 16, v160
  v_and_b32 v141, 0xffff0000, v160
  v_lshlrev_b32 v142, 16, v161
  v_and_b32 v143, 0xffff0000, v161
  s_waitcnt vmcnt(7)
  v_mfma_f32_16x16x32_bf16 v[128:131], v[152:155], v[96:99], 0
  s_waitcnt vmcnt(6)
  v_mfma_f32_16x16x32_bf16 v[128:131], v[152:155], v[100:103], v[128:131]
  v_bitop3_b32 v144, v96, v100, s79 bitop3:0x7e
  s_waitcnt vmcnt(5)
  v_mfma_f32_16x16x32_bf16 v[128:131], v[152:155], v[104:107], v[128:131]
  s_waitcnt vmcnt(4)
  v_mfma_f32_16x16x32_bf16 v[128:131], v[152:155], v[108:111], v[128:131]
  v_bitop3_b32 v145, v104, v108, s79 bitop3:0x7e
  s_waitcnt vmcnt(3)
  v_mfma_f32_16x16x32_bf16 v[128:131], v[156:159], v[112:115], v[128:131]
  s_waitcnt vmcnt(2)
  v_mfma_f32_16x16x32_bf16 v[128:131], v[156:159], v[116:119], v[128:131]
  v_bitop3_b32 v146, v112, v116, s79 bitop3:0x7e
  s_waitcnt vmcnt(1)
  v_mfma_f32_16x16x32_bf16 v[128:131], v[156:159], v[120:123], v[128:131]
  s_waitcnt vmcnt(0)
  v_mfma_f32_16x16x32_bf16 v[128:131], v[156:159], v[124:127], v[128:131]
  v_bitop3_b32 v147, v120, v124, s79 bitop3:0x7e
  v_or3_b32 v144, v144, v145, v146
  v_bitop3_b32 v144, v144, v147, s92 bitop3:0xa8
  v_cmp_ne_u32 vcc, 0, v144
  s_cbranch_vccnz r0_rede
r0_rede_ok:
  buffer_store_dword v186, v184, s[4:7], 0 offen
  buffer_store_dword v186, v187, s[4:7], 0 offen sc1
  s_nop 4
  v_cvt_pk_bf16_f32 v138, v128, v129
  v_cvt_pk_bf16_f32 v139, v130, v131
  v_lshlrev_b32 v132, 16, v138
  v_and_b32 v133, 0xffff0000, v138
  v_lshlrev_b32 v134, 16, v139
  v_and_b32 v135, 0xffff0000, v139
  v_add_f32 v132, v132, v140
  v_add_f32 v133, v133, v141
  v_add_f32 v134, v134, v142
  v_add_f32 v135, v135, v143
  v_cvt_pk_bf16_f32 v138, v132, v133
  v_cvt_pk_bf16_f32 v139, v134, v135
  v_lshlrev_b32 v132, 16, v138
  v_and_b32 v133, 0xffff0000, v138
  v_lshlrev_b32 v134, 16, v139
  v_and_b32 v135, 0xffff0000, v139
  v_mul_f32 v145, v132, v132
  v_add_f32 v144, v132, v133
  v_fmac_f32 v145, v133, v133
  v_add_f32 v146, v134, v135
  v_fmac_f32 v145, v134, v134
  v_add_f32 v144, v144, v146
  v_fmac_f32 v145, v135, v135
  v_min_u32 v138, -2, v138
  s_nop 0
  v_permlane16_swap_b32 v144, v145
  v_add_f32 v144, v144, v145
  s_nop 1
  v_add_f32_dpp v144, v144, v144 row_ror:8 row_mask:0xf bank_mask:0xf
  s_nop 1
  v_add_f32_dpp v144, v144, v144 row_ror:4 row_mask:0xf bank_mask:0xf
  s_nop 1
  v_add_f32_dpp v144, v144, v144 row_ror:2 row_mask:0xf bank_mask:0xf
  s_nop 1
  v_add_f32_dpp v144, v144, v144 row_ror:1 row_mask:0xf bank_mask:0xf
  ds_write_b32 v177, v144
  s_add_u32 s83, s83, 1
  s_max_i32 s79, s83, 0
  s_lshl_b32 s72, s79, 16
  s_and_b32 s78, s79, 1
  s_lshl_b32 s78, s78, 21
  s_add_u32 s78, s78, s77
  s_lshr_b32 s79, s79, 1
  s_add_u32 s72, s72, s86
  s_cmp_lt_i32 s83, 0
  s_cselect_b32 s92, 0, 1
  s_cselect_b32 s93, -1, -2
  v_add_u32 v186, s92, v186
  buffer_load_dwordx2 v[160:161], v175, s[4:7], s72 offen sc1
  s_waitcnt lgkmcnt(0)
  s_barrier
  ds_read_b128 v[144:147], v178 offset:33792
  ds_read_b128 v[148:151], v178 offset:33808
  s_waitcnt lgkmcnt(0)
  v_add_f32 v144, v144, v146
  v_add_f32 v145, v145, v147
  v_add_f32 v148, v148, v150
  v_add_f32 v149, v149, v151
  v_add_f32 v144, v144, v148
  v_add_f32 v145, v145, v149
  v_mul_f32 v144, 0x3b000000, v144
  v_mul_f32 v145, 0x3b000000, v145
  v_fma_f32 v145, -v144, v144, v145
  v_max_f32 v145, 0, v145
  v_cvt_pk_bf16_f32 v146, v144, v145
  v_and_b32 v145, 0xffff0000, v146
  v_add_f32 v145, 0x3727c5ac, v145
  v_cvt_pk_bf16_f32 v145, v145, v145
  v_lshlrev_b32 v145, 16, v145
  v_sqrt_f32 v145, v145
  v_lshlrev_b32 v144, 16, v146
  v_cvt_pk_bf16_f32 v145, v145, v145
  v_sub_f32 v132, v132, v144
  v_lshlrev_b32 v145, 16, v145
  v_sub_f32 v133, v133, v144
  v_rcp_f32 v145, v145
  v_sub_f32 v134, v134, v144
  v_sub_f32 v135, v135, v144
  v_cvt_pk_bf16_f32 v148, v132, v133
  v_cvt_pk_bf16_f32 v149, v134, v135
  v_lshlrev_b32 v132, 16, v148
  v_and_b32 v133, 0xffff0000, v148
  v_lshlrev_b32 v134, 16, v149
  v_and_b32 v135, 0xffff0000, v149
  v_mul_f32 v132, v132, v145
  v_mul_f32 v133, v133, v145
  v_mul_f32 v134, v134, v145
  v_mul_f32 v135, v135, v145
  v_cvt_pk_bf16_f32 v136, v132, v133
  v_cvt_pk_bf16_f32 v137, v134, v135
  v_min_u32 v136, -2, v136
  s_nop 0
  v_permlane16_swap_b32 v137, v139
  v_permlane16_swap_b32 v136, v138
  buffer_store_dwordx4 v[136:139], v176, s[4:7], s75 offen sc1
  v_mov_b32 v144, -1
  v_mov_b32 v145, -1
  v_mov_b32 v146, -1
  v_mov_b32 v147, -1
  buffer_store_dwordx4 v[144:147], v176, s[4:7], s76 offen sc1
  s_add_u32 s75, s72, 0x400000
  s_add_u32 s76, s75, 0x20000
  s_cmp_lt_i32 s83, 62
  s_cselect_b32 s76, s76, s52
  s_cmp_lt_i32 s83, 0
  s_cselect_b32 s75, s52, s75
  s_cmp_lt_i32 s83, 64
  s_cbranch_scc1 r0_last2
  s_endpgm
r1_top:
  s_barrier
  ds_read_b128 v[36:39], v174 offset:0
  ds_read_b128 v[40:43], v174 offset:32
  ds_read_b128 v[44:47], v174 offset:64
  ds_read_b128 v[48:51], v174 offset:96
  buffer_load_dwordx4 v[96:99], v172, s[4:7], s78 offen offset:0 sc1
  ds_read_b128 v[52:55], v174 offset:128
  s_add_u32 s71, s71, 1
  s_cmp_eq_u32 s71, 63
  s_cselect_b32 s88, 0, -1
  ds_read_b128 v[56:59], v174 offset:160
  s_add_u32 s73, s73, 0x10000
  s_min_u32 s73, s73, s74
  v_xor_b32 v173, 0x10000, v173
  s_xor_b32 s82, s82, 0x10000
  ds_read_b128 v[60:63], v174 offset:192
  ds_read_b128 v[64:67], v174 offset:224
  s_add_u32 s90, s90, 0x40000
  s_add_u32 s94, s94, 2048
  buffer_load_dwordx4 v[100:103], v172, s[4:7], s78 offen offset:1024 sc1
  s_waitcnt lgkmcnt(7)
  v_mfma_f32_32x32x16_bf16 v[4:19], a[0:3], v[36:39], 0
  s_waitcnt lgkmcnt(6)
  s_waitcnt lgkmcnt(5)
  s_waitcnt lgkmcnt(4)
  s_waitcnt lgkmcnt(3)
  s_add_u32 s81, s78, 528384
  v_mfma_f32_32x32x16_bf16 v[4:19], a[4:7], v[40:43], v[4:19]
  buffer_load_dwordx4 v[104:107], v172, s[4:7], s78 offen offset:2048 sc1
  s_waitcnt lgkmcnt(2)
  s_waitcnt lgkmcnt(1)
  v_mfma_f32_32x32x16_bf16 v[4:19], a[8:11], v[44:47], v[4:19]
  v_mfma_f32_32x32x16_bf16 v[4:19], a[12:15], v[48:51], v[4:19]
  buffer_load_dwordx4 v[108:111], v172, s[4:7], s78 offen offset:3072 sc1
  s_waitcnt lgkmcnt(0)
  v_mfma_f32_32x32x16_bf16 v[4:19], a[16:19], v[52:55], v[4:19]
  v_mfma_f32_32x32x16_bf16 v[20:35], a[128:131], v[36:39], 0
  buffer_load_dwordx4 v[112:115], v172, s[4:7], s81 offen offset:0 sc1
  ds_read_b128 v[36:39], v174 offset:256
  v_mfma_f32_32x32x16_bf16 v[4:19], a[20:23], v[56:59], v[4:19]
  v_mfma_f32_32x32x16_bf16 v[20:35], a[132:135], v[40:43], v[20:35]
  buffer_load_dwordx4 v[116:119], v172, s[4:7], s81 offen offset:1024 sc1
  ds_read_b128 v[40:43], v174 offset:288
  v_mfma_f32_32x32x16_bf16 v[4:19], a[24:27], v[60:63], v[4:19]
  s_waitcnt lgkmcnt(1)
  v_mfma_f32_32x32x16_bf16 v[20:35], a[136:139], v[44:47], v[20:35]
  buffer_load_dwordx4 v[120:123], v172, s[4:7], s81 offen offset:2048 sc1
  ds_read_b128 v[44:47], v174 offset:320
  v_mfma_f32_32x32x16_bf16 v[4:19], a[28:31], v[64:67], v[4:19]
  s_waitcnt lgkmcnt(1)
  v_mfma_f32_32x32x16_bf16 v[20:35], a[140:143], v[48:51], v[20:35]
  buffer_load_dwordx4 v[124:127], v172, s[4:7], s81 offen offset:3072 sc1
  ds_read_b128 v[48:51], v174 offset:352
  v_mfma_f32_32x32x16_bf16 v[4:19], a[32:35], v[36:39], v[4:19]
  s_waitcnt lgkmcnt(1)
  v_mfma_f32_32x32x16_bf16 v[20:35], a[144:147], v[52:55], v[20:35]
  ds_read_b128 v[52:55], v174 offset:384
  v_mfma_f32_32x32x16_bf16 v[4:19], a[36:39], v[40:43], v[4:19]
  v_mfma_f32_32x32x16_bf16 v[20:35], a[148:151], v[56:59], v[20:35]
  ds_read_b128 v[56:59], v174 offset:416
  s_waitcnt vmcnt(8)
  v_cmp_lt_u32 vcc, s93, v160
  v_mfma_f32_32x32x16_bf16 v[4:19], a[40:43], v[44:47], v[4:19]
  s_cbranch_vccnz r1_res
r1_res_ok:
  v_lshlrev_b32 v140, 16, v160
  v_and_b32 v141, 0xffff0000, v160
  v_lshlrev_b32 v142, 16, v161
  v_and_b32 v143, 0xffff0000, v161
  v_mfma_f32_32x32x16_bf16 v[20:35], a[152:155], v[60:63], v[20:35]
  s_waitcnt vmcnt(7)
  ds_read_b128 v[60:63], v174 offset:448
  s_waitcnt vmcnt(6)
  v_bitop3_b32 v144, v96, v100, s79 bitop3:0x7e
  s_waitcnt lgkmcnt(3)
  v_mfma_f32_16x16x32_bf16 v[128:131], v[152:155], v[96:99], 0
  s_waitcnt vmcnt(5)
  v_mfma_f32_16x16x32_bf16 v[128:131], v[152:155], v[100:103], v[128:131]
  s_waitcnt vmcnt(4)
  v_bitop3_b32 v145, v104, v108, s79 bitop3:0x7e
  v_mfma_f32_16x16x32_bf16 v[128:131], v[152:155], v[104:107], v[128:131]
  v_mfma_f32_16x16x32_bf16 v[128:131], v[152:155], v[108:111], v[128:131]
  s_waitcnt vmcnt(3)
  v_mfma_f32_32x32x16_bf16 v[4:19], a[44:47], v[48:51], v[4:19]
  s_waitcnt vmcnt(2)
  v_bitop3_b32 v146, v112, v116, s79 bitop3:0x7e
  v_or3_b32 v144, v144, v145, v146
  v_mfma_f32_16x16x32_bf16 v[128:131], v[156:159], v[112:115], v[128:131]
  s_waitcnt vmcnt(1)
  v_mfma_f32_16x16x32_bf16 v[128:131], v[156:159], v[116:119], v[128:131]
  s_waitcnt lgkmcnt(2)
  v_mfma_f32_16x16x32_bf16 v[128:131], v[156:159], v[120:123], v[128:131]
  v_mfma_f32_32x32x16_bf16 v[20:35], a[156:159], v[64:67], v[20:35]
  ds_read_b128 v[64:67], v174 offset:480
  s_waitcnt vmcnt(0)
  v_bitop3_b32 v147, v120, v124, s79 bitop3:0x7e
  v_bitop3_b32 v144, v144, v147, s92 bitop3:0xa8
  v_cmp_ne_u32 vcc, 0, v144
  s_mov_b32 m0, s82
  v_mfma_f32_16x16x32_bf16 v[128:131], v[156:159], v[124:127], v[128:131]
  s_cbranch_vccnz r1_red
r1_red_ok:
  v_mfma_f32_32x32x16_bf16 v[4:19], a[48:51], v[52:55], v[4:19]
  buffer_store_dword v186, v184, s[4:7], 0 offen
  buffer_store_dword v186, v187, s[4:7], 0 offen sc1
  v_mfma_f32_32x32x16_bf16 v[20:35], a[160:163], v[36:39], v[20:35]
  buffer_load_dwordx4 v172, s[4:7], s73 offen offset:0 sc1 lds
  ds_read_b128 v[36:39], v174 offset:512
  s_add_u32 s83, s83, 1
  v_cvt_pk_bf16_f32 v138, v128, v129
  s_waitcnt lgkmcnt(3)
  v_mfma_f32_32x32x16_bf16 v[4:19], a[52:55], v[56:59], v[4:19]
  s_max_i32 s79, s83, 0
  v_cvt_pk_bf16_f32 v139, v130, v131
  v_lshlrev_b32 v132, 16, v138
  v_and_b32 v133, 0xffff0000, v138
  v_lshlrev_b32 v134, 16, v139
  v_and_b32 v135, 0xffff0000, v139
  v_add_f32 v132, v132, v140
  v_add_f32 v133, v133, v141
  v_add_f32 v134, v134, v142
  v_add_f32 v135, v135, v143
  v_cvt_pk_bf16_f32 v138, v132, v133
  v_cvt_pk_bf16_f32 v139, v134, v135
  s_lshl_b32 s72, s79, 16
  s_waitcnt lgkmcnt(2)
  v_mfma_f32_32x32x16_bf16 v[4:19], a[56:59], v[60:63], v[4:19]
  s_and_b32 s78, s79, 3
  s_lshl_b32 s78, s78, 21
  s_add_u32 s78, s78, s77
  s_add_u32 s70, s73, 0xfffffff0
  v_permlane16_swap_b32 v137, v139
  v_permlane16_swap_b32 v136, v138
  v_mfma_f32_32x32x16_bf16 v[20:35], a[164:167], v[40:43], v[20:35]
  buffer_load_dwordx4 v172, s[4:7], s70 offen offset:1040 sc1 lds
  ds_read_b128 v[40:43], v174 offset:544
  s_lshr_b32 s79, s79, 2
  s_add_u32 s72, s72, s86
  s_cmp_lt_i32 s83, 0
  s_cselect_b32 s92, 0, 1
  s_cselect_b32 s93, -1, -2
  s_waitcnt lgkmcnt(2)
  v_mfma_f32_32x32x16_bf16 v[4:19], a[60:63], v[64:67], v[4:19]
  s_add_u32 s70, s73, 0xffffffe0
  v_add_u32 v186, s92, v186
  s_cmp_lt_i32 s83, 0
  s_cselect_b32 s76, 0x40000000, 0
  v_mfma_f32_32x32x16_bf16 v[20:35], a[168:171], v[44:47], v[20:35]
  buffer_load_dwordx4 v172, s[4:7], s70 offen offset:2080 sc1 lds
  ds_read_b128 v[44:47], v174 offset:576
  s_add_u32 s70, s73, 0xffffffd0
  s_waitcnt lgkmcnt(2)
  v_mfma_f32_32x32x16_bf16 v[4:19], a[64:67], v[36:39], v[4:19]
  buffer_store_dwordx4 v[136:139], v185, s[32:35], s75 offen
  v_or_b32 v185, s76, v176
  s_sub_u32 s75, s72, s86
  s_lshr_b32 s75, s75, 1
  s_waitcnt lgkmcnt(1)
  v_mfma_f32_32x32x16_bf16 v[20:35], a[172:175], v[48:51], v[20:35]
  buffer_load_dwordx4 v172, s[4:7], s70 offen offset:3120 sc1 lds
  v_mfma_f32_32x32x16_bf16 v[4:19], a[68:71], v[40:43], v[4:19]
  ds_read_b128 v[48:51], v174 offset:608
  s_add_u32 m0, s82, 4160
  s_add_u32 s70, s73, 0x1000
  s_waitcnt lgkmcnt(1)
  v_mfma_f32_32x32x16_bf16 v[20:35], a[176:179], v[52:55], v[20:35]
  buffer_load_dwordx4 v172, s[4:7], s70 offen offset:0 sc1 lds
  v_mfma_f32_32x32x16_bf16 v[4:19], a[72:75], v[44:47], v[4:19]
  ds_read_b128 v[52:55], v174 offset:640
  s_add_u32 s70, s73, 0xff0
  v_mfma_f32_32x32x16_bf16 v[20:35], a[180:183], v[56:59], v[20:35]
  buffer_load_dwordx4 v172, s[4:7], s70 offen offset:1040 sc1 lds
  s_waitcnt lgkmcnt(1)
  v_mfma_f32_32x32x16_bf16 v[4:19], a[76:79], v[48:51], v[4:19]
  ds_read_b128 v[56:59], v174 offset:672
  s_add_u32 s70, s73, 0xfe0
  v_mfma_f32_32x32x16_bf16 v[20:35], a[184:187], v[60:63], v[20:35]
  buffer_load_dwordx4 v172, s[4:7], s70 offen offset:2080 sc1 lds
  s_waitcnt lgkmcnt(1)
  v_mfma_f32_32x32x16_bf16 v[4:19], a[80:83], v[52:55], v[4:19]
  ds_read_b128 v[60:63], v174 offset:704
  s_add_u32 s70, s73, 0xfd0
  v_mfma_f32_32x32x16_bf16 v[20:35], a[188:191], v[64:67], v[20:35]
  buffer_load_dwordx4 v172, s[4:7], s70 offen offset:3120 sc1 lds
  s_waitcnt lgkmcnt(1)
  v_mfma_f32_32x32x16_bf16 v[20:35], a[192:195], v[36:39], v[20:35]
  ds_read_b128 v[64:67], v174 offset:736
  ds_read_b128 v[36:39], v174 offset:768
  v_mfma_f32_32x32x16_bf16 v[4:19], a[84:87], v[56:59], v[4:19]
  s_waitcnt lgkmcnt(2)
  buffer_store_dword v183, v182, s[4:7], s84 offen sc1
  v_mfma_f32_32x32x16_bf16 v[20:35], a[196:199], v[40:43], v[20:35]
  buffer_store_dwordx4 v[68:71], v181, s[4:7], s91 offen offset:0 sc1
  ds_read_b128 v[40:43], v174 offset:800
  s_add_u32 s80, s91, 8192
  s_waitcnt lgkmcnt(2)
  v_mfma_f32_32x32x16_bf16 v[4:19], a[88:91], v[60:63], v[4:19]
  s_waitcnt lgkmcnt(1)
  v_mfma_f32_32x32x16_bf16 v[20:35], a[200:203], v[44:47], v[20:35]
  ds_read_b128 v[44:47], v174 offset:832
  v_mfma_f32_32x32x16_bf16 v[4:19], a[92:95], v[64:67], v[4:19]
  buffer_store_dwordx4 v[72:75], v181, s[4:7], s91 offen offset:512 sc1
  s_waitcnt lgkmcnt(1)
  v_mfma_f32_32x32x16_bf16 v[20:35], a[204:207], v[48:51], v[20:35]
  ds_read_b128 v[48:51], v174 offset:864
  v_mfma_f32_32x32x16_bf16 v[4:19], a[96:99], v[36:39], v[4:19]
  s_waitcnt lgkmcnt(1)
  v_mfma_f32_32x32x16_bf16 v[20:35], a[208:211], v[52:55], v[20:35]
  buffer_store_dwordx4 v[76:79], v181, s[4:7], s80 offen offset:0 sc1
  ds_read_b128 v[52:55], v174 offset:896
  v_mfma_f32_32x32x16_bf16 v[4:19], a[100:103], v[40:43], v[4:19]
  s_waitcnt lgkmcnt(1)
  v_mfma_f32_32x32x16_bf16 v[20:35], a[212:215], v[56:59], v[20:35]
  ds_read_b128 v[56:59], v174 offset:928
  v_mfma_f32_32x32x16_bf16 v[4:19], a[104:107], v[44:47], v[4:19]
  buffer_store_dwordx4 v[80:83], v181, s[4:7], s80 offen offset:512 sc1
  s_waitcnt lgkmcnt(1)
  v_mfma_f32_32x32x16_bf16 v[20:35], a[216:219], v[60:63], v[20:35]
  ds_read_b128 v[60:63], v174 offset:960
  v_mfma_f32_32x32x16_bf16 v[4:19], a[108:111], v[48:51], v[4:19]
  s_waitcnt lgkmcnt(1)
  buffer_load_dwordx2 v[160:161], v175, s[4:7], s72 offen sc1
  v_mfma_f32_32x32x16_bf16 v[20:35], a[220:223], v[64:67], v[20:35]
  ds_read_b128 v[64:67], v174 offset:992
  v_mfma_f32_32x32x16_bf16 v[4:19], a[112:115], v[52:55], v[4:19]
  s_waitcnt lgkmcnt(1)
  v_mfma_f32_32x32x16_bf16 v[20:35], a[224:227], v[36:39], v[20:35]
  v_mfma_f32_32x32x16_bf16 v[4:19], a[116:119], v[56:59], v[4:19]
  s_waitcnt lgkmcnt(0)
  v_mfma_f32_32x32x16_bf16 v[20:35], a[228:231], v[40:43], v[20:35]
  v_mfma_f32_32x32x16_bf16 v[4:19], a[120:123], v[60:63], v[4:19]
  v_mfma_f32_32x32x16_bf16 v[20:35], a[232:235], v[44:47], v[20:35]
  s_waitcnt vmcnt(6)
  ds_read_b32 v164, v173 offset:0
  ds_read_b32 v165, v173 offset:1040
  ds_read_b32 v166, v173 offset:2080
  ds_read_b32 v167, v173 offset:3120
  ds_read_b32 v168, v173 offset:4160
  ds_read_b32 v169, v173 offset:5200
  v_mfma_f32_32x32x16_bf16 v[4:19], a[124:127], v[64:67], v[4:19]
  ds_read_b32 v170, v173 offset:6240
  ds_read_b32 v171, v173 offset:7280
  v_mfma_f32_32x32x16_bf16 v[20:35], a[236:239], v[48:51], v[20:35]
  v_mfma_f32_32x32x16_bf16 v[20:35], a[240:243], v[52:55], v[20:35]
  v_mfma_f32_32x32x16_bf16 v[20:35], a[244:247], v[56:59], v[20:35]
  s_waitcnt lgkmcnt(0)
  v_max3_u32 v1, v164, v166, v167
  v_max3_u32 v2, v165, v168, v169
  v_max3_u32 v1, v1, v170, v171
  v_mfma_f32_32x32x16_bf16 v[20:35], a[248:251], v[60:63], v[20:35]
  v_max_u32 v1, v1, v2
  v_cmp_le_u32 vcc, s88, v1
  v_cvt_pk_bf16_f32 v68, v4, v5
  v_cvt_pk_bf16_f32 v69, v6, v7
  v_cvt_pk_bf16_f32 v70, v8, v9
  v_cvt_pk_bf16_f32 v71, v10, v11
  v_mfma_f32_32x32x16_bf16 v[20:35], a[252:255], v[64:67], v[20:35]
  v_cvt_pk_bf16_f32 v72, v12, v13
  v_cvt_pk_bf16_f32 v73, v14, v15
  v_cvt_pk_bf16_f32 v74, v16, v17
  v_cvt_pk_bf16_f32 v75, v18, v19
  v_xor_b32 v174, 0x10000, v174
  s_mov_b32 s91, s90
  s_mov_b32 s84, s95
  s_mov_b32 s95, s94
  s_nop 2
  v_cvt_pk_bf16_f32 v76, v20, v21
  v_cvt_pk_bf16_f32 v77, v22, v23
  v_cvt_pk_bf16_f32 v78, v24, v25
  v_cvt_pk_bf16_f32 v79, v26, v27
  v_cvt_pk_bf16_f32 v80, v28, v29
  v_cvt_pk_bf16_f32 v81, v30, v31
  v_cvt_pk_bf16_f32 v82, v32, v33
  v_cvt_pk_bf16_f32 v83, v34, v35
  s_cbranch_vccz r1_top
r1_miss:
  s_cmp_eq_u32 s71, 63
  s_cbranch_scc1 r1_drain
  s_mov_b32 m0, s82
  s_nop 0
  buffer_load_dwordx4 v172, s[4:7], s73 offen offset:0 sc1 lds
  s_add_u32 s70, s73, 0xfffffff0
  buffer_load_dwordx4 v172, s[4:7], s70 offen offset:1040 sc1 lds
  s_add_u32 s70, s73, 0xffffffe0
  buffer_load_dwordx4 v172, s[4:7], s70 offen offset:2080 sc1 lds
  s_add_u32 s70, s73, 0xffffffd0
  buffer_load_dwordx4 v172, s[4:7], s70 offen offset:3120 sc1 lds
  s_add_u32 m0, s82, 4160
  s_add_u32 s70, s73, 0x1000
  buffer_load_dwordx4 v172, s[4:7], s70 offen offset:0 sc1 lds
  s_add_u32 s70, s73, 0xff0
  buffer_load_dwordx4 v172, s[4:7], s70 offen offset:1040 sc1 lds
  s_add_u32 s70, s73, 0xfe0
  buffer_load_dwordx4 v172, s[4:7], s70 offen offset:2080 sc1 lds
  s_add_u32 s70, s73, 0xfd0
  buffer_load_dwordx4 v172, s[4:7], s70 offen offset:3120 sc1 lds
  buffer_store_dwordx4 v[68:71], v181, s[4:7], s91 offen offset:0 sc1
  buffer_store_dwordx4 v[72:75], v181, s[4:7], s91 offen offset:512 sc1
  s_add_u32 s80, s91, 8192
  buffer_store_dwordx4 v[76:79], v181, s[4:7], s80 offen offset:0 sc1
  buffer_store_dwordx4 v[80:83], v181, s[4:7], s80 offen offset:512 sc1
  s_waitcnt vmcnt(12)
  buffer_store_dword v183, v182, s[4:7], s84 offen sc1
  s_mov_b32 s84, s95
  s_mov_b32 s91, s52
  s_mov_b32 s95, s52
  s_waitcnt vmcnt(5)
  ds_read_b32 v164, v173 offset:0
  ds_read_b32 v165, v173 offset:1040
  ds_read_b32 v166, v173 offset:2080
  ds_read_b32 v167, v173 offset:3120
  ds_read_b32 v168, v173 offset:4160
  ds_read_b32 v169, v173 offset:5200
  ds_read_b32 v170, v173 offset:6240
  ds_read_b32 v171, v173 offset:7280
  s_waitcnt lgkmcnt(0)
  v_max3_u32 v1, v164, v166, v167
  v_max3_u32 v2, v165, v168, v169
  v_max3_u32 v1, v1, v170, v171
  v_max_u32 v1, v1, v2
  v_cmp_le_u32 vcc, s88, v1
  s_cbranch_vccz r1_top
r1_drain:
  buffer_store_dwordx4 v[68:71], v181, s[4:7], s91 offen offset:0 sc1
  buffer_store_dwordx4 v[72:75], v181, s[4:7], s91 offen offset:512 sc1
  s_add_u32 s80, s91, 8192
  buffer_store_dwordx4 v[76:79], v181, s[4:7], s80 offen offset:0 sc1
  buffer_store_dwordx4 v[80:83], v181, s[4:7], s80 offen offset:512 sc1
  s_waitcnt vmcnt(4)
  buffer_store_dword v183, v182, s[4:7], s84 offen sc1
  s_waitcnt vmcnt(1)
  buffer_store_dword v183, v182, s[4:7], s95 offen sc1
  s_mov_b32 s91, s52
  s_mov_b32 s95, s52
  s_mov_b32 s84, s52
  s_cmp_eq_u32 s71, 63
  s_cbranch_scc1 r1_last
r1_xpoll:
  s_mul_i32 s70, s48, 8448
  s_add_u32 s70, s70, s73
r1_xpk:
  s_sub_u32 s51, s51, 1
  s_cbranch_scc1 main_end
  buffer_load_dword v1, off, s[4:7], s70 offset:3072 sc1
  s_waitcnt vmcnt(0)
  v_cmp_eq_u32 vcc, -1, v1
  s_cbranch_vccnz r1_xpk
  s_mov_b32 m0, s82
  s_nop 0
  buffer_load_dwordx4 v172, s[4:7], s73 offen offset:0 sc1 lds
  s_add_u32 s70, s73, 0xfffffff0
  buffer_load_dwordx4 v172, s[4:7], s70 offen offset:1040 sc1 lds
  s_add_u32 s70, s73, 0xffffffe0
  buffer_load_dwordx4 v172, s[4:7], s70 offen offset:2080 sc1 lds
  s_add_u32 s70, s73, 0xffffffd0
  buffer_load_dwordx4 v172, s[4:7], s70 offen offset:3120 sc1 lds
  s_add_u32 m0, s82, 4160
  s_add_u32 s70, s73, 0x1000
  buffer_load_dwordx4 v172, s[4:7], s70 offen offset:0 sc1 lds
  s_add_u32 s70, s73, 0xff0
  buffer_load_dwordx4 v172, s[4:7], s70 offen offset:1040 sc1 lds
  s_add_u32 s70, s73, 0xfe0
  buffer_load_dwordx4 v172, s[4:7], s70 offen offset:2080 sc1 lds
  s_add_u32 s70, s73, 0xfd0
  buffer_load_dwordx4 v172, s[4:7], s70 offen offset:3120 sc1 lds
  s_waitcnt vmcnt(0)
  ds_read_b32 v164, v173 offset:0
  ds_read_b32 v165, v173 offset:1040
  ds_read_b32 v166, v173 offset:2080
  ds_read_b32 v167, v173 offset:3120
  ds_read_b32 v168, v173 offset:4160
  ds_read_b32 v169, v173 offset:5200
  ds_read_b32 v170, v173 offset:6240
  ds_read_b32 v171, v173 offset:7280
  s_waitcnt lgkmcnt(0)
  v_max3_u32 v1, v164, v166, v167
  v_max3_u32 v2, v165, v168, v169
  v_max3_u32 v1, v1, v170, v171
  v_max_u32 v1, v1, v2
  v_cmp_le_u32 vcc, s88, v1
  s_cbranch_vccnz r1_xpoll
  s_branch r1_top
r1_res:
  s_sub_u32 s51, s51, 1
  s_cbranch_scc1 main_end
  buffer_load_dwordx2 v[160:161], v175, s[4:7], s72 offen sc1
  s_waitcnt vmcnt(0)
  v_cmp_lt_u32 vcc, s93, v160
  s_cbranch_vccnz r1_res
  s_branch r1_res_ok
r1_red:
  s_mov_b64 exec, vcc
  buffer_load_dwordx4 v[96:99], v172, s[4:7], s78 offen offset:0 sc1
  buffer_load_dwordx4 v[100:103], v172, s[4:7], s78 offen offset:1024 sc1
  buffer_load_dwordx4 v[104:107], v172, s[4:7], s78 offen offset:2048 sc1
  buffer_load_dwordx4 v[108:111], v172, s[4:7], s78 offen offset:3072 sc1
  s_add_u32 s81, s78, 528384
  buffer_load_dwordx4 v[112:115], v172, s[4:7], s81 offen offset:0 sc1
  buffer_load_dwordx4 v[116:119], v172, s[4:7], s81 offen offset:1024 sc1
  buffer_load_dwordx4 v[120:123], v172, s[4:7], s81 offen offset:2048 sc1
  buffer_load_dwordx4 v[124:127], v172, s[4:7], s81 offen offset:3072 sc1
  s_sub_u32 s51, s51, 1
  s_cbranch_scc1 main_end
  s_waitcnt vmcnt(0)
  v_bitop3_b32 v144, v96, v100, s79 bitop3:0x7e
  v_bitop3_b32 v145, v104, v108, s79 bitop3:0x7e
  v_bitop3_b32 v146, v112, v116, s79 bitop3:0x7e
  v_bitop3_b32 v147, v120, v124, s79 bitop3:0x7e
  v_or3_b32 v144, v144, v145, v146
  v_bitop3_b32 v144, v144, v147, s92 bitop3:0xa8
  v_cmp_ne_u32 vcc, 0, v144
  s_cbranch_vccnz r1_red
  s_mov_b64 exec, -1
  v_mfma_f32_16x16x32_bf16 v[128:131], v[152:155], v[96:99], 0
  v_mfma_f32_16x16x32_bf16 v[128:131], v[152:155], v[100:103], v[128:131]
  v_mfma_f32_16x16x32_bf16 v[128:131], v[152:155], v[104:107], v[128:131]
  v_mfma_f32_16x16x32_bf16 v[128:131], v[152:155], v[108:111], v[128:131]
  v_mfma_f32_16x16x32_bf16 v[128:131], v[156:159], v[112:115], v[128:131]
  v_mfma_f32_16x16x32_bf16 v[128:131], v[156:159], v[116:119], v[128:131]
  v_mfma_f32_16x16x32_bf16 v[128:131], v[156:159], v[120:123], v[128:131]
  v_mfma_f32_16x16x32_bf16 v[128:131], v[156:159], v[124:127], v[128:131]
  s_branch r1_red_ok
r1_rese:
  s_sub_u32 s51, s51, 1
  s_cbranch_scc1 main_end
  buffer_load_dwordx2 v[160:161], v175, s[4:7], s72 offen sc1
  s_waitcnt vmcnt(0)
  v_cmp_lt_u32 vcc, s93, v160
  s_cbranch_vccnz r1_rese
  s_branch r1_rese_ok
r1_rede:
  s_mov_b64 exec, vcc
  buffer_load_dwordx4 v[96:99], v172, s[4:7], s78 offen offset:0 sc1
  buffer_load_dwordx4 v[100:103], v172, s[4:7], s78 offen offset:1024 sc1
  buffer_load_dwordx4 v[104:107], v172, s[4:7], s78 offen offset:2048 sc1
  buffer_load_dwordx4 v[108:111], v172, s[4:7], s78 offen offset:3072 sc1
  s_add_u32 s81, s78, 528384
  buffer_load_dwordx4 v[112:115], v172, s[4:7], s81 offen offset:0 sc1
  buffer_load_dwordx4 v[116:119], v172, s[4:7], s81 offen offset:1024 sc1
  buffer_load_dwordx4 v[120:123], v172, s[4:7], s81 offen offset:2048 sc1
  buffer_load_dwordx4 v[124:127], v172, s[4:7], s81 offen offset:3072 sc1
  s_sub_u32 s51, s51, 1
  s_cbranch_scc1 main_end
  s_waitcnt vmcnt(0)
  v_bitop3_b32 v144, v96, v100, s79 bitop3:0x7e
  v_bitop3_b32 v145, v104, v108, s79 bitop3:0x7e
  v_bitop3_b32 v146, v112, v116, s79 bitop3:0x7e
  v_bitop3_b32 v147, v120, v124, s79 bitop3:0x7e
  v_or3_b32 v144, v144, v145, v146
  v_bitop3_b32 v144, v144, v147, s92 bitop3:0xa8
  v_cmp_ne_u32 vcc, 0, v144
  s_cbranch_vccnz r1_rede
  s_mov_b64 exec, -1
  v_mfma_f32_16x16x32_bf16 v[128:131], v[152:155], v[96:99], 0
  v_mfma_f32_16x16x32_bf16 v[128:131], v[152:155], v[100:103], v[128:131]
  v_mfma_f32_16x16x32_bf16 v[128:131], v[152:155], v[104:107], v[128:131]
  v_mfma_f32_16x16x32_bf16 v[128:131], v[152:155], v[108:111], v[128:131]
  v_mfma_f32_16x16x32_bf16 v[128:131], v[156:159], v[112:115], v[128:131]
  v_mfma_f32_16x16x32_bf16 v[128:131], v[156:159], v[116:119], v[128:131]
  v_mfma_f32_16x16x32_bf16 v[128:131], v[156:159], v[120:123], v[128:131]
  v_mfma_f32_16x16x32_bf16 v[128:131], v[156:159], v[124:127], v[128:131]
  s_branch r1_rede_ok
r1_last:
r1_last2:
  buffer_load_dwordx4 v[96:99], v172, s[4:7], s78 offen offset:0 sc1
  buffer_load_dwordx4 v[100:103], v172, s[4:7], s78 offen offset:1024 sc1
  buffer_load_dwordx4 v[104:107], v172, s[4:7], s78 offen offset:2048 sc1
  buffer_load_dwordx4 v[108:111], v172, s[4:7], s78 offen offset:3072 sc1
  s_add_u32 s81, s78, 528384
  buffer_load_dwordx4 v[112:115], v172, s[4:7], s81 offen offset:0 sc1
  buffer_load_dwordx4 v[116:119], v172, s[4:7], s81 offen offset:1024 sc1
  buffer_load_dwordx4 v[120:123], v172, s[4:7], s81 offen offset:2048 sc1
  buffer_load_dwordx4 v[124:127], v172, s[4:7], s81 offen offset:3072 sc1
  s_waitcnt vmcnt(9)
  v_cmp_lt_u32 vcc, s93, v160
  s_cbranch_vccnz r1_rese
r1_rese_ok:
  v_lshlrev_b32 v140, 16, v160
  v_and_b32 v141, 0xffff0000, v160
  v_lshlrev_b32 v142, 16, v161
  v_and_b32 v143, 0xffff0000, v161
  s_waitcnt vmcnt(7)
  v_mfma_f32_16x16x32_bf16 v[128:131], v[152:155], v[96:99], 0
  s_waitcnt vmcnt(6)
  v_mfma_f32_16x16x32_bf16 v[128:131], v[152:155], v[100:103], v[128:131]
  v_bitop3_b32 v144, v96, v100, s79 bitop3:0x7e
  s_waitcnt vmcnt(5)
  v_mfma_f32_16x16x32_bf16 v[128:131], v[152:155], v[104:107], v[128:131]
  s_waitcnt vmcnt(4)
  v_mfma_f32_16x16x32_bf16 v[128:131], v[152:155], v[108:111], v[128:131]
  v_bitop3_b32 v145, v104, v108, s79 bitop3:0x7e
  s_waitcnt vmcnt(3)
  v_mfma_f32_16x16x32_bf16 v[128:131], v[156:159], v[112:115], v[128:131]
  s_waitcnt vmcnt(2)
  v_mfma_f32_16x16x32_bf16 v[128:131], v[156:159], v[116:119], v[128:131]
  v_bitop3_b32 v146, v112, v116, s79 bitop3:0x7e
  s_waitcnt vmcnt(1)
  v_mfma_f32_16x16x32_bf16 v[128:131], v[156:159], v[120:123], v[128:131]
  s_waitcnt vmcnt(0)
  v_mfma_f32_16x16x32_bf16 v[128:131], v[156:159], v[124:127], v[128:131]
  v_bitop3_b32 v147, v120, v124, s79 bitop3:0x7e
  v_or3_b32 v144, v144, v145, v146
  v_bitop3_b32 v144, v144, v147, s92 bitop3:0xa8
  v_cmp_ne_u32 vcc, 0, v144
  s_cbranch_vccnz r1_rede
r1_rede_ok:
  buffer_store_dword v186, v184, s[4:7], 0 offen
  buffer_store_dword v186, v187, s[4:7], 0 offen sc1
  s_nop 4
  v_cvt_pk_bf16_f32 v138, v128, v129
  v_cvt_pk_bf16_f32 v139, v130, v131
  v_lshlrev_b32 v132, 16, v138
  v_and_b32 v133, 0xffff0000, v138
  v_lshlrev_b32 v134, 16, v139
  v_and_b32 v135, 0xffff0000, v139
  v_add_f32 v132, v132, v140
  v_add_f32 v133, v133, v141
  v_add_f32 v134, v134, v142
  v_add_f32 v135, v135, v143
  v_cvt_pk_bf16_f32 v138, v132, v133
  v_cvt_pk_bf16_f32 v139, v134, v135
  s_add_u32 s83, s83, 1
  s_max_i32 s79, s83, 0
  s_lshl_b32 s72, s79, 16
  s_and_b32 s78, s79, 3
  s_lshl_b32 s78, s78, 21
  s_add_u32 s78, s78, s77
  s_lshr_b32 s79, s79, 2
  s_add_u32 s72, s72, s86
  s_cmp_lt_i32 s83, 0
  s_cselect_b32 s92, 0, 1
  s_cselect_b32 s93, -1, -2
  v_add_u32 v186, s92, v186
  buffer_load_dwordx2 v[160:161], v175, s[4:7], s72 offen sc1
  v_permlane16_swap_b32 v137, v139
  v_permlane16_swap_b32 v136, v138
  buffer_store_dwordx4 v[136:139], v185, s[32:35], s75 offen
  s_sub_u32 s75, s72, s86
  s_lshr_b32 s75, s75, 1
  s_cmp_lt_i32 s83, 0
  s_cselect_b32 s76, 0x40000000, 0
  v_or_b32 v185, s76, v176
  s_cmp_lt_i32 s83, 64
  s_cbranch_scc1 r1_last2
  s_lshl_b32 s80, s50, 2
  s_add_u32 s80, s80, s48
  s_cmp_lg_u32 s80, 1020
  s_cbranch_scc1 main_end
  v_lshlrev_b32 v1, 2, v0
  v_mov_b32 v2, 0
  buffer_store_dword v2, v1, s[36:39], 0 offen sc1
  s_endpgm
rw_top:
  s_barrier
  ds_read_b128 v[36:39], v174 offset:0
  ds_read_b128 v[40:43], v174 offset:32
  ds_read_b128 v[44:47], v174 offset:64
  ds_read_b128 v[48:51], v174 offset:96
  ds_read_b128 v[52:55], v174 offset:128
  s_add_u32 s71, s71, 1
  s_cmp_eq_u32 s71, 63
  s_cselect_b32 s88, 0, -1
  ds_read_b128 v[56:59], v174 offset:160
  s_add_u32 s73, s73, 0x10000
  v_xor_b32 v173, 0x10000, v173
  s_min_u32 s73, s73, s74
  s_xor_b32 s82, s82, 0x10000
  ds_read_b128 v[60:63], v174 offset:192
  s_add_u32 s90, s90, 0x40000
  s_add_u32 s94, s94, 2048
  ds_read_b128 v[64:67], v174 offset:224
  s_waitcnt lgkmcnt(7)
  v_mfma_f32_32x32x16_bf16 v[4:19], a[0:3], v[36:39], 0
  s_waitcnt lgkmcnt(6)
  s_waitcnt lgkmcnt(5)
  s_waitcnt lgkmcnt(4)
  s_waitcnt lgkmcnt(3)
  s_mov_b32 m0, s82
  s_add_u32 s70, s73, 0xfffffff0
  s_waitcnt lgkmcnt(2)
  v_mfma_f32_32x32x16_bf16 v[4:19], a[4:7], v[40:43], v[4:19]
  s_waitcnt lgkmcnt(1)
  v_mfma_f32_32x32x16_bf16 v[4:19], a[8:11], v[44:47], v[4:19]
  v_mfma_f32_32x32x16_bf16 v[4:19], a[12:15], v[48:51], v[4:19]
  v_mfma_f32_32x32x16_bf16 v[4:19], a[16:19], v[52:55], v[4:19]
  s_waitcnt lgkmcnt(0)
  v_mfma_f32_32x32x16_bf16 v[20:35], a[128:131], v[36:39], 0
  buffer_load_dwordx4 v172, s[4:7], s73 offen offset:0 sc1 lds
  ds_read_b128 v[36:39], v174 offset:256
  v_mfma_f32_32x32x16_bf16 v[4:19], a[20:23], v[56:59], v[4:19]
  v_mfma_f32_32x32x16_bf16 v[20:35], a[132:135], v[40:43], v[20:35]
  buffer_load_dwordx4 v172, s[4:7], s70 offen offset:1040 sc1 lds
  ds_read_b128 v[40:43], v174 offset:288
  s_add_u32 s70, s73, 0xffffffe0
  v_mfma_f32_32x32x16_bf16 v[4:19], a[24:27], v[60:63], v[4:19]
  s_waitcnt lgkmcnt(1)
  v_mfma_f32_32x32x16_bf16 v[20:35], a[136:139], v[44:47], v[20:35]
  buffer_load_dwordx4 v172, s[4:7], s70 offen offset:2080 sc1 lds
  ds_read_b128 v[44:47], v174 offset:320
  s_add_u32 s70, s73, 0xffffffd0
  v_mfma_f32_32x32x16_bf16 v[4:19], a[28:31], v[64:67], v[4:19]
  s_waitcnt lgkmcnt(1)
  v_mfma_f32_32x32x16_bf16 v[20:35], a[140:143], v[48:51], v[20:35]
  buffer_load_dwordx4 v172, s[4:7], s70 offen offset:3120 sc1 lds
  ds_read_b128 v[48:51], v174 offset:352
  s_add_u32 m0, s82, 4160
  s_add_u32 s70, s73, 0x1000
  v_mfma_f32_32x32x16_bf16 v[4:19], a[32:35], v[36:39], v[4:19]
  s_waitcnt lgkmcnt(1)
  v_mfma_f32_32x32x16_bf16 v[20:35], a[144:147], v[52:55], v[20:35]
  buffer_load_dwordx4 v172, s[4:7], s70 offen offset:0 sc1 lds
  ds_read_b128 v[52:55], v174 offset:384
  s_add_u32 s70, s73, 0xff0
  v_mfma_f32_32x32x16_bf16 v[4:19], a[36:39], v[40:43], v[4:19]
  s_waitcnt lgkmcnt(1)
  v_mfma_f32_32x32x16_bf16 v[20:35], a[148:151], v[56:59], v[20:35]
  buffer_load_dwordx4 v172, s[4:7], s70 offen offset:1040 sc1 lds
  ds_read_b128 v[56:59], v174 offset:416
  s_add_u32 s70, s73, 0xfe0
  v_mfma_f32_32x32x16_bf16 v[4:19], a[40:43], v[44:47], v[4:19]
  s_waitcnt lgkmcnt(1)
  v_mfma_f32_32x32x16_bf16 v[20:35], a[152:155], v[60:63], v[20:35]
  buffer_load_dwordx4 v172, s[4:7], s70 offen offset:2080 sc1 lds
  ds_read_b128 v[60:63], v174 offset:448
  s_add_u32 s70, s73, 0xfd0
  v_mfma_f32_32x32x16_bf16 v[4:19], a[44:47], v[48:51], v[4:19]
  s_waitcnt lgkmcnt(1)
  v_mfma_f32_32x32x16_bf16 v[20:35], a[156:159], v[64:67], v[20:35]
  buffer_load_dwordx4 v172, s[4:7], s70 offen offset:3120 sc1 lds
  ds_read_b128 v[64:67], v174 offset:480
  v_mfma_f32_32x32x16_bf16 v[4:19], a[48:51], v[52:55], v[4:19]
  s_waitcnt lgkmcnt(1)
  v_mfma_f32_32x32x16_bf16 v[20:35], a[160:163], v[36:39], v[20:35]
  ds_read_b128 v[36:39], v174 offset:512
  s_waitcnt vmcnt(9)
  buffer_store_dword v183, v182, s[4:7], s84 offen sc1
  v_mfma_f32_32x32x16_bf16 v[4:19], a[52:55], v[56:59], v[4:19]
  s_waitcnt lgkmcnt(1)
  v_mfma_f32_32x32x16_bf16 v[20:35], a[164:167], v[40:43], v[20:35]
  ds_read_b128 v[40:43], v174 offset:544
  v_mfma_f32_32x32x16_bf16 v[4:19], a[56:59], v[60:63], v[4:19]
  s_waitcnt lgkmcnt(1)
  v_mfma_f32_32x32x16_bf16 v[20:35], a[168:171], v[44:47], v[20:35]
  ds_read_b128 v[44:47], v174 offset:576
  v_mfma_f32_32x32x16_bf16 v[4:19], a[60:63], v[64:67], v[4:19]
  buffer_store_dwordx4 v[68:71], v181, s[4:7], s91 offen offset:0 sc1
  s_waitcnt lgkmcnt(1)
  s_add_u32 s80, s91, 8192
  v_mfma_f32_32x32x16_bf16 v[20:35], a[172:175], v[48:51], v[20:35]
  ds_read_b128 v[48:51], v174 offset:608
  s_add_u32 s83, s83, 1
  s_max_i32 s79, s83, 0
  v_mfma_f32_32x32x16_bf16 v[4:19], a[64:67], v[36:39], v[4:19]
  s_waitcnt lgkmcnt(1)
  s_lshl_b32 s72, s79, 16
  s_and_b32 s78, s79, 1
  v_mfma_f32_32x32x16_bf16 v[20:35], a[176:179], v[52:55], v[20:35]
  buffer_store_dwordx4 v[72:75], v181, s[4:7], s91 offen offset:512 sc1
  ds_read_b128 v[52:55], v174 offset:640
  s_barrier
  s_lshl_b32 s78, s78, 21
  v_mfma_f32_32x32x16_bf16 v[4:19], a[68:71], v[40:43], v[4:19]
  s_waitcnt lgkmcnt(1)
  s_add_u32 s78, s78, s77
  s_lshr_b32 s79, s79, 1
  s_add_u32 s72, s72, s86
  v_mfma_f32_32x32x16_bf16 v[20:35], a[180:183], v[56:59], v[20:35]
  ds_read_b128 v[56:59], v174 offset:672
  s_cmp_lt_i32 s83, 0
  s_cselect_b32 s92, 0, 1
  s_cselect_b32 s93, -1, -2
  v_add_u32 v186, s92, v186
  v_mfma_f32_32x32x16_bf16 v[4:19], a[72:75], v[44:47], v[4:19]
  buffer_store_dwordx4 v[76:79], v181, s[4:7], s80 offen offset:0 sc1
  s_waitcnt lgkmcnt(1)
  s_add_u32 s75, s72, 0x400000
  s_add_u32 s76, s75, 0x20000
  v_mfma_f32_32x32x16_bf16 v[20:35], a[184:187], v[60:63], v[20:35]
  ds_read_b128 v[60:63], v174 offset:704
  s_cmp_lt_i32 s83, 62
  s_cselect_b32 s76, s76, s52
  s_cmp_lt_i32 s83, 0
  s_cselect_b32 s75, s52, s75
  v_mfma_f32_32x32x16_bf16 v[4:19], a[76:79], v[48:51], v[4:19]
  s_waitcnt lgkmcnt(1)
  v_mfma_f32_32x32x16_bf16 v[20:35], a[188:191], v[64:67], v[20:35]
  buffer_store_dwordx4 v[80:83], v181, s[4:7], s80 offen offset:512 sc1
  ds_read_b128 v[64:67], v174 offset:736
  v_mfma_f32_32x32x16_bf16 v[4:19], a[80:83], v[52:55], v[4:19]
  s_waitcnt lgkmcnt(1)
  v_mfma_f32_32x32x16_bf16 v[20:35], a[192:195], v[36:39], v[20:35]
  ds_read_b128 v[36:39], v174 offset:768
  v_mfma_f32_32x32x16_bf16 v[4:19], a[84:87], v[56:59], v[4:19]
  s_waitcnt lgkmcnt(1)
  v_mfma_f32_32x32x16_bf16 v[20:35], a[196:199], v[40:43], v[20:35]
  ds_read_b128 v[40:43], v174 offset:800
  v_mfma_f32_32x32x16_bf16 v[4:19], a[88:91], v[60:63], v[4:19]
  s_waitcnt lgkmcnt(1)
  v_mfma_f32_32x32x16_bf16 v[20:35], a[200:203], v[44:47], v[20:35]
  ds_read_b128 v[44:47], v174 offset:832
  v_mfma_f32_32x32x16_bf16 v[4:19], a[92:95], v[64:67], v[4:19]
  s_waitcnt lgkmcnt(1)
  v_mfma_f32_32x32x16_bf16 v[20:35], a[204:207], v[48:51], v[20:35]
  ds_read_b128 v[48:51], v174 offset:864
  v_mfma_f32_32x32x16_bf16 v[4:19], a[96:99], v[36:39], v[4:19]
  s_waitcnt lgkmcnt(1)
  v_mfma_f32_32x32x16_bf16 v[20:35], a[208:211], v[52:55], v[20:35]
  ds_read_b128 v[52:55], v174 offset:896
  v_mfma_f32_32x32x16_bf16 v[4:19], a[100:103], v[40:43], v[4:19]
  s_waitcnt lgkmcnt(1)
  v_mfma_f32_32x32x16_bf16 v[20:35], a[212:215], v[56:59], v[20:35]
  ds_read_b128 v[56:59], v174 offset:928
  buffer_load_dwordx2 v[160:161], v175, s[4:7], s72 offen sc1
  v_mfma_f32_32x32x16_bf16 v[4:19], a[104:107], v[44:47], v[4:19]
  s_waitcnt lgkmcnt(1)
  v_mfma_f32_32x32x16_bf16 v[20:35], a[216:219], v[60:63], v[20:35]
  ds_read_b128 v[60:63], v174 offset:960
  v_mfma_f32_32x32x16_bf16 v[4:19], a[108:111], v[48:51], v[4:19]
  s_waitcnt lgkmcnt(1)
  v_mfma_f32_32x32x16_bf16 v[20:35], a[220:223], v[64:67], v[20:35]
  ds_read_b128 v[64:67], v174 offset:992
  v_mfma_f32_32x32x16_bf16 v[4:19], a[112:115], v[52:55], v[4:19]
  s_waitcnt lgkmcnt(1)
  v_mfma_f32_32x32x16_bf16 v[20:35], a[224:227], v[36:39], v[20:35]
  v_mfma_f32_32x32x16_bf16 v[4:19], a[116:119], v[56:59], v[4:19]
  s_waitcnt lgkmcnt(0)
  v_mfma_f32_32x32x16_bf16 v[20:35], a[228:231], v[40:43], v[20:35]
  v_mfma_f32_32x32x16_bf16 v[4:19], a[120:123], v[60:63], v[4:19]
  v_mfma_f32_32x32x16_bf16 v[20:35], a[232:235], v[44:47], v[20:35]
  s_waitcnt vmcnt(6)
  ds_read_b32 v164, v173 offset:0
  ds_read_b32 v165, v173 offset:1040
  ds_read_b32 v166, v173 offset:2080
  ds_read_b32 v167, v173 offset:3120
  ds_read_b32 v168, v173 offset:4160
  ds_read_b32 v169, v173 offset:5200
  v_mfma_f32_32x32x16_bf16 v[4:19], a[124:127], v[64:67], v[4:19]
  ds_read_b32 v170, v173 offset:6240
  ds_read_b32 v171, v173 offset:7280
  v_mfma_f32_32x32x16_bf16 v[20:35], a[236:239], v[48:51], v[20:35]
  v_mfma_f32_32x32x16_bf16 v[20:35], a[240:243], v[52:55], v[20:35]
  v_mfma_f32_32x32x16_bf16 v[20:35], a[244:247], v[56:59], v[20:35]
  s_waitcnt lgkmcnt(0)
  v_max3_u32 v1, v164, v166, v167
  v_max3_u32 v2, v165, v168, v169
  v_max3_u32 v1, v1, v170, v171
  v_mfma_f32_32x32x16_bf16 v[20:35], a[248:251], v[60:63], v[20:35]
  v_max_u32 v1, v1, v2
  v_cmp_le_u32 vcc, s88, v1
  v_cvt_pk_bf16_f32 v68, v4, v5
  v_cvt_pk_bf16_f32 v69, v6, v7
  v_cvt_pk_bf16_f32 v70, v8, v9
  v_cvt_pk_bf16_f32 v71, v10, v11
  v_mfma_f32_32x32x16_bf16 v[20:35], a[252:255], v[64:67], v[20:35]
  v_cvt_pk_bf16_f32 v72, v12, v13
  v_cvt_pk_bf16_f32 v73, v14, v15
  v_cvt_pk_bf16_f32 v74, v16, v17
  v_cvt_pk_bf16_f32 v75, v18, v19
  v_xor_b32 v174, 0x10000, v174
  s_mov_b32 s91, s90
  s_mov_b32 s84, s95
  s_mov_b32 s95, s94
  s_nop 2
  v_cvt_pk_bf16_f32 v76, v20, v21
  v_cvt_pk_bf16_f32 v77, v22, v23
  v_cvt_pk_bf16_f32 v78, v24, v25
  v_cvt_pk_bf16_f32 v79, v26, v27
  v_cvt_pk_bf16_f32 v80, v28, v29
  v_cvt_pk_bf16_f32 v81, v30, v31
  v_cvt_pk_bf16_f32 v82, v32, v33
  v_cvt_pk_bf16_f32 v83, v34, v35
  s_cbranch_vccnz r0_miss
  s_cmp_lt_i32 s83, 0
  s_cbranch_scc1 rw_top
  s_waitcnt vmcnt(0)
  s_branch r0_top
rw_xpoll:
  s_mov_b32 m0, s82
  s_nop 0
  buffer_load_dwordx4 v172, s[4:7], s73 offen offset:0 sc1 lds
  s_add_u32 s70, s73, 0xfffffff0
  buffer_load_dwordx4 v172, s[4:7], s70 offen offset:1040 sc1 lds
  s_add_u32 s70, s73, 0xffffffe0
  buffer_load_dwordx4 v172, s[4:7], s70 offen offset:2080 sc1 lds
  s_add_u32 s70, s73, 0xffffffd0
  buffer_load_dwordx4 v172, s[4:7], s70 offen offset:3120 sc1 lds
  s_add_u32 m0, s82, 4160
  s_add_u32 s70, s73, 0x1000
  buffer_load_dwordx4 v172, s[4:7], s70 offen offset:0 sc1 lds
  s_add_u32 s70, s73, 0xff0
  buffer_load_dwordx4 v172, s[4:7], s70 offen offset:1040 sc1 lds
  s_add_u32 s70, s73, 0xfe0
  buffer_load_dwordx4 v172, s[4:7], s70 offen offset:2080 sc1 lds
  s_add_u32 s70, s73, 0xfd0
  buffer_load_dwordx4 v172, s[4:7], s70 offen offset:3120 sc1 lds
  s_waitcnt vmcnt(0)
  ds_read_b32 v164, v173 offset:0
  ds_read_b32 v165, v173 offset:1040
  ds_read_b32 v166, v173 offset:2080
  ds_read_b32 v167, v173 offset:3120
  ds_read_b32 v168, v173 offset:4160
  ds_read_b32 v169, v173 offset:5200
  ds_read_b32 v170, v173 offset:6240
  ds_read_b32 v171, v173 offset:7280
  s_waitcnt lgkmcnt(0)
  v_max3_u32 v1, v164, v166, v167
  v_max3_u32 v2, v165, v168, v169
  v_max3_u32 v1, v1, v170, v171
  v_max_u32 v1, v1, v2
  v_cmp_le_u32 vcc, s88, v1
  s_cbranch_vccnz r0_xpoll
  s_branch rw_top
role_o:
  s_mov_b32 s70, s57
  s_lshl_b32 s86, s55, 6
  s_lshl_b32 s72, s55, 23
  s_lshl_b32 s75, s55, 24
  s_add_u32 s75, s75, 0x2000000
  s_add_u32 s72, s72, 0x1000000
  s_add_u32 s89, s72, 0x400000
  s_mul_i32 s76, s70, 33024
  s_add_u32 s76, s76, s75
  s_lshl_b32 s81, s55, 10
  s_and_b32 s82, s70, 15
  s_add_u32 s81, s81, s82
  s_lshl_b32 s81, s81, 1
  s_lshl_b32 s79, s81, 6
  s_lshl_b32 s82, s48, 2
  s_add_u32 s79, s79, s82
  s_add_u32 s79, s79, 0x20000
  s_lshl_b32 s80, s81, 13
  s_lshl_b32 s88, s48, 11
  s_add_u32 s78, s80, s88
  s_add_u32 s78, s78, 0x6000000
  s_add_u32 s80, s80, 0xa000000
  s_lshl_b32 s88, s48, 10
  s_add_u32 s88, s88, 0x8000
  s_lshl_b32 s83, s48, 12
  v_lshlrev_b32 v88, 4, v0
  s_lshl_b32 s54, s48, 13
  v_add_u32 v88, s54, v88
  v_and_b32 v1, 15, v0
  v_lshrrev_b32 v2, 4, v0
  v_mul_u32_u24 v94, 132096, v2
  v_lshl_add_u32 v94, v1, 4, v94
  s_and_b32 s55, s70, 15
  s_lshl_b32 s55, s55, 8
  s_add_u32 s54, s54, s55
  s_and_b32 s55, s70, 16
  s_mul_i32 s55, s55, 33024
  s_add_u32 s54, s54, s55
  v_add_u32 v94, s54, v94
  s_lshl_b32 s54, s70, 10
  s_lshl_b32 s55, s48, 8
  s_add_u32 s54, s54, s55
  v_lshl_add_u32 v91, v1, 4, s54
  v_and_b32 v3, 1, v2
  v_lshrrev_b32 v2, 1, v2
  v_lshl_add_u32 v90, v3, 3, v91
  v_add_u32 v90, 0x8000, v90
  v_lshl_add_u32 v91, v3, 15, v91
  v_lshl_add_u32 v91, v2, 30, v91
  v_lshlrev_b32 v93, 5, v2
  s_lshl_b32 s54, s48, 3
  s_add_u32 s54, s54, 0xa000
  v_add_u32 v92, s54, v93
  v_lshl_add_u32 v92, v3, 2, v92
  v_lshlrev_b32 v2, 2, v0
o0_cnt:
  s_sub_u32 s51, s51, 1
  s_cbranch_scc1 main_end
  buffer_load_dword v1, v2, s[36:39], 0 offen sc1
  s_waitcnt vmcnt(0)
  v_readlane_b32 s60, v1, 0
  v_readlane_b32 s61, v1, 48
  v_readlane_b32 s62, v1, 16
  v_readlane_b32 s63, v1, 49
  v_readlane_b32 s64, v1, 50
  v_readlane_b32 s65, v1, 51
  v_readlane_b32 s66, v1, 32
  v_readlane_b32 s67, v1, 33
  s_add_u32 s56, s60, s61
  s_add_u32 s56, s56, s62
  s_add_u32 s56, s56, s63
  s_add_u32 s56, s56, s64
  s_add_u32 s56, s56, s65
  s_add_u32 s56, s56, s66
  s_add_u32 s56, s56, s67
  s_cmp_lt_u32 s56, 256
  s_cbranch_scc1 o0_cnt
  s_cmp_eq_u32 s86, 0
  s_cselect_b32 s85, s64, s66
  v_mov_b32 v4, -1
  v_mov_b32 v5, -1
  v_mov_b32 v6, -1
  v_mov_b32 v7, -1
  buffer_store_dwordx4 v[4:7], v91, s[4:7], s89 offen sc1
  s_add_u32 s81, s89, 0x10000
  buffer_store_dwordx4 v[4:7], v91, s[4:7], s81 offen sc1
  s_cmp_lt_u32 s85, 32
  s_cbranch_scc1 o_ri1
  s_add_u32 s81, s76, 0x0
  buffer_store_dwordx4 v[4:7], v88, s[4:7], s81 offen offset:0
  buffer_store_dwordx4 v[4:7], v88, s[4:7], s81 offen offset:1024
  buffer_store_dwordx4 v[4:7], v88, s[4:7], s81 offen offset:2048
  buffer_store_dwordx4 v[4:7], v88, s[4:7], s81 offen offset:3072
  s_add_u32 s81, s76, 0x200000
  buffer_store_dwordx4 v[4:7], v88, s[4:7], s81 offen offset:0
  buffer_store_dwordx4 v[4:7], v88, s[4:7], s81 offen offset:1024
  buffer_store_dwordx4 v[4:7], v88, s[4:7], s81 offen offset:2048
  buffer_store_dwordx4 v[4:7], v88, s[4:7], s81 offen offset:3072
  s_branch o_ri2
o_ri1:
  s_add_u32 s81, s76, 0x0
  buffer_store_dwordx4 v[4:7], v88, s[4:7], s81 offen offset:0 sc1
  buffer_store_dwordx4 v[4:7], v88, s[4:7], s81 offen offset:1024 sc1
  buffer_store_dwordx4 v[4:7], v88, s[4:7], s81 offen offset:2048 sc1
  buffer_store_dwordx4 v[4:7], v88, s[4:7], s81 offen offset:3072 sc1
  s_add_u32 s81, s76, 0x200000
  buffer_store_dwordx4 v[4:7], v88, s[4:7], s81 offen offset:0 sc1
  buffer_store_dwordx4 v[4:7], v88, s[4:7], s81 offen offset:1024 sc1
  buffer_store_dwordx4 v[4:7], v88, s[4:7], s81 offen offset:2048 sc1
  buffer_store_dwordx4 v[4:7], v88, s[4:7], s81 offen offset:3072 sc1
o_ri2:
  s_lshr_b32 s54, s50, 5
  s_bitcmp1_b32 0xca, s54
  s_cselect_b32 s54, 16, 8
  s_lshl_b32 s54, 1, s54
  v_mov_b32 v1, 0x40000000
  v_cmp_eq_u32 vcc, 0, v0
  s_nop 1
  v_cndmask_b32 v2, v1, 0, vcc
  v_mov_b32 v1, s54
  s_waitcnt vmcnt(0)
  s_barrier
  s_cmp_lg_u32 s48, 0
  s_cbranch_scc1 o_idone
  buffer_atomic_add v1, v2, s[36:39], 0 offen offset:68 sc1
o_idone:
  s_lshr_b32 s56, s50, 4
  s_bitcmp1_b32 0xf000, s56
  s_cbranch_scc0 dlo_go
  s_cmp_lg_u32 s48, 0
  s_cbranch_scc1 dlo_w
  v_lshlrev_b32 v2, 2, v0
  s_mov_b32 s58, 0xff000000
  s_and_b32 s59, s58, 0x20303040
  s_add_u32 s59, s59, 256
dlo_cnt:
  s_sub_u32 s51, s51, 1
  s_cbranch_scc1 main_end
  buffer_load_dword v1, v2, s[36:39], 0 offen sc1
  s_waitcnt vmcnt(0)
  v_readlane_b32 s60, v1, 0
  v_readlane_b32 s61, v1, 48
  v_readlane_b32 s62, v1, 16
  v_readlane_b32 s63, v1, 49
  v_readlane_b32 s64, v1, 50
  v_readlane_b32 s65, v1, 51
  v_readlane_b32 s66, v1, 32
  v_readlane_b32 s67, v1, 33
  v_readlane_b32 s57, v1, 17
  s_add_u32 s56, s60, s61
  s_add_u32 s56, s56, s62
  s_add_u32 s56, s56, s63
  s_add_u32 s56, s56, s64
  s_add_u32 s56, s56, s65
  s_add_u32 s56, s56, s66
  s_add_u32 s56, s56, s67
  s_and_b32 s57, s57, s58
  s_add_u32 s56, s56, s57
  s_cmp_lt_u32 s56, s59
  s_cbranch_scc1 dlo_cnt
dlo_w:
  s_barrier
dlo_go:
  s_and_b32 s84, s70, 15
  s_lshl_b32 s84, s84, 1
  s_and_b32 s54, s48, 1
  s_add_u32 s84, s84, s54
  s_lshl_b32 s84, s84, 17
  v_lshrrev_b32 v1, 4, v0
  v_lshlrev_b32 v1, 3, v1
  v_and_b32 v2, 15, v0
  v_lshlrev_b32 v2, 4, v2
  s_lshl_b32 s54, s48, 8
  v_add_u32 v2, s54, v2
  s_lshr_b32 s55, s48, 1
  s_lshl_b32 s55, s55, 6
  s_sub_u32 s56, 64, s55
  v_add_u32 v18, s55, v1
  v_add_u32 v19, s56, v1
  v_lshl_add_u32 v18, v18, 10, v2
  v_lshl_add_u32 v19, v19, 10, v2
  s_add_u32 s82, s84, 0
  buffer_load_dwordx4 v[128:131], v18, s[20:23], s82 offen offset:0
  buffer_load_dwordx4 v[132:135], v18, s[20:23], s82 offen offset:1024
  buffer_load_dwordx4 v[136:139], v18, s[20:23], s82 offen offset:2048
  buffer_load_dwordx4 v[140:143], v18, s[20:23], s82 offen offset:3072
  s_add_u32 s82, s84, 4096
  buffer_load_dwordx4 v[144:147], v18, s[20:23], s82 offen offset:0
  buffer_load_dwordx4 v[148:151], v18, s[20:23], s82 offen offset:1024
  buffer_load_dwordx4 v[152:155], v18, s[20:23], s82 offen offset:2048
  buffer_load_dwordx4 v[156:159], v18, s[20:23], s82 offen offset:3072
  s_add_u32 s82, s84, 32768
  buffer_load_dwordx4 v[160:163], v18, s[20:23], s82 offen offset:0
  buffer_load_dwordx4 v[164:167], v18, s[20:23], s82 offen offset:1024
  buffer_load_dwordx4 v[168:171], v18, s[20:23], s82 offen offset:2048
  buffer_load_dwordx4 v[172:175], v18, s[20:23], s82 offen offset:3072
  s_add_u32 s82, s84, 36864
  buffer_load_dwordx4 v[176:179], v18, s[20:23], s82 offen offset:0
  buffer_load_dwordx4 v[180:183], v18, s[20:23], s82 offen offset:1024
  buffer_load_dwordx4 v[184:187], v18, s[20:23], s82 offen offset:2048
  buffer_load_dwordx4 v[188:191], v18, s[20:23], s82 offen offset:3072
  s_add_u32 s82, s84, 0
  buffer_load_dwordx4 v[192:195], v19, s[20:23], s82 offen offset:0
  buffer_load_dwordx4 v[196:199], v19, s[20:23], s82 offen offset:1024
  buffer_load_dwordx4 v[200:203], v19, s[20:23], s82 offen offset:2048
  buffer_load_dwordx4 v[204:207], v19, s[20:23], s82 offen offset:3072
  s_add_u32 s82, s84, 4096
  buffer_load_dwordx4 v[208:211], v19, s[20:23], s82 offen offset:0
  buffer_load_dwordx4 v[212:215], v19, s[20:23], s82 offen offset:1024
  buffer_load_dwordx4 v[216:219], v19, s[20:23], s82 offen offset:2048
  buffer_load_dwordx4 v[220:223], v19, s[20:23], s82 offen offset:3072
  s_add_u32 s82, s84, 32768
  buffer_load_dwordx4 v[224:227], v19, s[20:23], s82 offen offset:0
  buffer_load_dwordx4 v[228:231], v19, s[20:23], s82 offen offset:1024
  buffer_load_dwordx4 v[232:235], v19, s[20:23], s82 offen offset:2048
  buffer_load_dwordx4 v[236:239], v19, s[20:23], s82 offen offset:3072
  s_add_u32 s82, s84, 36864
  buffer_load_dwordx4 v[240:243], v19, s[20:23], s82 offen offset:0
  buffer_load_dwordx4 v[244:247], v19, s[20:23], s82 offen offset:1024
  buffer_load_dwordx4 v[248:251], v19, s[20:23], s82 offen offset:2048
  buffer_load_dwordx4 v[252:255], v19, s[20:23], s82 offen offset:3072
  s_and_b32 s90, s70, 16
  s_lshl_b32 s90, s90, 6
  s_sub_u32 s90, 0x2000000, s90
  v_mov_b32 v2, 0x3f80
  v_mov_b32 v3, 0x3f800000
  v_and_b32 v1, 7, v0
  v_mov_b32 v84, 0
  v_cmp_eq_u32 vcc, 0, v1
  s_nop 1
  v_cndmask_b32 v84, v84, v2, vcc
  v_cmp_eq_u32 vcc, 1, v1
  s_nop 1
  v_cndmask_b32 v84, v84, v3, vcc
  v_mov_b32 v85, 0
  v_cmp_eq_u32 vcc, 2, v1
  s_nop 1
  v_cndmask_b32 v85, v85, v2, vcc
  v_cmp_eq_u32 vcc, 3, v1
  s_nop 1
  v_cndmask_b32 v85, v85, v3, vcc
  v_mov_b32 v86, 0
  v_cmp_eq_u32 vcc, 4, v1
  s_nop 1
  v_cndmask_b32 v86, v86, v2, vcc
  v_cmp_eq_u32 vcc, 5, v1
  s_nop 1
  v_cndmask_b32 v86, v86, v3, vcc
  v_mov_b32 v87, 0
  v_cmp_eq_u32 vcc, 6, v1
  s_nop 1
  v_cndmask_b32 v87, v87, v2, vcc
  v_cmp_eq_u32 vcc, 7, v1
  s_nop 1
  v_cndmask_b32 v87, v87, v3, vcc
  v_lshlrev_b32 v89, 4, v0
  s_and_b32 s54, s48, 1
  s_lshr_b32 s55, s48, 1
  s_lshl_b32 s56, s54, 14
  v_add_u32 v101, s56, v89
  s_lshl_b32 s56, s54, 12
  v_add_u32 v102, s56, v89
  s_lshl_b32 s56, s55, 13
  v_add_u32 v103, s56, v101
  s_lshl_b32 s56, s55, 12
  s_lshl_b32 s57, s54, 13
  s_add_u32 s56, s56, s57
  v_add_u32 v104, s56, v89
  s_lshl_b32 s56, s48, 11
  s_add_u32 s56, s56, 0xc000
  v_add_u32 v97, s56, v89
  v_xor_b32 v98, 0x800, v97
  v_xor_b32 v99, 0x1000, v97
  v_xor_b32 v100, 0x1800, v97
  v_lshrrev_b32 v1, 4, v0
  v_and_b32 v2, 15, v0
  v_and_b32 v96, 1, v0
  v_bfe_u32 v3, v0, 2, 2
  v_lshl_add_u32 v96, v3, 1, v96
  v_lshlrev_b32 v96, 4, v96
  v_lshl_add_u32 v96, v1, 7, v96
  v_bfe_u32 v3, v0, 1, 1
  v_lshl_add_u32 v96, v3, 11, v96
  v_add_u32 v96, s57, v96
  v_lshlrev_b32 v1, 2, v1
  v_sub_u32 v1, v2, v1
  s_and_b32 s56, s70, 16
  v_add_u32 v1, s56, v1
  v_mov_b32 v3, 0xf149f2ca
  v_cmp_le_i32 vcc, 0, v1
  s_nop 1
  v_cndmask_b32 v64, v3, 0, vcc
  v_cmp_le_i32 vcc, 1, v1
  s_nop 1
  v_cndmask_b32 v65, v3, 0, vcc
  v_cmp_le_i32 vcc, 2, v1
  s_nop 1
  v_cndmask_b32 v66, v3, 0, vcc
  v_cmp_le_i32 vcc, 3, v1
  s_nop 1
  v_cndmask_b32 v67, v3, 0, vcc
  v_cmp_le_i32 vcc, 16, v1
  s_nop 1
  v_cndmask_b32 v68, v3, 0, vcc
  v_cmp_le_i32 vcc, 17, v1
  s_nop 1
  v_cndmask_b32 v69, v3, 0, vcc
  v_cmp_le_i32 vcc, 18, v1
  s_nop 1
  v_cndmask_b32 v70, v3, 0, vcc
  v_cmp_le_i32 vcc, 19, v1
  s_nop 1
  v_cndmask_b32 v71, v3, 0, vcc
  v_mov_b32 v80, 0x3f803f80
  v_mov_b32 v81, 0x3f803f80
  v_mov_b32 v82, 0x3f803f80
  v_mov_b32 v83, 0x3f803f80
  v_mov_b32 v58, 0x3f003f00
  v_mov_b32 v59, 0x3f003f00
  s_xor_b32 s84, s84, 0x20000
  s_waitcnt vmcnt(24)
  s_mov_b32 s54, 0x05040100
  s_mov_b32 s55, 0x07060302
  v_perm_b32 v4, v132, v128, s54
  v_perm_b32 v5, v140, v136, s54
  v_perm_b32 v6, v148, v144, s54
  v_perm_b32 v7, v156, v152, s54
  v_accvgpr_write_b32 a0, v4
  v_accvgpr_write_b32 a1, v5
  v_accvgpr_write_b32 a2, v6
  v_accvgpr_write_b32 a3, v7
  v_perm_b32 v4, v132, v128, s55
  v_perm_b32 v5, v140, v136, s55
  v_perm_b32 v6, v148, v144, s55
  v_perm_b32 v7, v156, v152, s55
  v_accvgpr_write_b32 a4, v4
  v_accvgpr_write_b32 a5, v5
  v_accvgpr_write_b32 a6, v6
  v_accvgpr_write_b32 a7, v7
  v_perm_b32 v4, v133, v129, s54
  v_perm_b32 v5, v141, v137, s54
  v_perm_b32 v6, v149, v145, s54
  v_perm_b32 v7, v157, v153, s54
  v_accvgpr_write_b32 a8, v4
  v_accvgpr_write_b32 a9, v5
  v_accvgpr_write_b32 a10, v6
  v_accvgpr_write_b32 a11, v7
  v_perm_b32 v4, v133, v129, s55
  v_perm_b32 v5, v141, v137, s55
  v_perm_b32 v6, v149, v145, s55
  v_perm_b32 v7, v157, v153, s55
  v_accvgpr_write_b32 a12, v4
  v_accvgpr_write_b32 a13, v5
  v_accvgpr_write_b32 a14, v6
  v_accvgpr_write_b32 a15, v7
  v_perm_b32 v4, v134, v130, s54
  v_perm_b32 v5, v142, v138, s54
  v_perm_b32 v6, v150, v146, s54
  v_perm_b32 v7, v158, v154, s54
  v_accvgpr_write_b32 a16, v4
  v_accvgpr_write_b32 a17, v5
  v_accvgpr_write_b32 a18, v6
  v_accvgpr_write_b32 a19, v7
  v_perm_b32 v4, v134, v130, s55
  v_perm_b32 v5, v142, v138, s55
  v_perm_b32 v6, v150, v146, s55
  v_perm_b32 v7, v158, v154, s55
  v_accvgpr_write_b32 a20, v4
  v_accvgpr_write_b32 a21, v5
  v_accvgpr_write_b32 a22, v6
  v_accvgpr_write_b32 a23, v7
  v_perm_b32 v4, v135, v131, s54
  v_perm_b32 v5, v143, v139, s54
  v_perm_b32 v6, v151, v147, s54
  v_perm_b32 v7, v159, v155, s54
  v_accvgpr_write_b32 a24, v4
  v_accvgpr_write_b32 a25, v5
  v_accvgpr_write_b32 a26, v6
  v_accvgpr_write_b32 a27, v7
  v_perm_b32 v4, v135, v131, s55
  v_perm_b32 v5, v143, v139, s55
  v_perm_b32 v6, v151, v147, s55
  v_perm_b32 v7, v159, v155, s55
  v_accvgpr_write_b32 a28, v4
  v_accvgpr_write_b32 a29, v5
  v_accvgpr_write_b32 a30, v6
  v_accvgpr_write_b32 a31, v7
  s_add_u32 s82, s84, 0
  buffer_load_dwordx4 v[128:131], v18, s[20:23], s82 offen offset:0
  buffer_load_dwordx4 v[132:135], v18, s[20:23], s82 offen offset:1024
  buffer_load_dwordx4 v[136:139], v18, s[20:23], s82 offen offset:2048
  buffer_load_dwordx4 v[140:143], v18, s[20:23], s82 offen offset:3072
  s_add_u32 s82, s84, 4096
  buffer_load_dwordx4 v[144:147], v18, s[20:23], s82 offen offset:0
  buffer_load_dwordx4 v[148:151], v18, s[20:23], s82 offen offset:1024
  buffer_load_dwordx4 v[152:155], v18, s[20:23], s82 offen offset:2048
  buffer_load_dwordx4 v[156:159], v18, s[20:23], s82 offen offset:3072
  s_waitcnt vmcnt(24)
  s_mov_b32 s54, 0x05040100
  s_mov_b32 s55, 0x07060302
  v_perm_b32 v4, v164, v160, s54
  v_perm_b32 v5, v172, v168, s54
  v_perm_b32 v6, v180, v176, s54
  v_perm_b32 v7, v188, v184, s54
  v_accvgpr_write_b32 a32, v4
  v_accvgpr_write_b32 a33, v5
  v_accvgpr_write_b32 a34, v6
  v_accvgpr_write_b32 a35, v7
  v_perm_b32 v4, v164, v160, s55
  v_perm_b32 v5, v172, v168, s55
  v_perm_b32 v6, v180, v176, s55
  v_perm_b32 v7, v188, v184, s55
  v_accvgpr_write_b32 a36, v4
  v_accvgpr_write_b32 a37, v5
  v_accvgpr_write_b32 a38, v6
  v_accvgpr_write_b32 a39, v7
  v_perm_b32 v4, v165, v161, s54
  v_perm_b32 v5, v173, v169, s54
  v_perm_b32 v6, v181, v177, s54
  v_perm_b32 v7, v189, v185, s54
  v_accvgpr_write_b32 a40, v4
  v_accvgpr_write_b32 a41, v5
  v_accvgpr_write_b32 a42, v6
  v_accvgpr_write_b32 a43, v7
  v_perm_b32 v4, v165, v161, s55
  v_perm_b32 v5, v173, v169, s55
  v_perm_b32 v6, v181, v177, s55
  v_perm_b32 v7, v189, v185, s55
  v_accvgpr_write_b32 a44, v4
  v_accvgpr_write_b32 a45, v5
  v_accvgpr_write_b32 a46, v6
  v_accvgpr_write_b32 a47, v7
  v_perm_b32 v4, v166, v162, s54
  v_perm_b32 v5, v174, v170, s54
  v_perm_b32 v6, v182, v178, s54
  v_perm_b32 v7, v190, v186, s54
  v_accvgpr_write_b32 a48, v4
  v_accvgpr_write_b32 a49, v5
  v_accvgpr_write_b32 a50, v6
  v_accvgpr_write_b32 a51, v7
  v_perm_b32 v4, v166, v162, s55
  v_perm_b32 v5, v174, v170, s55
  v_perm_b32 v6, v182, v178, s55
  v_perm_b32 v7, v190, v186, s55
  v_accvgpr_write_b32 a52, v4
  v_accvgpr_write_b32 a53, v5
  v_accvgpr_write_b32 a54, v6
  v_accvgpr_write_b32 a55, v7
  v_perm_b32 v4, v167, v163, s54
  v_perm_b32 v5, v175, v171, s54
  v_perm_b32 v6, v183, v179, s54
  v_perm_b32 v7, v191, v187, s54
  v_accvgpr_write_b32 a56, v4
  v_accvgpr_write_b32 a57, v5
  v_accvgpr_write_b32 a58, v6
  v_accvgpr_write_b32 a59, v7
  v_perm_b32 v4, v167, v163, s55
  v_perm_b32 v5, v175, v171, s55
  v_perm_b32 v6, v183, v179, s55
  v_perm_b32 v7, v191, v187, s55
  v_accvgpr_write_b32 a60, v4
  v_accvgpr_write_b32 a61, v5
  v_accvgpr_write_b32 a62, v6
  v_accvgpr_write_b32 a63, v7
  s_add_u32 s82, s84, 32768
  buffer_load_dwordx4 v[160:163], v18, s[20:23], s82 offen offset:0
  buffer_load_dwordx4 v[164:167], v18, s[20:23], s82 offen offset:1024
  buffer_load_dwordx4 v[168:171], v18, s[20:23], s82 offen offset:2048
  buffer_load_dwordx4 v[172:175], v18, s[20:23], s82 offen offset:3072
  s_add_u32 s82, s84, 36864
  buffer_load_dwordx4 v[176:179], v18, s[20:23], s82 offen offset:0
  buffer_load_dwordx4 v[180:183], v18, s[20:23], s82 offen offset:1024
  buffer_load_dwordx4 v[184:187], v18, s[20:23], s82 offen offset:2048
  buffer_load_dwordx4 v[188:191], v18, s[20:23], s82 offen offset:3072
  s_waitcnt vmcnt(24)
  s_mov_b32 s54, 0x05040100
  s_mov_b32 s55, 0x07060302
  v_perm_b32 v4, v196, v192, s54
  v_perm_b32 v5, v204, v200, s54
  v_perm_b32 v6, v212, v208, s54
  v_perm_b32 v7, v220, v216, s54
  v_accvgpr_write_b32 a64, v4
  v_accvgpr_write_b32 a65, v5
  v_accvgpr_write_b32 a66, v6
  v_accvgpr_write_b32 a67, v7
  v_perm_b32 v4, v196, v192, s55
  v_perm_b32 v5, v204, v200, s55
  v_perm_b32 v6, v212, v208, s55
  v_perm_b32 v7, v220, v216, s55
  v_accvgpr_write_b32 a68, v4
  v_accvgpr_write_b32 a69, v5
  v_accvgpr_write_b32 a70, v6
  v_accvgpr_write_b32 a71, v7
  v_perm_b32 v4, v197, v193, s54
  v_perm_b32 v5, v205, v201, s54
  v_perm_b32 v6, v213, v209, s54
  v_perm_b32 v7, v221, v217, s54
  v_accvgpr_write_b32 a72, v4
  v_accvgpr_write_b32 a73, v5
  v_accvgpr_write_b32 a74, v6
  v_accvgpr_write_b32 a75, v7
  v_perm_b32 v4, v197, v193, s55
  v_perm_b32 v5, v205, v201, s55
  v_perm_b32 v6, v213, v209, s55
  v_perm_b32 v7, v221, v217, s55
  v_accvgpr_write_b32 a76, v4
  v_accvgpr_write_b32 a77, v5
  v_accvgpr_write_b32 a78, v6
  v_accvgpr_write_b32 a79, v7
  v_perm_b32 v4, v198, v194, s54
  v_perm_b32 v5, v206, v202, s54
  v_perm_b32 v6, v214, v210, s54
  v_perm_b32 v7, v222, v218, s54
  v_accvgpr_write_b32 a80, v4
  v_accvgpr_write_b32 a81, v5
  v_accvgpr_write_b32 a82, v6
  v_accvgpr_write_b32 a83, v7
  v_perm_b32 v4, v198, v194, s55
  v_perm_b32 v5, v206, v202, s55
  v_perm_b32 v6, v214, v210, s55
  v_perm_b32 v7, v222, v218, s55
  v_accvgpr_write_b32 a84, v4
  v_accvgpr_write_b32 a85, v5
  v_accvgpr_write_b32 a86, v6
  v_accvgpr_write_b32 a87, v7
  v_perm_b32 v4, v199, v195, s54
  v_perm_b32 v5, v207, v203, s54
  v_perm_b32 v6, v215, v211, s54
  v_perm_b32 v7, v223, v219, s54
  v_accvgpr_write_b32 a88, v4
  v_accvgpr_write_b32 a89, v5
  v_accvgpr_write_b32 a90, v6
  v_accvgpr_write_b32 a91, v7
  v_perm_b32 v4, v199, v195, s55
  v_perm_b32 v5, v207, v203, s55
  v_perm_b32 v6, v215, v211, s55
  v_perm_b32 v7, v223, v219, s55
  v_accvgpr_write_b32 a92, v4
  v_accvgpr_write_b32 a93, v5
  v_accvgpr_write_b32 a94, v6
  v_accvgpr_write_b32 a95, v7
  s_add_u32 s82, s84, 0
  buffer_load_dwordx4 v[192:195], v19, s[20:23], s82 offen offset:0
  buffer_load_dwordx4 v[196:199], v19, s[20:23], s82 offen offset:1024
  buffer_load_dwordx4 v[200:203], v19, s[20:23], s82 offen offset:2048
  buffer_load_dwordx4 v[204:207], v19, s[20:23], s82 offen offset:3072
  s_add_u32 s82, s84, 4096
  buffer_load_dwordx4 v[208:211], v19, s[20:23], s82 offen offset:0
  buffer_load_dwordx4 v[212:215], v19, s[20:23], s82 offen offset:1024
  buffer_load_dwordx4 v[216:219], v19, s[20:23], s82 offen offset:2048
  buffer_load_dwordx4 v[220:223], v19, s[20:23], s82 offen offset:3072
  s_waitcnt vmcnt(24)
  s_mov_b32 s54, 0x05040100
  s_mov_b32 s55, 0x07060302
  v_perm_b32 v4, v228, v224, s54
  v_perm_b32 v5, v236, v232, s54
  v_perm_b32 v6, v244, v240, s54
  v_perm_b32 v7, v252, v248, s54
  v_accvgpr_write_b32 a96, v4
  v_accvgpr_write_b32 a97, v5
  v_accvgpr_write_b32 a98, v6
  v_accvgpr_write_b32 a99, v7
  v_perm_b32 v4, v228, v224, s55
  v_perm_b32 v5, v236, v232, s55
  v_perm_b32 v6, v244, v240, s55
  v_perm_b32 v7, v252, v248, s55
  v_accvgpr_write_b32 a100, v4
  v_accvgpr_write_b32 a101, v5
  v_accvgpr_write_b32 a102, v6
  v_accvgpr_write_b32 a103, v7
  v_perm_b32 v4, v229, v225, s54
  v_perm_b32 v5, v237, v233, s54
  v_perm_b32 v6, v245, v241, s54
  v_perm_b32 v7, v253, v249, s54
  v_accvgpr_write_b32 a104, v4
  v_accvgpr_write_b32 a105, v5
  v_accvgpr_write_b32 a106, v6
  v_accvgpr_write_b32 a107, v7
  v_perm_b32 v4, v229, v225, s55
  v_perm_b32 v5, v237, v233, s55
  v_perm_b32 v6, v245, v241, s55
  v_perm_b32 v7, v253, v249, s55
  v_accvgpr_write_b32 a108, v4
  v_accvgpr_write_b32 a109, v5
  v_accvgpr_write_b32 a110, v6
  v_accvgpr_write_b32 a111, v7
  v_perm_b32 v4, v230, v226, s54
  v_perm_b32 v5, v238, v234, s54
  v_perm_b32 v6, v246, v242, s54
  v_perm_b32 v7, v254, v250, s54
  v_accvgpr_write_b32 a112, v4
  v_accvgpr_write_b32 a113, v5
  v_accvgpr_write_b32 a114, v6
  v_accvgpr_write_b32 a115, v7
  v_perm_b32 v4, v230, v226, s55
  v_perm_b32 v5, v238, v234, s55
  v_perm_b32 v6, v246, v242, s55
  v_perm_b32 v7, v254, v250, s55
  v_accvgpr_write_b32 a116, v4
  v_accvgpr_write_b32 a117, v5
  v_accvgpr_write_b32 a118, v6
  v_accvgpr_write_b32 a119, v7
  v_perm_b32 v4, v231, v227, s54
  v_perm_b32 v5, v239, v235, s54
  v_perm_b32 v6, v247, v243, s54
  v_perm_b32 v7, v255, v251, s54
  v_accvgpr_write_b32 a120, v4
  v_accvgpr_write_b32 a121, v5
  v_accvgpr_write_b32 a122, v6
  v_accvgpr_write_b32 a123, v7
  v_perm_b32 v4, v231, v227, s55
  v_perm_b32 v5, v239, v235, s55
  v_perm_b32 v6, v247, v243, s55
  v_perm_b32 v7, v255, v251, s55
  v_accvgpr_write_b32 a124, v4
  v_accvgpr_write_b32 a125, v5
  v_accvgpr_write_b32 a126, v6
  v_accvgpr_write_b32 a127, v7
  s_add_u32 s82, s84, 32768
  buffer_load_dwordx4 v[224:227], v19, s[20:23], s82 offen offset:0
  buffer_load_dwordx4 v[228:231], v19, s[20:23], s82 offen offset:1024
  buffer_load_dwordx4 v[232:235], v19, s[20:23], s82 offen offset:2048
  buffer_load_dwordx4 v[236:239], v19, s[20:23], s82 offen offset:3072
  s_add_u32 s82, s84, 36864
  buffer_load_dwordx4 v[240:243], v19, s[20:23], s82 offen offset:0
  buffer_load_dwordx4 v[244:247], v19, s[20:23], s82 offen offset:1024
  buffer_load_dwordx4 v[248:251], v19, s[20:23], s82 offen offset:2048
  buffer_load_dwordx4 v[252:255], v19, s[20:23], s82 offen offset:3072
  s_waitcnt vmcnt(24)
  s_mov_b32 s54, 0x05040100
  s_mov_b32 s55, 0x07060302
  v_perm_b32 v4, v132, v128, s54
  v_perm_b32 v5, v140, v136, s54
  v_perm_b32 v6, v148, v144, s54
  v_perm_b32 v7, v156, v152, s54
  v_accvgpr_write_b32 a128, v4
  v_accvgpr_write_b32 a129, v5
  v_accvgpr_write_b32 a130, v6
  v_accvgpr_write_b32 a131, v7
  v_perm_b32 v4, v132, v128, s55
  v_perm_b32 v5, v140, v136, s55
  v_perm_b32 v6, v148, v144, s55
  v_perm_b32 v7, v156, v152, s55
  v_accvgpr_write_b32 a132, v4
  v_accvgpr_write_b32 a133, v5
  v_accvgpr_write_b32 a134, v6
  v_accvgpr_write_b32 a135, v7
  v_perm_b32 v4, v133, v129, s54
  v_perm_b32 v5, v141, v137, s54
  v_perm_b32 v6, v149, v145, s54
  v_perm_b32 v7, v157, v153, s54
  v_accvgpr_write_b32 a136, v4
  v_accvgpr_write_b32 a137, v5
  v_accvgpr_write_b32 a138, v6
  v_accvgpr_write_b32 a139, v7
  v_perm_b32 v4, v133, v129, s55
  v_perm_b32 v5, v141, v137, s55
  v_perm_b32 v6, v149, v145, s55
  v_perm_b32 v7, v157, v153, s55
  v_accvgpr_write_b32 a140, v4
  v_accvgpr_write_b32 a141, v5
  v_accvgpr_write_b32 a142, v6
  v_accvgpr_write_b32 a143, v7
  v_perm_b32 v4, v134, v130, s54
  v_perm_b32 v5, v142, v138, s54
  v_perm_b32 v6, v150, v146, s54
  v_perm_b32 v7, v158, v154, s54
  v_accvgpr_write_b32 a144, v4
  v_accvgpr_write_b32 a145, v5
  v_accvgpr_write_b32 a146, v6
  v_accvgpr_write_b32 a147, v7
  v_perm_b32 v4, v134, v130, s55
  v_perm_b32 v5, v142, v138, s55
  v_perm_b32 v6, v150, v146, s55
  v_perm_b32 v7, v158, v154, s55
  v_accvgpr_write_b32 a148, v4
  v_accvgpr_write_b32 a149, v5
  v_accvgpr_write_b32 a150, v6
  v_accvgpr_write_b32 a151, v7
  v_perm_b32 v4, v135, v131, s54
  v_perm_b32 v5, v143, v139, s54
  v_perm_b32 v6, v151, v147, s54
  v_perm_b32 v7, v159, v155, s54
  v_accvgpr_write_b32 a152, v4
  v_accvgpr_write_b32 a153, v5
  v_accvgpr_write_b32 a154, v6
  v_accvgpr_write_b32 a155, v7
  v_perm_b32 v4, v135, v131, s55
  v_perm_b32 v5, v143, v139, s55
  v_perm_b32 v6, v151, v147, s55
  v_perm_b32 v7, v159, v155, s55
  v_accvgpr_write_b32 a156, v4
  v_accvgpr_write_b32 a157, v5
  v_accvgpr_write_b32 a158, v6
  v_accvgpr_write_b32 a159, v7
  s_waitcnt vmcnt(16)
  s_mov_b32 s54, 0x05040100
  s_mov_b32 s55, 0x07060302
  v_perm_b32 v4, v164, v160, s54
  v_perm_b32 v5, v172, v168, s54
  v_perm_b32 v6, v180, v176, s54
  v_perm_b32 v7, v188, v184, s54
  v_accvgpr_write_b32 a160, v4
  v_accvgpr_write_b32 a161, v5
  v_accvgpr_write_b32 a162, v6
  v_accvgpr_write_b32 a163, v7
  v_perm_b32 v4, v164, v160, s55
  v_perm_b32 v5, v172, v168, s55
  v_perm_b32 v6, v180, v176, s55
  v_perm_b32 v7, v188, v184, s55
  v_accvgpr_write_b32 a164, v4
  v_accvgpr_write_b32 a165, v5
  v_accvgpr_write_b32 a166, v6
  v_accvgpr_write_b32 a167, v7
  v_perm_b32 v4, v165, v161, s54
  v_perm_b32 v5, v173, v169, s54
  v_perm_b32 v6, v181, v177, s54
  v_perm_b32 v7, v189, v185, s54
  v_accvgpr_write_b32 a168, v4
  v_accvgpr_write_b32 a169, v5
  v_accvgpr_write_b32 a170, v6
  v_accvgpr_write_b32 a171, v7
  v_perm_b32 v4, v165, v161, s55
  v_perm_b32 v5, v173, v169, s55
  v_perm_b32 v6, v181, v177, s55
  v_perm_b32 v7, v189, v185, s55
  v_accvgpr_write_b32 a172, v4
  v_accvgpr_write_b32 a173, v5
  v_accvgpr_write_b32 a174, v6
  v_accvgpr_write_b32 a175, v7
  v_perm_b32 v4, v166, v162, s54
  v_perm_b32 v5, v174, v170, s54
  v_perm_b32 v6, v182, v178, s54
  v_perm_b32 v7, v190, v186, s54
  v_accvgpr_write_b32 a176, v4
  v_accvgpr_write_b32 a177, v5
  v_accvgpr_write_b32 a178, v6
  v_accvgpr_write_b32 a179, v7
  v_perm_b32 v4, v166, v162, s55
  v_perm_b32 v5, v174, v170, s55
  v_perm_b32 v6, v182, v178, s55
  v_perm_b32 v7, v190, v186, s55
  v_accvgpr_write_b32 a180, v4
  v_accvgpr_write_b32 a181, v5
  v_accvgpr_write_b32 a182, v6
  v_accvgpr_write_b32 a183, v7
  v_perm_b32 v4, v167, v163, s54
  v_perm_b32 v5, v175, v171, s54
  v_perm_b32 v6, v183, v179, s54
  v_perm_b32 v7, v191, v187, s54
  v_accvgpr_write_b32 a184, v4
  v_accvgpr_write_b32 a185, v5
  v_accvgpr_write_b32 a186, v6
  v_accvgpr_write_b32 a187, v7
  v_perm_b32 v4, v167, v163, s55
  v_perm_b32 v5, v175, v171, s55
  v_perm_b32 v6, v183, v179, s55
  v_perm_b32 v7, v191, v187, s55
  v_accvgpr_write_b32 a188, v4
  v_accvgpr_write_b32 a189, v5
  v_accvgpr_write_b32 a190, v6
  v_accvgpr_write_b32 a191, v7
  s_waitcnt vmcnt(8)
  s_mov_b32 s54, 0x05040100
  s_mov_b32 s55, 0x07060302
  v_perm_b32 v4, v196, v192, s54
  v_perm_b32 v5, v204, v200, s54
  v_perm_b32 v6, v212, v208, s54
  v_perm_b32 v7, v220, v216, s54
  v_accvgpr_write_b32 a192, v4
  v_accvgpr_write_b32 a193, v5
  v_accvgpr_write_b32 a194, v6
  v_accvgpr_write_b32 a195, v7
  v_perm_b32 v4, v196, v192, s55
  v_perm_b32 v5, v204, v200, s55
  v_perm_b32 v6, v212, v208, s55
  v_perm_b32 v7, v220, v216, s55
  v_accvgpr_write_b32 a196, v4
  v_accvgpr_write_b32 a197, v5
  v_accvgpr_write_b32 a198, v6
  v_accvgpr_write_b32 a199, v7
  v_perm_b32 v4, v197, v193, s54
  v_perm_b32 v5, v205, v201, s54
  v_perm_b32 v6, v213, v209, s54
  v_perm_b32 v7, v221, v217, s54
  v_accvgpr_write_b32 a200, v4
  v_accvgpr_write_b32 a201, v5
  v_accvgpr_write_b32 a202, v6
  v_accvgpr_write_b32 a203, v7
  v_perm_b32 v4, v197, v193, s55
  v_perm_b32 v5, v205, v201, s55
  v_perm_b32 v6, v213, v209, s55
  v_perm_b32 v7, v221, v217, s55
  v_accvgpr_write_b32 a204, v4
  v_accvgpr_write_b32 a205, v5
  v_accvgpr_write_b32 a206, v6
  v_accvgpr_write_b32 a207, v7
  v_perm_b32 v4, v198, v194, s54
  v_perm_b32 v5, v206, v202, s54
  v_perm_b32 v6, v214, v210, s54
  v_perm_b32 v7, v222, v218, s54
  v_accvgpr_write_b32 a208, v4
  v_accvgpr_write_b32 a209, v5
  v_accvgpr_write_b32 a210, v6
  v_accvgpr_write_b32 a211, v7
  v_perm_b32 v4, v198, v194, s55
  v_perm_b32 v5, v206, v202, s55
  v_perm_b32 v6, v214, v210, s55
  v_perm_b32 v7, v222, v218, s55
  v_accvgpr_write_b32 a212, v4
  v_accvgpr_write_b32 a213, v5
  v_accvgpr_write_b32 a214, v6
  v_accvgpr_write_b32 a215, v7
  v_perm_b32 v4, v199, v195, s54
  v_perm_b32 v5, v207, v203, s54
  v_perm_b32 v6, v215, v211, s54
  v_perm_b32 v7, v223, v219, s54
  v_accvgpr_write_b32 a216, v4
  v_accvgpr_write_b32 a217, v5
  v_accvgpr_write_b32 a218, v6
  v_accvgpr_write_b32 a219, v7
  v_perm_b32 v4, v199, v195, s55
  v_perm_b32 v5, v207, v203, s55
  v_perm_b32 v6, v215, v211, s55
  v_perm_b32 v7, v223, v219, s55
  v_accvgpr_write_b32 a220, v4
  v_accvgpr_write_b32 a221, v5
  v_accvgpr_write_b32 a222, v6
  v_accvgpr_write_b32 a223, v7
  s_waitcnt vmcnt(0)
  s_mov_b32 s54, 0x05040100
  s_mov_b32 s55, 0x07060302
  v_perm_b32 v4, v228, v224, s54
  v_perm_b32 v5, v236, v232, s54
  v_perm_b32 v6, v244, v240, s54
  v_perm_b32 v7, v252, v248, s54
  v_accvgpr_write_b32 a224, v4
  v_accvgpr_write_b32 a225, v5
  v_accvgpr_write_b32 a226, v6
  v_accvgpr_write_b32 a227, v7
  v_perm_b32 v4, v228, v224, s55
  v_perm_b32 v5, v236, v232, s55
  v_perm_b32 v6, v244, v240, s55
  v_perm_b32 v7, v252, v248, s55
  v_accvgpr_write_b32 a228, v4
  v_accvgpr_write_b32 a229, v5
  v_accvgpr_write_b32 a230, v6
  v_accvgpr_write_b32 a231, v7
  v_perm_b32 v4, v229, v225, s54
  v_perm_b32 v5, v237, v233, s54
  v_perm_b32 v6, v245, v241, s54
  v_perm_b32 v7, v253, v249, s54
  v_accvgpr_write_b32 a232, v4
  v_accvgpr_write_b32 a233, v5
  v_accvgpr_write_b32 a234, v6
  v_accvgpr_write_b32 a235, v7
  v_perm_b32 v4, v229, v225, s55
  v_perm_b32 v5, v237, v233, s55
  v_perm_b32 v6, v245, v241, s55
  v_perm_b32 v7, v253, v249, s55
  v_accvgpr_write_b32 a236, v4
  v_accvgpr_write_b32 a237, v5
  v_accvgpr_write_b32 a238, v6
  v_accvgpr_write_b32 a239, v7
  v_perm_b32 v4, v230, v226, s54
  v_perm_b32 v5, v238, v234, s54
  v_perm_b32 v6, v246, v242, s54
  v_perm_b32 v7, v254, v250, s54
  v_accvgpr_write_b32 a240, v4
  v_accvgpr_write_b32 a241, v5
  v_accvgpr_write_b32 a242, v6
  v_accvgpr_write_b32 a243, v7
  v_perm_b32 v4, v230, v226, s55
  v_perm_b32 v5, v238, v234, s55
  v_perm_b32 v6, v246, v242, s55
  v_perm_b32 v7, v254, v250, s55
  v_accvgpr_write_b32 a244, v4
  v_accvgpr_write_b32 a245, v5
  v_accvgpr_write_b32 a246, v6
  v_accvgpr_write_b32 a247, v7
  v_perm_b32 v4, v231, v227, s54
  v_perm_b32 v5, v239, v235, s54
  v_perm_b32 v6, v247, v243, s54
  v_perm_b32 v7, v255, v251, s54
  v_accvgpr_write_b32 a248, v4
  v_accvgpr_write_b32 a249, v5
  v_accvgpr_write_b32 a250, v6
  v_accvgpr_write_b32 a251, v7
  v_perm_b32 v4, v231, v227, s55
  v_perm_b32 v5, v239, v235, s55
  v_perm_b32 v6, v247, v243, s55
  v_perm_b32 v7, v255, v251, s55
  v_accvgpr_write_b32 a252, v4
  v_accvgpr_write_b32 a253, v5
  v_accvgpr_write_b32 a254, v6
  v_accvgpr_write_b32 a255, v7
  v_bfe_i32 v249, v0, 5, 1
  v_or_b32 v250, -2, v249
  v_and_b32 v248, 0x20000, v249
  v_and_b32 v251, 0xffff, v91
  v_or_b32 v248, v248, v251
  s_mov_b32 s84, 0x3e0293ee
  s_mov_b32 s71, -1
  s_mov_b32 s77, 1
  s_sub_u32 s86, s86, 1
  s_add_u32 s75, s75, 0x200000
  s_add_u32 s76, s76, 0x200000
  s_add_u32 s91, s89, 0x3f0000
  s_add_u32 s89, s89, 0x10000
  v_lshlrev_b32 v2, 2, v0
  s_lshr_b32 s58, s50, 5
  s_bitcmp1_b32 0xca, s58
  s_cselect_b32 s58, -1, 0xffff
  s_and_b32 s59, s58, 0x20303040
  s_add_u32 s59, s59, 256
o1_cnt:
  s_sub_u32 s51, s51, 1
  s_cbranch_scc1 main_end
  buffer_load_dword v1, v2, s[36:39], 0 offen sc1
  s_waitcnt vmcnt(0)
  v_readlane_b32 s60, v1, 0
  v_readlane_b32 s61, v1, 48
  v_readlane_b32 s62, v1, 16
  v_readlane_b32 s63, v1, 49
  v_readlane_b32 s64, v1, 50
  v_readlane_b32 s65, v1, 51
  v_readlane_b32 s66, v1, 32
  v_readlane_b32 s67, v1, 33
  v_readlane_b32 s57, v1, 17
  s_add_u32 s56, s60, s61
  s_add_u32 s56, s56, s62
  s_add_u32 s56, s56, s63
  s_add_u32 s56, s56, s64
  s_add_u32 s56, s56, s65
  s_add_u32 s56, s56, s66
  s_add_u32 s56, s56, s67
  s_and_b32 s57, s57, s58
  s_add_u32 s56, s56, s57
  s_cmp_lt_u32 s56, s59
  s_cbranch_scc1 o1_cnt
  v_and_b32 v0, 5, v0
  v_lshlrev_b32 v0, 4, v0
o_f0:
  s_sub_u32 s51, s51, 1
  s_cbranch_scc1 main_end
  buffer_load_dword v105, v0, s[4:7], s79 offen sc1
  s_waitcnt vmcnt(0)
  v_cmp_eq_u32 vcc, 0, v105
  s_cbranch_vccnz o_f0
  s_mov_b32 m0, s83
  s_nop 0
  buffer_load_dwordx4 v89, s[4:7], s78 offen offset:0 sc1 lds
  buffer_load_dwordx4 v89, s[4:7], s78 offen offset:1024 sc1 lds
  s_add_u32 m0, s83, 0x4000
  s_add_u32 s70, s78, 8192
  buffer_load_dwordx4 v89, s[4:7], s70 offen offset:0 sc1 lds
  buffer_load_dwordx4 v89, s[4:7], s70 offen offset:1024 sc1 lds
  s_mov_b32 m0, s88
  s_sub_u32 s70, s78, s90
  buffer_load_dwordx4 v89, s[4:7], s70 offen offset:0 sc1 lds
  s_add_u32 m0, s88, 0x1000
  s_add_u32 s70, s70, 8192
  buffer_load_dwordx4 v89, s[4:7], s70 offen offset:0 sc1 lds
  s_bfe_u32 s92, s79, 0x6000b
  s_cmp_lt_u32 s92, 63
  s_cselect_b32 s92, 0x800, 0
  s_add_u32 s79, s79, s92
  s_lshl_b32 s92, s92, 7
  s_mov_b32 m0, s83
  s_add_u32 s70, s78, 0x1fff800
  buffer_load_dwordx4 v89, s[4:7], s70 offen offset:2048 sc1 lds
  buffer_load_dwordx4 v89, s[4:7], s70 offen offset:3072 sc1 lds
  s_add_u32 m0, s83, 0x4000
  s_add_u32 s70, s70, 8192
  buffer_load_dwordx4 v89, s[4:7], s70 offen offset:2048 sc1 lds
  buffer_load_dwordx4 v89, s[4:7], s70 offen offset:3072 sc1 lds
  s_add_u32 s78, s78, s92
  s_xor_b32 s83, s83, 0x10000
  s_xor_b32 s88, s88, 0x10000
o_f1:
  s_sub_u32 s51, s51, 1
  s_cbranch_scc1 main_end
  buffer_load_dword v105, v0, s[4:7], s79 offen sc1
  s_waitcnt vmcnt(0)
  v_cmp_eq_u32 vcc, 0, v105
  s_cbranch_vccnz o_f1
  s_mov_b32 m0, s83
  s_nop 0
  buffer_load_dwordx4 v89, s[4:7], s78 offen offset:0 sc1 lds
  buffer_load_dwordx4 v89, s[4:7], s78 offen offset:1024 sc1 lds
  s_add_u32 m0, s83, 0x4000
  s_add_u32 s70, s78, 8192
  buffer_load_dwordx4 v89, s[4:7], s70 offen offset:0 sc1 lds
  buffer_load_dwordx4 v89, s[4:7], s70 offen offset:1024 sc1 lds
  s_mov_b32 m0, s88
  s_sub_u32 s70, s78, s90
  buffer_load_dwordx4 v89, s[4:7], s70 offen offset:0 sc1 lds
  s_add_u32 m0, s88, 0x1000
  s_add_u32 s70, s70, 8192
  buffer_load_dwordx4 v89, s[4:7], s70 offen offset:0 sc1 lds
  s_bfe_u32 s92, s79, 0x6000b
  s_cmp_lt_u32 s92, 63
  s_cselect_b32 s92, 0x800, 0
  s_add_u32 s79, s79, s92
  s_lshl_b32 s92, s92, 7
  s_add_u32 s87, s80, 4096
  s_waitcnt vmcnt(0)
  s_barrier
  v_mov_b32 v106, 0
  buffer_load_dwordx4 v[20:23], v96, s[4:7], s80 offen offset:1024 sc1
  buffer_load_dwordx4 v[24:27], v96, s[4:7], s87 offen offset:1024 sc1
  buffer_load_dwordx4 v[72:75], v104, s[4:7], s80 offen offset:0 sc1
  buffer_load_dwordx4 v[76:79], v104, s[4:7], s80 offen offset:2048 sc1
  buffer_load_dword v105, v0, s[4:7], s79 offen sc1
  ds_read_b128 v[232:235], v102 offset:32768
  ds_read_b128 v[200:203], v101 offset:0
  ds_read_b128 v[204:207], v101 offset:1024
  ds_read_b128 v[236:239], v102 offset:33792
  ds_read_b128 v[208:211], v101 offset:4096
  ds_read_b128 v[212:215], v101 offset:5120
  ds_read_b128 v[240:243], v102 offset:34816
  ds_read_b128 v[216:219], v101 offset:8192
  ds_read_b128 v[220:223], v101 offset:9216
  ds_read_b128 v[244:247], v102 offset:35840
  ds_read_b128 v[224:227], v101 offset:12288
  ds_read_b128 v[228:231], v101 offset:13312
  v_xor_b32 v101, 0x10000, v101
  v_xor_b32 v102, 0x10000, v102
  s_waitcnt vmcnt(0) lgkmcnt(0)
  s_cmp_lt_u32 s85, 32
  s_mov_b32 s85, 1
  s_mov_b32 s73, s52
  s_mov_b32 s74, s52
  s_cbranch_scc1 o1_att
  s_branch o0_att
o0_top:
  v_mfma_f32_16x16x16_bf16 v[4:7], v[72:73], v[56:57], v[4:7]
  s_add_u32 s71, s71, 1
  s_lshr_b32 s77, s71, 1
  s_add_u32 s75, s75, 0x200000
  v_mfma_f32_16x16x16_bf16 v[8:11], v[74:75], v[56:57], v[8:11]
  s_and_b32 s75, s75, 0xffbfffff
  s_lshl_b32 s74, s71, 16
  s_add_u32 s74, s74, s89
  v_mfma_f32_16x16x16_bf16 v[12:15], v[76:77], v[56:57], v[12:15]
  v_mfma_f32_16x16x16_bf16 v[16:19], v[78:79], v[56:57], v[16:19]
  v_pk_mul_f32 v[4:5], v[4:5], v[52:53] op_sel_hi:[1,0]
  v_pk_mul_f32 v[6:7], v[6:7], v[52:53] op_sel_hi:[1,0]
  v_cvt_pk_bf16_f32 v152, v4, v5
  v_pk_mul_f32 v[8:9], v[8:9], v[52:53] op_sel_hi:[1,0]
  v_pk_mul_f32 v[10:11], v[10:11], v[52:53] op_sel_hi:[1,0]
  v_cvt_pk_bf16_f32 v153, v6, v7
  v_cvt_pk_bf16_f32 v154, v8, v9
  v_cvt_pk_bf16_f32 v155, v10, v11
  v_pk_mul_f32 v[12:13], v[12:13], v[52:53] op_sel_hi:[1,0]
  v_pk_mul_f32 v[14:15], v[14:15], v[52:53] op_sel_hi:[1,0]
  v_mfma_f32_16x16x32_bf16 v[120:123], v[152:155], a[0:3], 0
  v_cvt_pk_bf16_f32 v156, v12, v13
  v_cvt_pk_bf16_f32 v157, v14, v15
  v_mfma_f32_16x16x32_bf16 v[124:127], v[152:155], a[4:7], 0
  ds_write_b128 v97, v[152:155] offset:0
  v_mfma_f32_16x16x32_bf16 v[128:131], v[152:155], a[8:11], 0
  v_mfma_f32_16x16x32_bf16 v[132:135], v[152:155], a[12:15], 0
  v_mfma_f32_16x16x32_bf16 v[136:139], v[152:155], a[16:19], 0
  v_mfma_f32_16x16x32_bf16 v[140:143], v[152:155], a[20:23], 0
  v_mfma_f32_16x16x32_bf16 v[144:147], v[152:155], a[24:27], 0
  v_pk_mul_f32 v[16:17], v[16:17], v[52:53] op_sel_hi:[1,0]
  v_mfma_f32_16x16x32_bf16 v[148:151], v[152:155], a[28:31], 0
  v_cvt_pk_bf16_f32 v158, v16, v17
  v_pk_mul_f32 v[18:19], v[18:19], v[52:53] op_sel_hi:[1,0]
  v_cvt_pk_bf16_f32 v159, v18, v19
  s_nop 1
  v_mfma_f32_16x16x32_bf16 v[120:123], v[156:159], a[32:35], v[120:123]
  ds_write_b128 v97, v[156:159] offset:1024
  v_mfma_f32_16x16x32_bf16 v[124:127], v[156:159], a[36:39], v[124:127]
  buffer_load_dwordx4 v[184:187], v88, s[4:7], s76 offen offset:0 sc1
  v_mfma_f32_16x16x32_bf16 v[128:131], v[156:159], a[40:43], v[128:131]
  s_waitcnt lgkmcnt(0)
  s_barrier
  ds_read_b128 v[160:163], v99 offset:0
  v_mfma_f32_16x16x32_bf16 v[132:135], v[156:159], a[44:47], v[132:135]
  ds_read_b128 v[164:167], v99 offset:1024
  ds_read_b128 v[168:171], v98 offset:0
  ds_read_b128 v[172:175], v98 offset:1024
  v_mfma_f32_16x16x32_bf16 v[136:139], v[156:159], a[48:51], v[136:139]
  ds_read_b128 v[176:179], v100 offset:0
  s_waitcnt vmcnt(11)
  v_cmp_eq_u32 vcc, -1, v106
  v_mfma_f32_16x16x32_bf16 v[140:143], v[156:159], a[52:55], v[140:143]
  ds_read_b128 v[180:183], v100 offset:1024
  buffer_load_dwordx4 v[188:191], v88, s[4:7], s76 offen offset:1024 sc1
  v_mfma_f32_16x16x32_bf16 v[144:147], v[156:159], a[56:59], v[144:147]
  s_cbranch_vccnz o0_res
o0_res_ok:
  v_mfma_f32_16x16x32_bf16 v[148:151], v[156:159], a[60:63], v[148:151]
  s_sub_u32 s72, s74, 0x410000
  v_lshlrev_b32 v60, 16, v106
  v_and_b32 v61, 0xffff0000, v106
  v_lshlrev_b32 v62, 16, v107
  v_and_b32 v63, 0xffff0000, v107
  s_add_u32 s80, s80, 0x40000
  s_waitcnt lgkmcnt(5)
  v_mfma_f32_16x16x32_bf16 v[120:123], v[160:163], a[64:67], v[120:123]
  s_add_u32 s87, s80, 4096
  buffer_load_dwordx4 v[192:195], v88, s[4:7], s76 offen offset:2048 sc1
  v_mfma_f32_16x16x32_bf16 v[124:127], v[160:163], a[68:71], v[124:127]
  s_waitcnt lgkmcnt(4)
  v_mfma_f32_16x16x32_bf16 v[128:131], v[160:163], a[72:75], v[128:131]
  v_mfma_f32_16x16x32_bf16 v[132:135], v[160:163], a[76:79], v[132:135]
  v_mfma_f32_16x16x32_bf16 v[136:139], v[160:163], a[80:83], v[136:139]
  buffer_load_dwordx4 v[196:199], v88, s[4:7], s76 offen offset:3072 sc1
  v_mfma_f32_16x16x32_bf16 v[140:143], v[160:163], a[84:87], v[140:143]
  v_mfma_f32_16x16x32_bf16 v[144:147], v[160:163], a[88:91], v[144:147]
  v_mfma_f32_16x16x32_bf16 v[148:151], v[160:163], a[92:95], v[148:151]
  v_mfma_f32_16x16x32_bf16 v[120:123], v[164:167], a[96:99], v[120:123]
  buffer_load_dwordx4 v[20:23], v96, s[4:7], s80 offen offset:1024
  v_mfma_f32_16x16x32_bf16 v[124:127], v[164:167], a[100:103], v[124:127]
  s_waitcnt lgkmcnt(3)
  v_mfma_f32_16x16x32_bf16 v[128:131], v[164:167], a[104:107], v[128:131]
  v_mfma_f32_16x16x32_bf16 v[132:135], v[164:167], a[108:111], v[132:135]
  v_mfma_f32_16x16x32_bf16 v[136:139], v[164:167], a[112:115], v[136:139]
  buffer_load_dwordx4 v[24:27], v96, s[4:7], s87 offen offset:1024
  v_mfma_f32_16x16x32_bf16 v[140:143], v[164:167], a[116:119], v[140:143]
  v_mfma_f32_16x16x32_bf16 v[144:147], v[164:167], a[120:123], v[144:147]
  v_mfma_f32_16x16x32_bf16 v[148:151], v[164:167], a[124:127], v[148:151]
  v_mfma_f32_16x16x32_bf16 v[120:123], v[168:171], a[128:131], v[120:123]
  buffer_load_dwordx4 v[72:75], v104, s[4:7], s80 offen offset:0
  s_waitcnt vmcnt(6)
  v_mfma_f32_16x16x32_bf16 v[108:111], v[84:87], v[184:187], 0
  s_waitcnt vmcnt(5)
  v_bitop3_b32 v28, v184, v188, s85 bitop3:0x7e
  v_mfma_f32_16x16x32_bf16 v[108:111], v[84:87], v[188:191], v[108:111]
  v_mfma_f32_16x16x32_bf16 v[124:127], v[168:171], a[132:135], v[124:127]
  s_waitcnt vmcnt(4)
  v_mfma_f32_16x16x32_bf16 v[108:111], v[84:87], v[192:195], v[108:111]
  s_waitcnt vmcnt(3)
  v_bitop3_b32 v29, v192, v196, s85 bitop3:0x7e
  v_bitop3_b32 v28, v28, v29, 1 bitop3:0xa8
  v_mfma_f32_16x16x32_bf16 v[108:111], v[84:87], v[196:199], v[108:111]
  s_mov_b32 m0, s83
  v_cmp_ne_u32 vcc, 0, v28
  v_mfma_f32_16x16x32_bf16 v[128:131], v[168:171], a[136:139], v[128:131]
  buffer_load_dwordx4 v[76:79], v104, s[4:7], s80 offen offset:2048
  s_cbranch_vccnz o0_red
o0_red_ok:
  v_mfma_f32_16x16x32_bf16 v[136:139], v[168:171], a[144:147], v[136:139]
  v_cmp_eq_u32 vcc, 0, v105
  v_mfma_f32_16x16x32_bf16 v[140:143], v[168:171], a[148:151], v[140:143]
  v_cvt_pk_bf16_f32 v118, v108, v109
  v_cvt_pk_bf16_f32 v119, v110, v111
  v_lshlrev_b32 v112, 16, v118
  v_and_b32 v113, 0xffff0000, v118
  v_lshlrev_b32 v114, 16, v119
  v_and_b32 v115, 0xffff0000, v119
  v_add_f32 v112, v112, v60
  v_mfma_f32_16x16x32_bf16 v[148:151], v[168:171], a[156:159], v[148:151]
  s_cbranch_vccnz o0_fl
o0_fl_ok:
  v_mfma_f32_16x16x32_bf16 v[132:135], v[168:171], a[140:143], v[132:135]
  buffer_load_dwordx4 v89, s[4:7], s78 offen offset:0 sc1 lds
  v_add_f32 v113, v113, v61
  s_waitcnt lgkmcnt(2)
  v_mfma_f32_16x16x32_bf16 v[144:147], v[168:171], a[152:155], v[144:147]
  buffer_load_dwordx4 v89, s[4:7], s78 offen offset:1024 sc1 lds
  v_mfma_f32_16x16x32_bf16 v[120:123], v[172:175], a[160:163], v[120:123]
  v_add_f32 v114, v114, v62
  v_add_f32 v115, v115, v63
  v_cvt_pk_bf16_f32 v118, v112, v113
  v_cvt_pk_bf16_f32 v119, v114, v115
  v_lshlrev_b32 v112, 16, v118
  v_and_b32 v113, 0xffff0000, v118
  v_lshlrev_b32 v114, 16, v119
  v_and_b32 v115, 0xffff0000, v119
  v_mfma_f32_16x16x32_bf16 v[128:131], v[172:175], a[168:171], v[128:131]
  s_add_u32 m0, s83, 0x4000
  v_mul_f32 v29, v112, v112
  v_add_f32 v28, v112, v113
  v_mfma_f32_16x16x32_bf16 v[132:135], v[172:175], a[172:175], v[132:135]
  s_add_u32 s70, s78, 8192
  v_fmac_f32 v29, v113, v113
  v_add_f32 v30, v114, v115
  v_mfma_f32_16x16x32_bf16 v[124:127], v[172:175], a[164:167], v[124:127]
  buffer_load_dwordx4 v89, s[4:7], s70 offen offset:0 sc1 lds
  v_fmac_f32 v29, v114, v114
  v_mfma_f32_16x16x32_bf16 v[136:139], v[172:175], a[176:179], v[136:139]
  v_add_f32 v28, v28, v30
  v_fmac_f32 v29, v115, v115
  v_med3_u32 v118, v118, v249, v250
  s_add_u32 s76, s76, 0x200000
  v_permlane16_swap_b32 v28, v29
  v_mfma_f32_16x16x32_bf16 v[144:147], v[172:175], a[184:187], v[144:147]
  s_and_b32 s76, s76, 0xffbfffff
  v_add_f32 v28, v28, v29
  s_lshr_b32 s85, s71, 1
  v_mfma_f32_16x16x32_bf16 v[148:151], v[172:175], a[188:191], v[148:151]
  v_add_f32_dpp v28, v28, v28 row_ror:8 row_mask:0xf bank_mask:0xf
  s_nop 1
  v_add_f32_dpp v28, v28, v28 row_ror:4 row_mask:0xf bank_mask:0xf
  s_nop 1
  v_add_f32_dpp v28, v28, v28 row_ror:2 row_mask:0xf bank_mask:0xf
  s_nop 1
  v_add_f32_dpp v28, v28, v28 row_ror:1 row_mask:0xf bank_mask:0xf
  ds_write_b32 v92, v28
  v_mfma_f32_16x16x32_bf16 v[140:143], v[172:175], a[180:183], v[140:143]
  buffer_load_dwordx4 v89, s[4:7], s70 offen offset:1024 sc1 lds
  s_mov_b32 m0, s88
  s_sub_u32 s70, s78, s90
  s_waitcnt lgkmcnt(0)
  v_mfma_f32_16x16x32_bf16 v[120:123], v[176:179], a[192:195], v[120:123]
  s_barrier
  ds_read_b128 v[28:31], v93 offset:40960
  v_mfma_f32_16x16x32_bf16 v[128:131], v[176:179], a[200:203], v[128:131]
  ds_read_b128 v[32:35], v93 offset:40976
  ds_read_b128 v[232:235], v102 offset:32768
  v_mfma_f32_16x16x32_bf16 v[124:127], v[176:179], a[196:199], v[124:127]
  buffer_load_dwordx4 v89, s[4:7], s70 offen offset:0 sc1 lds
  ds_read_b128 v[200:203], v101 offset:0
  ds_read_b128 v[204:207], v101 offset:1024
  v_mfma_f32_16x16x32_bf16 v[132:135], v[176:179], a[204:207], v[132:135]
  s_waitcnt lgkmcnt(3)
  v_add_f32 v28, v28, v30
  v_add_f32 v29, v29, v31
  v_add_f32 v32, v32, v34
  v_add_f32 v33, v33, v35
  v_add_f32 v28, v28, v32
  v_add_f32 v29, v29, v33
  v_mul_f32 v28, 0x3b000000, v28
  v_mfma_f32_16x16x32_bf16 v[136:139], v[176:179], a[208:211], v[136:139]
  v_mul_f32 v29, 0x3b000000, v29
  v_fma_f32 v29, -v28, v28, v29
  v_max_f32 v29, 0, v29
  v_cvt_pk_bf16_f32 v30, v28, v29
  v_and_b32 v29, 0xffff0000, v30
  v_add_f32 v29, 0x3727c5ac, v29
  v_cvt_pk_bf16_f32 v29, v29, v29
  v_lshlrev_b32 v29, 16, v29
  v_sqrt_f32 v29, v29
  v_lshlrev_b32 v28, 16, v30
  v_cvt_pk_bf16_f32 v29, v29, v29
  v_sub_f32 v112, v112, v28
  v_lshlrev_b32 v29, 16, v29
  v_sub_f32 v113, v113, v28
  v_rcp_f32 v29, v29
  v_sub_f32 v114, v114, v28
  s_add_u32 m0, s88, 0x1000
  v_mfma_f32_16x16x32_bf16 v[144:147], v[176:179], a[216:219], v[144:147]
  ds_read_b128 v[236:239], v102 offset:33792
  v_sub_f32 v115, v115, v28
  v_cvt_pk_bf16_f32 v32, v112, v113
  v_cvt_pk_bf16_f32 v33, v114, v115
  v_lshlrev_b32 v112, 16, v32
  s_add_u32 s70, s70, 8192
  v_mfma_f32_16x16x32_bf16 v[148:151], v[176:179], a[220:223], v[148:151]
  ds_read_b128 v[208:211], v101 offset:4096
  v_and_b32 v113, 0xffff0000, v32
  v_lshlrev_b32 v114, 16, v33
  v_mfma_f32_16x16x32_bf16 v[140:143], v[176:179], a[212:215], v[140:143]
  buffer_load_dwordx4 v89, s[4:7], s70 offen offset:0 sc1 lds
  v_and_b32 v115, 0xffff0000, v33
  v_mfma_f32_16x16x32_bf16 v[120:123], v[180:183], a[224:227], v[120:123]
  s_bfe_u32 s92, s79, 0x6000b
  v_mul_f32 v112, v112, v29
  v_mul_f32 v113, v113, v29
  v_mul_f32 v114, v114, v29
  v_mul_f32 v115, v115, v29
  v_mfma_f32_16x16x32_bf16 v[124:127], v[180:183], a[228:231], v[124:127]
  s_cmp_lt_u32 s92, 63
  s_cselect_b32 s92, 0x800, 0
  v_cvt_pk_bf16_f32 v116, v112, v113
  v_cvt_pk_bf16_f32 v117, v114, v115
  v_med3_u32 v116, v116, v249, v250
  s_add_u32 s79, s79, s92
  v_mfma_f32_16x16x32_bf16 v[128:131], v[180:183], a[232:235], v[128:131]
  s_lshl_b32 s92, s92, 7
  v_permlane16_swap_b32 v117, v119
  v_permlane16_swap_b32 v116, v118
  ds_read_b128 v[212:215], v101 offset:5120
  buffer_load_dwordx2 v[106:107], v90, s[4:7], s72 offen sc1
  ds_read_b128 v[240:243], v102 offset:34816
  ds_read_b128 v[216:219], v101 offset:8192
  ds_read_b128 v[220:223], v101 offset:9216
  ds_read_b128 v[244:247], v102 offset:35840
  s_cmp_eq_u32 s71, 63
  s_cselect_b32 exec_hi, 0, -1
  buffer_store_dwordx4 v[116:119], v248, s[4:7], s73 offen sc1
  s_mov_b32 exec_hi, -1
  v_xor_b32 v102, 0x10000, v102
  v_mfma_f32_16x16x32_bf16 v[132:135], v[180:183], a[236:239], v[132:135]
  ds_read_b128 v[224:227], v101 offset:12288
  ds_read_b128 v[228:231], v101 offset:13312
  v_xor_b32 v101, 0x10000, v101
  v_mfma_f32_16x16x32_bf16 v[136:139], v[180:183], a[240:243], v[136:139]
  v_mfma_f32_16x16x32_bf16 v[140:143], v[180:183], a[244:247], v[140:143]
  v_mfma_f32_16x16x32_bf16 v[144:147], v[180:183], a[248:251], v[144:147]
  v_mfma_f32_16x16x32_bf16 v[148:151], v[180:183], a[252:255], v[148:151]
  s_cmp_eq_u32 s71, 63
  s_cbranch_scc1 o0_last
o0_att:
  s_waitcnt lgkmcnt(9)
  v_mfma_f32_16x16x32_bf16 v[36:39], v[200:203], v[232:235], v[64:67]
  v_cvt_pk_bf16_f32 v160, v120, v124
  v_cvt_pk_bf16_f32 v161, v128, v132
  v_mfma_f32_16x16x32_bf16 v[40:43], v[204:207], v[232:235], v[68:71]
  s_waitcnt lgkmcnt(6)
  v_cvt_pk_bf16_f32 v162, v136, v140
  v_cvt_pk_bf16_f32 v163, v144, v148
  v_mfma_f32_16x16x32_bf16 v[36:39], v[208:211], v[236:239], v[36:39]
  v_bfi_b32 v160, 1, s77, v160
  buffer_store_dwordx4 v[160:163], v94, s[4:7], s75 offen
  v_cvt_pk_bf16_f32 v164, v121, v125
  v_cvt_pk_bf16_f32 v165, v129, v133
  v_cvt_pk_bf16_f32 v166, v137, v141
  v_cvt_pk_bf16_f32 v167, v145, v149
  v_mfma_f32_16x16x32_bf16 v[40:43], v[212:215], v[236:239], v[40:43]
  s_add_u32 s81, s75, 33024
  v_bfi_b32 v164, 1, s77, v164
  buffer_store_dwordx4 v[164:167], v94, s[4:7], s81 offen
  v_cvt_pk_bf16_f32 v168, v122, v126
  v_cvt_pk_bf16_f32 v169, v130, v134
  v_cvt_pk_bf16_f32 v170, v138, v142
  s_waitcnt lgkmcnt(3)
  v_mfma_f32_16x16x32_bf16 v[36:39], v[216:219], v[240:243], v[36:39]
  s_waitcnt lgkmcnt(0)
  v_cvt_pk_bf16_f32 v171, v146, v150
  v_cvt_pk_bf16_f32 v172, v123, v127
  v_mfma_f32_16x16x32_bf16 v[40:43], v[220:223], v[240:243], v[40:43]
  s_add_u32 s81, s75, 66048
  v_bfi_b32 v168, 1, s77, v168
  buffer_store_dwordx4 v[168:171], v94, s[4:7], s81 offen
  v_cvt_pk_bf16_f32 v173, v131, v135
  v_cvt_pk_bf16_f32 v174, v139, v143
  v_cvt_pk_bf16_f32 v175, v147, v151
  s_add_u32 s81, s75, 99072
  v_bfi_b32 v172, 1, s77, v172
  buffer_store_dwordx4 v[172:175], v94, s[4:7], s81 offen
  ds_read_b128 v[200:203], v103 offset:2048
  s_mov_b32 m0, s83
  s_add_u32 s70, s78, 0x1fff800
  v_mfma_f32_16x16x32_bf16 v[36:39], v[224:227], v[244:247], v[36:39]
  s_waitcnt vmcnt(14)
  v_max_u32 v1, v20, v24
  v_cmp_eq_u32 vcc, -1, v1
  v_mfma_f32_16x16x32_bf16 v[40:43], v[228:231], v[244:247], v[40:43]
  s_cbranch_vccnz o0_km
o0_km_ok:
  v_mfma_f32_16x16x32_bf16 v[48:51], v[20:23], v[236:239], 0
  buffer_load_dword v105, v0, s[4:7], s79 offen sc1
  v_mfma_f32_16x16x32_bf16 v[44:47], v[20:23], v[232:235], 0
  buffer_load_dwordx4 v89, s[4:7], s70 offen offset:2048 sc1 lds
  v_mfma_f32_16x16x32_bf16 v[48:51], v[24:27], v[244:247], v[48:51]
  ds_read_b128 v[204:207], v103 offset:3072
  v_max3_f32 v3, v36, v37, v38
  v_max3_f32 v52, v39, v40, v41
  v_mfma_f32_16x16x32_bf16 v[44:47], v[24:27], v[240:243], v[44:47]
  v_max3_f32 v3, v3, v42, v43
  v_max_f32 v2, v3, v52
  ds_read_b128 v[208:211], v103 offset:6144
  ds_read_b128 v[212:215], v103 offset:7168
  v_xor_b32 v103, 0x10000, v103
  s_nop 1
  v_pk_add_f32 v[44:45], v[44:45], v[50:51]
  v_max3_f32 v3, v2, v44, v45
  v_max3_f32 v1, v2, v44, v45
  buffer_load_dwordx4 v89, s[4:7], s70 offen offset:3072 sc1 lds
  s_nop 0
  v_permlane16_swap_b32 v1, v3
  v_max_f32 v2, v1, v3
  v_max_f32 v1, v1, v3
  s_add_u32 m0, s83, 0x4000
  s_add_u32 s70, s70, 8192
  v_permlane32_swap_b32 v1, v2
  v_max_f32 v1, v1, v2
  v_mul_f32 v1, s84, v1
  v_fma_f32 v36, v36, s84, -v1
  v_fma_f32 v37, v37, s84, -v1
  v_fma_f32 v38, v38, s84, -v1
  v_fma_f32 v39, v39, s84, -v1
  v_fma_f32 v40, v40, s84, -v1
  buffer_load_dwordx4 v89, s[4:7], s70 offen offset:2048 sc1 lds
  v_fma_f32 v41, v41, s84, -v1
  v_fma_f32 v42, v42, s84, -v1
  v_fma_f32 v43, v43, s84, -v1
  v_fma_f32 v44, v44, s84, -v1
  v_fma_f32 v45, v45, s84, -v1
  v_exp_f32 v36, v36
  v_exp_f32 v37, v37
  v_exp_f32 v38, v38
  buffer_load_dwordx4 v89, s[4:7], s70 offen offset:3072 sc1 lds
  v_exp_f32 v39, v39
  v_exp_f32 v40, v40
  v_exp_f32 v41, v41
  v_exp_f32 v42, v42
  v_exp_f32 v43, v43
  v_exp_f32 v44, v44
  v_exp_f32 v45, v45
  v_cvt_pk_bf16_f32 v48, v36, v37
  s_waitcnt lgkmcnt(0)
  v_cvt_pk_bf16_f32 v49, v38, v39
  v_cvt_pk_bf16_f32 v50, v40, v41
  v_cvt_pk_bf16_f32 v51, v42, v43
  v_cvt_pk_bf16_f32 v56, v44, v45
  v_cvt_pk_bf16_f32 v57, v44, v45
  v_mfma_f32_16x16x32_bf16 v[52:55], v[80:83], v[48:51], 0
  s_add_u32 s78, s78, s92
  s_xor_b32 s83, s83, 0x10000
  s_xor_b32 s88, s88, 0x10000
  v_mfma_f32_16x16x32_bf16 v[4:7], v[200:203], v[48:51], 0
  s_add_u32 s86, s86, 1
  s_add_u32 s73, s72, 0x400000
  s_cmp_lt_i32 s71, 0
  s_cselect_b32 s73, s52, s73
  v_mfma_f32_16x16x16_bf16 v[52:55], v[58:59], v[56:57], v[52:55]
  v_mfma_f32_16x16x32_bf16 v[8:11], v[204:207], v[48:51], 0
  v_mfma_f32_16x16x32_bf16 v[12:15], v[208:211], v[48:51], 0
  v_mfma_f32_16x16x32_bf16 v[16:19], v[212:215], v[48:51], 0
  v_rcp_f32 v52, v52
  s_waitcnt vmcnt(17)
  v_max_u32 v1, v72, v76
  v_cmp_eq_u32 vcc, -1, v1
  s_cbranch_vccz o0_top
o0_vm:
  s_sub_u32 s51, s51, 1
  s_cbranch_scc1 main_end
  buffer_load_dwordx4 v[72:75], v104, s[4:7], s80 offen offset:0 sc1
  buffer_load_dwordx4 v[76:79], v104, s[4:7], s80 offen offset:2048 sc1
  s_waitcnt vmcnt(0)
  v_max_u32 v1, v72, v76
  v_cmp_eq_u32 vcc, -1, v1
  s_cbranch_vccnz o0_vm
  s_branch o0_top
o0_fl:
  s_sub_u32 s51, s51, 1
  s_cbranch_scc1 main_end
  buffer_load_dword v105, v0, s[4:7], s79 offen sc1
  s_waitcnt vmcnt(0)
  v_cmp_eq_u32 vcc, 0, v105
  s_cbranch_vccnz o0_fl
  s_branch o0_fl_ok
o0_km:
  s_sub_u32 s51, s51, 1
  s_cbranch_scc1 main_end
  buffer_load_dwordx4 v[20:23], v96, s[4:7], s80 offen offset:1024 sc1
  buffer_load_dwordx4 v[24:27], v96, s[4:7], s87 offen offset:1024 sc1
  buffer_load_dwordx4 v[72:75], v104, s[4:7], s80 offen offset:0 sc1
  buffer_load_dwordx4 v[76:79], v104, s[4:7], s80 offen offset:2048 sc1
  s_waitcnt vmcnt(0)
  v_max_u32 v1, v20, v24
  v_cmp_eq_u32 vcc, -1, v1
  s_cbranch_vccnz o0_km
  s_branch o0_km_ok
o0_res:
  s_sub_u32 s51, s51, 1
  s_cbranch_scc1 main_end
  buffer_load_dwordx2 v[106:107], v90, s[4:7], s72 offen sc1
  s_waitcnt vmcnt(0)
  v_cmp_eq_u32 vcc, -1, v106
  s_cbranch_vccnz o0_res
  s_branch o0_res_ok
o0_red:
  s_mov_b64 exec, vcc
  buffer_load_dwordx4 v[184:187], v88, s[4:7], s76 offen offset:0 sc1
  buffer_load_dwordx4 v[188:191], v88, s[4:7], s76 offen offset:1024 sc1
  buffer_load_dwordx4 v[192:195], v88, s[4:7], s76 offen offset:2048 sc1
  buffer_load_dwordx4 v[196:199], v88, s[4:7], s76 offen offset:3072 sc1
  s_sub_u32 s51, s51, 1
  s_cbranch_scc1 main_end
  s_waitcnt vmcnt(0)
  v_bitop3_b32 v28, v184, v188, s85 bitop3:0x7e
  v_bitop3_b32 v29, v192, v196, s85 bitop3:0x7e
  v_bitop3_b32 v28, v28, v29, 1 bitop3:0xa8
  v_cmp_ne_u32 vcc, 0, v28
  s_cbranch_vccnz o0_red
  s_mov_b64 exec, -1
  v_mfma_f32_16x16x32_bf16 v[108:111], v[84:87], v[184:187], 0
  v_mfma_f32_16x16x32_bf16 v[108:111], v[84:87], v[188:191], v[108:111]
  v_mfma_f32_16x16x32_bf16 v[108:111], v[84:87], v[192:195], v[108:111]
  v_mfma_f32_16x16x32_bf16 v[108:111], v[84:87], v[196:199], v[108:111]
  s_branch o0_red_ok
o0_rese:
  s_sub_u32 s51, s51, 1
  s_cbranch_scc1 main_end
  buffer_load_dwordx2 v[106:107], v90, s[4:7], s72 offen sc1
  s_waitcnt vmcnt(0)
  v_cmp_eq_u32 vcc, -1, v106
  s_cbranch_vccnz o0_rese
  s_branch o0_rese_ok
o0_rede:
  s_mov_b64 exec, vcc
  buffer_load_dwordx4 v[184:187], v88, s[4:7], s76 offen offset:0 sc1
  buffer_load_dwordx4 v[188:191], v88, s[4:7], s76 offen offset:1024 sc1
  buffer_load_dwordx4 v[192:195], v88, s[4:7], s76 offen offset:2048 sc1
  buffer_load_dwordx4 v[196:199], v88, s[4:7], s76 offen offset:3072 sc1
  s_sub_u32 s51, s51, 1
  s_cbranch_scc1 main_end
  s_waitcnt vmcnt(0)
  v_bitop3_b32 v28, v184, v188, s85 bitop3:0x7e
  v_bitop3_b32 v29, v192, v196, s85 bitop3:0x7e
  v_bitop3_b32 v28, v28, v29, 1 bitop3:0xa8
  v_cmp_ne_u32 vcc, 0, v28
  s_cbranch_vccnz o0_rede
  s_mov_b64 exec, -1
  v_mfma_f32_16x16x32_bf16 v[108:111], v[84:87], v[184:187], 0
  v_mfma_f32_16x16x32_bf16 v[108:111], v[84:87], v[188:191], v[108:111]
  v_mfma_f32_16x16x32_bf16 v[108:111], v[84:87], v[192:195], v[108:111]
  v_mfma_f32_16x16x32_bf16 v[108:111], v[84:87], v[196:199], v[108:111]
  s_branch o0_rede_ok
o0_last:
  v_cvt_pk_bf16_f32 v160, v120, v124
  v_cvt_pk_bf16_f32 v161, v128, v132
  v_cvt_pk_bf16_f32 v162, v136, v140
  s_nop 2
  v_cvt_pk_bf16_f32 v163, v144, v148
  v_bfi_b32 v160, 1, s77, v160
  buffer_store_dwordx4 v[160:163], v94, s[4:7], s75 offen
  v_cvt_pk_bf16_f32 v164, v121, v125
  v_cvt_pk_bf16_f32 v165, v129, v133
  v_cvt_pk_bf16_f32 v166, v137, v141
  v_cvt_pk_bf16_f32 v167, v145, v149
  v_bfi_b32 v164, 1, s77, v164
  s_add_u32 s81, s75, 33024
  buffer_store_dwordx4 v[164:167], v94, s[4:7], s81 offen
  v_cvt_pk_bf16_f32 v168, v122, v126
  v_cvt_pk_bf16_f32 v169, v130, v134
  v_cvt_pk_bf16_f32 v170, v138, v142
  v_cvt_pk_bf16_f32 v171, v146, v150
  v_bfi_b32 v168, 1, s77, v168
  s_add_u32 s81, s75, 66048
  buffer_store_dwordx4 v[168:171], v94, s[4:7], s81 offen
  v_cvt_pk_bf16_f32 v172, v123, v127
  v_cvt_pk_bf16_f32 v173, v131, v135
  v_cvt_pk_bf16_f32 v174, v139, v143
  v_cvt_pk_bf16_f32 v175, v147, v151
  v_bfi_b32 v172, 1, s77, v172
  s_add_u32 s81, s75, 99072
  buffer_store_dwordx4 v[172:175], v94, s[4:7], s81 offen
o0_last2:
  s_add_u32 s86, s86, 1
  s_add_u32 s71, s71, 1
  s_add_u32 s73, s72, 0x400000
  s_waitcnt lgkmcnt(0)
  s_barrier
  buffer_load_dwordx4 v[184:187], v88, s[4:7], s76 offen offset:0 sc1
  buffer_load_dwordx4 v[188:191], v88, s[4:7], s76 offen offset:1024 sc1
  buffer_load_dwordx4 v[192:195], v88, s[4:7], s76 offen offset:2048 sc1
  buffer_load_dwordx4 v[196:199], v88, s[4:7], s76 offen offset:3072 sc1
  s_waitcnt vmcnt(4)
  v_cmp_eq_u32 vcc, -1, v106
  s_cbranch_vccnz o0_rese
o0_rese_ok:
  v_lshlrev_b32 v60, 16, v106
  v_and_b32 v61, 0xffff0000, v106
  v_lshlrev_b32 v62, 16, v107
  v_and_b32 v63, 0xffff0000, v107
  s_waitcnt vmcnt(3)
  v_mfma_f32_16x16x32_bf16 v[108:111], v[84:87], v[184:187], 0
  s_waitcnt vmcnt(2)
  v_mfma_f32_16x16x32_bf16 v[108:111], v[84:87], v[188:191], v[108:111]
  v_bitop3_b32 v28, v184, v188, s85 bitop3:0x7e
  s_waitcnt vmcnt(1)
  v_mfma_f32_16x16x32_bf16 v[108:111], v[84:87], v[192:195], v[108:111]
  s_waitcnt vmcnt(0)
  v_mfma_f32_16x16x32_bf16 v[108:111], v[84:87], v[196:199], v[108:111]
  v_bitop3_b32 v29, v192, v196, s85 bitop3:0x7e
  v_bitop3_b32 v28, v28, v29, 1 bitop3:0xa8
  v_cmp_ne_u32 vcc, 0, v28
  s_cbranch_vccnz o0_rede
o0_rede_ok:
  s_nop 6
  v_cvt_pk_bf16_f32 v118, v108, v109
  v_cvt_pk_bf16_f32 v119, v110, v111
  v_lshlrev_b32 v112, 16, v118
  v_and_b32 v113, 0xffff0000, v118
  v_lshlrev_b32 v114, 16, v119
  v_and_b32 v115, 0xffff0000, v119
  v_add_f32 v112, v112, v60
  v_add_f32 v113, v113, v61
  v_add_f32 v114, v114, v62
  v_add_f32 v115, v115, v63
  v_cvt_pk_bf16_f32 v118, v112, v113
  v_cvt_pk_bf16_f32 v119, v114, v115
  v_lshlrev_b32 v112, 16, v118
  v_and_b32 v113, 0xffff0000, v118
  v_lshlrev_b32 v114, 16, v119
  v_and_b32 v115, 0xffff0000, v119
  v_mul_f32 v29, v112, v112
  v_add_f32 v28, v112, v113
  v_fmac_f32 v29, v113, v113
  v_add_f32 v30, v114, v115
  v_fmac_f32 v29, v114, v114
  v_add_f32 v28, v28, v30
  v_fmac_f32 v29, v115, v115
  v_med3_u32 v118, v118, v249, v250
  s_nop 0
  v_permlane16_swap_b32 v28, v29
  v_add_f32 v28, v28, v29
  s_nop 1
  v_add_f32_dpp v28, v28, v28 row_ror:8 row_mask:0xf bank_mask:0xf
  s_nop 1
  v_add_f32_dpp v28, v28, v28 row_ror:4 row_mask:0xf bank_mask:0xf
  s_nop 1
  v_add_f32_dpp v28, v28, v28 row_ror:2 row_mask:0xf bank_mask:0xf
  s_nop 1
  v_add_f32_dpp v28, v28, v28 row_ror:1 row_mask:0xf bank_mask:0xf
  ds_write_b32 v92, v28
  s_waitcnt lgkmcnt(0)
  s_barrier
  ds_read_b128 v[28:31], v93 offset:40960
  ds_read_b128 v[32:35], v93 offset:40976
  s_add_u32 s76, s76, 0x200000
  s_and_b32 s76, s76, 0xffbfffff
  s_lshr_b32 s85, s71, 1
  s_waitcnt lgkmcnt(0)
  v_add_f32 v28, v28, v30
  v_add_f32 v29, v29, v31
  v_add_f32 v32, v32, v34
  v_add_f32 v33, v33, v35
  v_add_f32 v28, v28, v32
  v_add_f32 v29, v29, v33
  v_mul_f32 v28, 0x3b000000, v28
  v_mul_f32 v29, 0x3b000000, v29
  v_fma_f32 v29, -v28, v28, v29
  v_max_f32 v29, 0, v29
  v_cvt_pk_bf16_f32 v30, v28, v29
  v_and_b32 v29, 0xffff0000, v30
  v_add_f32 v29, 0x3727c5ac, v29
  v_cvt_pk_bf16_f32 v29, v29, v29
  v_lshlrev_b32 v29, 16, v29
  v_sqrt_f32 v29, v29
  v_lshlrev_b32 v28, 16, v30
  v_cvt_pk_bf16_f32 v29, v29, v29
  v_sub_f32 v112, v112, v28
  v_lshlrev_b32 v29, 16, v29
  v_sub_f32 v113, v113, v28
  v_rcp_f32 v29, v29
  v_sub_f32 v114, v114, v28
  v_sub_f32 v115, v115, v28
  v_cvt_pk_bf16_f32 v32, v112, v113
  v_cvt_pk_bf16_f32 v33, v114, v115
  v_lshlrev_b32 v112, 16, v32
  v_and_b32 v113, 0xffff0000, v32
  v_lshlrev_b32 v114, 16, v33
  v_and_b32 v115, 0xffff0000, v33
  v_mul_f32 v112, v112, v29
  v_mul_f32 v113, v113, v29
  v_mul_f32 v114, v114, v29
  v_mul_f32 v115, v115, v29
  v_cvt_pk_bf16_f32 v116, v112, v113
  v_cvt_pk_bf16_f32 v117, v114, v115
  v_med3_u32 v116, v116, v249, v250
  s_nop 0
  v_permlane16_swap_b32 v117, v119
  v_permlane16_swap_b32 v116, v118
  buffer_store_dwordx4 v[116:119], v91, s[4:7], s73 offen sc1
  s_endpgm
o1_top:
  v_mfma_f32_16x16x16_bf16 v[4:7], v[72:73], v[56:57], v[4:7]
  s_add_u32 s71, s71, 1
  s_lshr_b32 s77, s71, 1
  s_add_u32 s75, s75, 0x200000
  v_mfma_f32_16x16x16_bf16 v[8:11], v[74:75], v[56:57], v[8:11]
  s_and_b32 s75, s75, 0xffbfffff
  s_lshl_b32 s74, s71, 16
  s_add_u32 s74, s74, s89
  v_mfma_f32_16x16x16_bf16 v[12:15], v[76:77], v[56:57], v[12:15]
  v_mfma_f32_16x16x16_bf16 v[16:19], v[78:79], v[56:57], v[16:19]
  v_pk_mul_f32 v[4:5], v[4:5], v[52:53] op_sel_hi:[1,0]
  v_pk_mul_f32 v[6:7], v[6:7], v[52:53] op_sel_hi:[1,0]
  v_cvt_pk_bf16_f32 v152, v4, v5
  v_pk_mul_f32 v[8:9], v[8:9], v[52:53] op_sel_hi:[1,0]
  v_pk_mul_f32 v[10:11], v[10:11], v[52:53] op_sel_hi:[1,0]
  v_cvt_pk_bf16_f32 v153, v6, v7
  v_cvt_pk_bf16_f32 v154, v8, v9
  v_cvt_pk_bf16_f32 v155, v10, v11
  v_pk_mul_f32 v[12:13], v[12:13], v[52:53] op_sel_hi:[1,0]
  v_pk_mul_f32 v[14:15], v[14:15], v[52:53] op_sel_hi:[1,0]
  v_mfma_f32_16x16x32_bf16 v[120:123], v[152:155], a[0:3], 0
  v_cvt_pk_bf16_f32 v156, v12, v13
  v_cvt_pk_bf16_f32 v157, v14, v15
  v_mfma_f32_16x16x32_bf16 v[124:127], v[152:155], a[4:7], 0
  ds_write_b128 v97, v[152:155] offset:0
  v_mfma_f32_16x16x32_bf16 v[128:131], v[152:155], a[8:11], 0
  v_mfma_f32_16x16x32_bf16 v[132:135], v[152:155], a[12:15], 0
  v_mfma_f32_16x16x32_bf16 v[136:139], v[152:155], a[16:19], 0
  v_mfma_f32_16x16x32_bf16 v[140:143], v[152:155], a[20:23], 0
  v_mfma_f32_16x16x32_bf16 v[144:147], v[152:155], a[24:27], 0
  v_pk_mul_f32 v[16:17], v[16:17], v[52:53] op_sel_hi:[1,0]
  v_mfma_f32_16x16x32_bf16 v[148:151], v[152:155], a[28:31], 0
  v_cvt_pk_bf16_f32 v158, v16, v17
  v_pk_mul_f32 v[18:19], v[18:19], v[52:53] op_sel_hi:[1,0]
  v_cvt_pk_bf16_f32 v159, v18, v19
  s_nop 1
  v_mfma_f32_16x16x32_bf16 v[120:123], v[156:159], a[32:35], v[120:123]
  ds_write_b128 v97, v[156:159] offset:1024
  v_mfma_f32_16x16x32_bf16 v[124:127], v[156:159], a[36:39], v[124:127]
  buffer_load_dwordx4 v[184:187], v88, s[4:7], s76 offen offset:0 sc1
  v_mfma_f32_16x16x32_bf16 v[128:131], v[156:159], a[40:43], v[128:131]
  s_waitcnt lgkmcnt(0)
  s_barrier
  ds_read_b128 v[160:163], v99 offset:0
  v_mfma_f32_16x16x32_bf16 v[132:135], v[156:159], a[44:47], v[132:135]
  ds_read_b128 v[164:167], v99 offset:1024
  ds_read_b128 v[168:171], v98 offset:0
  ds_read_b128 v[172:175], v98 offset:1024
  v_mfma_f32_16x16x32_bf16 v[136:139], v[156:159], a[48:51], v[136:139]
  ds_read_b128 v[176:179], v100 offset:0
  s_waitcnt vmcnt(11)
  v_cmp_eq_u32 vcc, -1, v106
  v_mfma_f32_16x16x32_bf16 v[140:143], v[156:159], a[52:55], v[140:143]
  ds_read_b128 v[180:183], v100 offset:1024
  buffer_load_dwordx4 v[188:191], v88, s[4:7], s76 offen offset:1024 sc1
  v_mfma_f32_16x16x32_bf16 v[144:147], v[156:159], a[56:59], v[144:147]
  s_cbranch_vccnz o1_res
o1_res_ok:
  v_mfma_f32_16x16x32_bf16 v[148:151], v[156:159], a[60:63], v[148:151]
  s_sub_u32 s72, s74, 0x410000
  v_lshlrev_b32 v60, 16, v106
  v_and_b32 v61, 0xffff0000, v106
  v_lshlrev_b32 v62, 16, v107
  v_and_b32 v63, 0xffff0000, v107
  s_add_u32 s80, s80, 0x40000
  s_waitcnt lgkmcnt(5)
  v_mfma_f32_16x16x32_bf16 v[120:123], v[160:163], a[64:67], v[120:123]
  s_add_u32 s87, s80, 4096
  buffer_load_dwordx4 v[192:195], v88, s[4:7], s76 offen offset:2048 sc1
  v_mfma_f32_16x16x32_bf16 v[124:127], v[160:163], a[68:71], v[124:127]
  s_waitcnt lgkmcnt(4)
  v_mfma_f32_16x16x32_bf16 v[128:131], v[160:163], a[72:75], v[128:131]
  v_mfma_f32_16x16x32_bf16 v[132:135], v[160:163], a[76:79], v[132:135]
  v_mfma_f32_16x16x32_bf16 v[136:139], v[160:163], a[80:83], v[136:139]
  buffer_load_dwordx4 v[196:199], v88, s[4:7], s76 offen offset:3072 sc1
  v_mfma_f32_16x16x32_bf16 v[140:143], v[160:163], a[84:87], v[140:143]
  v_mfma_f32_16x16x32_bf16 v[144:147], v[160:163], a[88:91], v[144:147]
  v_mfma_f32_16x16x32_bf16 v[148:151], v[160:163], a[92:95], v[148:151]
  v_mfma_f32_16x16x32_bf16 v[120:123], v[164:167], a[96:99], v[120:123]
  buffer_load_dwordx4 v[20:23], v96, s[4:7], s80 offen offset:1024
  v_mfma_f32_16x16x32_bf16 v[124:127], v[164:167], a[100:103], v[124:127]
  s_waitcnt lgkmcnt(3)
  v_mfma_f32_16x16x32_bf16 v[128:131], v[164:167], a[104:107], v[128:131]
  v_mfma_f32_16x16x32_bf16 v[132:135], v[164:167], a[108:111], v[132:135]
  v_mfma_f32_16x16x32_bf16 v[136:139], v[164:167], a[112:115], v[136:139]
  buffer_load_dwordx4 v[24:27], v96, s[4:7], s87 offen offset:1024
  v_mfma_f32_16x16x32_bf16 v[140:143], v[164:167], a[116:119], v[140:143]
  v_mfma_f32_16x16x32_bf16 v[144:147], v[164:167], a[120:123], v[144:147]
  v_mfma_f32_16x16x32_bf16 v[148:151], v[164:167], a[124:127], v[148:151]
  v_mfma_f32_16x16x32_bf16 v[120:123], v[168:171], a[128:131], v[120:123]
  buffer_load_dwordx4 v[72:75], v104, s[4:7], s80 offen offset:0
  s_waitcnt vmcnt(6)
  v_mfma_f32_16x16x32_bf16 v[108:111], v[84:87], v[184:187], 0
  s_waitcnt vmcnt(5)
  v_bitop3_b32 v28, v184, v188, s85 bitop3:0x7e
  v_mfma_f32_16x16x32_bf16 v[108:111], v[84:87], v[188:191], v[108:111]
  v_mfma_f32_16x16x32_bf16 v[124:127], v[168:171], a[132:135], v[124:127]
  s_waitcnt vmcnt(4)
  v_mfma_f32_16x16x32_bf16 v[108:111], v[84:87], v[192:195], v[108:111]
  s_waitcnt vmcnt(3)
  v_bitop3_b32 v29, v192, v196, s85 bitop3:0x7e
  v_bitop3_b32 v28, v28, v29, 1 bitop3:0xa8
  v_mfma_f32_16x16x32_bf16 v[108:111], v[84:87], v[196:199], v[108:111]
  s_mov_b32 m0, s83
  v_cmp_ne_u32 vcc, 0, v28
  v_mfma_f32_16x16x32_bf16 v[128:131], v[168:171], a[136:139], v[128:131]
  buffer_load_dwordx4 v[76:79], v104, s[4:7], s80 offen offset:2048
  s_cbranch_vccnz o1_red
o1_red_ok:
  v_mfma_f32_16x16x32_bf16 v[136:139], v[168:171], a[144:147], v[136:139]
  v_cmp_eq_u32 vcc, 0, v105
  v_mfma_f32_16x16x32_bf16 v[140:143], v[168:171], a[148:151], v[140:143]
  v_cvt_pk_bf16_f32 v118, v108, v109
  v_cvt_pk_bf16_f32 v119, v110, v111
  v_lshlrev_b32 v112, 16, v118
  v_and_b32 v113, 0xffff0000, v118
  v_lshlrev_b32 v114, 16, v119
  v_and_b32 v115, 0xffff0000, v119
  v_add_f32 v112, v112, v60
  v_mfma_f32_16x16x32_bf16 v[148:151], v[168:171], a[156:159], v[148:151]
  s_cbranch_vccnz o1_fl
o1_fl_ok:
  v_mfma_f32_16x16x32_bf16 v[132:135], v[168:171], a[140:143], v[132:135]
  buffer_load_dwordx4 v89, s[4:7], s78 offen offset:0 sc1 lds
  v_add_f32 v113, v113, v61
  s_waitcnt lgkmcnt(2)
  v_mfma_f32_16x16x32_bf16 v[144:147], v[168:171], a[152:155], v[144:147]
  buffer_load_dwordx4 v89, s[4:7], s78 offen offset:1024 sc1 lds
  v_mfma_f32_16x16x32_bf16 v[120:123], v[172:175], a[160:163], v[120:123]
  v_add_f32 v114, v114, v62
  v_add_f32 v115, v115, v63
  v_cvt_pk_bf16_f32 v118, v112, v113
  v_cvt_pk_bf16_f32 v119, v114, v115
  v_lshlrev_b32 v112, 16, v118
  v_and_b32 v113, 0xffff0000, v118
  v_lshlrev_b32 v114, 16, v119
  v_and_b32 v115, 0xffff0000, v119
  v_mfma_f32_16x16x32_bf16 v[128:131], v[172:175], a[168:171], v[128:131]
  s_add_u32 m0, s83, 0x4000
  v_mul_f32 v29, v112, v112
  v_add_f32 v28, v112, v113
  v_mfma_f32_16x16x32_bf16 v[132:135], v[172:175], a[172:175], v[132:135]
  s_add_u32 s70, s78, 8192
  v_fmac_f32 v29, v113, v113
  v_add_f32 v30, v114, v115
  v_mfma_f32_16x16x32_bf16 v[124:127], v[172:175], a[164:167], v[124:127]
  buffer_load_dwordx4 v89, s[4:7], s70 offen offset:0 sc1 lds
  v_fmac_f32 v29, v114, v114
  v_mfma_f32_16x16x32_bf16 v[136:139], v[172:175], a[176:179], v[136:139]
  v_add_f32 v28, v28, v30
  v_fmac_f32 v29, v115, v115
  v_med3_u32 v118, v118, v249, v250
  s_add_u32 s76, s76, 0x200000
  v_permlane16_swap_b32 v28, v29
  v_mfma_f32_16x16x32_bf16 v[144:147], v[172:175], a[184:187], v[144:147]
  s_and_b32 s76, s76, 0xffbfffff
  v_add_f32 v28, v28, v29
  s_lshr_b32 s85, s71, 1
  v_mfma_f32_16x16x32_bf16 v[148:151], v[172:175], a[188:191], v[148:151]
  v_add_f32_dpp v28, v28, v28 row_ror:8 row_mask:0xf bank_mask:0xf
  s_nop 1
  v_add_f32_dpp v28, v28, v28 row_ror:4 row_mask:0xf bank_mask:0xf
  s_nop 1
  v_add_f32_dpp v28, v28, v28 row_ror:2 row_mask:0xf bank_mask:0xf
  s_nop 1
  v_add_f32_dpp v28, v28, v28 row_ror:1 row_mask:0xf bank_mask:0xf
  ds_write_b32 v92, v28
  v_mfma_f32_16x16x32_bf16 v[140:143], v[172:175], a[180:183], v[140:143]
  buffer_load_dwordx4 v89, s[4:7], s70 offen offset:1024 sc1 lds
  s_mov_b32 m0, s88
  s_sub_u32 s70, s78, s90
  s_waitcnt lgkmcnt(0)
  v_mfma_f32_16x16x32_bf16 v[120:123], v[176:179], a[192:195], v[120:123]
  s_barrier
  ds_read_b128 v[28:31], v93 offset:40960
  v_mfma_f32_16x16x32_bf16 v[128:131], v[176:179], a[200:203], v[128:131]
  ds_read_b128 v[32:35], v93 offset:40976
  ds_read_b128 v[232:235], v102 offset:32768
  v_mfma_f32_16x16x32_bf16 v[124:127], v[176:179], a[196:199], v[124:127]
  buffer_load_dwordx4 v89, s[4:7], s70 offen offset:0 sc1 lds
  ds_read_b128 v[200:203], v101 offset:0
  ds_read_b128 v[204:207], v101 offset:1024
  v_mfma_f32_16x16x32_bf16 v[132:135], v[176:179], a[204:207], v[132:135]
  s_waitcnt lgkmcnt(3)
  v_add_f32 v28, v28, v30
  v_add_f32 v29, v29, v31
  v_add_f32 v32, v32, v34
  v_add_f32 v33, v33, v35
  v_add_f32 v28, v28, v32
  v_add_f32 v29, v29, v33
  v_mul_f32 v28, 0x3b000000, v28
  v_mfma_f32_16x16x32_bf16 v[136:139], v[176:179], a[208:211], v[136:139]
  v_mul_f32 v29, 0x3b000000, v29
  v_fma_f32 v29, -v28, v28, v29
  v_max_f32 v29, 0, v29
  v_cvt_pk_bf16_f32 v30, v28, v29
  v_and_b32 v29, 0xffff0000, v30
  v_add_f32 v29, 0x3727c5ac, v29
  v_cvt_pk_bf16_f32 v29, v29, v29
  v_lshlrev_b32 v29, 16, v29
  v_sqrt_f32 v29, v29
  v_lshlrev_b32 v28, 16, v30
  v_cvt_pk_bf16_f32 v29, v29, v29
  v_sub_f32 v112, v112, v28
  v_lshlrev_b32 v29, 16, v29
  v_sub_f32 v113, v113, v28
  v_rcp_f32 v29, v29
  v_sub_f32 v114, v114, v28
  s_add_u32 m0, s88, 0x1000
  v_mfma_f32_16x16x32_bf16 v[144:147], v[176:179], a[216:219], v[144:147]
  ds_read_b128 v[236:239], v102 offset:33792
  v_sub_f32 v115, v115, v28
  v_cvt_pk_bf16_f32 v32, v112, v113
  v_cvt_pk_bf16_f32 v33, v114, v115
  v_lshlrev_b32 v112, 16, v32
  s_add_u32 s70, s70, 8192
  v_mfma_f32_16x16x32_bf16 v[148:151], v[176:179], a[220:223], v[148:151]
  ds_read_b128 v[208:211], v101 offset:4096
  v_and_b32 v113, 0xffff0000, v32
  v_lshlrev_b32 v114, 16, v33
  v_mfma_f32_16x16x32_bf16 v[140:143], v[176:179], a[212:215], v[140:143]
  buffer_load_dwordx4 v89, s[4:7], s70 offen offset:0 sc1 lds
  v_and_b32 v115, 0xffff0000, v33
  v_mfma_f32_16x16x32_bf16 v[120:123], v[180:183], a[224:227], v[120:123]
  s_bfe_u32 s92, s79, 0x6000b
  v_mul_f32 v112, v112, v29
  v_mul_f32 v113, v113, v29
  v_mul_f32 v114, v114, v29
  v_mul_f32 v115, v115, v29
  v_mfma_f32_16x16x32_bf16 v[124:127], v[180:183], a[228:231], v[124:127]
  s_cmp_lt_u32 s92, 63
  s_cselect_b32 s92, 0x800, 0
  v_cvt_pk_bf16_f32 v116, v112, v113
  v_cvt_pk_bf16_f32 v117, v114, v115
  v_med3_u32 v116, v116, v249, v250
  s_add_u32 s79, s79, s92
  v_mfma_f32_16x16x32_bf16 v[128:131], v[180:183], a[232:235], v[128:131]
  s_lshl_b32 s92, s92, 7
  v_permlane16_swap_b32 v117, v119
  v_permlane16_swap_b32 v116, v118
  ds_read_b128 v[212:215], v101 offset:5120
  buffer_load_dwordx2 v[106:107], v90, s[4:7], s72 offen sc1
  ds_read_b128 v[240:243], v102 offset:34816
  ds_read_b128 v[216:219], v101 offset:8192
  ds_read_b128 v[220:223], v101 offset:9216
  ds_read_b128 v[244:247], v102 offset:35840
  s_cmp_eq_u32 s71, 63
  s_cselect_b32 exec_hi, 0, -1
  buffer_store_dwordx4 v[116:119], v248, s[4:7], s73 offen sc1
  s_mov_b32 exec_hi, -1
  v_xor_b32 v102, 0x10000, v102
  v_mfma_f32_16x16x32_bf16 v[132:135], v[180:183], a[236:239], v[132:135]
  ds_read_b128 v[224:227], v101 offset:12288
  ds_read_b128 v[228:231], v101 offset:13312
  v_xor_b32 v101, 0x10000, v101
  v_mfma_f32_16x16x32_bf16 v[136:139], v[180:183], a[240:243], v[136:139]
  v_mfma_f32_16x16x32_bf16 v[140:143], v[180:183], a[244:247], v[140:143]
  v_mfma_f32_16x16x32_bf16 v[144:147], v[180:183], a[248:251], v[144:147]
  v_mfma_f32_16x16x32_bf16 v[148:151], v[180:183], a[252:255], v[148:151]
  s_cmp_eq_u32 s71, 63
  s_cbranch_scc1 o1_last
o1_att:
  s_waitcnt lgkmcnt(9)
  v_mfma_f32_16x16x32_bf16 v[36:39], v[200:203], v[232:235], v[64:67]
  v_cvt_pk_bf16_f32 v160, v120, v124
  v_cvt_pk_bf16_f32 v161, v128, v132
  v_mfma_f32_16x16x32_bf16 v[40:43], v[204:207], v[232:235], v[68:71]
  s_waitcnt lgkmcnt(6)
  v_cvt_pk_bf16_f32 v162, v136, v140
  v_cvt_pk_bf16_f32 v163, v144, v148
  v_mfma_f32_16x16x32_bf16 v[36:39], v[208:211], v[236:239], v[36:39]
  v_bfi_b32 v160, 1, s77, v160
  buffer_store_dwordx4 v[160:163], v94, s[4:7], s75 offen sc1
  v_cvt_pk_bf16_f32 v164, v121, v125
  v_cvt_pk_bf16_f32 v165, v129, v133
  v_cvt_pk_bf16_f32 v166, v137, v141
  v_cvt_pk_bf16_f32 v167, v145, v149
  v_mfma_f32_16x16x32_bf16 v[40:43], v[212:215], v[236:239], v[40:43]
  s_add_u32 s81, s75, 33024
  v_bfi_b32 v164, 1, s77, v164
  buffer_store_dwordx4 v[164:167], v94, s[4:7], s81 offen sc1
  v_cvt_pk_bf16_f32 v168, v122, v126
  v_cvt_pk_bf16_f32 v169, v130, v134
  v_cvt_pk_bf16_f32 v170, v138, v142
  s_waitcnt lgkmcnt(3)
  v_mfma_f32_16x16x32_bf16 v[36:39], v[216:219], v[240:243], v[36:39]
  s_waitcnt lgkmcnt(0)
  v_cvt_pk_bf16_f32 v171, v146, v150
  v_cvt_pk_bf16_f32 v172, v123, v127
  v_mfma_f32_16x16x32_bf16 v[40:43], v[220:223], v[240:243], v[40:43]
  s_add_u32 s81, s75, 66048
  v_bfi_b32 v168, 1, s77, v168
  buffer_store_dwordx4 v[168:171], v94, s[4:7], s81 offen sc1
  v_cvt_pk_bf16_f32 v173, v131, v135
  v_cvt_pk_bf16_f32 v174, v139, v143
  v_cvt_pk_bf16_f32 v175, v147, v151
  s_add_u32 s81, s75, 99072
  v_bfi_b32 v172, 1, s77, v172
  buffer_store_dwordx4 v[172:175], v94, s[4:7], s81 offen sc1
  ds_read_b128 v[200:203], v103 offset:2048
  s_mov_b32 m0, s83
  s_add_u32 s70, s78, 0x1fff800
  v_mfma_f32_16x16x32_bf16 v[36:39], v[224:227], v[244:247], v[36:39]
  s_waitcnt vmcnt(14)
  v_max_u32 v1, v20, v24
  v_cmp_eq_u32 vcc, -1, v1
  v_mfma_f32_16x16x32_bf16 v[40:43], v[228:231], v[244:247], v[40:43]
  s_cbranch_vccnz o1_km
o1_km_ok:
  v_mfma_f32_16x16x32_bf16 v[48:51], v[20:23], v[236:239], 0
  buffer_load_dword v105, v0, s[4:7], s79 offen sc1
  v_mfma_f32_16x16x32_bf16 v[44:47], v[20:23], v[232:235], 0
  buffer_load_dwordx4 v89, s[4:7], s70 offen offset:2048 sc1 lds
  v_mfma_f32_16x16x32_bf16 v[48:51], v[24:27], v[244:247], v[48:51]
  ds_read_b128 v[204:207], v103 offset:3072
  v_max3_f32 v3, v36, v37, v38
  v_max3_f32 v52, v39, v40, v41
  v_mfma_f32_16x16x32_bf16 v[44:47], v[24:27], v[240:243], v[44:47]
  v_max3_f32 v3, v3, v42, v43
  v_max_f32 v2, v3, v52
  ds_read_b128 v[208:211], v103 offset:6144
  ds_read_b128 v[212:215], v103 offset:7168
  v_xor_b32 v103, 0x10000, v103
  s_nop 1
  v_pk_add_f32 v[44:45], v[44:45], v[50:51]
  v_max3_f32 v3, v2, v44, v45
  v_max3_f32 v1, v2, v44, v45
  buffer_load_dwordx4 v89, s[4:7], s70 offen offset:3072 sc1 lds
  s_nop 0
  v_permlane16_swap_b32 v1, v3
  v_max_f32 v2, v1, v3
  v_max_f32 v1, v1, v3
  s_add_u32 m0, s83, 0x4000
  s_add_u32 s70, s70, 8192
  v_permlane32_swap_b32 v1, v2
  v_max_f32 v1, v1, v2
  v_mul_f32 v1, s84, v1
  v_fma_f32 v36, v36, s84, -v1
  v_fma_f32 v37, v37, s84, -v1
  v_fma_f32 v38, v38, s84, -v1
  v_fma_f32 v39, v39, s84, -v1
  v_fma_f32 v40, v40, s84, -v1
  buffer_load_dwordx4 v89, s[4:7], s70 offen offset:2048 sc1 lds
  v_fma_f32 v41, v41, s84, -v1
  v_fma_f32 v42, v42, s84, -v1
  v_fma_f32 v43, v43, s84, -v1
  v_fma_f32 v44, v44, s84, -v1
  v_fma_f32 v45, v45, s84, -v1
  v_exp_f32 v36, v36
  v_exp_f32 v37, v37
  v_exp_f32 v38, v38
  buffer_load_dwordx4 v89, s[4:7], s70 offen offset:3072 sc1 lds
  v_exp_f32 v39, v39
  v_exp_f32 v40, v40
  v_exp_f32 v41, v41
  v_exp_f32 v42, v42
  v_exp_f32 v43, v43
  v_exp_f32 v44, v44
  v_exp_f32 v45, v45
  v_cvt_pk_bf16_f32 v48, v36, v37
  s_waitcnt lgkmcnt(0)
  v_cvt_pk_bf16_f32 v49, v38, v39
  v_cvt_pk_bf16_f32 v50, v40, v41
  v_cvt_pk_bf16_f32 v51, v42, v43
  v_cvt_pk_bf16_f32 v56, v44, v45
  v_cvt_pk_bf16_f32 v57, v44, v45
  v_mfma_f32_16x16x32_bf16 v[52:55], v[80:83], v[48:51], 0
  s_add_u32 s78, s78, s92
  s_xor_b32 s83, s83, 0x10000
  s_xor_b32 s88, s88, 0x10000
  v_mfma_f32_16x16x32_bf16 v[4:7], v[200:203], v[48:51], 0
  s_add_u32 s86, s86, 1
  s_add_u32 s73, s72, 0x400000
  s_cmp_lt_i32 s71, 0
  s_cselect_b32 s73, s52, s73
  v_mfma_f32_16x16x16_bf16 v[52:55], v[58:59], v[56:57], v[52:55]
  v_mfma_f32_16x16x32_bf16 v[8:11], v[204:207], v[48:51], 0
  v_mfma_f32_16x16x32_bf16 v[12:15], v[208:211], v[48:51], 0
  v_mfma_f32_16x16x32_bf16 v[16:19], v[212:215], v[48:51], 0
  v_rcp_f32 v52, v52
  s_waitcnt vmcnt(17)
  v_max_u32 v1, v72, v76
  v_cmp_eq_u32 vcc, -1, v1
  s_cbranch_vccz o1_top
o1_vm:
  s_sub_u32 s51, s51, 1
  s_cbranch_scc1 main_end
  buffer_load_dwordx4 v[72:75], v104, s[4:7], s80 offen offset:0 sc1
  buffer_load_dwordx4 v[76:79], v104, s[4:7], s80 offen offset:2048 sc1
  s_waitcnt vmcnt(0)
  v_max_u32 v1, v72, v76
  v_cmp_eq_u32 vcc, -1, v1
  s_cbranch_vccnz o1_vm
  s_branch o1_top
o1_fl:
  s_sub_u32 s51, s51, 1
  s_cbranch_scc1 main_end
  buffer_load_dword v105, v0, s[4:7], s79 offen sc1
  s_waitcnt vmcnt(0)
  v_cmp_eq_u32 vcc, 0, v105
  s_cbranch_vccnz o1_fl
  s_branch o1_fl_ok
o1_km:
  s_sub_u32 s51, s51, 1
  s_cbranch_scc1 main_end
  buffer_load_dwordx4 v[20:23], v96, s[4:7], s80 offen offset:1024 sc1
  buffer_load_dwordx4 v[24:27], v96, s[4:7], s87 offen offset:1024 sc1
  buffer_load_dwordx4 v[72:75], v104, s[4:7], s80 offen offset:0 sc1
  buffer_load_dwordx4 v[76:79], v104, s[4:7], s80 offen offset:2048 sc1
  s_waitcnt vmcnt(0)
  v_max_u32 v1, v20, v24
  v_cmp_eq_u32 vcc, -1, v1
  s_cbranch_vccnz o1_km
  s_branch o1_km_ok
o1_res:
  s_sub_u32 s51, s51, 1
  s_cbranch_scc1 main_end
  buffer_load_dwordx2 v[106:107], v90, s[4:7], s72 offen sc1
  s_waitcnt vmcnt(0)
  v_cmp_eq_u32 vcc, -1, v106
  s_cbranch_vccnz o1_res
  s_branch o1_res_ok
o1_red:
  s_mov_b64 exec, vcc
  buffer_load_dwordx4 v[184:187], v88, s[4:7], s76 offen offset:0 sc1
  buffer_load_dwordx4 v[188:191], v88, s[4:7], s76 offen offset:1024 sc1
  buffer_load_dwordx4 v[192:195], v88, s[4:7], s76 offen offset:2048 sc1
  buffer_load_dwordx4 v[196:199], v88, s[4:7], s76 offen offset:3072 sc1
  s_sub_u32 s51, s51, 1
  s_cbranch_scc1 main_end
  s_waitcnt vmcnt(0)
  v_bitop3_b32 v28, v184, v188, s85 bitop3:0x7e
  v_bitop3_b32 v29, v192, v196, s85 bitop3:0x7e
  v_bitop3_b32 v28, v28, v29, 1 bitop3:0xa8
  v_cmp_ne_u32 vcc, 0, v28
  s_cbranch_vccnz o1_red
  s_mov_b64 exec, -1
  v_mfma_f32_16x16x32_bf16 v[108:111], v[84:87], v[184:187], 0
  v_mfma_f32_16x16x32_bf16 v[108:111], v[84:87], v[188:191], v[108:111]
  v_mfma_f32_16x16x32_bf16 v[108:111], v[84:87], v[192:195], v[108:111]
  v_mfma_f32_16x16x32_bf16 v[108:111], v[84:87], v[196:199], v[108:111]
  s_branch o1_red_ok
o1_rese:
  s_sub_u32 s51, s51, 1
  s_cbranch_scc1 main_end
  buffer_load_dwordx2 v[106:107], v90, s[4:7], s72 offen sc1
  s_waitcnt vmcnt(0)
  v_cmp_eq_u32 vcc, -1, v106
  s_cbranch_vccnz o1_rese
  s_branch o1_rese_ok
o1_rede:
  s_mov_b64 exec, vcc
  buffer_load_dwordx4 v[184:187], v88, s[4:7], s76 offen offset:0 sc1
  buffer_load_dwordx4 v[188:191], v88, s[4:7], s76 offen offset:1024 sc1
  buffer_load_dwordx4 v[192:195], v88, s[4:7], s76 offen offset:2048 sc1
  buffer_load_dwordx4 v[196:199], v88, s[4:7], s76 offen offset:3072 sc1
  s_sub_u32 s51, s51, 1
  s_cbranch_scc1 main_end
  s_waitcnt vmcnt(0)
  v_bitop3_b32 v28, v184, v188, s85 bitop3:0x7e
  v_bitop3_b32 v29, v192, v196, s85 bitop3:0x7e
  v_bitop3_b32 v28, v28, v29, 1 bitop3:0xa8
  v_cmp_ne_u32 vcc, 0, v28
  s_cbranch_vccnz o1_rede
  s_mov_b64 exec, -1
  v_mfma_f32_16x16x32_bf16 v[108:111], v[84:87], v[184:187], 0
  v_mfma_f32_16x16x32_bf16 v[108:111], v[84:87], v[188:191], v[108:111]
  v_mfma_f32_16x16x32_bf16 v[108:111], v[84:87], v[192:195], v[108:111]
  v_mfma_f32_16x16x32_bf16 v[108:111], v[84:87], v[196:199], v[108:111]
  s_branch o1_rede_ok
o1_last:
  v_cvt_pk_bf16_f32 v160, v120, v124
  v_cvt_pk_bf16_f32 v161, v128, v132
  v_cvt_pk_bf16_f32 v162, v136, v140
  s_nop 2
  v_cvt_pk_bf16_f32 v163, v144, v148
  v_bfi_b32 v160, 1, s77, v160
  buffer_store_dwordx4 v[160:163], v94, s[4:7], s75 offen sc1
  v_cvt_pk_bf16_f32 v164, v121, v125
  v_cvt_pk_bf16_f32 v165, v129, v133
  v_cvt_pk_bf16_f32 v166, v137, v141
  v_cvt_pk_bf16_f32 v167, v145, v149
  v_bfi_b32 v164, 1, s77, v164
  s_add_u32 s81, s75, 33024
  buffer_store_dwordx4 v[164:167], v94, s[4:7], s81 offen sc1
  v_cvt_pk_bf16_f32 v168, v122, v126
  v_cvt_pk_bf16_f32 v169, v130, v134
  v_cvt_pk_bf16_f32 v170, v138, v142
  v_cvt_pk_bf16_f32 v171, v146, v150
  v_bfi_b32 v168, 1, s77, v168
  s_add_u32 s81, s75, 66048
  buffer_store_dwordx4 v[168:171], v94, s[4:7], s81 offen sc1
  v_cvt_pk_bf16_f32 v172, v123, v127
  v_cvt_pk_bf16_f32 v173, v131, v135
  v_cvt_pk_bf16_f32 v174, v139, v143
  v_cvt_pk_bf16_f32 v175, v147, v151
  v_bfi_b32 v172, 1, s77, v172
  s_add_u32 s81, s75, 99072
  buffer_store_dwordx4 v[172:175], v94, s[4:7], s81 offen sc1
o1_last2:
  s_add_u32 s86, s86, 1
  s_add_u32 s71, s71, 1
  s_add_u32 s73, s72, 0x400000
  s_waitcnt lgkmcnt(0)
  s_barrier
  buffer_load_dwordx4 v[184:187], v88, s[4:7], s76 offen offset:0 sc1
  buffer_load_dwordx4 v[188:191], v88, s[4:7], s76 offen offset:1024 sc1
  buffer_load_dwordx4 v[192:195], v88, s[4:7], s76 offen offset:2048 sc1
  buffer_load_dwordx4 v[196:199], v88, s[4:7], s76 offen offset:3072 sc1
  s_waitcnt vmcnt(4)
  v_cmp_eq_u32 vcc, -1, v106
  s_cbranch_vccnz o1_rese
o1_rese_ok:
  v_lshlrev_b32 v60, 16, v106
  v_and_b32 v61, 0xffff0000, v106
  v_lshlrev_b32 v62, 16, v107
  v_and_b32 v63, 0xffff0000, v107
  s_waitcnt vmcnt(3)
  v_mfma_f32_16x16x32_bf16 v[108:111], v[84:87], v[184:187], 0
  s_waitcnt vmcnt(2)
  v_mfma_f32_16x16x32_bf16 v[108:111], v[84:87], v[188:191], v[108:111]
  v_bitop3_b32 v28, v184, v188, s85 bitop3:0x7e
  s_waitcnt vmcnt(1)
  v_mfma_f32_16x16x32_bf16 v[108:111], v[84:87], v[192:195], v[108:111]
  s_waitcnt vmcnt(0)
  v_mfma_f32_16x16x32_bf16 v[108:111], v[84:87], v[196:199], v[108:111]
  v_bitop3_b32 v29, v192, v196, s85 bitop3:0x7e
  v_bitop3_b32 v28, v28, v29, 1 bitop3:0xa8
  v_cmp_ne_u32 vcc, 0, v28
  s_cbranch_vccnz o1_rede
o1_rede_ok:
  s_nop 6
  v_cvt_pk_bf16_f32 v118, v108, v109
  v_cvt_pk_bf16_f32 v119, v110, v111
  v_lshlrev_b32 v112, 16, v118
  v_and_b32 v113, 0xffff0000, v118
  v_lshlrev_b32 v114, 16, v119
  v_and_b32 v115, 0xffff0000, v119
  v_add_f32 v112, v112, v60
  v_add_f32 v113, v113, v61
  v_add_f32 v114, v114, v62
  v_add_f32 v115, v115, v63
  v_cvt_pk_bf16_f32 v118, v112, v113
  v_cvt_pk_bf16_f32 v119, v114, v115
  v_lshlrev_b32 v112, 16, v118
  v_and_b32 v113, 0xffff0000, v118
  v_lshlrev_b32 v114, 16, v119
  v_and_b32 v115, 0xffff0000, v119
  v_mul_f32 v29, v112, v112
  v_add_f32 v28, v112, v113
  v_fmac_f32 v29, v113, v113
  v_add_f32 v30, v114, v115
  v_fmac_f32 v29, v114, v114
  v_add_f32 v28, v28, v30
  v_fmac_f32 v29, v115, v115
  v_med3_u32 v118, v118, v249, v250
  s_nop 0
  v_permlane16_swap_b32 v28, v29
  v_add_f32 v28, v28, v29
  s_nop 1
  v_add_f32_dpp v28, v28, v28 row_ror:8 row_mask:0xf bank_mask:0xf
  s_nop 1
  v_add_f32_dpp v28, v28, v28 row_ror:4 row_mask:0xf bank_mask:0xf
  s_nop 1
  v_add_f32_dpp v28, v28, v28 row_ror:2 row_mask:0xf bank_mask:0xf
  s_nop 1
  v_add_f32_dpp v28, v28, v28 row_ror:1 row_mask:0xf bank_mask:0xf
  ds_write_b32 v92, v28
  s_waitcnt lgkmcnt(0)
  s_barrier
  ds_read_b128 v[28:31], v93 offset:40960
  ds_read_b128 v[32:35], v93 offset:40976
  s_add_u32 s76, s76, 0x200000
  s_and_b32 s76, s76, 0xffbfffff
  s_lshr_b32 s85, s71, 1
  s_waitcnt lgkmcnt(0)
  v_add_f32 v28, v28, v30
  v_add_f32 v29, v29, v31
  v_add_f32 v32, v32, v34
  v_add_f32 v33, v33, v35
  v_add_f32 v28, v28, v32
  v_add_f32 v29, v29, v33
  v_mul_f32 v28, 0x3b000000, v28
  v_mul_f32 v29, 0x3b000000, v29
  v_fma_f32 v29, -v28, v28, v29
  v_max_f32 v29, 0, v29
  v_cvt_pk_bf16_f32 v30, v28, v29
  v_and_b32 v29, 0xffff0000, v30
  v_add_f32 v29, 0x3727c5ac, v29
  v_cvt_pk_bf16_f32 v29, v29, v29
  v_lshlrev_b32 v29, 16, v29
  v_sqrt_f32 v29, v29
  v_lshlrev_b32 v28, 16, v30
  v_cvt_pk_bf16_f32 v29, v29, v29
  v_sub_f32 v112, v112, v28
  v_lshlrev_b32 v29, 16, v29
  v_sub_f32 v113, v113, v28
  v_rcp_f32 v29, v29
  v_sub_f32 v114, v114, v28
  v_sub_f32 v115, v115, v28
  v_cvt_pk_bf16_f32 v32, v112, v113
  v_cvt_pk_bf16_f32 v33, v114, v115
  v_lshlrev_b32 v112, 16, v32
  v_and_b32 v113, 0xffff0000, v32
  v_lshlrev_b32 v114, 16, v33
  v_and_b32 v115, 0xffff0000, v33
  v_mul_f32 v112, v112, v29
  v_mul_f32 v113, v113, v29
  v_mul_f32 v114, v114, v29
  v_mul_f32 v115, v115, v29
  v_cvt_pk_bf16_f32 v116, v112, v113
  v_cvt_pk_bf16_f32 v117, v114, v115
  v_med3_u32 v116, v116, v249, v250
  s_nop 0
  v_permlane16_swap_b32 v117, v119
  v_permlane16_swap_b32 v116, v118
  buffer_store_dwordx4 v[116:119], v91, s[4:7], s73 offen sc1
  s_endpgm
role_n:
  s_mov_b32 s70, s57
  s_mov_b32 s89, s55
  s_sub_u32 s57, s70, 16
  s_cbranch_scc0 role_r
  s_lshr_b32 s56, s50, 4
  s_bitcmp1_b32 0xf000, s56
  s_cbranch_scc0 dln_go
  s_cmp_lg_u32 s48, 0
  s_cbranch_scc1 dln_w
  v_lshlrev_b32 v2, 2, v0
  s_mov_b32 s58, 0xff000000
  s_and_b32 s59, s58, 0x20303040
  s_add_u32 s59, s59, 256
dln_cnt:
  s_sub_u32 s51, s51, 1
  s_cbranch_scc1 main_end
  buffer_load_dword v1, v2, s[36:39], 0 offen sc1
  s_waitcnt vmcnt(0)
  v_readlane_b32 s60, v1, 0
  v_readlane_b32 s61, v1, 48
  v_readlane_b32 s62, v1, 16
  v_readlane_b32 s63, v1, 49
  v_readlane_b32 s64, v1, 50
  v_readlane_b32 s65, v1, 51
  v_readlane_b32 s66, v1, 32
  v_readlane_b32 s67, v1, 33
  v_readlane_b32 s57, v1, 17
  s_add_u32 s56, s60, s61
  s_add_u32 s56, s56, s62
  s_add_u32 s56, s56, s63
  s_add_u32 s56, s56, s64
  s_add_u32 s56, s56, s65
  s_add_u32 s56, s56, s66
  s_add_u32 s56, s56, s67
  s_and_b32 s57, s57, s58
  s_add_u32 s56, s56, s57
  s_cmp_lt_u32 s56, s59
  s_cbranch_scc1 dln_cnt
dln_w:
  s_barrier
dln_go:
  v_bfe_u32 v1, v0, 4, 1
  v_lshrrev_b32 v2, 5, v0
  v_lshl_add_u32 v1, v1, 1, v2
  v_lshlrev_b32 v1, 3, v1
  v_and_b32 v2, 15, v0
  v_lshlrev_b32 v2, 4, v2
  s_lshl_b32 s54, s48, 8
  v_add_u32 v2, s54, v2
  s_mul_i32 s83, s70, 114688
  s_add_u32 s81, s83, 4096
  s_xor_b32 s54, s48, 0
  s_lshl_b32 s54, s54, 5
  v_add_u32 v14, s54, v1
  v_min_u32 v14, 104, v14
  v_lshl_add_u32 v14, v14, 10, v2
  buffer_load_dwordx4 v[128:131], v14, s[28:31], s83 offen offset:0
  buffer_load_dwordx4 v[132:135], v14, s[28:31], s83 offen offset:1024
  buffer_load_dwordx4 v[136:139], v14, s[28:31], s83 offen offset:2048
  buffer_load_dwordx4 v[140:143], v14, s[28:31], s83 offen offset:3072
  buffer_load_dwordx4 v[144:147], v14, s[28:31], s81 offen offset:0
  buffer_load_dwordx4 v[148:151], v14, s[28:31], s81 offen offset:1024
  buffer_load_dwordx4 v[152:155], v14, s[28:31], s81 offen offset:2048
  buffer_load_dwordx4 v[156:159], v14, s[28:31], s81 offen offset:3072
  s_xor_b32 s54, s48, 1
  s_lshl_b32 s54, s54, 5
  v_add_u32 v15, s54, v1
  v_min_u32 v15, 104, v15
  v_lshl_add_u32 v15, v15, 10, v2
  buffer_load_dwordx4 v[160:163], v15, s[28:31], s83 offen offset:0
  buffer_load_dwordx4 v[164:167], v15, s[28:31], s83 offen offset:1024
  buffer_load_dwordx4 v[168:171], v15, s[28:31], s83 offen offset:2048
  buffer_load_dwordx4 v[172:175], v15, s[28:31], s83 offen offset:3072
  buffer_load_dwordx4 v[176:179], v15, s[28:31], s81 offen offset:0
  buffer_load_dwordx4 v[180:183], v15, s[28:31], s81 offen offset:1024
  buffer_load_dwordx4 v[184:187], v15, s[28:31], s81 offen offset:2048
  buffer_load_dwordx4 v[188:191], v15, s[28:31], s81 offen offset:3072
  s_xor_b32 s54, s48, 2
  s_lshl_b32 s54, s54, 5
  v_add_u32 v16, s54, v1
  v_min_u32 v16, 104, v16
  v_lshl_add_u32 v16, v16, 10, v2
  buffer_load_dwordx4 v[192:195], v16, s[28:31], s83 offen offset:0
  buffer_load_dwordx4 v[196:199], v16, s[28:31], s83 offen offset:1024
  buffer_load_dwordx4 v[200:203], v16, s[28:31], s83 offen offset:2048
  buffer_load_dwordx4 v[204:207], v16, s[28:31], s83 offen offset:3072
  buffer_load_dwordx4 v[208:211], v16, s[28:31], s81 offen offset:0
  buffer_load_dwordx4 v[212:215], v16, s[28:31], s81 offen offset:1024
  buffer_load_dwordx4 v[216:219], v16, s[28:31], s81 offen offset:2048
  buffer_load_dwordx4 v[220:223], v16, s[28:31], s81 offen offset:3072
  s_xor_b32 s54, s48, 3
  s_lshl_b32 s54, s54, 5
  v_add_u32 v17, s54, v1
  v_min_u32 v17, 104, v17
  v_lshl_add_u32 v17, v17, 10, v2
  buffer_load_dwordx4 v[224:227], v17, s[28:31], s83 offen offset:0
  buffer_load_dwordx4 v[228:231], v17, s[28:31], s83 offen offset:1024
  buffer_load_dwordx4 v[232:235], v17, s[28:31], s83 offen offset:2048
  buffer_load_dwordx4 v[236:239], v17, s[28:31], s83 offen offset:3072
  buffer_load_dwordx4 v[240:243], v17, s[28:31], s81 offen offset:0
  buffer_load_dwordx4 v[244:247], v17, s[28:31], s81 offen offset:1024
  buffer_load_dwordx4 v[248:251], v17, s[28:31], s81 offen offset:2048
  buffer_load_dwordx4 v[252:255], v17, s[28:31], s81 offen offset:3072
  v_bfe_u32 v1, v0, 2, 2
  v_lshrrev_b32 v2, 5, v0
  v_lshl_add_u32 v10, v2, 3, v1
  v_lshlrev_b32 v10, 8, v10
  v_xor_b32 v1, s48, v1
  v_lshl_add_u32 v10, v1, 6, v10
  v_bfe_u32 v1, v0, 4, 1
  v_lshl_add_u32 v10, v1, 5, v10
  v_and_b32 v1, 1, v0
  v_lshl_add_u32 v10, v1, 4, v10
  v_bfe_u32 v1, v0, 1, 1
  v_lshl_add_u32 v10, v1, 3, v10
  v_add_u32 v11, 0x10000, v10
  v_add_u32 v12, 0x20000, v10
  v_lshrrev_b32 v1, 4, v0
  v_lshlrev_b32 v2, 2, v1
  v_and_b32 v13, 15, v0
  v_xor_b32 v13, v13, v2
  v_min_u32 v13, 13, v13
  v_lshlrev_b32 v13, 4, v13
  s_lshl_b32 s54, s48, 4
  v_add_u32 v1, s54, v1
  v_mul_u32_u24 v1, 3584, v1
  v_add_u32 v13, v13, v1
  s_lshl_b32 s82, s48, 12
  s_mul_i32 s80, s70, 224
  s_add_u32 m0, s82, 0x0
  s_add_u32 s81, s80, 0x0
  buffer_load_dwordx4 v13, s[24:27], s81 offen lds
  s_add_u32 m0, s82, 0x400
  s_add_u32 s81, s80, 0x3800
  buffer_load_dwordx4 v13, s[24:27], s81 offen lds
  s_add_u32 m0, s82, 0x800
  s_add_u32 s81, s80, 0x7000
  buffer_load_dwordx4 v13, s[24:27], s81 offen lds
  s_add_u32 m0, s82, 0xc00
  s_add_u32 s81, s80, 0xa800
  buffer_load_dwordx4 v13, s[24:27], s81 offen lds
  s_add_u32 m0, s82, 0x4000
  s_add_u32 s81, s80, 0x38000
  buffer_load_dwordx4 v13, s[24:27], s81 offen lds
  s_add_u32 m0, s82, 0x4400
  s_add_u32 s81, s80, 0x3b800
  buffer_load_dwordx4 v13, s[24:27], s81 offen lds
  s_add_u32 m0, s82, 0x4800
  s_add_u32 s81, s80, 0x3f000
  buffer_load_dwordx4 v13, s[24:27], s81 offen lds
  s_add_u32 m0, s82, 0x4c00
  s_add_u32 s81, s80, 0x42800
  buffer_load_dwordx4 v13, s[24:27], s81 offen lds
  s_add_u32 m0, s82, 0x8000
  s_add_u32 s81, s80, 0x70000
  buffer_load_dwordx4 v13, s[24:27], s81 offen lds
  s_add_u32 m0, s82, 0x8400
  s_add_u32 s81, s80, 0x73800
  buffer_load_dwordx4 v13, s[24:27], s81 offen lds
  s_add_u32 m0, s82, 0x8800
  s_add_u32 s81, s80, 0x77000
  buffer_load_dwordx4 v13, s[24:27], s81 offen lds
  s_add_u32 m0, s82, 0x8c00
  s_add_u32 s81, s80, 0x7a800
  buffer_load_dwordx4 v13, s[24:27], s81 offen lds
  s_add_u32 m0, s82, 0xc000
  s_add_u32 s81, s80, 0xa8000
  buffer_load_dwordx4 v13, s[24:27], s81 offen lds
  s_add_u32 m0, s82, 0xc400
  s_add_u32 s81, s80, 0xab800
  buffer_load_dwordx4 v13, s[24:27], s81 offen lds
  s_add_u32 m0, s82, 0xc800
  s_add_u32 s81, s80, 0xaf000
  buffer_load_dwordx4 v13, s[24:27], s81 offen lds
  s_add_u32 m0, s82, 0xcc00
  s_add_u32 s81, s80, 0xb2800
  buffer_load_dwordx4 v13, s[24:27], s81 offen lds
  s_add_u32 m0, s82, 0x10000
  s_add_u32 s81, s80, 0xe0000
  buffer_load_dwordx4 v13, s[24:27], s81 offen lds
  s_add_u32 m0, s82, 0x10400
  s_add_u32 s81, s80, 0xe3800
  buffer_load_dwordx4 v13, s[24:27], s81 offen lds
  s_add_u32 m0, s82, 0x10800
  s_add_u32 s81, s80, 0xe7000
  buffer_load_dwordx4 v13, s[24:27], s81 offen lds
  s_add_u32 m0, s82, 0x10c00
  s_add_u32 s81, s80, 0xea800
  buffer_load_dwordx4 v13, s[24:27], s81 offen lds
  s_add_u32 m0, s82, 0x14000
  s_add_u32 s81, s80, 0x118000
  buffer_load_dwordx4 v13, s[24:27], s81 offen lds
  s_add_u32 m0, s82, 0x14400
  s_add_u32 s81, s80, 0x11b800
  buffer_load_dwordx4 v13, s[24:27], s81 offen lds
  s_add_u32 m0, s82, 0x14800
  s_add_u32 s81, s80, 0x11f000
  buffer_load_dwordx4 v13, s[24:27], s81 offen lds
  s_add_u32 m0, s82, 0x14c00
  s_add_u32 s81, s80, 0x122800
  buffer_load_dwordx4 v13, s[24:27], s81 offen lds
  s_add_u32 m0, s82, 0x18000
  s_add_u32 s81, s80, 0x150000
  buffer_load_dwordx4 v13, s[24:27], s81 offen lds
  s_add_u32 m0, s82, 0x18400
  s_add_u32 s81, s80, 0x153800
  buffer_load_dwordx4 v13, s[24:27], s81 offen lds
  s_add_u32 m0, s82, 0x18800
  s_add_u32 s81, s80, 0x157000
  buffer_load_dwordx4 v13, s[24:27], s81 offen lds
  s_add_u32 m0, s82, 0x18c00
  s_add_u32 s81, s80, 0x15a800
  buffer_load_dwordx4 v13, s[24:27], s81 offen lds
  s_add_u32 m0, s82, 0x1c000
  s_add_u32 s81, s80, 0x188000
  buffer_load_dwordx4 v13, s[24:27], s81 offen lds
  s_add_u32 m0, s82, 0x1c400
  s_add_u32 s81, s80, 0x18b800
  buffer_load_dwordx4 v13, s[24:27], s81 offen lds
  s_add_u32 m0, s82, 0x1c800
  s_add_u32 s81, s80, 0x18f000
  buffer_load_dwordx4 v13, s[24:27], s81 offen lds
  s_add_u32 m0, s82, 0x1cc00
  s_add_u32 s81, s80, 0x192800
  buffer_load_dwordx4 v13, s[24:27], s81 offen lds
  s_waitcnt vmcnt(28) lgkmcnt(0)
  s_barrier
  ds_read_b64_tr_b16 a[0:1], v10 offset:0
  ds_read_b64_tr_b16 a[2:3], v10 offset:1024
  ds_read_b64_tr_b16 a[4:5], v10 offset:4096
  ds_read_b64_tr_b16 a[6:7], v10 offset:5120
  ds_read_b64_tr_b16 a[8:9], v10 offset:8192
  ds_read_b64_tr_b16 a[10:11], v10 offset:9216
  ds_read_b64_tr_b16 a[12:13], v10 offset:12288
  ds_read_b64_tr_b16 a[14:15], v10 offset:13312
  s_waitcnt vmcnt(24) lgkmcnt(0)
  s_barrier
  ds_read_b64_tr_b16 a[16:17], v10 offset:16384
  ds_read_b64_tr_b16 a[18:19], v10 offset:17408
  ds_read_b64_tr_b16 a[20:21], v10 offset:20480
  ds_read_b64_tr_b16 a[22:23], v10 offset:21504
  ds_read_b64_tr_b16 a[24:25], v10 offset:24576
  ds_read_b64_tr_b16 a[26:27], v10 offset:25600
  ds_read_b64_tr_b16 a[28:29], v10 offset:28672
  ds_read_b64_tr_b16 a[30:31], v10 offset:29696
  s_waitcnt vmcnt(20) lgkmcnt(0)
  s_barrier
  ds_read_b64_tr_b16 a[32:33], v10 offset:32768
  ds_read_b64_tr_b16 a[34:35], v10 offset:33792
  ds_read_b64_tr_b16 a[36:37], v10 offset:36864
  ds_read_b64_tr_b16 a[38:39], v10 offset:37888
  ds_read_b64_tr_b16 a[40:41], v10 offset:40960
  ds_read_b64_tr_b16 a[42:43], v10 offset:41984
  ds_read_b64_tr_b16 a[44:45], v10 offset:45056
  ds_read_b64_tr_b16 a[46:47], v10 offset:46080
  s_waitcnt vmcnt(16) lgkmcnt(0)
  s_barrier
  ds_read_b64_tr_b16 a[48:49], v10 offset:49152
  ds_read_b64_tr_b16 a[50:51], v10 offset:50176
  ds_read_b64_tr_b16 a[52:53], v10 offset:53248
  ds_read_b64_tr_b16 a[54:55], v10 offset:54272
  ds_read_b64_tr_b16 a[56:57], v10 offset:57344
  ds_read_b64_tr_b16 a[58:59], v10 offset:58368
  ds_read_b64_tr_b16 a[60:61], v10 offset:61440
  ds_read_b64_tr_b16 a[62:63], v10 offset:62464
  s_waitcnt vmcnt(12) lgkmcnt(0)
  s_barrier
  ds_read_b64_tr_b16 a[64:65], v11 offset:0
  ds_read_b64_tr_b16 a[66:67], v11 offset:1024
  ds_read_b64_tr_b16 a[68:69], v11 offset:4096
  ds_read_b64_tr_b16 a[70:71], v11 offset:5120
  ds_read_b64_tr_b16 a[72:73], v11 offset:8192
  ds_read_b64_tr_b16 a[74:75], v11 offset:9216
  ds_read_b64_tr_b16 a[76:77], v11 offset:12288
  ds_read_b64_tr_b16 a[78:79], v11 offset:13312
  s_waitcnt vmcnt(8) lgkmcnt(0)
  s_barrier
  ds_read_b64_tr_b16 a[80:81], v11 offset:16384
  ds_read_b64_tr_b16 a[82:83], v11 offset:17408
  ds_read_b64_tr_b16 a[84:85], v11 offset:20480
  ds_read_b64_tr_b16 a[86:87], v11 offset:21504
  ds_read_b64_tr_b16 a[88:89], v11 offset:24576
  ds_read_b64_tr_b16 a[90:91], v11 offset:25600
  ds_read_b64_tr_b16 a[92:93], v11 offset:28672
  ds_read_b64_tr_b16 a[94:95], v11 offset:29696
  s_waitcnt vmcnt(4) lgkmcnt(0)
  s_barrier
  ds_read_b64_tr_b16 a[96:97], v11 offset:32768
  ds_read_b64_tr_b16 a[98:99], v11 offset:33792
  ds_read_b64_tr_b16 a[100:101], v11 offset:36864
  ds_read_b64_tr_b16 a[102:103], v11 offset:37888
  ds_read_b64_tr_b16 a[104:105], v11 offset:40960
  ds_read_b64_tr_b16 a[106:107], v11 offset:41984
  ds_read_b64_tr_b16 a[108:109], v11 offset:45056
  ds_read_b64_tr_b16 a[110:111], v11 offset:46080
  s_waitcnt vmcnt(0) lgkmcnt(0)
  s_barrier
  ds_read_b64_tr_b16 a[112:113], v11 offset:49152
  ds_read_b64_tr_b16 a[114:115], v11 offset:50176
  ds_read_b64_tr_b16 a[116:117], v11 offset:53248
  ds_read_b64_tr_b16 a[118:119], v11 offset:54272
  ds_read_b64_tr_b16 a[120:121], v11 offset:57344
  ds_read_b64_tr_b16 a[122:123], v11 offset:58368
  ds_read_b64_tr_b16 a[124:125], v11 offset:61440
  ds_read_b64_tr_b16 a[126:127], v11 offset:62464
  s_waitcnt lgkmcnt(0)
  s_barrier
  s_mov_b32 s54, 0x05040100
  s_mov_b32 s55, 0x07060302
  v_perm_b32 v4, v132, v128, s54
  v_perm_b32 v5, v140, v136, s54
  v_perm_b32 v6, v148, v144, s54
  v_perm_b32 v7, v156, v152, s54
  v_accvgpr_write_b32 a128, v4
  v_accvgpr_write_b32 a129, v5
  v_accvgpr_write_b32 a130, v6
  v_accvgpr_write_b32 a131, v7
  v_perm_b32 v4, v132, v128, s55
  v_perm_b32 v5, v140, v136, s55
  v_perm_b32 v6, v148, v144, s55
  v_perm_b32 v7, v156, v152, s55
  v_accvgpr_write_b32 a132, v4
  v_accvgpr_write_b32 a133, v5
  v_accvgpr_write_b32 a134, v6
  v_accvgpr_write_b32 a135, v7
  v_perm_b32 v4, v133, v129, s54
  v_perm_b32 v5, v141, v137, s54
  v_perm_b32 v6, v149, v145, s54
  v_perm_b32 v7, v157, v153, s54
  v_accvgpr_write_b32 a136, v4
  v_accvgpr_write_b32 a137, v5
  v_accvgpr_write_b32 a138, v6
  v_accvgpr_write_b32 a139, v7
  v_perm_b32 v4, v133, v129, s55
  v_perm_b32 v5, v141, v137, s55
  v_perm_b32 v6, v149, v145, s55
  v_perm_b32 v7, v157, v153, s55
  v_accvgpr_write_b32 a140, v4
  v_accvgpr_write_b32 a141, v5
  v_accvgpr_write_b32 a142, v6
  v_accvgpr_write_b32 a143, v7
  v_perm_b32 v4, v134, v130, s54
  v_perm_b32 v5, v142, v138, s54
  v_perm_b32 v6, v150, v146, s54
  v_perm_b32 v7, v158, v154, s54
  v_accvgpr_write_b32 a144, v4
  v_accvgpr_write_b32 a145, v5
  v_accvgpr_write_b32 a146, v6
  v_accvgpr_write_b32 a147, v7
  v_perm_b32 v4, v134, v130, s55
  v_perm_b32 v5, v142, v138, s55
  v_perm_b32 v6, v150, v146, s55
  v_perm_b32 v7, v158, v154, s55
  v_accvgpr_write_b32 a148, v4
  v_accvgpr_write_b32 a149, v5
  v_accvgpr_write_b32 a150, v6
  v_accvgpr_write_b32 a151, v7
  v_perm_b32 v4, v135, v131, s54
  v_perm_b32 v5, v143, v139, s54
  v_perm_b32 v6, v151, v147, s54
  v_perm_b32 v7, v159, v155, s54
  v_accvgpr_write_b32 a152, v4
  v_accvgpr_write_b32 a153, v5
  v_accvgpr_write_b32 a154, v6
  v_accvgpr_write_b32 a155, v7
  v_perm_b32 v4, v135, v131, s55
  v_perm_b32 v5, v143, v139, s55
  v_perm_b32 v6, v151, v147, s55
  v_perm_b32 v7, v159, v155, s55
  v_accvgpr_write_b32 a156, v4
  v_accvgpr_write_b32 a157, v5
  v_accvgpr_write_b32 a158, v6
  v_accvgpr_write_b32 a159, v7
  v_perm_b32 v4, v164, v160, s54
  v_perm_b32 v5, v172, v168, s54
  v_perm_b32 v6, v180, v176, s54
  v_perm_b32 v7, v188, v184, s54
  v_accvgpr_write_b32 a160, v4
  v_accvgpr_write_b32 a161, v5
  v_accvgpr_write_b32 a162, v6
  v_accvgpr_write_b32 a163, v7
  v_perm_b32 v4, v164, v160, s55
  v_perm_b32 v5, v172, v168, s55
  v_perm_b32 v6, v180, v176, s55
  v_perm_b32 v7, v188, v184, s55
  v_accvgpr_write_b32 a164, v4
  v_accvgpr_write_b32 a165, v5
  v_accvgpr_write_b32 a166, v6
  v_accvgpr_write_b32 a167, v7
  v_perm_b32 v4, v165, v161, s54
  v_perm_b32 v5, v173, v169, s54
  v_perm_b32 v6, v181, v177, s54
  v_perm_b32 v7, v189, v185, s54
  v_accvgpr_write_b32 a168, v4
  v_accvgpr_write_b32 a169, v5
  v_accvgpr_write_b32 a170, v6
  v_accvgpr_write_b32 a171, v7
  v_perm_b32 v4, v165, v161, s55
  v_perm_b32 v5, v173, v169, s55
  v_perm_b32 v6, v181, v177, s55
  v_perm_b32 v7, v189, v185, s55
  v_accvgpr_write_b32 a172, v4
  v_accvgpr_write_b32 a173, v5
  v_accvgpr_write_b32 a174, v6
  v_accvgpr_write_b32 a175, v7
  v_perm_b32 v4, v166, v162, s54
  v_perm_b32 v5, v174, v170, s54
  v_perm_b32 v6, v182, v178, s54
  v_perm_b32 v7, v190, v186, s54
  v_accvgpr_write_b32 a176, v4
  v_accvgpr_write_b32 a177, v5
  v_accvgpr_write_b32 a178, v6
  v_accvgpr_write_b32 a179, v7
  v_perm_b32 v4, v166, v162, s55
  v_perm_b32 v5, v174, v170, s55
  v_perm_b32 v6, v182, v178, s55
  v_perm_b32 v7, v190, v186, s55
  v_accvgpr_write_b32 a180, v4
  v_accvgpr_write_b32 a181, v5
  v_accvgpr_write_b32 a182, v6
  v_accvgpr_write_b32 a183, v7
  v_perm_b32 v4, v167, v163, s54
  v_perm_b32 v5, v175, v171, s54
  v_perm_b32 v6, v183, v179, s54
  v_perm_b32 v7, v191, v187, s54
  v_accvgpr_write_b32 a184, v4
  v_accvgpr_write_b32 a185, v5
  v_accvgpr_write_b32 a186, v6
  v_accvgpr_write_b32 a187, v7
  v_perm_b32 v4, v167, v163, s55
  v_perm_b32 v5, v175, v171, s55
  v_perm_b32 v6, v183, v179, s55
  v_perm_b32 v7, v191, v187, s55
  v_accvgpr_write_b32 a188, v4
  v_accvgpr_write_b32 a189, v5
  v_accvgpr_write_b32 a190, v6
  v_accvgpr_write_b32 a191, v7
  v_perm_b32 v4, v196, v192, s54
  v_perm_b32 v5, v204, v200, s54
  v_perm_b32 v6, v212, v208, s54
  v_perm_b32 v7, v220, v216, s54
  v_accvgpr_write_b32 a192, v4
  v_accvgpr_write_b32 a193, v5
  v_accvgpr_write_b32 a194, v6
  v_accvgpr_write_b32 a195, v7
  v_perm_b32 v4, v196, v192, s55
  v_perm_b32 v5, v204, v200, s55
  v_perm_b32 v6, v212, v208, s55
  v_perm_b32 v7, v220, v216, s55
  v_accvgpr_write_b32 a196, v4
  v_accvgpr_write_b32 a197, v5
  v_accvgpr_write_b32 a198, v6
  v_accvgpr_write_b32 a199, v7
  v_perm_b32 v4, v197, v193, s54
  v_perm_b32 v5, v205, v201, s54
  v_perm_b32 v6, v213, v209, s54
  v_perm_b32 v7, v221, v217, s54
  v_accvgpr_write_b32 a200, v4
  v_accvgpr_write_b32 a201, v5
  v_accvgpr_write_b32 a202, v6
  v_accvgpr_write_b32 a203, v7
  v_perm_b32 v4, v197, v193, s55
  v_perm_b32 v5, v205, v201, s55
  v_perm_b32 v6, v213, v209, s55
  v_perm_b32 v7, v221, v217, s55
  v_accvgpr_write_b32 a204, v4
  v_accvgpr_write_b32 a205, v5
  v_accvgpr_write_b32 a206, v6
  v_accvgpr_write_b32 a207, v7
  v_perm_b32 v4, v198, v194, s54
  v_perm_b32 v5, v206, v202, s54
  v_perm_b32 v6, v214, v210, s54
  v_perm_b32 v7, v222, v218, s54
  v_accvgpr_write_b32 a208, v4
  v_accvgpr_write_b32 a209, v5
  v_accvgpr_write_b32 a210, v6
  v_accvgpr_write_b32 a211, v7
  v_perm_b32 v4, v198, v194, s55
  v_perm_b32 v5, v206, v202, s55
  v_perm_b32 v6, v214, v210, s55
  v_perm_b32 v7, v222, v218, s55
  v_accvgpr_write_b32 a212, v4
  v_accvgpr_write_b32 a213, v5
  v_accvgpr_write_b32 a214, v6
  v_accvgpr_write_b32 a215, v7
  v_perm_b32 v4, v199, v195, s54
  v_perm_b32 v5, v207, v203, s54
  v_perm_b32 v6, v215, v211, s54
  v_perm_b32 v7, v223, v219, s54
  v_accvgpr_write_b32 a216, v4
  v_accvgpr_write_b32 a217, v5
  v_accvgpr_write_b32 a218, v6
  v_accvgpr_write_b32 a219, v7
  v_perm_b32 v4, v199, v195, s55
  v_perm_b32 v5, v207, v203, s55
  v_perm_b32 v6, v215, v211, s55
  v_perm_b32 v7, v223, v219, s55
  v_accvgpr_write_b32 a220, v4
  v_accvgpr_write_b32 a221, v5
  v_accvgpr_write_b32 a222, v6
  v_accvgpr_write_b32 a223, v7
  v_perm_b32 v4, v228, v224, s54
  v_perm_b32 v5, v236, v232, s54
  v_perm_b32 v6, v244, v240, s54
  v_perm_b32 v7, v252, v248, s54
  v_accvgpr_write_b32 a224, v4
  v_accvgpr_write_b32 a225, v5
  v_accvgpr_write_b32 a226, v6
  v_accvgpr_write_b32 a227, v7
  v_perm_b32 v4, v228, v224, s55
  v_perm_b32 v5, v236, v232, s55
  v_perm_b32 v6, v244, v240, s55
  v_perm_b32 v7, v252, v248, s55
  v_accvgpr_write_b32 a228, v4
  v_accvgpr_write_b32 a229, v5
  v_accvgpr_write_b32 a230, v6
  v_accvgpr_write_b32 a231, v7
  v_perm_b32 v4, v229, v225, s54
  v_perm_b32 v5, v237, v233, s54
  v_perm_b32 v6, v245, v241, s54
  v_perm_b32 v7, v253, v249, s54
  v_accvgpr_write_b32 a232, v4
  v_accvgpr_write_b32 a233, v5
  v_accvgpr_write_b32 a234, v6
  v_accvgpr_write_b32 a235, v7
  v_perm_b32 v4, v229, v225, s55
  v_perm_b32 v5, v237, v233, s55
  v_perm_b32 v6, v245, v241, s55
  v_perm_b32 v7, v253, v249, s55
  v_accvgpr_write_b32 a236, v4
  v_accvgpr_write_b32 a237, v5
  v_accvgpr_write_b32 a238, v6
  v_accvgpr_write_b32 a239, v7
  v_perm_b32 v4, v230, v226, s54
  v_perm_b32 v5, v238, v234, s54
  v_perm_b32 v6, v246, v242, s54
  v_perm_b32 v7, v254, v250, s54
  v_accvgpr_write_b32 a240, v4
  v_accvgpr_write_b32 a241, v5
  v_accvgpr_write_b32 a242, v6
  v_accvgpr_write_b32 a243, v7
  v_perm_b32 v4, v230, v226, s55
  v_perm_b32 v5, v238, v234, s55
  v_perm_b32 v6, v246, v242, s55
  v_perm_b32 v7, v254, v250, s55
  v_accvgpr_write_b32 a244, v4
  v_accvgpr_write_b32 a245, v5
  v_accvgpr_write_b32 a246, v6
  v_accvgpr_write_b32 a247, v7
  v_perm_b32 v4, v231, v227, s54
  v_perm_b32 v5, v239, v235, s54
  v_perm_b32 v6, v247, v243, s54
  v_perm_b32 v7, v255, v251, s54
  v_accvgpr_write_b32 a248, v4
  v_accvgpr_write_b32 a249, v5
  v_accvgpr_write_b32 a250, v6
  v_accvgpr_write_b32 a251, v7
  v_perm_b32 v4, v231, v227, s55
  v_perm_b32 v5, v239, v235, s55
  v_perm_b32 v6, v247, v243, s55
  v_perm_b32 v7, v255, v251, s55
  v_accvgpr_write_b32 a252, v4
  v_accvgpr_write_b32 a253, v5
  v_accvgpr_write_b32 a254, v6
  v_accvgpr_write_b32 a255, v7
  s_cmp_lt_u32 s48, 3
  s_cbranch_scc1 n_nopad
  s_mov_b32 exec_lo, 0xffff0000
  s_mov_b32 exec_hi, 0xffff0000
  v_accvgpr_write_b32 a0, 0
  v_accvgpr_write_b32 a1, 0
  v_accvgpr_write_b32 a2, 0
  v_accvgpr_write_b32 a3, 0
  v_accvgpr_write_b32 a4, 0
  v_accvgpr_write_b32 a5, 0
  v_accvgpr_write_b32 a6, 0
  v_accvgpr_write_b32 a7, 0
  v_accvgpr_write_b32 a8, 0
  v_accvgpr_write_b32 a9, 0
  v_accvgpr_write_b32 a10, 0
  v_accvgpr_write_b32 a11, 0
  v_accvgpr_write_b32 a12, 0
  v_accvgpr_write_b32 a13, 0
  v_accvgpr_write_b32 a14, 0
  v_accvgpr_write_b32 a15, 0
  v_accvgpr_write_b32 a16, 0
  v_accvgpr_write_b32 a17, 0
  v_accvgpr_write_b32 a18, 0
  v_accvgpr_write_b32 a19, 0
  v_accvgpr_write_b32 a20, 0
  v_accvgpr_write_b32 a21, 0
  v_accvgpr_write_b32 a22, 0
  v_accvgpr_write_b32 a23, 0
  v_accvgpr_write_b32 a24, 0
  v_accvgpr_write_b32 a25, 0
  v_accvgpr_write_b32 a26, 0
  v_accvgpr_write_b32 a27, 0
  v_accvgpr_write_b32 a28, 0
  v_accvgpr_write_b32 a29, 0
  v_accvgpr_write_b32 a30, 0
  v_accvgpr_write_b32 a31, 0
  v_accvgpr_write_b32 a32, 0
  v_accvgpr_write_b32 a33, 0
  v_accvgpr_write_b32 a34, 0
  v_accvgpr_write_b32 a35, 0
  v_accvgpr_write_b32 a36, 0
  v_accvgpr_write_b32 a37, 0
  v_accvgpr_write_b32 a38, 0
  v_accvgpr_write_b32 a39, 0
  v_accvgpr_write_b32 a40, 0
  v_accvgpr_write_b32 a41, 0
  v_accvgpr_write_b32 a42, 0
  v_accvgpr_write_b32 a43, 0
  v_accvgpr_write_b32 a44, 0
  v_accvgpr_write_b32 a45, 0
  v_accvgpr_write_b32 a46, 0
  v_accvgpr_write_b32 a47, 0
  v_accvgpr_write_b32 a48, 0
  v_accvgpr_write_b32 a49, 0
  v_accvgpr_write_b32 a50, 0
  v_accvgpr_write_b32 a51, 0
  v_accvgpr_write_b32 a52, 0
  v_accvgpr_write_b32 a53, 0
  v_accvgpr_write_b32 a54, 0
  v_accvgpr_write_b32 a55, 0
  v_accvgpr_write_b32 a56, 0
  v_accvgpr_write_b32 a57, 0
  v_accvgpr_write_b32 a58, 0
  v_accvgpr_write_b32 a59, 0
  v_accvgpr_write_b32 a60, 0
  v_accvgpr_write_b32 a61, 0
  v_accvgpr_write_b32 a62, 0
  v_accvgpr_write_b32 a63, 0
  v_accvgpr_write_b32 a64, 0
  v_accvgpr_write_b32 a65, 0
  v_accvgpr_write_b32 a66, 0
  v_accvgpr_write_b32 a67, 0
  v_accvgpr_write_b32 a68, 0
  v_accvgpr_write_b32 a69, 0
  v_accvgpr_write_b32 a70, 0
  v_accvgpr_write_b32 a71, 0
  v_accvgpr_write_b32 a72, 0
  v_accvgpr_write_b32 a73, 0
  v_accvgpr_write_b32 a74, 0
  v_accvgpr_write_b32 a75, 0
  v_accvgpr_write_b32 a76, 0
  v_accvgpr_write_b32 a77, 0
  v_accvgpr_write_b32 a78, 0
  v_accvgpr_write_b32 a79, 0
  v_accvgpr_write_b32 a80, 0
  v_accvgpr_write_b32 a81, 0
  v_accvgpr_write_b32 a82, 0
  v_accvgpr_write_b32 a83, 0
  v_accvgpr_write_b32 a84, 0
  v_accvgpr_write_b32 a85, 0
  v_accvgpr_write_b32 a86, 0
  v_accvgpr_write_b32 a87, 0
  v_accvgpr_write_b32 a88, 0
  v_accvgpr_write_b32 a89, 0
  v_accvgpr_write_b32 a90, 0
  v_accvgpr_write_b32 a91, 0
  v_accvgpr_write_b32 a92, 0
  v_accvgpr_write_b32 a93, 0
  v_accvgpr_write_b32 a94, 0
  v_accvgpr_write_b32 a95, 0
  v_accvgpr_write_b32 a96, 0
  v_accvgpr_write_b32 a97, 0
  v_accvgpr_write_b32 a98, 0
  v_accvgpr_write_b32 a99, 0
  v_accvgpr_write_b32 a100, 0
  v_accvgpr_write_b32 a101, 0
  v_accvgpr_write_b32 a102, 0
  v_accvgpr_write_b32 a103, 0
  v_accvgpr_write_b32 a104, 0
  v_accvgpr_write_b32 a105, 0
  v_accvgpr_write_b32 a106, 0
  v_accvgpr_write_b32 a107, 0
  v_accvgpr_write_b32 a108, 0
  v_accvgpr_write_b32 a109, 0
  v_accvgpr_write_b32 a110, 0
  v_accvgpr_write_b32 a111, 0
  v_accvgpr_write_b32 a112, 0
  v_accvgpr_write_b32 a113, 0
  v_accvgpr_write_b32 a114, 0
  v_accvgpr_write_b32 a115, 0
  v_accvgpr_write_b32 a116, 0
  v_accvgpr_write_b32 a117, 0
  v_accvgpr_write_b32 a118, 0
  v_accvgpr_write_b32 a119, 0
  v_accvgpr_write_b32 a120, 0
  v_accvgpr_write_b32 a121, 0
  v_accvgpr_write_b32 a122, 0
  v_accvgpr_write_b32 a123, 0
  v_accvgpr_write_b32 a124, 0
  v_accvgpr_write_b32 a125, 0
  v_accvgpr_write_b32 a126, 0
  v_accvgpr_write_b32 a127, 0
  s_mov_b64 exec, -1
n_nopad:
  v_lshlrev_b32 v21, 4, v0
  s_mul_i32 s54, s48, 8320
  s_add_u32 s54, s54, 0x0
  v_add_u32 v21, s54, v21
  v_and_b32 v1, 31, v0
  v_lshrrev_b32 v2, 5, v0
  v_mul_u32_u24 v22, 1040, v1
  v_lshl_add_u32 v22, v2, 4, v22
  s_lshl_b32 s54, s48, 11
  s_add_u32 s54, s54, 0x9000
  v_lshl_add_u32 v29, v0, 4, s54
  s_lshl_b32 s54, s48, 11
  s_xor_b32 s55, s54, 2048
  s_add_u32 s55, s55, 0x9000
  v_lshl_add_u32 v30, v0, 4, s55
  s_xor_b32 s55, s54, 4096
  s_add_u32 s55, s55, 0x9000
  v_lshl_add_u32 v31, v0, 4, s55
  s_xor_b32 s55, s54, 6144
  s_add_u32 s55, s55, 0x9000
  v_lshl_add_u32 v25, v0, 4, s55
  v_lshlrev_b32 v20, 4, v0
  s_lshl_b32 s54, s48, 13
  v_add_u32 v20, s54, v20
  v_and_b32 v1, 15, v0
  v_lshrrev_b32 v2, 4, v0
  v_mul_u32_u24 v27, 132096, v2
  v_lshl_add_u32 v27, v1, 4, v27
  s_lshl_b32 s55, s70, 8
  s_add_u32 s54, s54, s55
  s_add_u32 s56, s54, 528384
  v_add_u32 v28, s56, v27
  v_add_u32 v27, s54, v27
  s_lshl_b32 s54, s70, 10
  s_lshl_b32 s55, s48, 8
  s_add_u32 s54, s54, s55
  v_lshl_add_u32 v5, v1, 4, s54
  v_and_b32 v3, 1, v2
  v_lshrrev_b32 v2, 1, v2
  v_lshl_add_u32 v5, v2, 14, v5
  v_lshl_add_u32 v4, v3, 3, v5
  v_add_u32 v4, 0x8000, v4
  v_lshl_add_u32 v5, v3, 15, v5
  v_lshlrev_b32 v7, 5, v2
  s_lshl_b32 s54, s48, 3
  s_add_u32 s54, s54, 0x0
  v_add_u32 v6, s54, v7
  v_lshl_add_u32 v6, v3, 2, v6
  s_lshl_b32 s54, s89, 2
  s_add_u32 s54, s54, s48
  s_lshl_b32 s54, s54, 6
  s_add_u32 s54, s54, 0x380000
  v_and_b32 v23, 15, v0
  v_lshl_add_u32 v23, v23, 2, s54
  s_lshl_b32 s85, s89, 6
  s_lshl_b32 s73, s89, 23
  s_add_u32 s73, s73, 0x1400000
  s_add_u32 s74, s73, 0x3f0000
  s_cmp_eq_u32 s89, 0
  s_cselect_b32 s75, 1, 2
  s_lshl_b32 s76, 0x200000, s75
  s_lshl_b32 s77, s89, 24
  s_add_u32 s77, s77, s76
  s_add_u32 s77, s77, 0xbe00000
  s_not_b32 s76, s76
  s_lshl_b32 s72, -1, s75
  s_mov_b32 s71, -1
  s_mov_b32 s88, -1
  s_mul_i32 s82, s48, 8320
  v_lshlrev_b32 v2, 2, v0
  s_lshr_b32 s58, s50, 5
  s_bitcmp1_b32 0xca, s58
  s_cselect_b32 s58, -1, 0xffff
  s_and_b32 s59, s58, 0x20303040
  s_add_u32 s59, s59, 256
n1_cnt:
  s_sub_u32 s51, s51, 1
  s_cbranch_scc1 main_end
  buffer_load_dword v1, v2, s[36:39], 0 offen sc1
  s_waitcnt vmcnt(0)
  v_readlane_b32 s60, v1, 0
  v_readlane_b32 s61, v1, 48
  v_readlane_b32 s62, v1, 16
  v_readlane_b32 s63, v1, 49
  v_readlane_b32 s64, v1, 50
  v_readlane_b32 s65, v1, 51
  v_readlane_b32 s66, v1, 32
  v_readlane_b32 s67, v1, 33
  v_readlane_b32 s57, v1, 17
  s_add_u32 s56, s60, s61
  s_add_u32 s56, s56, s62
  s_add_u32 s56, s56, s63
  s_add_u32 s56, s56, s64
  s_add_u32 s56, s56, s65
  s_add_u32 s56, s56, s66
  s_add_u32 s56, s56, s67
  s_and_b32 s57, s57, s58
  s_add_u32 s56, s56, s57
  s_cmp_lt_u32 s56, s59
  s_cbranch_scc1 n1_cnt
  s_cmp_eq_u32 s89, 0
  s_cselect_b32 s84, s65, s67
  s_cmp_lt_u32 s84, 32
  s_cbranch_scc1 n1_xpoll
  s_branch n0_xpoll
n0_top:
  s_barrier
  ds_read_b128 v[32:35], v22 offset:0
  ds_read_b128 v[36:39], v22 offset:32
  ds_read_b128 v[40:43], v22 offset:64
  ds_read_b128 v[44:47], v22 offset:96
  v_cvt_pk_bf16_f32 v112, v160, v164
  v_cvt_pk_bf16_f32 v113, v168, v172
  v_cvt_pk_bf16_f32 v114, v176, v180
  v_cvt_pk_bf16_f32 v115, v184, v188
  v_bfi_b32 v112, 1, s79, v112
  ds_read_b128 v[48:51], v22 offset:128
  ds_read_b128 v[52:55], v22 offset:160
  ds_read_b128 v[56:59], v22 offset:192
  v_cvt_pk_bf16_f32 v116, v161, v165
  v_cvt_pk_bf16_f32 v117, v169, v173
  v_cvt_pk_bf16_f32 v118, v177, v181
  ds_read_b128 v[60:63], v22 offset:224
  s_waitcnt lgkmcnt(7)
  v_mfma_f32_32x32x16_bf16 v[4:19], a[0:3], v[32:35], 0
  s_waitcnt lgkmcnt(6)
  v_cvt_pk_bf16_f32 v119, v185, v189
  v_bfi_b32 v116, 1, s79, v116
  s_waitcnt lgkmcnt(5)
  s_waitcnt lgkmcnt(4)
  ds_read_b128 v[32:35], v22 offset:256
  s_add_u32 s80, s77, 33024
  v_mfma_f32_32x32x16_bf16 v[4:19], a[4:7], v[36:39], v[4:19]
  ds_read_b128 v[36:39], v22 offset:288
  v_cvt_pk_bf16_f32 v120, v162, v166
  v_cvt_pk_bf16_f32 v121, v170, v174
  v_cvt_pk_bf16_f32 v122, v178, v182
  s_waitcnt lgkmcnt(5)
  s_waitcnt lgkmcnt(4)
  s_waitcnt lgkmcnt(3)
  v_mfma_f32_32x32x16_bf16 v[4:19], a[8:11], v[40:43], v[4:19]
  buffer_store_dwordx4 v[112:115], v26, s[4:7], s77 offen
  v_cvt_pk_bf16_f32 v123, v186, v190
  v_bfi_b32 v120, 1, s79, v120
  s_waitcnt lgkmcnt(2)
  v_mfma_f32_32x32x16_bf16 v[4:19], a[12:15], v[44:47], v[4:19]
  ds_read_b128 v[40:43], v22 offset:320
  ds_read_b128 v[44:47], v22 offset:352
  s_waitcnt lgkmcnt(3)
  v_mfma_f32_32x32x16_bf16 v[4:19], a[16:19], v[48:51], v[4:19]
  ds_read_b128 v[48:51], v22 offset:384
  v_cvt_pk_bf16_f32 v124, v163, v167
  v_cvt_pk_bf16_f32 v125, v171, v175
  v_cvt_pk_bf16_f32 v126, v179, v183
  s_waitcnt lgkmcnt(3)
  v_mfma_f32_32x32x16_bf16 v[4:19], a[20:23], v[52:55], v[4:19]
  buffer_store_dwordx4 v[116:119], v26, s[4:7], s80 offen
  v_cvt_pk_bf16_f32 v127, v187, v191
  v_bfi_b32 v124, 1, s79, v124
  s_add_u32 s80, s77, 66048
  v_mfma_f32_32x32x16_bf16 v[4:19], a[24:27], v[56:59], v[4:19]
  ds_read_b128 v[52:55], v22 offset:416
  s_waitcnt lgkmcnt(3)
  ds_read_b128 v[56:59], v22 offset:448
  s_waitcnt lgkmcnt(3)
  v_mfma_f32_32x32x16_bf16 v[4:19], a[28:31], v[60:63], v[4:19]
  ds_read_b128 v[60:63], v22 offset:480
  s_waitcnt lgkmcnt(3)
  s_add_u32 s73, s73, 0x10000
  s_min_u32 s73, s73, s74
  v_mfma_f32_32x32x16_bf16 v[4:19], a[32:35], v[32:35], v[4:19]
  buffer_store_dwordx4 v[120:123], v26, s[4:7], s80 offen
  s_add_u32 s80, s77, 99072
  v_xor_b32 v21, 0x10000, v21
  s_xor_b32 s82, s82, 0x10000
  v_mfma_f32_32x32x16_bf16 v[4:19], a[36:39], v[36:39], v[4:19]
  ds_read_b128 v[32:35], v22 offset:512
  s_waitcnt lgkmcnt(3)
  ds_read_b128 v[36:39], v22 offset:544
  s_waitcnt lgkmcnt(3)
  s_add_u32 s71, s71, 1
  v_mfma_f32_32x32x16_bf16 v[4:19], a[40:43], v[40:43], v[4:19]
  ds_read_b128 v[40:43], v22 offset:576
  s_waitcnt lgkmcnt(3)
  s_lshr_b32 s79, s71, s75
  s_add_u32 s77, s77, 0x200000
  v_mfma_f32_32x32x16_bf16 v[4:19], a[44:47], v[44:47], v[4:19]
  buffer_store_dwordx4 v[124:127], v26, s[4:7], s80 offen
  v_mov_b32 v26, v28
  s_and_b32 s77, s77, s76
  s_cmp_eq_u32 s71, 63
  s_cselect_b32 s88, 0, -1
  v_mfma_f32_32x32x16_bf16 v[4:19], a[48:51], v[48:51], v[4:19]
  ds_read_b128 v[44:47], v22 offset:608
  s_waitcnt lgkmcnt(3)
  ds_read_b128 v[48:51], v22 offset:640
  s_waitcnt lgkmcnt(3)
  s_add_u32 s72, s72, 1
  v_mfma_f32_32x32x16_bf16 v[4:19], a[52:55], v[52:55], v[4:19]
  ds_read_b128 v[52:55], v22 offset:672
  s_waitcnt lgkmcnt(3)
  buffer_load_dword v24, v23, s[4:7], 0 offen sc1
  v_mfma_f32_32x32x16_bf16 v[4:19], a[56:59], v[56:59], v[4:19]
  ds_read_b128 v[56:59], v22 offset:704
  buffer_load_dwordx4 v[192:195], v20, s[4:7], s73 offen offset:0 sc1
  v_mfma_f32_32x32x16_bf16 v[4:19], a[60:63], v[60:63], v[4:19]
  s_waitcnt lgkmcnt(3)
  ds_read_b128 v[60:63], v22 offset:736
  s_waitcnt lgkmcnt(3)
  v_mfma_f32_32x32x16_bf16 v[4:19], a[64:67], v[32:35], v[4:19]
  ds_read_b128 v[32:35], v22 offset:768
  s_waitcnt lgkmcnt(3)
  buffer_load_dwordx4 v[196:199], v20, s[4:7], s73 offen offset:1024 sc1
  v_mfma_f32_32x32x16_bf16 v[4:19], a[68:71], v[36:39], v[4:19]
  ds_read_b128 v[36:39], v22 offset:800
  s_waitcnt lgkmcnt(3)
  v_mfma_f32_32x32x16_bf16 v[4:19], a[72:75], v[40:43], v[4:19]
  ds_read_b128 v[40:43], v22 offset:832
  s_waitcnt lgkmcnt(3)
  buffer_load_dwordx4 v[200:203], v20, s[4:7], s73 offen offset:2048 sc1
  v_mfma_f32_32x32x16_bf16 v[4:19], a[76:79], v[44:47], v[4:19]
  ds_read_b128 v[44:47], v22 offset:864
  s_waitcnt lgkmcnt(3)
  s_add_u32 s70, s73, 4096
  v_mfma_f32_32x32x16_bf16 v[4:19], a[80:83], v[48:51], v[4:19]
  ds_read_b128 v[48:51], v22 offset:896
  s_waitcnt lgkmcnt(3)
  buffer_load_dwordx4 v[204:207], v20, s[4:7], s73 offen offset:3072 sc1
  v_mfma_f32_32x32x16_bf16 v[4:19], a[84:87], v[52:55], v[4:19]
  ds_read_b128 v[52:55], v22 offset:928
  s_waitcnt lgkmcnt(3)
  v_mfma_f32_32x32x16_bf16 v[4:19], a[88:91], v[56:59], v[4:19]
  ds_read_b128 v[56:59], v22 offset:960
  s_waitcnt lgkmcnt(3)
  buffer_load_dwordx4 v[208:211], v20, s[4:7], s70 offen offset:0 sc1
  v_mfma_f32_32x32x16_bf16 v[4:19], a[92:95], v[60:63], v[4:19]
  ds_read_b128 v[60:63], v22 offset:992
  v_xor_b32 v22, 0x10000, v22
  s_waitcnt lgkmcnt(3)
  v_mfma_f32_32x32x16_bf16 v[4:19], a[96:99], v[32:35], v[4:19]
  s_waitcnt lgkmcnt(2)
  buffer_load_dwordx4 v[212:215], v20, s[4:7], s70 offen offset:1024 sc1
  v_mfma_f32_32x32x16_bf16 v[4:19], a[100:103], v[36:39], v[4:19]
  s_waitcnt lgkmcnt(1)
  v_mfma_f32_32x32x16_bf16 v[4:19], a[104:107], v[40:43], v[4:19]
  s_waitcnt lgkmcnt(0)
  buffer_load_dwordx4 v[216:219], v20, s[4:7], s70 offen offset:2048 sc1
  v_mfma_f32_32x32x16_bf16 v[4:19], a[108:111], v[44:47], v[4:19]
  v_mfma_f32_32x32x16_bf16 v[4:19], a[112:115], v[48:51], v[4:19]
  buffer_load_dwordx4 v[220:223], v20, s[4:7], s70 offen offset:3072 sc1
  v_mfma_f32_32x32x16_bf16 v[4:19], a[116:119], v[52:55], v[4:19]
  v_mfma_f32_32x32x16_bf16 v[4:19], a[120:123], v[56:59], v[4:19]
  v_mfma_f32_32x32x16_bf16 v[4:19], a[124:127], v[60:63], v[4:19]
  s_nop 11
  v_cvt_pk_bf16_f32 v64, v4, v5
  v_cvt_pk_bf16_f32 v68, v12, v13
  v_cvt_pk_bf16_f32 v65, v6, v7
  v_cvt_pk_bf16_f32 v69, v14, v15
  v_cvt_pk_bf16_f32 v66, v8, v9
  v_cvt_pk_bf16_f32 v70, v16, v17
  v_cvt_pk_bf16_f32 v67, v10, v11
  v_cvt_pk_bf16_f32 v71, v18, v19
  v_pk_max_i16 v64, v64, 0
  v_pk_max_i16 v68, v68, 0
  v_pk_max_i16 v65, v65, 0
  v_pk_max_i16 v69, v69, 0
  v_pk_max_i16 v66, v66, 0
  v_pk_max_i16 v70, v70, 0
  v_pk_max_i16 v67, v67, 0
  v_pk_max_i16 v71, v71, 0
  v_permlane16_swap_b32 v64, v68
  v_permlane16_swap_b32 v65, v69
  v_permlane16_swap_b32 v66, v70
  v_permlane16_swap_b32 v67, v71
  s_nop 1
  v_mfma_f32_16x16x32_bf16 v[128:131], v[64:67], a[128:131], 0
  ds_write_b128 v29, v[64:67] offset:0
  v_mfma_f32_16x16x32_bf16 v[132:135], v[64:67], a[132:135], 0
  ds_write_b128 v29, v[68:71] offset:1024
  v_mfma_f32_16x16x32_bf16 v[136:139], v[64:67], a[136:139], 0
  v_mfma_f32_16x16x32_bf16 v[140:143], v[64:67], a[140:143], 0
  v_mfma_f32_16x16x32_bf16 v[144:147], v[64:67], a[144:147], 0
  v_mfma_f32_16x16x32_bf16 v[148:151], v[64:67], a[148:151], 0
  v_mfma_f32_16x16x32_bf16 v[152:155], v[64:67], a[152:155], 0
  s_waitcnt lgkmcnt(0)
  v_mfma_f32_16x16x32_bf16 v[156:159], v[64:67], a[156:159], 0
  s_barrier
  ds_read_b128 v[72:75], v30 offset:0
  v_mfma_f32_16x16x32_bf16 v[160:163], v[68:71], a[128:131], 0
  ds_read_b128 v[80:83], v31 offset:0
  ds_read_b128 v[88:91], v25 offset:0
  ds_read_b128 v[76:79], v30 offset:1024
  v_mfma_f32_16x16x32_bf16 v[164:167], v[68:71], a[132:135], 0
  ds_read_b128 v[84:87], v31 offset:1024
  ds_read_b128 v[92:95], v25 offset:1024
  v_mfma_f32_16x16x32_bf16 v[168:171], v[68:71], a[136:139], 0
  v_mfma_f32_16x16x32_bf16 v[172:175], v[68:71], a[140:143], 0
  v_mfma_f32_16x16x32_bf16 v[176:179], v[68:71], a[144:147], 0
  v_mfma_f32_16x16x32_bf16 v[180:183], v[68:71], a[148:151], 0
  s_waitcnt lgkmcnt(5)
  v_mfma_f32_16x16x32_bf16 v[184:187], v[68:71], a[152:155], 0
  s_waitcnt lgkmcnt(4)
  v_mfma_f32_16x16x32_bf16 v[188:191], v[68:71], a[156:159], 0
  v_mfma_f32_16x16x32_bf16 v[128:131], v[72:75], a[160:163], v[128:131]
  v_mfma_f32_16x16x32_bf16 v[132:135], v[72:75], a[164:167], v[132:135]
  v_mfma_f32_16x16x32_bf16 v[136:139], v[72:75], a[168:171], v[136:139]
  v_mfma_f32_16x16x32_bf16 v[140:143], v[72:75], a[172:175], v[140:143]
  v_mfma_f32_16x16x32_bf16 v[144:147], v[72:75], a[176:179], v[144:147]
  v_mfma_f32_16x16x32_bf16 v[148:151], v[72:75], a[180:183], v[148:151]
  v_mfma_f32_16x16x32_bf16 v[152:155], v[72:75], a[184:187], v[152:155]
  v_mfma_f32_16x16x32_bf16 v[156:159], v[72:75], a[188:191], v[156:159]
  s_waitcnt vmcnt(7)
  v_cmp_gt_i32 vcc, s72, v24
  v_mfma_f32_16x16x32_bf16 v[128:131], v[80:83], a[192:195], v[128:131]
  ds_write_b128 v21, v[192:195] offset:0
  v_mfma_f32_16x16x32_bf16 v[132:135], v[80:83], a[196:199], v[132:135]
  s_waitcnt vmcnt(6)
  ds_write_b128 v21, v[196:199] offset:1040
  v_mfma_f32_16x16x32_bf16 v[136:139], v[80:83], a[200:203], v[136:139]
  s_cbranch_vccnz n0_cr
n0_cr_ok:
  v_mfma_f32_16x16x32_bf16 v[140:143], v[80:83], a[204:207], v[140:143]
  s_waitcnt vmcnt(5)
  ds_write_b128 v21, v[200:203] offset:2080
  v_mfma_f32_16x16x32_bf16 v[144:147], v[80:83], a[208:211], v[144:147]
  s_waitcnt lgkmcnt(6)
  v_mfma_f32_16x16x32_bf16 v[148:151], v[80:83], a[212:215], v[148:151]
  s_waitcnt vmcnt(4)
  ds_write_b128 v21, v[204:207] offset:3120
  v_mfma_f32_16x16x32_bf16 v[152:155], v[80:83], a[216:219], v[152:155]
  v_mfma_f32_16x16x32_bf16 v[156:159], v[80:83], a[220:223], v[156:159]
  s_waitcnt vmcnt(3)
  ds_write_b128 v21, v[208:211] offset:4160
  v_mfma_f32_16x16x32_bf16 v[128:131], v[88:91], a[224:227], v[128:131]
  v_mfma_f32_16x16x32_bf16 v[132:135], v[88:91], a[228:231], v[132:135]
  s_waitcnt vmcnt(2)
  ds_write_b128 v21, v[212:215] offset:5200
  v_mfma_f32_16x16x32_bf16 v[136:139], v[88:91], a[232:235], v[136:139]
  s_waitcnt lgkmcnt(8)
  v_mfma_f32_16x16x32_bf16 v[140:143], v[88:91], a[236:239], v[140:143]
  s_waitcnt vmcnt(1)
  v_mfma_f32_16x16x32_bf16 v[144:147], v[88:91], a[240:243], v[144:147]
  v_cvt_pk_bf16_f32 v96, v128, v132
  v_mfma_f32_16x16x32_bf16 v[148:151], v[88:91], a[244:247], v[148:151]
  ds_write_b128 v21, v[216:219] offset:6240
  v_mfma_f32_16x16x32_bf16 v[152:155], v[88:91], a[248:251], v[152:155]
  s_waitcnt vmcnt(0)
  v_cvt_pk_bf16_f32 v97, v136, v140
  v_bfi_b32 v96, 1, s79, v96
  v_mfma_f32_16x16x32_bf16 v[156:159], v[88:91], a[252:255], v[156:159]
  ds_write_b128 v21, v[220:223] offset:7280
  v_mfma_f32_16x16x32_bf16 v[160:163], v[76:79], a[160:163], v[160:163]
  v_cvt_pk_bf16_f32 v98, v144, v148
  v_cvt_pk_bf16_f32 v100, v129, v133
  v_mfma_f32_16x16x32_bf16 v[164:167], v[76:79], a[164:167], v[164:167]
  v_cvt_pk_bf16_f32 v101, v137, v141
  s_waitcnt lgkmcnt(9)
  v_mfma_f32_16x16x32_bf16 v[168:171], v[76:79], a[168:171], v[168:171]
  v_cvt_pk_bf16_f32 v99, v152, v156
  v_cvt_pk_bf16_f32 v102, v145, v149
  v_mfma_f32_16x16x32_bf16 v[172:175], v[76:79], a[172:175], v[172:175]
  s_add_u32 s80, s77, 33024
  v_cvt_pk_bf16_f32 v103, v153, v157
  v_bfi_b32 v100, 1, s79, v100
  v_mfma_f32_16x16x32_bf16 v[176:179], v[76:79], a[176:179], v[176:179]
  buffer_store_dwordx4 v[96:99], v27, s[4:7], s77 offen
  v_cvt_pk_bf16_f32 v104, v130, v134
  v_cvt_pk_bf16_f32 v105, v138, v142
  v_cvt_pk_bf16_f32 v106, v146, v150
  v_cvt_pk_bf16_f32 v107, v154, v158
  v_mfma_f32_16x16x32_bf16 v[180:183], v[76:79], a[180:183], v[180:183]
  v_bfi_b32 v104, 1, s79, v104
  v_mfma_f32_16x16x32_bf16 v[184:187], v[76:79], a[184:187], v[184:187]
  v_mfma_f32_16x16x32_bf16 v[188:191], v[76:79], a[188:191], v[188:191]
  s_waitcnt lgkmcnt(8)
  v_mfma_f32_16x16x32_bf16 v[160:163], v[84:87], a[192:195], v[160:163]
  v_cvt_pk_bf16_f32 v108, v131, v135
  v_cvt_pk_bf16_f32 v109, v139, v143
  v_mfma_f32_16x16x32_bf16 v[164:167], v[84:87], a[196:199], v[164:167]
  buffer_store_dwordx4 v[100:103], v27, s[4:7], s80 offen
  v_cvt_pk_bf16_f32 v110, v147, v151
  v_cvt_pk_bf16_f32 v111, v155, v159
  s_add_u32 s80, s77, 66048
  v_bfi_b32 v108, 1, s79, v108
  v_mfma_f32_16x16x32_bf16 v[168:171], v[84:87], a[200:203], v[168:171]
  v_max3_u32 v1, v192, v200, v204
  v_max3_u32 v2, v196, v208, v212
  v_mfma_f32_16x16x32_bf16 v[172:175], v[84:87], a[204:207], v[172:175]
  v_max3_u32 v1, v1, v216, v220
  v_max_u32 v1, v1, v2
  v_mfma_f32_16x16x32_bf16 v[176:179], v[84:87], a[208:211], v[176:179]
  v_cmp_le_u32 vcc, s88, v1
  s_waitcnt lgkmcnt(0)
  v_mfma_f32_16x16x32_bf16 v[180:183], v[84:87], a[212:215], v[180:183]
  v_mfma_f32_16x16x32_bf16 v[184:187], v[84:87], a[216:219], v[184:187]
  buffer_store_dwordx4 v[104:107], v27, s[4:7], s80 offen
  s_add_u32 s80, s77, 99072
  v_mfma_f32_16x16x32_bf16 v[188:191], v[84:87], a[220:223], v[188:191]
  v_mfma_f32_16x16x32_bf16 v[160:163], v[92:95], a[224:227], v[160:163]
  v_mfma_f32_16x16x32_bf16 v[164:167], v[92:95], a[228:231], v[164:167]
  v_mfma_f32_16x16x32_bf16 v[168:171], v[92:95], a[232:235], v[168:171]
  v_mfma_f32_16x16x32_bf16 v[172:175], v[92:95], a[236:239], v[172:175]
  buffer_store_dwordx4 v[108:111], v27, s[4:7], s80 offen
  v_mfma_f32_16x16x32_bf16 v[176:179], v[92:95], a[240:243], v[176:179]
  v_mfma_f32_16x16x32_bf16 v[180:183], v[92:95], a[244:247], v[180:183]
  v_mfma_f32_16x16x32_bf16 v[184:187], v[92:95], a[248:251], v[184:187]
  v_mfma_f32_16x16x32_bf16 v[188:191], v[92:95], a[252:255], v[188:191]
  s_cbranch_vccz n0_top
  v_cvt_pk_bf16_f32 v112, v160, v164
  v_cvt_pk_bf16_f32 v113, v168, v172
  v_cvt_pk_bf16_f32 v114, v176, v180
  s_nop 3
  v_cvt_pk_bf16_f32 v115, v184, v188
  v_bfi_b32 v112, 1, s79, v112
  buffer_store_dwordx4 v[112:115], v26, s[4:7], s77 offen
  v_cvt_pk_bf16_f32 v116, v161, v165
  v_cvt_pk_bf16_f32 v117, v169, v173
  v_cvt_pk_bf16_f32 v118, v177, v181
  v_cvt_pk_bf16_f32 v119, v185, v189
  v_bfi_b32 v116, 1, s79, v116
  s_add_u32 s80, s77, 33024
  buffer_store_dwordx4 v[116:119], v26, s[4:7], s80 offen
  v_cvt_pk_bf16_f32 v120, v162, v166
  v_cvt_pk_bf16_f32 v121, v170, v174
  v_cvt_pk_bf16_f32 v122, v178, v182
  v_cvt_pk_bf16_f32 v123, v186, v190
  v_bfi_b32 v120, 1, s79, v120
  s_add_u32 s80, s77, 66048
  buffer_store_dwordx4 v[120:123], v26, s[4:7], s80 offen
  v_cvt_pk_bf16_f32 v124, v163, v167
  v_cvt_pk_bf16_f32 v125, v171, v175
  v_cvt_pk_bf16_f32 v126, v179, v183
  v_cvt_pk_bf16_f32 v127, v187, v191
  v_bfi_b32 v124, 1, s79, v124
  s_add_u32 s80, s77, 99072
  buffer_store_dwordx4 v[124:127], v26, s[4:7], s80 offen
  s_cmp_eq_u32 s71, 63
  s_cbranch_scc1 n_end
  v_mov_b32 v26, 0x40000000
  buffer_load_dwordx4 v[192:195], v20, s[4:7], s73 offen offset:0 sc1
  buffer_load_dwordx4 v[196:199], v20, s[4:7], s73 offen offset:1024 sc1
  buffer_load_dwordx4 v[200:203], v20, s[4:7], s73 offen offset:2048 sc1
  buffer_load_dwordx4 v[204:207], v20, s[4:7], s73 offen offset:3072 sc1
  s_add_u32 s70, s73, 4096
  buffer_load_dwordx4 v[208:211], v20, s[4:7], s70 offen offset:0 sc1
  buffer_load_dwordx4 v[212:215], v20, s[4:7], s70 offen offset:1024 sc1
  buffer_load_dwordx4 v[216:219], v20, s[4:7], s70 offen offset:2048 sc1
  buffer_load_dwordx4 v[220:223], v20, s[4:7], s70 offen offset:3072 sc1
  s_waitcnt vmcnt(7)
  ds_write_b128 v21, v[192:195] offset:0
  s_waitcnt vmcnt(6)
  ds_write_b128 v21, v[196:199] offset:1040
  s_waitcnt vmcnt(5)
  ds_write_b128 v21, v[200:203] offset:2080
  s_waitcnt vmcnt(4)
  ds_write_b128 v21, v[204:207] offset:3120
  s_waitcnt vmcnt(3)
  ds_write_b128 v21, v[208:211] offset:4160
  s_waitcnt vmcnt(2)
  ds_write_b128 v21, v[212:215] offset:5200
  s_waitcnt vmcnt(1)
  ds_write_b128 v21, v[216:219] offset:6240
  s_waitcnt vmcnt(0)
  ds_write_b128 v21, v[220:223] offset:7280
  v_max3_u32 v1, v192, v200, v204
  v_max3_u32 v2, v196, v208, v212
  v_max3_u32 v1, v1, v216, v220
  v_max_u32 v1, v1, v2
  v_cmp_le_u32 vcc, s88, v1
  s_waitcnt lgkmcnt(0)
  s_cbranch_vccz n0_top
  s_branch n0_xp2
n0_xpoll:
  v_mov_b32 v26, 0x40000000
  s_mul_i32 s70, s48, 8448
  s_add_u32 s70, s70, s73
n0_xpk:
  s_sub_u32 s51, s51, 1
  s_cbranch_scc1 main_end
  buffer_load_dword v1, off, s[4:7], s70 offset:3072 sc1
  s_waitcnt vmcnt(0)
  v_cmp_eq_u32 vcc, -1, v1
  s_cbranch_vccnz n0_xpk
n0_xp2:
  buffer_load_dwordx4 v[192:195], v20, s[4:7], s73 offen offset:0 sc1
  buffer_load_dwordx4 v[196:199], v20, s[4:7], s73 offen offset:1024 sc1
  buffer_load_dwordx4 v[200:203], v20, s[4:7], s73 offen offset:2048 sc1
  buffer_load_dwordx4 v[204:207], v20, s[4:7], s73 offen offset:3072 sc1
  s_add_u32 s70, s73, 4096
  buffer_load_dwordx4 v[208:211], v20, s[4:7], s70 offen offset:0 sc1
  buffer_load_dwordx4 v[212:215], v20, s[4:7], s70 offen offset:1024 sc1
  buffer_load_dwordx4 v[216:219], v20, s[4:7], s70 offen offset:2048 sc1
  buffer_load_dwordx4 v[220:223], v20, s[4:7], s70 offen offset:3072 sc1
  s_waitcnt vmcnt(7)
  ds_write_b128 v21, v[192:195] offset:0
  s_waitcnt vmcnt(6)
  ds_write_b128 v21, v[196:199] offset:1040
  s_waitcnt vmcnt(5)
  ds_write_b128 v21, v[200:203] offset:2080
  s_waitcnt vmcnt(4)
  ds_write_b128 v21, v[204:207] offset:3120
  s_waitcnt vmcnt(3)
  ds_write_b128 v21, v[208:211] offset:4160
  s_waitcnt vmcnt(2)
  ds_write_b128 v21, v[212:215] offset:5200
  s_waitcnt vmcnt(1)
  ds_write_b128 v21, v[216:219] offset:6240
  s_waitcnt vmcnt(0)
  ds_write_b128 v21, v[220:223] offset:7280
  v_max3_u32 v1, v192, v200, v204
  v_max3_u32 v2, v196, v208, v212
  v_max3_u32 v1, v1, v216, v220
  v_max_u32 v1, v1, v2
  v_cmp_le_u32 vcc, s88, v1
  s_waitcnt lgkmcnt(0)
  s_cbranch_vccnz n0_xpoll
  s_branch n0_top
n0_cr:
  s_sub_u32 s51, s51, 1
  s_cbranch_scc1 main_end
  buffer_load_dword v24, v23, s[4:7], 0 offen sc1
  s_waitcnt vmcnt(0)
  v_cmp_gt_i32 vcc, s72, v24
  s_cbranch_vccnz n0_cr
  s_branch n0_cr_ok
n1_top:
  s_barrier
  ds_read_b128 v[32:35], v22 offset:0
  ds_read_b128 v[36:39], v22 offset:32
  ds_read_b128 v[40:43], v22 offset:64
  ds_read_b128 v[44:47], v22 offset:96
  v_cvt_pk_bf16_f32 v112, v160, v164
  v_cvt_pk_bf16_f32 v113, v168, v172
  v_cvt_pk_bf16_f32 v114, v176, v180
  v_cvt_pk_bf16_f32 v115, v184, v188
  v_bfi_b32 v112, 1, s79, v112
  ds_read_b128 v[48:51], v22 offset:128
  ds_read_b128 v[52:55], v22 offset:160
  ds_read_b128 v[56:59], v22 offset:192
  v_cvt_pk_bf16_f32 v116, v161, v165
  v_cvt_pk_bf16_f32 v117, v169, v173
  v_cvt_pk_bf16_f32 v118, v177, v181
  ds_read_b128 v[60:63], v22 offset:224
  s_waitcnt lgkmcnt(7)
  v_mfma_f32_32x32x16_bf16 v[4:19], a[0:3], v[32:35], 0
  s_waitcnt lgkmcnt(6)
  v_cvt_pk_bf16_f32 v119, v185, v189
  v_bfi_b32 v116, 1, s79, v116
  s_waitcnt lgkmcnt(5)
  s_waitcnt lgkmcnt(4)
  ds_read_b128 v[32:35], v22 offset:256
  s_add_u32 s80, s77, 33024
  v_mfma_f32_32x32x16_bf16 v[4:19], a[4:7], v[36:39], v[4:19]
  ds_read_b128 v[36:39], v22 offset:288
  v_cvt_pk_bf16_f32 v120, v162, v166
  v_cvt_pk_bf16_f32 v121, v170, v174
  v_cvt_pk_bf16_f32 v122, v178, v182
  s_waitcnt lgkmcnt(5)
  s_waitcnt lgkmcnt(4)
  s_waitcnt lgkmcnt(3)
  v_mfma_f32_32x32x16_bf16 v[4:19], a[8:11], v[40:43], v[4:19]
  buffer_store_dwordx4 v[112:115], v26, s[4:7], s77 offen sc1
  v_cvt_pk_bf16_f32 v123, v186, v190
  v_bfi_b32 v120, 1, s79, v120
  s_waitcnt lgkmcnt(2)
  v_mfma_f32_32x32x16_bf16 v[4:19], a[12:15], v[44:47], v[4:19]
  ds_read_b128 v[40:43], v22 offset:320
  ds_read_b128 v[44:47], v22 offset:352
  s_waitcnt lgkmcnt(3)
  v_mfma_f32_32x32x16_bf16 v[4:19], a[16:19], v[48:51], v[4:19]
  ds_read_b128 v[48:51], v22 offset:384
  v_cvt_pk_bf16_f32 v124, v163, v167
  v_cvt_pk_bf16_f32 v125, v171, v175
  v_cvt_pk_bf16_f32 v126, v179, v183
  s_waitcnt lgkmcnt(3)
  v_mfma_f32_32x32x16_bf16 v[4:19], a[20:23], v[52:55], v[4:19]
  buffer_store_dwordx4 v[116:119], v26, s[4:7], s80 offen sc1
  v_cvt_pk_bf16_f32 v127, v187, v191
  v_bfi_b32 v124, 1, s79, v124
  s_add_u32 s80, s77, 66048
  v_mfma_f32_32x32x16_bf16 v[4:19], a[24:27], v[56:59], v[4:19]
  ds_read_b128 v[52:55], v22 offset:416
  s_waitcnt lgkmcnt(3)
  ds_read_b128 v[56:59], v22 offset:448
  s_waitcnt lgkmcnt(3)
  v_mfma_f32_32x32x16_bf16 v[4:19], a[28:31], v[60:63], v[4:19]
  ds_read_b128 v[60:63], v22 offset:480
  s_waitcnt lgkmcnt(3)
  s_add_u32 s73, s73, 0x10000
  s_min_u32 s73, s73, s74
  v_mfma_f32_32x32x16_bf16 v[4:19], a[32:35], v[32:35], v[4:19]
  buffer_store_dwordx4 v[120:123], v26, s[4:7], s80 offen sc1
  s_add_u32 s80, s77, 99072
  v_xor_b32 v21, 0x10000, v21
  s_xor_b32 s82, s82, 0x10000
  v_mfma_f32_32x32x16_bf16 v[4:19], a[36:39], v[36:39], v[4:19]
  ds_read_b128 v[32:35], v22 offset:512
  s_waitcnt lgkmcnt(3)
  ds_read_b128 v[36:39], v22 offset:544
  s_waitcnt lgkmcnt(3)
  s_add_u32 s71, s71, 1
  v_mfma_f32_32x32x16_bf16 v[4:19], a[40:43], v[40:43], v[4:19]
  ds_read_b128 v[40:43], v22 offset:576
  s_waitcnt lgkmcnt(3)
  s_lshr_b32 s79, s71, s75
  s_add_u32 s77, s77, 0x200000
  v_mfma_f32_32x32x16_bf16 v[4:19], a[44:47], v[44:47], v[4:19]
  buffer_store_dwordx4 v[124:127], v26, s[4:7], s80 offen sc1
  v_mov_b32 v26, v28
  s_and_b32 s77, s77, s76
  s_cmp_eq_u32 s71, 63
  s_cselect_b32 s88, 0, -1
  v_mfma_f32_32x32x16_bf16 v[4:19], a[48:51], v[48:51], v[4:19]
  ds_read_b128 v[44:47], v22 offset:608
  s_waitcnt lgkmcnt(3)
  ds_read_b128 v[48:51], v22 offset:640
  s_waitcnt lgkmcnt(3)
  s_add_u32 s72, s72, 1
  v_mfma_f32_32x32x16_bf16 v[4:19], a[52:55], v[52:55], v[4:19]
  ds_read_b128 v[52:55], v22 offset:672
  s_waitcnt lgkmcnt(3)
  buffer_load_dword v24, v23, s[4:7], 0 offen sc1
  v_mfma_f32_32x32x16_bf16 v[4:19], a[56:59], v[56:59], v[4:19]
  ds_read_b128 v[56:59], v22 offset:704
  buffer_load_dwordx4 v[192:195], v20, s[4:7], s73 offen offset:0 sc1
  v_mfma_f32_32x32x16_bf16 v[4:19], a[60:63], v[60:63], v[4:19]
  s_waitcnt lgkmcnt(3)
  ds_read_b128 v[60:63], v22 offset:736
  s_waitcnt lgkmcnt(3)
  v_mfma_f32_32x32x16_bf16 v[4:19], a[64:67], v[32:35], v[4:19]
  ds_read_b128 v[32:35], v22 offset:768
  s_waitcnt lgkmcnt(3)
  buffer_load_dwordx4 v[196:199], v20, s[4:7], s73 offen offset:1024 sc1
  v_mfma_f32_32x32x16_bf16 v[4:19], a[68:71], v[36:39], v[4:19]
  ds_read_b128 v[36:39], v22 offset:800
  s_waitcnt lgkmcnt(3)
  v_mfma_f32_32x32x16_bf16 v[4:19], a[72:75], v[40:43], v[4:19]
  ds_read_b128 v[40:43], v22 offset:832
  s_waitcnt lgkmcnt(3)
  buffer_load_dwordx4 v[200:203], v20, s[4:7], s73 offen offset:2048 sc1
  v_mfma_f32_32x32x16_bf16 v[4:19], a[76:79], v[44:47], v[4:19]
  ds_read_b128 v[44:47], v22 offset:864
  s_waitcnt lgkmcnt(3)
  s_add_u32 s70, s73, 4096
  v_mfma_f32_32x32x16_bf16 v[4:19], a[80:83], v[48:51], v[4:19]
  ds_read_b128 v[48:51], v22 offset:896
  s_waitcnt lgkmcnt(3)
  buffer_load_dwordx4 v[204:207], v20, s[4:7], s73 offen offset:3072 sc1
  v_mfma_f32_32x32x16_bf16 v[4:19], a[84:87], v[52:55], v[4:19]
  ds_read_b128 v[52:55], v22 offset:928
  s_waitcnt lgkmcnt(3)
  v_mfma_f32_32x32x16_bf16 v[4:19], a[88:91], v[56:59], v[4:19]
  ds_read_b128 v[56:59], v22 offset:960
  s_waitcnt lgkmcnt(3)
  buffer_load_dwordx4 v[208:211], v20, s[4:7], s70 offen offset:0 sc1
  v_mfma_f32_32x32x16_bf16 v[4:19], a[92:95], v[60:63], v[4:19]
  ds_read_b128 v[60:63], v22 offset:992
  v_xor_b32 v22, 0x10000, v22
  s_waitcnt lgkmcnt(3)
  v_mfma_f32_32x32x16_bf16 v[4:19], a[96:99], v[32:35], v[4:19]
  s_waitcnt lgkmcnt(2)
  buffer_load_dwordx4 v[212:215], v20, s[4:7], s70 offen offset:1024 sc1
  v_mfma_f32_32x32x16_bf16 v[4:19], a[100:103], v[36:39], v[4:19]
  s_waitcnt lgkmcnt(1)
  v_mfma_f32_32x32x16_bf16 v[4:19], a[104:107], v[40:43], v[4:19]
  s_waitcnt lgkmcnt(0)
  buffer_load_dwordx4 v[216:219], v20, s[4:7], s70 offen offset:2048 sc1
  v_mfma_f32_32x32x16_bf16 v[4:19], a[108:111], v[44:47], v[4:19]
  v_mfma_f32_32x32x16_bf16 v[4:19], a[112:115], v[48:51], v[4:19]
  buffer_load_dwordx4 v[220:223], v20, s[4:7], s70 offen offset:3072 sc1
  v_mfma_f32_32x32x16_bf16 v[4:19], a[116:119], v[52:55], v[4:19]
  v_mfma_f32_32x32x16_bf16 v[4:19], a[120:123], v[56:59], v[4:19]
  v_mfma_f32_32x32x16_bf16 v[4:19], a[124:127], v[60:63], v[4:19]
  s_nop 11
  v_cvt_pk_bf16_f32 v64, v4, v5
  v_cvt_pk_bf16_f32 v68, v12, v13
  v_cvt_pk_bf16_f32 v65, v6, v7
  v_cvt_pk_bf16_f32 v69, v14, v15
  v_cvt_pk_bf16_f32 v66, v8, v9
  v_cvt_pk_bf16_f32 v70, v16, v17
  v_cvt_pk_bf16_f32 v67, v10, v11
  v_cvt_pk_bf16_f32 v71, v18, v19
  v_pk_max_i16 v64, v64, 0
  v_pk_max_i16 v68, v68, 0
  v_pk_max_i16 v65, v65, 0
  v_pk_max_i16 v69, v69, 0
  v_pk_max_i16 v66, v66, 0
  v_pk_max_i16 v70, v70, 0
  v_pk_max_i16 v67, v67, 0
  v_pk_max_i16 v71, v71, 0
  v_permlane16_swap_b32 v64, v68
  v_permlane16_swap_b32 v65, v69
  v_permlane16_swap_b32 v66, v70
  v_permlane16_swap_b32 v67, v71
  s_nop 1
  v_mfma_f32_16x16x32_bf16 v[128:131], v[64:67], a[128:131], 0
  ds_write_b128 v29, v[64:67] offset:0
  v_mfma_f32_16x16x32_bf16 v[132:135], v[64:67], a[132:135], 0
  ds_write_b128 v29, v[68:71] offset:1024
  v_mfma_f32_16x16x32_bf16 v[136:139], v[64:67], a[136:139], 0
  v_mfma_f32_16x16x32_bf16 v[140:143], v[64:67], a[140:143], 0
  v_mfma_f32_16x16x32_bf16 v[144:147], v[64:67], a[144:147], 0
  v_mfma_f32_16x16x32_bf16 v[148:151], v[64:67], a[148:151], 0
  v_mfma_f32_16x16x32_bf16 v[152:155], v[64:67], a[152:155], 0
  s_waitcnt lgkmcnt(0)
  v_mfma_f32_16x16x32_bf16 v[156:159], v[64:67], a[156:159], 0
  s_barrier
  ds_read_b128 v[72:75], v30 offset:0
  v_mfma_f32_16x16x32_bf16 v[160:163], v[68:71], a[128:131], 0
  ds_read_b128 v[80:83], v31 offset:0
  ds_read_b128 v[88:91], v25 offset:0
  ds_read_b128 v[76:79], v30 offset:1024
  v_mfma_f32_16x16x32_bf16 v[164:167], v[68:71], a[132:135], 0
  ds_read_b128 v[84:87], v31 offset:1024
  ds_read_b128 v[92:95], v25 offset:1024
  v_mfma_f32_16x16x32_bf16 v[168:171], v[68:71], a[136:139], 0
  v_mfma_f32_16x16x32_bf16 v[172:175], v[68:71], a[140:143], 0
  v_mfma_f32_16x16x32_bf16 v[176:179], v[68:71], a[144:147], 0
  v_mfma_f32_16x16x32_bf16 v[180:183], v[68:71], a[148:151], 0
  s_waitcnt lgkmcnt(5)
  v_mfma_f32_16x16x32_bf16 v[184:187], v[68:71], a[152:155], 0
  s_waitcnt lgkmcnt(4)
  v_mfma_f32_16x16x32_bf16 v[188:191], v[68:71], a[156:159], 0
  v_mfma_f32_16x16x32_bf16 v[128:131], v[72:75], a[160:163], v[128:131]
  v_mfma_f32_16x16x32_bf16 v[132:135], v[72:75], a[164:167], v[132:135]
  v_mfma_f32_16x16x32_bf16 v[136:139], v[72:75], a[168:171], v[136:139]
  v_mfma_f32_16x16x32_bf16 v[140:143], v[72:75], a[172:175], v[140:143]
  v_mfma_f32_16x16x32_bf16 v[144:147], v[72:75], a[176:179], v[144:147]
  v_mfma_f32_16x16x32_bf16 v[148:151], v[72:75], a[180:183], v[148:151]
  v_mfma_f32_16x16x32_bf16 v[152:155], v[72:75], a[184:187], v[152:155]
  v_mfma_f32_16x16x32_bf16 v[156:159], v[72:75], a[188:191], v[156:159]
  s_waitcnt vmcnt(7)
  v_cmp_gt_i32 vcc, s72, v24
  v_mfma_f32_16x16x32_bf16 v[128:131], v[80:83], a[192:195], v[128:131]
  ds_write_b128 v21, v[192:195] offset:0
  v_mfma_f32_16x16x32_bf16 v[132:135], v[80:83], a[196:199], v[132:135]
  s_waitcnt vmcnt(6)
  ds_write_b128 v21, v[196:199] offset:1040
  v_mfma_f32_16x16x32_bf16 v[136:139], v[80:83], a[200:203], v[136:139]
  s_cbranch_vccnz n1_cr
n1_cr_ok:
  v_mfma_f32_16x16x32_bf16 v[140:143], v[80:83], a[204:207], v[140:143]
  s_waitcnt vmcnt(5)
  ds_write_b128 v21, v[200:203] offset:2080
  v_mfma_f32_16x16x32_bf16 v[144:147], v[80:83], a[208:211], v[144:147]
  s_waitcnt lgkmcnt(6)
  v_mfma_f32_16x16x32_bf16 v[148:151], v[80:83], a[212:215], v[148:151]
  s_waitcnt vmcnt(4)
  ds_write_b128 v21, v[204:207] offset:3120
  v_mfma_f32_16x16x32_bf16 v[152:155], v[80:83], a[216:219], v[152:155]
  v_mfma_f32_16x16x32_bf16 v[156:159], v[80:83], a[220:223], v[156:159]
  s_waitcnt vmcnt(3)
  ds_write_b128 v21, v[208:211] offset:4160
  v_mfma_f32_16x16x32_bf16 v[128:131], v[88:91], a[224:227], v[128:131]
  v_mfma_f32_16x16x32_bf16 v[132:135], v[88:91], a[228:231], v[132:135]
  s_waitcnt vmcnt(2)
  ds_write_b128 v21, v[212:215] offset:5200
  v_mfma_f32_16x16x32_bf16 v[136:139], v[88:91], a[232:235], v[136:139]
  s_waitcnt lgkmcnt(8)
  v_mfma_f32_16x16x32_bf16 v[140:143], v[88:91], a[236:239], v[140:143]
  s_waitcnt vmcnt(1)
  v_mfma_f32_16x16x32_bf16 v[144:147], v[88:91], a[240:243], v[144:147]
  v_cvt_pk_bf16_f32 v96, v128, v132
  v_mfma_f32_16x16x32_bf16 v[148:151], v[88:91], a[244:247], v[148:151]
  ds_write_b128 v21, v[216:219] offset:6240
  v_mfma_f32_16x16x32_bf16 v[152:155], v[88:91], a[248:251], v[152:155]
  s_waitcnt vmcnt(0)
  v_cvt_pk_bf16_f32 v97, v136, v140
  v_bfi_b32 v96, 1, s79, v96
  v_mfma_f32_16x16x32_bf16 v[156:159], v[88:91], a[252:255], v[156:159]
  ds_write_b128 v21, v[220:223] offset:7280
  v_mfma_f32_16x16x32_bf16 v[160:163], v[76:79], a[160:163], v[160:163]
  v_cvt_pk_bf16_f32 v98, v144, v148
  v_cvt_pk_bf16_f32 v100, v129, v133
  v_mfma_f32_16x16x32_bf16 v[164:167], v[76:79], a[164:167], v[164:167]
  v_cvt_pk_bf16_f32 v101, v137, v141
  s_waitcnt lgkmcnt(9)
  v_mfma_f32_16x16x32_bf16 v[168:171], v[76:79], a[168:171], v[168:171]
  v_cvt_pk_bf16_f32 v99, v152, v156
  v_cvt_pk_bf16_f32 v102, v145, v149
  v_mfma_f32_16x16x32_bf16 v[172:175], v[76:79], a[172:175], v[172:175]
  s_add_u32 s80, s77, 33024
  v_cvt_pk_bf16_f32 v103, v153, v157
  v_bfi_b32 v100, 1, s79, v100
  v_mfma_f32_16x16x32_bf16 v[176:179], v[76:79], a[176:179], v[176:179]
  buffer_store_dwordx4 v[96:99], v27, s[4:7], s77 offen sc1
  v_cvt_pk_bf16_f32 v104, v130, v134
  v_cvt_pk_bf16_f32 v105, v138, v142
  v_cvt_pk_bf16_f32 v106, v146, v150
  v_cvt_pk_bf16_f32 v107, v154, v158
  v_mfma_f32_16x16x32_bf16 v[180:183], v[76:79], a[180:183], v[180:183]
  v_bfi_b32 v104, 1, s79, v104
  v_mfma_f32_16x16x32_bf16 v[184:187], v[76:79], a[184:187], v[184:187]
  v_mfma_f32_16x16x32_bf16 v[188:191], v[76:79], a[188:191], v[188:191]
  s_waitcnt lgkmcnt(8)
  v_mfma_f32_16x16x32_bf16 v[160:163], v[84:87], a[192:195], v[160:163]
  v_cvt_pk_bf16_f32 v108, v131, v135
  v_cvt_pk_bf16_f32 v109, v139, v143
  v_mfma_f32_16x16x32_bf16 v[164:167], v[84:87], a[196:199], v[164:167]
  buffer_store_dwordx4 v[100:103], v27, s[4:7], s80 offen sc1
  v_cvt_pk_bf16_f32 v110, v147, v151
  v_cvt_pk_bf16_f32 v111, v155, v159
  s_add_u32 s80, s77, 66048
  v_bfi_b32 v108, 1, s79, v108
  v_mfma_f32_16x16x32_bf16 v[168:171], v[84:87], a[200:203], v[168:171]
  v_max3_u32 v1, v192, v200, v204
  v_max3_u32 v2, v196, v208, v212
  v_mfma_f32_16x16x32_bf16 v[172:175], v[84:87], a[204:207], v[172:175]
  v_max3_u32 v1, v1, v216, v220
  v_max_u32 v1, v1, v2
  v_mfma_f32_16x16x32_bf16 v[176:179], v[84:87], a[208:211], v[176:179]
  v_cmp_le_u32 vcc, s88, v1
  s_waitcnt lgkmcnt(0)
  v_mfma_f32_16x16x32_bf16 v[180:183], v[84:87], a[212:215], v[180:183]
  v_mfma_f32_16x16x32_bf16 v[184:187], v[84:87], a[216:219], v[184:187]
  buffer_store_dwordx4 v[104:107], v27, s[4:7], s80 offen sc1
  s_add_u32 s80, s77, 99072
  v_mfma_f32_16x16x32_bf16 v[188:191], v[84:87], a[220:223], v[188:191]
  v_mfma_f32_16x16x32_bf16 v[160:163], v[92:95], a[224:227], v[160:163]
  v_mfma_f32_16x16x32_bf16 v[164:167], v[92:95], a[228:231], v[164:167]
  v_mfma_f32_16x16x32_bf16 v[168:171], v[92:95], a[232:235], v[168:171]
  v_mfma_f32_16x16x32_bf16 v[172:175], v[92:95], a[236:239], v[172:175]
  buffer_store_dwordx4 v[108:111], v27, s[4:7], s80 offen sc1
  v_mfma_f32_16x16x32_bf16 v[176:179], v[92:95], a[240:243], v[176:179]
  v_mfma_f32_16x16x32_bf16 v[180:183], v[92:95], a[244:247], v[180:183]
  v_mfma_f32_16x16x32_bf16 v[184:187], v[92:95], a[248:251], v[184:187]
  v_mfma_f32_16x16x32_bf16 v[188:191], v[92:95], a[252:255], v[188:191]
  s_cbranch_vccz n1_top
  v_cvt_pk_bf16_f32 v112, v160, v164
  v_cvt_pk_bf16_f32 v113, v168, v172
  v_cvt_pk_bf16_f32 v114, v176, v180
  s_nop 3
  v_cvt_pk_bf16_f32 v115, v184, v188
  v_bfi_b32 v112, 1, s79, v112
  buffer_store_dwordx4 v[112:115], v26, s[4:7], s77 offen sc1
  v_cvt_pk_bf16_f32 v116, v161, v165
  v_cvt_pk_bf16_f32 v117, v169, v173
  v_cvt_pk_bf16_f32 v118, v177, v181
  v_cvt_pk_bf16_f32 v119, v185, v189
  v_bfi_b32 v116, 1, s79, v116
  s_add_u32 s80, s77, 33024
  buffer_store_dwordx4 v[116:119], v26, s[4:7], s80 offen sc1
  v_cvt_pk_bf16_f32 v120, v162, v166
  v_cvt_pk_bf16_f32 v121, v170, v174
  v_cvt_pk_bf16_f32 v122, v178, v182
  v_cvt_pk_bf16_f32 v123, v186, v190
  v_bfi_b32 v120, 1, s79, v120
  s_add_u32 s80, s77, 66048
  buffer_store_dwordx4 v[120:123], v26, s[4:7], s80 offen sc1
  v_cvt_pk_bf16_f32 v124, v163, v167
  v_cvt_pk_bf16_f32 v125, v171, v175
  v_cvt_pk_bf16_f32 v126, v179, v183
  v_cvt_pk_bf16_f32 v127, v187, v191
  v_bfi_b32 v124, 1, s79, v124
  s_add_u32 s80, s77, 99072
  buffer_store_dwordx4 v[124:127], v26, s[4:7], s80 offen sc1
  s_cmp_eq_u32 s71, 63
  s_cbranch_scc1 n_end
  v_mov_b32 v26, 0x40000000
  buffer_load_dwordx4 v[192:195], v20, s[4:7], s73 offen offset:0 sc1
  buffer_load_dwordx4 v[196:199], v20, s[4:7], s73 offen offset:1024 sc1
  buffer_load_dwordx4 v[200:203], v20, s[4:7], s73 offen offset:2048 sc1
  buffer_load_dwordx4 v[204:207], v20, s[4:7], s73 offen offset:3072 sc1
  s_add_u32 s70, s73, 4096
  buffer_load_dwordx4 v[208:211], v20, s[4:7], s70 offen offset:0 sc1
  buffer_load_dwordx4 v[212:215], v20, s[4:7], s70 offen offset:1024 sc1
  buffer_load_dwordx4 v[216:219], v20, s[4:7], s70 offen offset:2048 sc1
  buffer_load_dwordx4 v[220:223], v20, s[4:7], s70 offen offset:3072 sc1
  s_waitcnt vmcnt(7)
  ds_write_b128 v21, v[192:195] offset:0
  s_waitcnt vmcnt(6)
  ds_write_b128 v21, v[196:199] offset:1040
  s_waitcnt vmcnt(5)
  ds_write_b128 v21, v[200:203] offset:2080
  s_waitcnt vmcnt(4)
  ds_write_b128 v21, v[204:207] offset:3120
  s_waitcnt vmcnt(3)
  ds_write_b128 v21, v[208:211] offset:4160
  s_waitcnt vmcnt(2)
  ds_write_b128 v21, v[212:215] offset:5200
  s_waitcnt vmcnt(1)
  ds_write_b128 v21, v[216:219] offset:6240
  s_waitcnt vmcnt(0)
  ds_write_b128 v21, v[220:223] offset:7280
  v_max3_u32 v1, v192, v200, v204
  v_max3_u32 v2, v196, v208, v212
  v_max3_u32 v1, v1, v216, v220
  v_max_u32 v1, v1, v2
  v_cmp_le_u32 vcc, s88, v1
  s_waitcnt lgkmcnt(0)
  s_cbranch_vccz n1_top
  s_branch n1_xp2
n1_xpoll:
  v_mov_b32 v26, 0x40000000
  s_mul_i32 s70, s48, 8448
  s_add_u32 s70, s70, s73
n1_xpk:
  s_sub_u32 s51, s51, 1
  s_cbranch_scc1 main_end
  buffer_load_dword v1, off, s[4:7], s70 offset:3072 sc1
  s_waitcnt vmcnt(0)
  v_cmp_eq_u32 vcc, -1, v1
  s_cbranch_vccnz n1_xpk
n1_xp2:
  buffer_load_dwordx4 v[192:195], v20, s[4:7], s73 offen offset:0 sc1
  buffer_load_dwordx4 v[196:199], v20, s[4:7], s73 offen offset:1024 sc1
  buffer_load_dwordx4 v[200:203], v20, s[4:7], s73 offen offset:2048 sc1
  buffer_load_dwordx4 v[204:207], v20, s[4:7], s73 offen offset:3072 sc1
  s_add_u32 s70, s73, 4096
  buffer_load_dwordx4 v[208:211], v20, s[4:7], s70 offen offset:0 sc1
  buffer_load_dwordx4 v[212:215], v20, s[4:7], s70 offen offset:1024 sc1
  buffer_load_dwordx4 v[216:219], v20, s[4:7], s70 offen offset:2048 sc1
  buffer_load_dwordx4 v[220:223], v20, s[4:7], s70 offen offset:3072 sc1
  s_waitcnt vmcnt(7)
  ds_write_b128 v21, v[192:195] offset:0
  s_waitcnt vmcnt(6)
  ds_write_b128 v21, v[196:199] offset:1040
  s_waitcnt vmcnt(5)
  ds_write_b128 v21, v[200:203] offset:2080
  s_waitcnt vmcnt(4)
  ds_write_b128 v21, v[204:207] offset:3120
  s_waitcnt vmcnt(3)
  ds_write_b128 v21, v[208:211] offset:4160
  s_waitcnt vmcnt(2)
  ds_write_b128 v21, v[212:215] offset:5200
  s_waitcnt vmcnt(1)
  ds_write_b128 v21, v[216:219] offset:6240
  s_waitcnt vmcnt(0)
  ds_write_b128 v21, v[220:223] offset:7280
  v_max3_u32 v1, v192, v200, v204
  v_max3_u32 v2, v196, v208, v212
  v_max3_u32 v1, v1, v216, v220
  v_max_u32 v1, v1, v2
  v_cmp_le_u32 vcc, s88, v1
  s_waitcnt lgkmcnt(0)
  s_cbranch_vccnz n1_xpoll
  s_branch n1_top
n1_cr:
  s_sub_u32 s51, s51, 1
  s_cbranch_scc1 main_end
  buffer_load_dword v24, v23, s[4:7], 0 offen sc1
  s_waitcnt vmcnt(0)
  v_cmp_gt_i32 vcc, s72, v24
  s_cbranch_vccnz n1_cr
  s_branch n1_cr_ok
n_end:
  s_endpgm
.section .rodata,"a"
.p2align 6
.amdhsa_kernel interleave_layers__memory_aug_recurrent_mem_tr__dense_activation_relu__prompt_kernel
  .amdhsa_next_free_vgpr 512
  .amdhsa_next_free_sgpr 102
  .amdhsa_accum_offset 256
  .amdhsa_group_segment_fixed_size 0
  .amdhsa_kernarg_size 104
  .amdhsa_user_sgpr_count 2
  .amdhsa_user_sgpr_kernarg_segment_ptr 1
  .amdhsa_system_sgpr_workgroup_id_x 1
.end_amdhsa_kernel
```
